```python
import torch

def _softmax(x, axis=-1):
    return torch.softmax(x, dim=axis)
def _gelu(x):
    return torch.nn.functional.gelu(x, approximate="tanh")
def _silu(x):
    return torch.nn.functional.silu(x)
def _sigmoid(x):
    return torch.sigmoid(x)
def _layernorm(x, axis=-1, eps=1e-5):
    m = x.mean(dim=axis, keepdim=True)
    v = x.var(dim=axis, keepdim=True, unbiased=False)
    return (x - m) / torch.sqrt(v + eps)
def _scatter_add(tgt, idx, src, axis=0):
    return tgt.clone().index_add_(axis, idx, src)
def _segment_sum(src, seg, n):
    out = torch.zeros((n,) + src.shape[1:], dtype=src.dtype)
    return out.index_add_(0, seg, src)
def _pad(x, pw):
    flat = tuple(v for pair in reversed(pw) for v in pair)
    return torch.nn.functional.pad(x, flat)

kernel_name = 'concat_heads__mha_block_cached__mha_block_cached__near_ridge'

def setup_inputs():

    _w = (lambda a: (lambda t: t.to(torch.bfloat16) if t.is_floating_point() else t)(torch.as_tensor(a)))
    def _A_setup():
        B, Sq, D = 16, 160, 640
        H, Sk, Dh = 32, 1024, 128
        return {
            "x": _w((lambda *s: torch.randn(*s, dtype=torch.bfloat16) * 0.8)(B, Sq, D)),
            "k_cache": _w((lambda *s: torch.randn(*s, dtype=torch.bfloat16) * 0.8)(B, H, Sk, Dh)),
            "v_cache": _w((lambda *s: torch.randn(*s, dtype=torch.bfloat16) * 0.05)(B, H, Sk, Dh)),
            "wq": _w((lambda *s: torch.randn(*s, dtype=torch.bfloat16) * 0.8)(D, H * Dh) * (D ** -0.5)),
            "wo": _w((lambda *s: torch.randn(*s, dtype=torch.bfloat16) * 0.05)(H * Dh, D) * ((H * Dh) ** -0.5)),
        }
    _A_in = _A_setup()

    def _B_setup():
        B, Sq, D = 16, 160, 640
        H, Sk, Dh = 32, 1024, 128
        return {
            "x": _w((lambda *s: torch.randn(*s, dtype=torch.bfloat16) * 0.8)(B, Sq, D)),
            "k_cache": _w((lambda *s: torch.randn(*s, dtype=torch.bfloat16) * 0.8)(B, H, Sk, Dh)),
            "v_cache": _w((lambda *s: torch.randn(*s, dtype=torch.bfloat16) * 0.05)(B, H, Sk, Dh)),
            "wq": _w((lambda *s: torch.randn(*s, dtype=torch.bfloat16) * 0.8)(D, H * Dh) * (D ** -0.5)),
            "wo": _w((lambda *s: torch.randn(*s, dtype=torch.bfloat16) * 0.05)(H * Dh, D) * ((H * Dh) ** -0.5)),
        }
    _B_in = _B_setup()

    return {
        "A_x": _A_in["x"],
        "A_k_cache": _A_in["k_cache"],
        "A_v_cache": _A_in["v_cache"],
        "A_wq": _A_in["wq"],
        "A_wo": _A_in["wo"],
        "B_x": _B_in["x"],
        "B_k_cache": _B_in["k_cache"],
        "B_v_cache": _B_in["v_cache"],
        "B_wq": _B_in["wq"],
        "B_wo": _B_in["wo"],
    }

def reference(A_x, A_k_cache, A_v_cache, A_wq, A_wo, B_x, B_k_cache, B_v_cache, B_wq, B_wo):
    def _A_ref(x, k_cache, v_cache, wq, wo):
        B, Sq, D = x.shape
        H, Dh = 32, 128
        q = (lambda x, *d: x.permute(*d))((x @ wq).reshape(B, Sq, H, Dh), 0, 2, 1, 3)
        scores = torch.einsum("bhqd,bhkd->bhqk", q, k_cache) * (Dh ** -0.5)
        p = _softmax(scores, axis=-1)
        o = torch.einsum("bhqk,bhkd->bhqd", p, v_cache)
        return (lambda x, *d: x.permute(*d))(o, 0, 2, 1, 3).reshape(B, Sq, H * Dh) @ wo

    def _B_ref(x, k_cache, v_cache, wq, wo):
        B, Sq, D = x.shape
        H, Dh = 32, 128
        q = (lambda x, *d: x.permute(*d))((x @ wq).reshape(B, Sq, H, Dh), 0, 2, 1, 3)
        scores = torch.einsum("bhqd,bhkd->bhqk", q, k_cache) * (Dh ** -0.5)
        p = _softmax(scores, axis=-1)
        o = torch.einsum("bhqk,bhkd->bhqd", p, v_cache)
        return (lambda x, *d: x.permute(*d))(o, 0, 2, 1, 3).reshape(B, Sq, H * Dh) @ wo

    a = _A_ref(A_x, A_k_cache, A_v_cache, A_wq, A_wo)
    b = _B_ref(B_x, B_k_cache, B_v_cache, B_wq, B_wo)
    return torch.concatenate([a, b], axis=-1)
```

```asm
; @launch grid=(256,1,1) block=(256,1,1) lds=163840
.amdgcn_target "amdgcn-amd-amdhsa--gfx950"
.text
.globl concat_heads__mha_block_cached__mha_block_cached__near_ridge_kernel
.p2align 8
.type concat_heads__mha_block_cached__mha_block_cached__near_ridge_kernel,@function
concat_heads__mha_block_cached__mha_block_cached__near_ridge_kernel:
  s_cmp_lt_u32 s2, 256
  s_cbranch_scc1 concat_heads__mha_block_cached__mha_block_cached__near_ridge_kernel_go
  s_endpgm
concat_heads__mha_block_cached__mha_block_cached__near_ridge_kernel_go:
  s_load_dwordx16 s[44:59], s[0:1], 0
  s_load_dwordx4 s[80:83], s[0:1], 64
  s_load_dwordx4 s[84:87], s[0:1], 80
  s_load_dwordx2 s[60:61], s[0:1], 96
  v_lshrrev_b32 v1, 6, v0
  v_and_b32 v2, 63, v0
  s_nop 0
  v_readfirstlane_b32 s24, v1
  s_and_b32 s66, s2, 7
  s_lshr_b32 s67, s2, 3
  s_lshr_b32 s68, s66, 2
  s_and_b32 s88, s66, 3
  s_lshl_b32 s88, s88, 2
  s_lshr_b32 s89, s67, 3
  s_add_u32 s88, s88, s89
  s_and_b32 s90, s67, 7
  s_lshl_b32 s91, s89, 1
  s_add_u32 s91, s91, s90
  s_cmp_ge_u32 s91, 10
  s_cselect_b32 s92, 10, 0
  s_sub_u32 s91, s91, s92
  s_cmp_lt_u32 s67, 25
  s_cselect_b32 s71, 1, 0
  s_waitcnt lgkmcnt(0)
  s_cmp_eq_u32 s68, 0
  s_cselect_b64 s[44:45], s[44:45], s[54:55]
  s_cselect_b64 s[46:47], s[46:47], s[56:57]
  s_cselect_b64 s[48:49], s[48:49], s[58:59]
  s_cselect_b64 s[50:51], s[50:51], s[80:81]
  s_cselect_b64 s[62:63], s[52:53], s[82:83]
  s_mov_b64 s[64:65], s[84:85]
  s_mov_b32 s76, s86
  s_and_b32 s77, s87, 0xffff
  s_mov_b32 s78, 256
  s_mov_b32 s79, 0x20000
  s_mul_i32 s92, s88, 204800
  s_add_u32 s12, s44, s92
  s_addc_u32 s13, s45, 0
  s_and_b32 s13, s13, 0xffff
  s_mov_b32 s14, 204800
  s_mov_b32 s15, 0x20000
  s_mov_b32 s16, s50
  s_and_b32 s17, s51, 0xffff
  s_mov_b32 s18, 5242880
  s_mov_b32 s19, 0x20000
  s_lshr_b32 s80, s24, 1
  s_and_b32 s81, s24, 1
  s_lshl_b32 s25, s80, 13
  s_lshl_b32 s93, s81, 12
  s_add_u32 s25, s25, s93
  s_lshl_b32 s26, s24, 10
  s_lshl_b32 s29, s91, 7
  s_lshl_b32 s30, s91, 19
  s_lshl_b32 s93, s90, 9
  s_add_u32 s30, s30, s93
  s_mov_b32 s38, 0x3e0293ee
  s_mov_b32 s32, 0
  s_mov_b32 s70, 0
  v_lshlrev_b32 v66, 4, v2
  v_add_u32 v67, s26, v66
  v_lshrrev_b32 v3, 4, v2
  v_lshrrev_b32 v5, 3, v2
  v_mul_u32_u24 v5, 1280, v5
  s_mul_i32 s93, s24, 10240
  v_add_u32 v5, s93, v5
  s_lshl_b32 s93, s81, 2
  v_add_u32 v6, s93, v3
  v_and_b32 v7, 7, v2
  v_xor_b32 v7, v7, v6
  v_lshlrev_b32 v7, 4, v7
  v_add_u32 v64, v5, v7
  v_lshrrev_b32 v5, 5, v2
  s_lshl_b32 s93, s81, 1
  v_add_u32 v6, s93, v5
  v_lshlrev_b32 v6, 2, v6
  v_and_b32 v7, 31, v2
  v_xor_b32 v7, v7, v6
  v_lshlrev_b32 v7, 4, v7
  v_lshlrev_b32 v5, 13, v5
  v_add_u32 v5, v5, v7
  s_lshl_b32 s93, s24, 14
  v_add_u32 v65, s93, v5
  s_add_u32 m0, s26, 139264
  s_nop 0
  buffer_load_dwordx4 v64, s[12:15], s29 offen lds
  s_add_u32 m0, s26, 143360
  s_add_u32 s33, s29, 40960
  buffer_load_dwordx4 v64, s[12:15], s33 offen lds
  s_add_u32 m0, s26, 147456
  s_add_u32 s33, s29, 81920
  buffer_load_dwordx4 v64, s[12:15], s33 offen lds
  s_add_u32 m0, s26, 151552
  s_add_u32 s33, s29, 122880
  buffer_load_dwordx4 v64, s[12:15], s33 offen lds
  s_add_u32 m0, s26, 155648
  s_add_u32 s33, s29, 163840
  buffer_load_dwordx4 v64, s[12:15], s33 offen lds
  s_add_u32 m0, s26, 65536
  s_nop 0
  buffer_load_dwordx4 v65, s[16:19], s30 offen lds
  s_add_u32 m0, s26, 69632
  s_add_u32 s33, s30, 65536
  buffer_load_dwordx4 v65, s[16:19], s33 offen lds
  s_add_u32 m0, s26, 73728
  s_add_u32 s33, s30, 131072
  buffer_load_dwordx4 v65, s[16:19], s33 offen lds
  s_add_u32 m0, s26, 77824
  s_add_u32 s33, s30, 196608
  buffer_load_dwordx4 v65, s[16:19], s33 offen lds
  s_add_u32 m0, s26, 81920
  s_add_u32 s33, s30, 262144
  buffer_load_dwordx4 v65, s[16:19], s33 offen lds
  s_add_u32 m0, s26, 86016
  s_add_u32 s33, s30, 327680
  buffer_load_dwordx4 v65, s[16:19], s33 offen lds
  s_add_u32 m0, s26, 90112
  s_add_u32 s33, s30, 393216
  buffer_load_dwordx4 v65, s[16:19], s33 offen lds
  s_add_u32 m0, s26, 94208
  s_add_u32 s33, s30, 458752
  buffer_load_dwordx4 v65, s[16:19], s33 offen lds
  s_add_u32 s29, s29, 128
  s_add_u32 s30, s30, 524288
  s_cmp_eq_u32 s29, 1280
  s_cselect_b32 s29, 0, s29
  s_cselect_b32 s33, 5242880, 0
  s_sub_u32 s30, s30, s33
  s_add_u32 m0, s26, 98304
  s_nop 0
  buffer_load_dwordx4 v64, s[12:15], s29 offen lds
  s_add_u32 m0, s26, 102400
  s_add_u32 s33, s29, 40960
  buffer_load_dwordx4 v64, s[12:15], s33 offen lds
  s_add_u32 m0, s26, 106496
  s_add_u32 s33, s29, 81920
  buffer_load_dwordx4 v64, s[12:15], s33 offen lds
  s_add_u32 m0, s26, 110592
  s_add_u32 s33, s29, 122880
  buffer_load_dwordx4 v64, s[12:15], s33 offen lds
  s_add_u32 m0, s26, 114688
  s_add_u32 s33, s29, 163840
  buffer_load_dwordx4 v64, s[12:15], s33 offen lds
  s_add_u32 m0, s26, 0
  s_nop 0
  buffer_load_dwordx4 v65, s[16:19], s30 offen lds
  s_add_u32 m0, s26, 4096
  s_add_u32 s33, s30, 65536
  buffer_load_dwordx4 v65, s[16:19], s33 offen lds
  s_add_u32 m0, s26, 8192
  s_add_u32 s33, s30, 131072
  buffer_load_dwordx4 v65, s[16:19], s33 offen lds
  s_add_u32 m0, s26, 12288
  s_add_u32 s33, s30, 196608
  buffer_load_dwordx4 v65, s[16:19], s33 offen lds
  s_add_u32 m0, s26, 16384
  s_add_u32 s33, s30, 262144
  buffer_load_dwordx4 v65, s[16:19], s33 offen lds
  s_add_u32 m0, s26, 20480
  s_add_u32 s33, s30, 327680
  buffer_load_dwordx4 v65, s[16:19], s33 offen lds
  s_add_u32 m0, s26, 24576
  s_add_u32 s33, s30, 393216
  buffer_load_dwordx4 v65, s[16:19], s33 offen lds
  s_add_u32 m0, s26, 28672
  s_add_u32 s33, s30, 458752
  buffer_load_dwordx4 v65, s[16:19], s33 offen lds
  s_add_u32 s29, s29, 128
  s_add_u32 s30, s30, 524288
  s_cmp_eq_u32 s29, 1280
  s_cselect_b32 s29, 0, s29
  s_cselect_b32 s33, 5242880, 0
  s_sub_u32 s30, s30, s33
  s_cmp_eq_u32 s71, 0
  s_cbranch_scc0 concat_heads__mha_block_cached__mha_block_cached__near_ridge_kernel_nowarm
  s_and_b32 s92, s66, 3
  s_mul_i32 s92, s92, 7
  s_add_u32 s92, s92, s67
  s_sub_u32 s92, s92, 25
  s_mul_i32 s92, s92, 187392
  s_add_u32 s52, s62, s92
  s_addc_u32 s53, s63, 0
  s_and_b32 s53, s53, 0xffff
  s_sub_u32 s54, 5242880, s92
  s_min_u32 s54, s54, 187392
  s_mov_b32 s55, 0x20000
  s_add_u32 m0, s26, 159744
  s_mov_b32 s56, 0
  s_mov_b32 s57, 46
concat_heads__mha_block_cached__mha_block_cached__near_ridge_kernel_warm:
  buffer_load_dwordx4 v67, s[52:55], s56 offen lds
  s_add_u32 s56, s56, 4096
  s_sub_u32 s57, s57, 1
  s_cmp_lg_u32 s57, 0
  s_cbranch_scc1 concat_heads__mha_block_cached__mha_block_cached__near_ridge_kernel_warm
concat_heads__mha_block_cached__mha_block_cached__near_ridge_kernel_nowarm:
  s_lshl_b32 s92, s88, 23
  s_lshl_b32 s93, s90, 19
  s_add_u32 s92, s92, s93
  s_add_u32 s4, s46, s92
  s_addc_u32 s5, s47, 0
  s_and_b32 s5, s5, 0xffff
  s_mov_b32 s6, 524288
  s_mov_b32 s7, 0x20000
  s_add_u32 s8, s48, s92
  s_addc_u32 s9, s49, 0
  s_and_b32 s9, s9, 0xffff
  s_mov_b32 s10, 524288
  s_mov_b32 s11, 0x20000
  s_lshl_b32 s92, s68, 4
  s_add_u32 s92, s92, s88
  s_mul_i32 s92, s92, 1310720
  s_add_u32 s20, s60, s92
  s_addc_u32 s21, s61, 0
  s_and_b32 s21, s21, 0xffff
  s_mov_b32 s22, 1310720
  s_mov_b32 s23, 0x20000
  s_lshl_b32 s37, s90, 1
  s_add_u32 s37, s37, s80
  s_lshl_b32 s37, s37, 12
  s_mul_i32 s93, s81, 655360
  s_add_u32 s37, s37, s93
  v_and_b32 v3, 15, v2
  v_lshrrev_b32 v4, 4, v2
  v_lshlrev_b32 v5, 8, v3
  s_lshl_b32 s90, s80, 13
  v_add_u32 v5, s90, v5
  v_xor_b32 v6, v4, v3
  v_xor_b32 v7, 0, v6
  v_lshlrev_b32 v7, 4, v7
  v_add_u32 v16, v5, v7
  v_add_u32 v24, 0x10000, v16
  v_xor_b32 v7, 4, v6
  v_lshlrev_b32 v7, 4, v7
  v_add_u32 v17, v5, v7
  v_add_u32 v25, 0x10000, v17
  v_xor_b32 v7, 8, v6
  v_lshlrev_b32 v7, 4, v7
  v_add_u32 v18, v5, v7
  v_add_u32 v26, 0x10000, v18
  v_xor_b32 v7, 12, v6
  v_lshlrev_b32 v7, 4, v7
  v_add_u32 v19, v5, v7
  v_add_u32 v27, 0x10000, v19
  v_xor_b32 v7, 0, v6
  v_lshlrev_b32 v7, 4, v7
  v_add_u32 v20, v5, v7
  v_add_u32 v20, 4096, v20
  v_add_u32 v28, 0x10000, v20
  v_xor_b32 v7, 4, v6
  v_lshlrev_b32 v7, 4, v7
  v_add_u32 v21, v5, v7
  v_add_u32 v21, 4096, v21
  v_add_u32 v29, 0x10000, v21
  v_xor_b32 v7, 8, v6
  v_lshlrev_b32 v7, 4, v7
  v_add_u32 v22, v5, v7
  v_add_u32 v22, 4096, v22
  v_add_u32 v30, 0x10000, v22
  v_xor_b32 v7, 12, v6
  v_lshlrev_b32 v7, 4, v7
  v_add_u32 v23, v5, v7
  v_add_u32 v23, 4096, v23
  v_add_u32 v31, 0x10000, v23
  s_lshl_b32 s90, s80, 13
  s_add_u32 s90, s90, 16384
  v_lshrrev_b32 v3, 2, v2
  v_lshlrev_b32 v4, 8, v3
  v_and_b32 v5, 2, v2
  v_lshlrev_b32 v5, 3, v5
  v_add_u32 v4, v4, v5
  v_and_b32 v5, 1, v2
  v_lshlrev_b32 v5, 3, v5
  v_add_u32 v4, v4, v5
  v_add_u32 v4, s90, v4
  v_and_b32 v3, 7, v3
  v_xor_b32 v5, 0, v3
  v_lshlrev_b32 v5, 5, v5
  v_add_u32 v32, v4, v5
  v_add_u32 v40, 0x10000, v32
  v_xor_b32 v5, 1, v3
  v_lshlrev_b32 v5, 5, v5
  v_add_u32 v33, v4, v5
  v_add_u32 v41, 0x10000, v33
  v_xor_b32 v5, 2, v3
  v_lshlrev_b32 v5, 5, v5
  v_add_u32 v34, v4, v5
  v_add_u32 v42, 0x10000, v34
  v_xor_b32 v5, 3, v3
  v_lshlrev_b32 v5, 5, v5
  v_add_u32 v35, v4, v5
  v_add_u32 v43, 0x10000, v35
  v_xor_b32 v5, 4, v3
  v_lshlrev_b32 v5, 5, v5
  v_add_u32 v36, v4, v5
  v_add_u32 v44, 0x10000, v36
  v_xor_b32 v5, 5, v3
  v_lshlrev_b32 v5, 5, v5
  v_add_u32 v37, v4, v5
  v_add_u32 v45, 0x10000, v37
  v_xor_b32 v5, 6, v3
  v_lshlrev_b32 v5, 5, v5
  v_add_u32 v38, v4, v5
  v_add_u32 v46, 0x10000, v38
  v_xor_b32 v5, 7, v3
  v_lshlrev_b32 v5, 5, v5
  v_add_u32 v39, v4, v5
  v_add_u32 v47, 0x10000, v39
  v_lshrrev_b32 v3, 2, v2
  v_and_b32 v3, 3, v3
  v_lshrrev_b32 v4, 4, v2
  v_lshlrev_b32 v4, 3, v4
  v_add_u32 v4, v4, v3
  v_lshlrev_b32 v4, 9, v4
  v_and_b32 v5, 3, v2
  v_lshlrev_b32 v5, 4, v5
  v_add_u32 v4, v4, v5
  s_lshl_b32 s90, s80, 8
  v_add_u32 v4, s90, v4
  v_xor_b32 v5, 0, v3
  v_lshlrev_b32 v5, 6, v5
  v_add_u32 v48, v4, v5
  v_add_u32 v52, 0x10000, v48
  v_xor_b32 v5, 1, v3
  v_lshlrev_b32 v5, 6, v5
  v_add_u32 v49, v4, v5
  v_add_u32 v53, 0x10000, v49
  v_xor_b32 v5, 2, v3
  v_lshlrev_b32 v5, 6, v5
  v_add_u32 v50, v4, v5
  v_add_u32 v54, 0x10000, v50
  v_xor_b32 v5, 3, v3
  v_lshlrev_b32 v5, 6, v5
  v_add_u32 v51, v4, v5
  v_add_u32 v55, 0x10000, v51
  v_and_b32 v3, 15, v2
  v_lshlrev_b32 v4, 7, v3
  s_mul_i32 s90, s81, 10240
  s_add_u32 s90, s90, 98304
  v_add_u32 v4, s90, v4
  v_lshrrev_b32 v5, 1, v3
  v_lshrrev_b32 v6, 4, v2
  v_xor_b32 v5, v5, v6
  v_xor_b32 v6, 0, v5
  v_lshlrev_b32 v6, 4, v6
  v_add_u32 v56, v4, v6
  v_xor_b32 v6, 4, v5
  v_lshlrev_b32 v6, 4, v6
  v_add_u32 v57, v4, v6
  v_lshrrev_b32 v3, 4, v2
  v_and_b32 v4, 15, v2
  s_lshl_b32 s90, s80, 18
  s_lshl_b32 s91, s81, 12
  s_add_u32 s90, s90, s91
  v_lshlrev_b32 v5, 8, v3
  v_add_u32 v5, s90, v5
  v_xor_b32 v6, v4, v3
  v_xor_b32 v7, 0, v6
  v_lshlrev_b32 v7, 4, v7
  v_add_u32 v58, v5, v7
  v_xor_b32 v7, 4, v6
  v_lshlrev_b32 v7, 4, v7
  v_add_u32 v59, v5, v7
  v_xor_b32 v7, 8, v6
  v_lshlrev_b32 v7, 4, v7
  v_add_u32 v60, v5, v7
  v_xor_b32 v7, 12, v6
  v_lshlrev_b32 v7, 4, v7
  v_add_u32 v61, v5, v7
  v_add_u32 v7, 0, v3
  v_lshlrev_b32 v7, 1, v7
  v_xor_b32 v7, v7, v4
  v_lshlrev_b32 v7, 4, v7
  v_add_u32 v62, v5, v7
  v_add_u32 v7, 4, v3
  v_lshlrev_b32 v7, 1, v7
  v_xor_b32 v7, v7, v4
  v_lshlrev_b32 v7, 4, v7
  v_add_u32 v63, v5, v7
  s_mov_b32 s58, s38
  s_mov_b32 s59, s38
  s_waitcnt vmcnt(13)
  s_mov_b32 s27, 0
  s_mov_b32 s28, 0
  s_barrier
  ds_read_b128 a[224:227], v56 offset:40960
  ds_read_b64_tr_b16 a[160:161], v52 offset:0
  ds_read_b64_tr_b16 a[162:163], v52 offset:2048
  ds_read_b128 a[228:231], v56 offset:43008
  ds_read_b64_tr_b16 a[164:165], v52 offset:8
  ds_read_b64_tr_b16 a[166:167], v52 offset:2056
  ds_read_b128 a[232:235], v56 offset:45056
  ds_read_b64_tr_b16 a[168:169], v53 offset:0
  ds_read_b64_tr_b16 a[170:171], v53 offset:2048
  ds_read_b128 a[236:239], v56 offset:47104
  ds_read_b64_tr_b16 a[172:173], v53 offset:8
  ds_read_b64_tr_b16 a[174:175], v53 offset:2056
  ds_read_b128 a[240:243], v56 offset:49152
  ds_read_b64_tr_b16 a[176:177], v54 offset:0
  ds_read_b64_tr_b16 a[178:179], v54 offset:2048
  ds_read_b64_tr_b16 a[180:181], v54 offset:8
  ds_read_b64_tr_b16 a[182:183], v54 offset:2056
  ds_read_b64_tr_b16 a[184:185], v55 offset:0
  ds_read_b64_tr_b16 a[186:187], v55 offset:2048
  ds_read_b64_tr_b16 a[188:189], v55 offset:8
  ds_read_b64_tr_b16 a[190:191], v55 offset:2056
  s_add_u32 m0, s26, 118784
  s_nop 0
  buffer_load_dwordx4 v64, s[12:15], s29 offen lds
  s_add_u32 m0, s26, 122880
  s_add_u32 s33, s29, 40960
  buffer_load_dwordx4 v64, s[12:15], s33 offen lds
  s_add_u32 m0, s26, 126976
  s_add_u32 s33, s29, 81920
  buffer_load_dwordx4 v64, s[12:15], s33 offen lds
  s_add_u32 m0, s26, 131072
  s_add_u32 s33, s29, 122880
  buffer_load_dwordx4 v64, s[12:15], s33 offen lds
  s_add_u32 m0, s26, 135168
  s_add_u32 s33, s29, 163840
  buffer_load_dwordx4 v64, s[12:15], s33 offen lds
  s_add_u32 m0, s26, 32768
  s_nop 0
  buffer_load_dwordx4 v65, s[16:19], s30 offen lds
  s_waitcnt lgkmcnt(0)
  v_mfma_f32_16x16x32_bf16 v[96:99], a[160:163], a[224:227], 0
  ds_read_b128 v[76:79], v57 offset:40960
  v_mfma_f32_16x16x32_bf16 v[100:103], a[164:167], a[224:227], 0
  ds_read_b64_tr_b16 a[192:193], v52 offset:16384
  s_add_u32 m0, s26, 36864
  s_add_u32 s33, s30, 65536
  v_mfma_f32_16x16x32_bf16 v[104:107], a[168:171], a[224:227], 0
  buffer_load_dwordx4 v65, s[16:19], s33 offen lds
  v_mfma_f32_16x16x32_bf16 v[108:111], a[172:175], a[224:227], 0
  ds_read_b64_tr_b16 a[194:195], v52 offset:18432
  v_mfma_f32_16x16x32_bf16 v[112:115], a[176:179], a[224:227], 0
  ds_read_b128 v[80:83], v57 offset:43008
  v_mfma_f32_16x16x32_bf16 v[116:119], a[180:183], a[224:227], 0
  v_mfma_f32_16x16x32_bf16 v[120:123], a[184:187], a[224:227], 0
  ds_read_b64_tr_b16 a[196:197], v52 offset:16392
  v_mfma_f32_16x16x32_bf16 v[124:127], a[188:191], a[224:227], 0
  ds_read_b64_tr_b16 a[198:199], v52 offset:18440
  s_add_u32 m0, s26, 40960
  s_add_u32 s33, s30, 131072
  v_mfma_f32_16x16x32_bf16 v[128:131], a[160:163], a[228:231], 0
  buffer_load_dwordx4 v65, s[16:19], s33 offen lds
  v_mfma_f32_16x16x32_bf16 v[132:135], a[164:167], a[228:231], 0
  ds_read_b128 v[84:87], v57 offset:45056
  v_mfma_f32_16x16x32_bf16 v[136:139], a[168:171], a[228:231], 0
  ds_read_b64_tr_b16 a[200:201], v53 offset:16384
  v_mfma_f32_16x16x32_bf16 v[140:143], a[172:175], a[228:231], 0
  v_mfma_f32_16x16x32_bf16 v[144:147], a[176:179], a[228:231], 0
  ds_read_b64_tr_b16 a[202:203], v53 offset:18432
  v_mfma_f32_16x16x32_bf16 v[148:151], a[180:183], a[228:231], 0
  ds_read_b128 v[88:91], v57 offset:47104
  s_add_u32 m0, s26, 45056
  s_add_u32 s33, s30, 196608
  v_mfma_f32_16x16x32_bf16 v[152:155], a[184:187], a[228:231], 0
  buffer_load_dwordx4 v65, s[16:19], s33 offen lds
  v_mfma_f32_16x16x32_bf16 v[156:159], a[188:191], a[228:231], 0
  ds_read_b64_tr_b16 a[204:205], v53 offset:16392
  v_mfma_f32_16x16x32_bf16 v[160:163], a[160:163], a[232:235], 0
  ds_read_b64_tr_b16 a[206:207], v53 offset:18440
  v_mfma_f32_16x16x32_bf16 v[164:167], a[164:167], a[232:235], 0
  v_mfma_f32_16x16x32_bf16 v[168:171], a[168:171], a[232:235], 0
  ds_read_b128 v[92:95], v57 offset:49152
  v_mfma_f32_16x16x32_bf16 v[172:175], a[172:175], a[232:235], 0
  ds_read_b64_tr_b16 a[208:209], v54 offset:16384
  s_add_u32 m0, s26, 49152
  s_add_u32 s33, s30, 262144
  v_mfma_f32_16x16x32_bf16 v[176:179], a[176:179], a[232:235], 0
  buffer_load_dwordx4 v65, s[16:19], s33 offen lds
  v_mfma_f32_16x16x32_bf16 v[180:183], a[180:183], a[232:235], 0
  ds_read_b64_tr_b16 a[210:211], v54 offset:18432
  v_mfma_f32_16x16x32_bf16 v[184:187], a[184:187], a[232:235], 0
  ds_read_b64_tr_b16 a[212:213], v54 offset:16392
  s_add_u32 m0, s26, 53248
  s_add_u32 s33, s30, 327680
  v_mfma_f32_16x16x32_bf16 v[188:191], a[188:191], a[232:235], 0
  buffer_load_dwordx4 v65, s[16:19], s33 offen lds
  v_mfma_f32_16x16x32_bf16 v[192:195], a[160:163], a[236:239], 0
  ds_read_b64_tr_b16 a[214:215], v54 offset:18440
  v_mfma_f32_16x16x32_bf16 v[196:199], a[164:167], a[236:239], 0
  ds_read_b64_tr_b16 a[216:217], v55 offset:16384
  v_mfma_f32_16x16x32_bf16 v[200:203], a[168:171], a[236:239], 0
  v_mfma_f32_16x16x32_bf16 v[204:207], a[172:175], a[236:239], 0
  ds_read_b64_tr_b16 a[218:219], v55 offset:18432
  v_mfma_f32_16x16x32_bf16 v[208:211], a[176:179], a[236:239], 0
  ds_read_b64_tr_b16 a[220:221], v55 offset:16392
  s_add_u32 m0, s26, 57344
  s_add_u32 s33, s30, 393216
  v_mfma_f32_16x16x32_bf16 v[212:215], a[180:183], a[236:239], 0
  buffer_load_dwordx4 v65, s[16:19], s33 offen lds
  v_mfma_f32_16x16x32_bf16 v[216:219], a[184:187], a[236:239], 0
  ds_read_b64_tr_b16 a[222:223], v55 offset:18440
  v_mfma_f32_16x16x32_bf16 v[220:223], a[188:191], a[236:239], 0
  v_mfma_f32_16x16x32_bf16 v[224:227], a[160:163], a[240:243], 0
  v_mfma_f32_16x16x32_bf16 v[228:231], a[164:167], a[240:243], 0
  s_add_u32 m0, s26, 61440
  s_add_u32 s33, s30, 458752
  v_mfma_f32_16x16x32_bf16 v[232:235], a[168:171], a[240:243], 0
  buffer_load_dwordx4 v65, s[16:19], s33 offen lds
  s_add_u32 s29, s29, 128
  s_add_u32 s30, s30, 524288
  s_cmp_eq_u32 s29, 1280
  s_cselect_b32 s29, 0, s29
  s_cselect_b32 s33, 5242880, 0
  s_sub_u32 s30, s30, s33
  v_mfma_f32_16x16x32_bf16 v[236:239], a[172:175], a[240:243], 0
  v_mfma_f32_16x16x32_bf16 v[240:243], a[176:179], a[240:243], 0
  v_mfma_f32_16x16x32_bf16 v[244:247], a[180:183], a[240:243], 0
  v_mfma_f32_16x16x32_bf16 v[248:251], a[184:187], a[240:243], 0
  v_mfma_f32_16x16x32_bf16 v[252:255], a[188:191], a[240:243], 0
  s_waitcnt vmcnt(13) lgkmcnt(0)
  s_barrier
  v_mfma_f32_16x16x32_bf16 v[96:99], a[192:195], v[76:79], v[96:99]
  ds_read_b128 a[224:227], v56 offset:0
  v_mfma_f32_16x16x32_bf16 v[100:103], a[196:199], v[76:79], v[100:103]
  ds_read_b64_tr_b16 a[160:161], v48 offset:0
  s_add_u32 m0, s26, 139264
  v_mfma_f32_16x16x32_bf16 v[104:107], a[200:203], v[76:79], v[104:107]
  buffer_load_dwordx4 v64, s[12:15], s29 offen lds
  v_mfma_f32_16x16x32_bf16 v[108:111], a[204:207], v[76:79], v[108:111]
  ds_read_b64_tr_b16 a[162:163], v48 offset:2048
  v_mfma_f32_16x16x32_bf16 v[112:115], a[208:211], v[76:79], v[112:115]
  ds_read_b128 a[228:231], v56 offset:2048
  v_mfma_f32_16x16x32_bf16 v[116:119], a[212:215], v[76:79], v[116:119]
  v_mfma_f32_16x16x32_bf16 v[120:123], a[216:219], v[76:79], v[120:123]
  ds_read_b64_tr_b16 a[164:165], v48 offset:8
  v_mfma_f32_16x16x32_bf16 v[124:127], a[220:223], v[76:79], v[124:127]
  ds_read_b64_tr_b16 a[166:167], v48 offset:2056
  s_add_u32 m0, s26, 143360
  s_add_u32 s33, s29, 40960
  v_mfma_f32_16x16x32_bf16 v[128:131], a[192:195], v[80:83], v[128:131]
  buffer_load_dwordx4 v64, s[12:15], s33 offen lds
  v_mfma_f32_16x16x32_bf16 v[132:135], a[196:199], v[80:83], v[132:135]
  ds_read_b128 a[232:235], v56 offset:4096
  v_mfma_f32_16x16x32_bf16 v[136:139], a[200:203], v[80:83], v[136:139]
  ds_read_b64_tr_b16 a[168:169], v49 offset:0
  v_mfma_f32_16x16x32_bf16 v[140:143], a[204:207], v[80:83], v[140:143]
  v_mfma_f32_16x16x32_bf16 v[144:147], a[208:211], v[80:83], v[144:147]
  ds_read_b64_tr_b16 a[170:171], v49 offset:2048
  v_mfma_f32_16x16x32_bf16 v[148:151], a[212:215], v[80:83], v[148:151]
  ds_read_b128 a[236:239], v56 offset:6144
  s_add_u32 m0, s26, 147456
  s_add_u32 s33, s29, 81920
  v_mfma_f32_16x16x32_bf16 v[152:155], a[216:219], v[80:83], v[152:155]
  buffer_load_dwordx4 v64, s[12:15], s33 offen lds
  v_mfma_f32_16x16x32_bf16 v[156:159], a[220:223], v[80:83], v[156:159]
  ds_read_b64_tr_b16 a[172:173], v49 offset:8
  v_mfma_f32_16x16x32_bf16 v[160:163], a[192:195], v[84:87], v[160:163]
  ds_read_b64_tr_b16 a[174:175], v49 offset:2056
  v_mfma_f32_16x16x32_bf16 v[164:167], a[196:199], v[84:87], v[164:167]
  v_mfma_f32_16x16x32_bf16 v[168:171], a[200:203], v[84:87], v[168:171]
  ds_read_b128 a[240:243], v56 offset:8192
  v_mfma_f32_16x16x32_bf16 v[172:175], a[204:207], v[84:87], v[172:175]
  ds_read_b64_tr_b16 a[176:177], v50 offset:0
  v_mfma_f32_16x16x32_bf16 v[176:179], a[208:211], v[84:87], v[176:179]
  v_mfma_f32_16x16x32_bf16 v[180:183], a[212:215], v[84:87], v[180:183]
  ds_read_b64_tr_b16 a[178:179], v50 offset:2048
  v_mfma_f32_16x16x32_bf16 v[184:187], a[216:219], v[84:87], v[184:187]
  ds_read_b64_tr_b16 a[180:181], v50 offset:8
  s_add_u32 m0, s26, 151552
  s_add_u32 s33, s29, 122880
  v_mfma_f32_16x16x32_bf16 v[188:191], a[220:223], v[84:87], v[188:191]
  buffer_load_dwordx4 v64, s[12:15], s33 offen lds
  v_mfma_f32_16x16x32_bf16 v[192:195], a[192:195], v[88:91], v[192:195]
  ds_read_b64_tr_b16 a[182:183], v50 offset:2056
  v_mfma_f32_16x16x32_bf16 v[196:199], a[196:199], v[88:91], v[196:199]
  ds_read_b64_tr_b16 a[184:185], v51 offset:0
  v_mfma_f32_16x16x32_bf16 v[200:203], a[200:203], v[88:91], v[200:203]
  v_mfma_f32_16x16x32_bf16 v[204:207], a[204:207], v[88:91], v[204:207]
  ds_read_b64_tr_b16 a[186:187], v51 offset:2048
  v_mfma_f32_16x16x32_bf16 v[208:211], a[208:211], v[88:91], v[208:211]
  ds_read_b64_tr_b16 a[188:189], v51 offset:8
  s_add_u32 m0, s26, 155648
  s_add_u32 s33, s29, 163840
  v_mfma_f32_16x16x32_bf16 v[212:215], a[212:215], v[88:91], v[212:215]
  buffer_load_dwordx4 v64, s[12:15], s33 offen lds
  v_mfma_f32_16x16x32_bf16 v[216:219], a[216:219], v[88:91], v[216:219]
  ds_read_b64_tr_b16 a[190:191], v51 offset:2056
  v_mfma_f32_16x16x32_bf16 v[220:223], a[220:223], v[88:91], v[220:223]
  v_mfma_f32_16x16x32_bf16 v[224:227], a[192:195], v[92:95], v[224:227]
  s_add_u32 m0, s26, 65536
  v_mfma_f32_16x16x32_bf16 v[228:231], a[196:199], v[92:95], v[228:231]
  buffer_load_dwordx4 v65, s[16:19], s30 offen lds
  v_mfma_f32_16x16x32_bf16 v[232:235], a[200:203], v[92:95], v[232:235]
  v_mfma_f32_16x16x32_bf16 v[236:239], a[204:207], v[92:95], v[236:239]
  v_mfma_f32_16x16x32_bf16 v[240:243], a[208:211], v[92:95], v[240:243]
  v_mfma_f32_16x16x32_bf16 v[244:247], a[212:215], v[92:95], v[244:247]
  v_mfma_f32_16x16x32_bf16 v[248:251], a[216:219], v[92:95], v[248:251]
  v_mfma_f32_16x16x32_bf16 v[252:255], a[220:223], v[92:95], v[252:255]
  s_waitcnt lgkmcnt(0)
  v_mfma_f32_16x16x32_bf16 v[96:99], a[160:163], a[224:227], v[96:99]
  ds_read_b128 v[76:79], v57 offset:0
  v_mfma_f32_16x16x32_bf16 v[100:103], a[164:167], a[224:227], v[100:103]
  ds_read_b64_tr_b16 a[192:193], v48 offset:16384
  s_add_u32 m0, s26, 69632
  s_add_u32 s33, s30, 65536
  v_mfma_f32_16x16x32_bf16 v[104:107], a[168:171], a[224:227], v[104:107]
  buffer_load_dwordx4 v65, s[16:19], s33 offen lds
  v_mfma_f32_16x16x32_bf16 v[108:111], a[172:175], a[224:227], v[108:111]
  ds_read_b64_tr_b16 a[194:195], v48 offset:18432
  v_mfma_f32_16x16x32_bf16 v[112:115], a[176:179], a[224:227], v[112:115]
  ds_read_b128 v[80:83], v57 offset:2048
  v_mfma_f32_16x16x32_bf16 v[116:119], a[180:183], a[224:227], v[116:119]
  v_mfma_f32_16x16x32_bf16 v[120:123], a[184:187], a[224:227], v[120:123]
  ds_read_b64_tr_b16 a[196:197], v48 offset:16392
  v_mfma_f32_16x16x32_bf16 v[124:127], a[188:191], a[224:227], v[124:127]
  ds_read_b64_tr_b16 a[198:199], v48 offset:18440
  s_add_u32 m0, s26, 73728
  s_add_u32 s33, s30, 131072
  v_mfma_f32_16x16x32_bf16 v[128:131], a[160:163], a[228:231], v[128:131]
  buffer_load_dwordx4 v65, s[16:19], s33 offen lds
  v_mfma_f32_16x16x32_bf16 v[132:135], a[164:167], a[228:231], v[132:135]
  ds_read_b128 v[84:87], v57 offset:4096
  v_mfma_f32_16x16x32_bf16 v[136:139], a[168:171], a[228:231], v[136:139]
  ds_read_b64_tr_b16 a[200:201], v49 offset:16384
  v_mfma_f32_16x16x32_bf16 v[140:143], a[172:175], a[228:231], v[140:143]
  v_mfma_f32_16x16x32_bf16 v[144:147], a[176:179], a[228:231], v[144:147]
  ds_read_b64_tr_b16 a[202:203], v49 offset:18432
  v_mfma_f32_16x16x32_bf16 v[148:151], a[180:183], a[228:231], v[148:151]
  ds_read_b128 v[88:91], v57 offset:6144
  s_add_u32 m0, s26, 77824
  s_add_u32 s33, s30, 196608
  v_mfma_f32_16x16x32_bf16 v[152:155], a[184:187], a[228:231], v[152:155]
  buffer_load_dwordx4 v65, s[16:19], s33 offen lds
  v_mfma_f32_16x16x32_bf16 v[156:159], a[188:191], a[228:231], v[156:159]
  ds_read_b64_tr_b16 a[204:205], v49 offset:16392
  v_mfma_f32_16x16x32_bf16 v[160:163], a[160:163], a[232:235], v[160:163]
  ds_read_b64_tr_b16 a[206:207], v49 offset:18440
  v_mfma_f32_16x16x32_bf16 v[164:167], a[164:167], a[232:235], v[164:167]
  v_mfma_f32_16x16x32_bf16 v[168:171], a[168:171], a[232:235], v[168:171]
  ds_read_b128 v[92:95], v57 offset:8192
  v_mfma_f32_16x16x32_bf16 v[172:175], a[172:175], a[232:235], v[172:175]
  ds_read_b64_tr_b16 a[208:209], v50 offset:16384
  s_add_u32 m0, s26, 81920
  s_add_u32 s33, s30, 262144
  v_mfma_f32_16x16x32_bf16 v[176:179], a[176:179], a[232:235], v[176:179]
  buffer_load_dwordx4 v65, s[16:19], s33 offen lds
  v_mfma_f32_16x16x32_bf16 v[180:183], a[180:183], a[232:235], v[180:183]
  ds_read_b64_tr_b16 a[210:211], v50 offset:18432
  v_mfma_f32_16x16x32_bf16 v[184:187], a[184:187], a[232:235], v[184:187]
  ds_read_b64_tr_b16 a[212:213], v50 offset:16392
  s_add_u32 m0, s26, 86016
  s_add_u32 s33, s30, 327680
  v_mfma_f32_16x16x32_bf16 v[188:191], a[188:191], a[232:235], v[188:191]
  buffer_load_dwordx4 v65, s[16:19], s33 offen lds
  v_mfma_f32_16x16x32_bf16 v[192:195], a[160:163], a[236:239], v[192:195]
  ds_read_b64_tr_b16 a[214:215], v50 offset:18440
  v_mfma_f32_16x16x32_bf16 v[196:199], a[164:167], a[236:239], v[196:199]
  ds_read_b64_tr_b16 a[216:217], v51 offset:16384
  v_mfma_f32_16x16x32_bf16 v[200:203], a[168:171], a[236:239], v[200:203]
  v_mfma_f32_16x16x32_bf16 v[204:207], a[172:175], a[236:239], v[204:207]
  ds_read_b64_tr_b16 a[218:219], v51 offset:18432
  v_mfma_f32_16x16x32_bf16 v[208:211], a[176:179], a[236:239], v[208:211]
  ds_read_b64_tr_b16 a[220:221], v51 offset:16392
  s_add_u32 m0, s26, 90112
  s_add_u32 s33, s30, 393216
  v_mfma_f32_16x16x32_bf16 v[212:215], a[180:183], a[236:239], v[212:215]
  buffer_load_dwordx4 v65, s[16:19], s33 offen lds
  v_mfma_f32_16x16x32_bf16 v[216:219], a[184:187], a[236:239], v[216:219]
  ds_read_b64_tr_b16 a[222:223], v51 offset:18440
  v_mfma_f32_16x16x32_bf16 v[220:223], a[188:191], a[236:239], v[220:223]
  v_mfma_f32_16x16x32_bf16 v[224:227], a[160:163], a[240:243], v[224:227]
  v_mfma_f32_16x16x32_bf16 v[228:231], a[164:167], a[240:243], v[228:231]
  s_add_u32 m0, s26, 94208
  s_add_u32 s33, s30, 458752
  v_mfma_f32_16x16x32_bf16 v[232:235], a[168:171], a[240:243], v[232:235]
  buffer_load_dwordx4 v65, s[16:19], s33 offen lds
  s_add_u32 s29, s29, 128
  s_add_u32 s30, s30, 524288
  s_cmp_eq_u32 s29, 1280
  s_cselect_b32 s29, 0, s29
  s_cselect_b32 s33, 5242880, 0
  s_sub_u32 s30, s30, s33
  v_mfma_f32_16x16x32_bf16 v[236:239], a[172:175], a[240:243], v[236:239]
  v_mfma_f32_16x16x32_bf16 v[240:243], a[176:179], a[240:243], v[240:243]
  v_mfma_f32_16x16x32_bf16 v[244:247], a[180:183], a[240:243], v[244:247]
  v_mfma_f32_16x16x32_bf16 v[248:251], a[184:187], a[240:243], v[248:251]
  v_mfma_f32_16x16x32_bf16 v[252:255], a[188:191], a[240:243], v[252:255]
  s_waitcnt vmcnt(13) lgkmcnt(0)
  s_barrier
  v_mfma_f32_16x16x32_bf16 v[96:99], a[192:195], v[76:79], v[96:99]
  ds_read_b128 a[224:227], v56 offset:20480
  v_mfma_f32_16x16x32_bf16 v[100:103], a[196:199], v[76:79], v[100:103]
  ds_read_b64_tr_b16 a[160:161], v48 offset:32768
  s_add_u32 m0, s26, 98304
  v_mfma_f32_16x16x32_bf16 v[104:107], a[200:203], v[76:79], v[104:107]
  buffer_load_dwordx4 v64, s[12:15], s29 offen lds
  v_mfma_f32_16x16x32_bf16 v[108:111], a[204:207], v[76:79], v[108:111]
  ds_read_b64_tr_b16 a[162:163], v48 offset:34816
  v_mfma_f32_16x16x32_bf16 v[112:115], a[208:211], v[76:79], v[112:115]
  ds_read_b128 a[228:231], v56 offset:22528
  v_mfma_f32_16x16x32_bf16 v[116:119], a[212:215], v[76:79], v[116:119]
  v_mfma_f32_16x16x32_bf16 v[120:123], a[216:219], v[76:79], v[120:123]
  ds_read_b64_tr_b16 a[164:165], v48 offset:32776
  v_mfma_f32_16x16x32_bf16 v[124:127], a[220:223], v[76:79], v[124:127]
  ds_read_b64_tr_b16 a[166:167], v48 offset:34824
  s_add_u32 m0, s26, 102400
  s_add_u32 s33, s29, 40960
  v_mfma_f32_16x16x32_bf16 v[128:131], a[192:195], v[80:83], v[128:131]
  buffer_load_dwordx4 v64, s[12:15], s33 offen lds
  v_mfma_f32_16x16x32_bf16 v[132:135], a[196:199], v[80:83], v[132:135]
  ds_read_b128 a[232:235], v56 offset:24576
  v_mfma_f32_16x16x32_bf16 v[136:139], a[200:203], v[80:83], v[136:139]
  ds_read_b64_tr_b16 a[168:169], v49 offset:32768
  v_mfma_f32_16x16x32_bf16 v[140:143], a[204:207], v[80:83], v[140:143]
  v_mfma_f32_16x16x32_bf16 v[144:147], a[208:211], v[80:83], v[144:147]
  ds_read_b64_tr_b16 a[170:171], v49 offset:34816
  v_mfma_f32_16x16x32_bf16 v[148:151], a[212:215], v[80:83], v[148:151]
  ds_read_b128 a[236:239], v56 offset:26624
  s_add_u32 m0, s26, 106496
  s_add_u32 s33, s29, 81920
  v_mfma_f32_16x16x32_bf16 v[152:155], a[216:219], v[80:83], v[152:155]
  buffer_load_dwordx4 v64, s[12:15], s33 offen lds
  v_mfma_f32_16x16x32_bf16 v[156:159], a[220:223], v[80:83], v[156:159]
  ds_read_b64_tr_b16 a[172:173], v49 offset:32776
  v_mfma_f32_16x16x32_bf16 v[160:163], a[192:195], v[84:87], v[160:163]
  ds_read_b64_tr_b16 a[174:175], v49 offset:34824
  v_mfma_f32_16x16x32_bf16 v[164:167], a[196:199], v[84:87], v[164:167]
  v_mfma_f32_16x16x32_bf16 v[168:171], a[200:203], v[84:87], v[168:171]
  ds_read_b128 a[240:243], v56 offset:28672
  v_mfma_f32_16x16x32_bf16 v[172:175], a[204:207], v[84:87], v[172:175]
  ds_read_b64_tr_b16 a[176:177], v50 offset:32768
  v_mfma_f32_16x16x32_bf16 v[176:179], a[208:211], v[84:87], v[176:179]
  v_mfma_f32_16x16x32_bf16 v[180:183], a[212:215], v[84:87], v[180:183]
  ds_read_b64_tr_b16 a[178:179], v50 offset:34816
  v_mfma_f32_16x16x32_bf16 v[184:187], a[216:219], v[84:87], v[184:187]
  ds_read_b64_tr_b16 a[180:181], v50 offset:32776
  s_add_u32 m0, s26, 110592
  s_add_u32 s33, s29, 122880
  v_mfma_f32_16x16x32_bf16 v[188:191], a[220:223], v[84:87], v[188:191]
  buffer_load_dwordx4 v64, s[12:15], s33 offen lds
  v_mfma_f32_16x16x32_bf16 v[192:195], a[192:195], v[88:91], v[192:195]
  ds_read_b64_tr_b16 a[182:183], v50 offset:34824
  v_mfma_f32_16x16x32_bf16 v[196:199], a[196:199], v[88:91], v[196:199]
  ds_read_b64_tr_b16 a[184:185], v51 offset:32768
  v_mfma_f32_16x16x32_bf16 v[200:203], a[200:203], v[88:91], v[200:203]
  v_mfma_f32_16x16x32_bf16 v[204:207], a[204:207], v[88:91], v[204:207]
  ds_read_b64_tr_b16 a[186:187], v51 offset:34816
  v_mfma_f32_16x16x32_bf16 v[208:211], a[208:211], v[88:91], v[208:211]
  ds_read_b64_tr_b16 a[188:189], v51 offset:32776
  s_add_u32 m0, s26, 114688
  s_add_u32 s33, s29, 163840
  v_mfma_f32_16x16x32_bf16 v[212:215], a[212:215], v[88:91], v[212:215]
  buffer_load_dwordx4 v64, s[12:15], s33 offen lds
  v_mfma_f32_16x16x32_bf16 v[216:219], a[216:219], v[88:91], v[216:219]
  ds_read_b64_tr_b16 a[190:191], v51 offset:34824
  v_mfma_f32_16x16x32_bf16 v[220:223], a[220:223], v[88:91], v[220:223]
  v_mfma_f32_16x16x32_bf16 v[224:227], a[192:195], v[92:95], v[224:227]
  s_add_u32 m0, s26, 0
  v_mfma_f32_16x16x32_bf16 v[228:231], a[196:199], v[92:95], v[228:231]
  buffer_load_dwordx4 v65, s[16:19], s30 offen lds
  v_mfma_f32_16x16x32_bf16 v[232:235], a[200:203], v[92:95], v[232:235]
  v_mfma_f32_16x16x32_bf16 v[236:239], a[204:207], v[92:95], v[236:239]
  v_mfma_f32_16x16x32_bf16 v[240:243], a[208:211], v[92:95], v[240:243]
  v_mfma_f32_16x16x32_bf16 v[244:247], a[212:215], v[92:95], v[244:247]
  v_mfma_f32_16x16x32_bf16 v[248:251], a[216:219], v[92:95], v[248:251]
  v_mfma_f32_16x16x32_bf16 v[252:255], a[220:223], v[92:95], v[252:255]
  s_waitcnt lgkmcnt(0)
  v_mfma_f32_16x16x32_bf16 v[96:99], a[160:163], a[224:227], v[96:99]
  ds_read_b128 v[76:79], v57 offset:20480
  v_mfma_f32_16x16x32_bf16 v[100:103], a[164:167], a[224:227], v[100:103]
  ds_read_b64_tr_b16 a[192:193], v48 offset:49152
  s_add_u32 m0, s26, 4096
  s_add_u32 s33, s30, 65536
  v_mfma_f32_16x16x32_bf16 v[104:107], a[168:171], a[224:227], v[104:107]
  buffer_load_dwordx4 v65, s[16:19], s33 offen lds
  v_mfma_f32_16x16x32_bf16 v[108:111], a[172:175], a[224:227], v[108:111]
  ds_read_b64_tr_b16 a[194:195], v48 offset:51200
  v_mfma_f32_16x16x32_bf16 v[112:115], a[176:179], a[224:227], v[112:115]
  ds_read_b128 v[80:83], v57 offset:22528
  v_mfma_f32_16x16x32_bf16 v[116:119], a[180:183], a[224:227], v[116:119]
  v_mfma_f32_16x16x32_bf16 v[120:123], a[184:187], a[224:227], v[120:123]
  ds_read_b64_tr_b16 a[196:197], v48 offset:49160
  v_mfma_f32_16x16x32_bf16 v[124:127], a[188:191], a[224:227], v[124:127]
  ds_read_b64_tr_b16 a[198:199], v48 offset:51208
  s_add_u32 m0, s26, 8192
  s_add_u32 s33, s30, 131072
  v_mfma_f32_16x16x32_bf16 v[128:131], a[160:163], a[228:231], v[128:131]
  buffer_load_dwordx4 v65, s[16:19], s33 offen lds
  v_mfma_f32_16x16x32_bf16 v[132:135], a[164:167], a[228:231], v[132:135]
  ds_read_b128 v[84:87], v57 offset:24576
  v_mfma_f32_16x16x32_bf16 v[136:139], a[168:171], a[228:231], v[136:139]
  ds_read_b64_tr_b16 a[200:201], v49 offset:49152
  v_mfma_f32_16x16x32_bf16 v[140:143], a[172:175], a[228:231], v[140:143]
  v_mfma_f32_16x16x32_bf16 v[144:147], a[176:179], a[228:231], v[144:147]
  ds_read_b64_tr_b16 a[202:203], v49 offset:51200
  v_mfma_f32_16x16x32_bf16 v[148:151], a[180:183], a[228:231], v[148:151]
  ds_read_b128 v[88:91], v57 offset:26624
  s_add_u32 m0, s26, 12288
  s_add_u32 s33, s30, 196608
  v_mfma_f32_16x16x32_bf16 v[152:155], a[184:187], a[228:231], v[152:155]
  buffer_load_dwordx4 v65, s[16:19], s33 offen lds
  v_mfma_f32_16x16x32_bf16 v[156:159], a[188:191], a[228:231], v[156:159]
  ds_read_b64_tr_b16 a[204:205], v49 offset:49160
  v_mfma_f32_16x16x32_bf16 v[160:163], a[160:163], a[232:235], v[160:163]
  ds_read_b64_tr_b16 a[206:207], v49 offset:51208
  v_mfma_f32_16x16x32_bf16 v[164:167], a[164:167], a[232:235], v[164:167]
  v_mfma_f32_16x16x32_bf16 v[168:171], a[168:171], a[232:235], v[168:171]
  ds_read_b128 v[92:95], v57 offset:28672
  v_mfma_f32_16x16x32_bf16 v[172:175], a[172:175], a[232:235], v[172:175]
  ds_read_b64_tr_b16 a[208:209], v50 offset:49152
  s_add_u32 m0, s26, 16384
  s_add_u32 s33, s30, 262144
  v_mfma_f32_16x16x32_bf16 v[176:179], a[176:179], a[232:235], v[176:179]
  buffer_load_dwordx4 v65, s[16:19], s33 offen lds
  v_mfma_f32_16x16x32_bf16 v[180:183], a[180:183], a[232:235], v[180:183]
  ds_read_b64_tr_b16 a[210:211], v50 offset:51200
  v_mfma_f32_16x16x32_bf16 v[184:187], a[184:187], a[232:235], v[184:187]
  ds_read_b64_tr_b16 a[212:213], v50 offset:49160
  s_add_u32 m0, s26, 20480
  s_add_u32 s33, s30, 327680
  v_mfma_f32_16x16x32_bf16 v[188:191], a[188:191], a[232:235], v[188:191]
  buffer_load_dwordx4 v65, s[16:19], s33 offen lds
  v_mfma_f32_16x16x32_bf16 v[192:195], a[160:163], a[236:239], v[192:195]
  ds_read_b64_tr_b16 a[214:215], v50 offset:51208
  v_mfma_f32_16x16x32_bf16 v[196:199], a[164:167], a[236:239], v[196:199]
  ds_read_b64_tr_b16 a[216:217], v51 offset:49152
  v_mfma_f32_16x16x32_bf16 v[200:203], a[168:171], a[236:239], v[200:203]
  v_mfma_f32_16x16x32_bf16 v[204:207], a[172:175], a[236:239], v[204:207]
  ds_read_b64_tr_b16 a[218:219], v51 offset:51200
  v_mfma_f32_16x16x32_bf16 v[208:211], a[176:179], a[236:239], v[208:211]
  ds_read_b64_tr_b16 a[220:221], v51 offset:49160
  s_add_u32 m0, s26, 24576
  s_add_u32 s33, s30, 393216
  v_mfma_f32_16x16x32_bf16 v[212:215], a[180:183], a[236:239], v[212:215]
  buffer_load_dwordx4 v65, s[16:19], s33 offen lds
  v_mfma_f32_16x16x32_bf16 v[216:219], a[184:187], a[236:239], v[216:219]
  ds_read_b64_tr_b16 a[222:223], v51 offset:51208
  v_mfma_f32_16x16x32_bf16 v[220:223], a[188:191], a[236:239], v[220:223]
  v_mfma_f32_16x16x32_bf16 v[224:227], a[160:163], a[240:243], v[224:227]
  v_mfma_f32_16x16x32_bf16 v[228:231], a[164:167], a[240:243], v[228:231]
  s_add_u32 m0, s26, 28672
  s_add_u32 s33, s30, 458752
  v_mfma_f32_16x16x32_bf16 v[232:235], a[168:171], a[240:243], v[232:235]
  buffer_load_dwordx4 v65, s[16:19], s33 offen lds
  s_add_u32 s29, s29, 128
  s_add_u32 s30, s30, 524288
  s_cmp_eq_u32 s29, 1280
  s_cselect_b32 s29, 0, s29
  s_cselect_b32 s33, 5242880, 0
  s_sub_u32 s30, s30, s33
  v_mfma_f32_16x16x32_bf16 v[236:239], a[172:175], a[240:243], v[236:239]
  v_mfma_f32_16x16x32_bf16 v[240:243], a[176:179], a[240:243], v[240:243]
  v_mfma_f32_16x16x32_bf16 v[244:247], a[180:183], a[240:243], v[244:247]
  v_mfma_f32_16x16x32_bf16 v[248:251], a[184:187], a[240:243], v[248:251]
  v_mfma_f32_16x16x32_bf16 v[252:255], a[188:191], a[240:243], v[252:255]
  s_waitcnt vmcnt(13) lgkmcnt(0)
  s_barrier
  v_mfma_f32_16x16x32_bf16 v[96:99], a[192:195], v[76:79], v[96:99]
  ds_read_b128 a[224:227], v56 offset:40960
  v_mfma_f32_16x16x32_bf16 v[100:103], a[196:199], v[76:79], v[100:103]
  ds_read_b64_tr_b16 a[160:161], v52 offset:0
  s_add_u32 m0, s26, 118784
  v_mfma_f32_16x16x32_bf16 v[104:107], a[200:203], v[76:79], v[104:107]
  buffer_load_dwordx4 v64, s[12:15], s29 offen lds
  v_mfma_f32_16x16x32_bf16 v[108:111], a[204:207], v[76:79], v[108:111]
  ds_read_b64_tr_b16 a[162:163], v52 offset:2048
  v_mfma_f32_16x16x32_bf16 v[112:115], a[208:211], v[76:79], v[112:115]
  ds_read_b128 a[228:231], v56 offset:43008
  v_mfma_f32_16x16x32_bf16 v[116:119], a[212:215], v[76:79], v[116:119]
  v_mfma_f32_16x16x32_bf16 v[120:123], a[216:219], v[76:79], v[120:123]
  ds_read_b64_tr_b16 a[164:165], v52 offset:8
  v_mfma_f32_16x16x32_bf16 v[124:127], a[220:223], v[76:79], v[124:127]
  ds_read_b64_tr_b16 a[166:167], v52 offset:2056
  s_add_u32 m0, s26, 122880
  s_add_u32 s33, s29, 40960
  v_mfma_f32_16x16x32_bf16 v[128:131], a[192:195], v[80:83], v[128:131]
  buffer_load_dwordx4 v64, s[12:15], s33 offen lds
  v_mfma_f32_16x16x32_bf16 v[132:135], a[196:199], v[80:83], v[132:135]
  ds_read_b128 a[232:235], v56 offset:45056
  v_mfma_f32_16x16x32_bf16 v[136:139], a[200:203], v[80:83], v[136:139]
  ds_read_b64_tr_b16 a[168:169], v53 offset:0
  v_mfma_f32_16x16x32_bf16 v[140:143], a[204:207], v[80:83], v[140:143]
  v_mfma_f32_16x16x32_bf16 v[144:147], a[208:211], v[80:83], v[144:147]
  ds_read_b64_tr_b16 a[170:171], v53 offset:2048
  v_mfma_f32_16x16x32_bf16 v[148:151], a[212:215], v[80:83], v[148:151]
  ds_read_b128 a[236:239], v56 offset:47104
  s_add_u32 m0, s26, 126976
  s_add_u32 s33, s29, 81920
  v_mfma_f32_16x16x32_bf16 v[152:155], a[216:219], v[80:83], v[152:155]
  buffer_load_dwordx4 v64, s[12:15], s33 offen lds
  v_mfma_f32_16x16x32_bf16 v[156:159], a[220:223], v[80:83], v[156:159]
  ds_read_b64_tr_b16 a[172:173], v53 offset:8
  v_mfma_f32_16x16x32_bf16 v[160:163], a[192:195], v[84:87], v[160:163]
  ds_read_b64_tr_b16 a[174:175], v53 offset:2056
  v_mfma_f32_16x16x32_bf16 v[164:167], a[196:199], v[84:87], v[164:167]
  v_mfma_f32_16x16x32_bf16 v[168:171], a[200:203], v[84:87], v[168:171]
  ds_read_b128 a[240:243], v56 offset:49152
  v_mfma_f32_16x16x32_bf16 v[172:175], a[204:207], v[84:87], v[172:175]
  ds_read_b64_tr_b16 a[176:177], v54 offset:0
  v_mfma_f32_16x16x32_bf16 v[176:179], a[208:211], v[84:87], v[176:179]
  v_mfma_f32_16x16x32_bf16 v[180:183], a[212:215], v[84:87], v[180:183]
  ds_read_b64_tr_b16 a[178:179], v54 offset:2048
  v_mfma_f32_16x16x32_bf16 v[184:187], a[216:219], v[84:87], v[184:187]
  ds_read_b64_tr_b16 a[180:181], v54 offset:8
  s_add_u32 m0, s26, 131072
  s_add_u32 s33, s29, 122880
  v_mfma_f32_16x16x32_bf16 v[188:191], a[220:223], v[84:87], v[188:191]
  buffer_load_dwordx4 v64, s[12:15], s33 offen lds
  v_mfma_f32_16x16x32_bf16 v[192:195], a[192:195], v[88:91], v[192:195]
  ds_read_b64_tr_b16 a[182:183], v54 offset:2056
  v_mfma_f32_16x16x32_bf16 v[196:199], a[196:199], v[88:91], v[196:199]
  ds_read_b64_tr_b16 a[184:185], v55 offset:0
  v_mfma_f32_16x16x32_bf16 v[200:203], a[200:203], v[88:91], v[200:203]
  v_mfma_f32_16x16x32_bf16 v[204:207], a[204:207], v[88:91], v[204:207]
  ds_read_b64_tr_b16 a[186:187], v55 offset:2048
  v_mfma_f32_16x16x32_bf16 v[208:211], a[208:211], v[88:91], v[208:211]
  ds_read_b64_tr_b16 a[188:189], v55 offset:8
  s_add_u32 m0, s26, 135168
  s_add_u32 s33, s29, 163840
  v_mfma_f32_16x16x32_bf16 v[212:215], a[212:215], v[88:91], v[212:215]
  buffer_load_dwordx4 v64, s[12:15], s33 offen lds
  v_mfma_f32_16x16x32_bf16 v[216:219], a[216:219], v[88:91], v[216:219]
  ds_read_b64_tr_b16 a[190:191], v55 offset:2056
  v_mfma_f32_16x16x32_bf16 v[220:223], a[220:223], v[88:91], v[220:223]
  v_mfma_f32_16x16x32_bf16 v[224:227], a[192:195], v[92:95], v[224:227]
  s_add_u32 m0, s26, 32768
  v_mfma_f32_16x16x32_bf16 v[228:231], a[196:199], v[92:95], v[228:231]
  buffer_load_dwordx4 v65, s[16:19], s30 offen lds
  v_mfma_f32_16x16x32_bf16 v[232:235], a[200:203], v[92:95], v[232:235]
  v_mfma_f32_16x16x32_bf16 v[236:239], a[204:207], v[92:95], v[236:239]
  v_mfma_f32_16x16x32_bf16 v[240:243], a[208:211], v[92:95], v[240:243]
  v_mfma_f32_16x16x32_bf16 v[244:247], a[212:215], v[92:95], v[244:247]
  v_mfma_f32_16x16x32_bf16 v[248:251], a[216:219], v[92:95], v[248:251]
  v_mfma_f32_16x16x32_bf16 v[252:255], a[220:223], v[92:95], v[252:255]
  s_waitcnt lgkmcnt(0)
  v_mfma_f32_16x16x32_bf16 v[96:99], a[160:163], a[224:227], v[96:99]
  ds_read_b128 v[76:79], v57 offset:40960
  v_mfma_f32_16x16x32_bf16 v[100:103], a[164:167], a[224:227], v[100:103]
  ds_read_b64_tr_b16 a[192:193], v52 offset:16384
  s_add_u32 m0, s26, 36864
  s_add_u32 s33, s30, 65536
  v_mfma_f32_16x16x32_bf16 v[104:107], a[168:171], a[224:227], v[104:107]
  buffer_load_dwordx4 v65, s[16:19], s33 offen lds
  v_mfma_f32_16x16x32_bf16 v[108:111], a[172:175], a[224:227], v[108:111]
  ds_read_b64_tr_b16 a[194:195], v52 offset:18432
  v_mfma_f32_16x16x32_bf16 v[112:115], a[176:179], a[224:227], v[112:115]
  ds_read_b128 v[80:83], v57 offset:43008
  v_mfma_f32_16x16x32_bf16 v[116:119], a[180:183], a[224:227], v[116:119]
  v_mfma_f32_16x16x32_bf16 v[120:123], a[184:187], a[224:227], v[120:123]
  ds_read_b64_tr_b16 a[196:197], v52 offset:16392
  v_mfma_f32_16x16x32_bf16 v[124:127], a[188:191], a[224:227], v[124:127]
  ds_read_b64_tr_b16 a[198:199], v52 offset:18440
  s_add_u32 m0, s26, 40960
  s_add_u32 s33, s30, 131072
  v_mfma_f32_16x16x32_bf16 v[128:131], a[160:163], a[228:231], v[128:131]
  buffer_load_dwordx4 v65, s[16:19], s33 offen lds
  v_mfma_f32_16x16x32_bf16 v[132:135], a[164:167], a[228:231], v[132:135]
  ds_read_b128 v[84:87], v57 offset:45056
  v_mfma_f32_16x16x32_bf16 v[136:139], a[168:171], a[228:231], v[136:139]
  ds_read_b64_tr_b16 a[200:201], v53 offset:16384
  v_mfma_f32_16x16x32_bf16 v[140:143], a[172:175], a[228:231], v[140:143]
  v_mfma_f32_16x16x32_bf16 v[144:147], a[176:179], a[228:231], v[144:147]
  ds_read_b64_tr_b16 a[202:203], v53 offset:18432
  v_mfma_f32_16x16x32_bf16 v[148:151], a[180:183], a[228:231], v[148:151]
  ds_read_b128 v[88:91], v57 offset:47104
  s_add_u32 m0, s26, 45056
  s_add_u32 s33, s30, 196608
  v_mfma_f32_16x16x32_bf16 v[152:155], a[184:187], a[228:231], v[152:155]
  buffer_load_dwordx4 v65, s[16:19], s33 offen lds
  v_mfma_f32_16x16x32_bf16 v[156:159], a[188:191], a[228:231], v[156:159]
  ds_read_b64_tr_b16 a[204:205], v53 offset:16392
  v_mfma_f32_16x16x32_bf16 v[160:163], a[160:163], a[232:235], v[160:163]
  ds_read_b64_tr_b16 a[206:207], v53 offset:18440
  v_mfma_f32_16x16x32_bf16 v[164:167], a[164:167], a[232:235], v[164:167]
  v_mfma_f32_16x16x32_bf16 v[168:171], a[168:171], a[232:235], v[168:171]
  ds_read_b128 v[92:95], v57 offset:49152
  v_mfma_f32_16x16x32_bf16 v[172:175], a[172:175], a[232:235], v[172:175]
  ds_read_b64_tr_b16 a[208:209], v54 offset:16384
  s_add_u32 m0, s26, 49152
  s_add_u32 s33, s30, 262144
  v_mfma_f32_16x16x32_bf16 v[176:179], a[176:179], a[232:235], v[176:179]
  buffer_load_dwordx4 v65, s[16:19], s33 offen lds
  v_mfma_f32_16x16x32_bf16 v[180:183], a[180:183], a[232:235], v[180:183]
  ds_read_b64_tr_b16 a[210:211], v54 offset:18432
  v_mfma_f32_16x16x32_bf16 v[184:187], a[184:187], a[232:235], v[184:187]
  ds_read_b64_tr_b16 a[212:213], v54 offset:16392
  s_add_u32 m0, s26, 53248
  s_add_u32 s33, s30, 327680
  v_mfma_f32_16x16x32_bf16 v[188:191], a[188:191], a[232:235], v[188:191]
  buffer_load_dwordx4 v65, s[16:19], s33 offen lds
  v_mfma_f32_16x16x32_bf16 v[192:195], a[160:163], a[236:239], v[192:195]
  ds_read_b64_tr_b16 a[214:215], v54 offset:18440
  v_mfma_f32_16x16x32_bf16 v[196:199], a[164:167], a[236:239], v[196:199]
  ds_read_b64_tr_b16 a[216:217], v55 offset:16384
  v_mfma_f32_16x16x32_bf16 v[200:203], a[168:171], a[236:239], v[200:203]
  v_mfma_f32_16x16x32_bf16 v[204:207], a[172:175], a[236:239], v[204:207]
  ds_read_b64_tr_b16 a[218:219], v55 offset:18432
  v_mfma_f32_16x16x32_bf16 v[208:211], a[176:179], a[236:239], v[208:211]
  ds_read_b64_tr_b16 a[220:221], v55 offset:16392
  s_add_u32 m0, s26, 57344
  s_add_u32 s33, s30, 393216
  v_mfma_f32_16x16x32_bf16 v[212:215], a[180:183], a[236:239], v[212:215]
  buffer_load_dwordx4 v65, s[16:19], s33 offen lds
  v_mfma_f32_16x16x32_bf16 v[216:219], a[184:187], a[236:239], v[216:219]
  ds_read_b64_tr_b16 a[222:223], v55 offset:18440
  v_mfma_f32_16x16x32_bf16 v[220:223], a[188:191], a[236:239], v[220:223]
  v_mfma_f32_16x16x32_bf16 v[224:227], a[160:163], a[240:243], v[224:227]
  v_mfma_f32_16x16x32_bf16 v[228:231], a[164:167], a[240:243], v[228:231]
  s_add_u32 m0, s26, 61440
  s_add_u32 s33, s30, 458752
  v_mfma_f32_16x16x32_bf16 v[232:235], a[168:171], a[240:243], v[232:235]
  buffer_load_dwordx4 v65, s[16:19], s33 offen lds
  s_add_u32 s29, s29, 128
  s_add_u32 s30, s30, 524288
  s_cmp_eq_u32 s29, 1280
  s_cselect_b32 s29, 0, s29
  s_cselect_b32 s33, 5242880, 0
  s_sub_u32 s30, s30, s33
  v_mfma_f32_16x16x32_bf16 v[236:239], a[172:175], a[240:243], v[236:239]
  v_mfma_f32_16x16x32_bf16 v[240:243], a[176:179], a[240:243], v[240:243]
  v_mfma_f32_16x16x32_bf16 v[244:247], a[180:183], a[240:243], v[244:247]
  v_mfma_f32_16x16x32_bf16 v[248:251], a[184:187], a[240:243], v[248:251]
  v_mfma_f32_16x16x32_bf16 v[252:255], a[188:191], a[240:243], v[252:255]
  s_waitcnt vmcnt(13) lgkmcnt(0)
  s_barrier
  v_mfma_f32_16x16x32_bf16 v[96:99], a[192:195], v[76:79], v[96:99]
  ds_read_b128 a[224:227], v56 offset:0
  v_mfma_f32_16x16x32_bf16 v[100:103], a[196:199], v[76:79], v[100:103]
  ds_read_b64_tr_b16 a[160:161], v48 offset:0
  s_add_u32 m0, s26, 139264
  v_mfma_f32_16x16x32_bf16 v[104:107], a[200:203], v[76:79], v[104:107]
  buffer_load_dwordx4 v64, s[12:15], s29 offen lds
  v_mfma_f32_16x16x32_bf16 v[108:111], a[204:207], v[76:79], v[108:111]
  ds_read_b64_tr_b16 a[162:163], v48 offset:2048
  v_mfma_f32_16x16x32_bf16 v[112:115], a[208:211], v[76:79], v[112:115]
  ds_read_b128 a[228:231], v56 offset:2048
  v_mfma_f32_16x16x32_bf16 v[116:119], a[212:215], v[76:79], v[116:119]
  v_mfma_f32_16x16x32_bf16 v[120:123], a[216:219], v[76:79], v[120:123]
  ds_read_b64_tr_b16 a[164:165], v48 offset:8
  v_mfma_f32_16x16x32_bf16 v[124:127], a[220:223], v[76:79], v[124:127]
  ds_read_b64_tr_b16 a[166:167], v48 offset:2056
  s_add_u32 m0, s26, 143360
  s_add_u32 s33, s29, 40960
  v_mfma_f32_16x16x32_bf16 v[128:131], a[192:195], v[80:83], v[128:131]
  buffer_load_dwordx4 v64, s[12:15], s33 offen lds
  v_mfma_f32_16x16x32_bf16 v[132:135], a[196:199], v[80:83], v[132:135]
  ds_read_b128 a[232:235], v56 offset:4096
  v_mfma_f32_16x16x32_bf16 v[136:139], a[200:203], v[80:83], v[136:139]
  ds_read_b64_tr_b16 a[168:169], v49 offset:0
  v_mfma_f32_16x16x32_bf16 v[140:143], a[204:207], v[80:83], v[140:143]
  v_mfma_f32_16x16x32_bf16 v[144:147], a[208:211], v[80:83], v[144:147]
  ds_read_b64_tr_b16 a[170:171], v49 offset:2048
  v_mfma_f32_16x16x32_bf16 v[148:151], a[212:215], v[80:83], v[148:151]
  ds_read_b128 a[236:239], v56 offset:6144
  s_add_u32 m0, s26, 147456
  s_add_u32 s33, s29, 81920
  v_mfma_f32_16x16x32_bf16 v[152:155], a[216:219], v[80:83], v[152:155]
  buffer_load_dwordx4 v64, s[12:15], s33 offen lds
  v_mfma_f32_16x16x32_bf16 v[156:159], a[220:223], v[80:83], v[156:159]
  ds_read_b64_tr_b16 a[172:173], v49 offset:8
  v_mfma_f32_16x16x32_bf16 v[160:163], a[192:195], v[84:87], v[160:163]
  ds_read_b64_tr_b16 a[174:175], v49 offset:2056
  v_mfma_f32_16x16x32_bf16 v[164:167], a[196:199], v[84:87], v[164:167]
  v_mfma_f32_16x16x32_bf16 v[168:171], a[200:203], v[84:87], v[168:171]
  ds_read_b128 a[240:243], v56 offset:8192
  v_mfma_f32_16x16x32_bf16 v[172:175], a[204:207], v[84:87], v[172:175]
  ds_read_b64_tr_b16 a[176:177], v50 offset:0
  v_mfma_f32_16x16x32_bf16 v[176:179], a[208:211], v[84:87], v[176:179]
  v_mfma_f32_16x16x32_bf16 v[180:183], a[212:215], v[84:87], v[180:183]
  ds_read_b64_tr_b16 a[178:179], v50 offset:2048
  v_mfma_f32_16x16x32_bf16 v[184:187], a[216:219], v[84:87], v[184:187]
  ds_read_b64_tr_b16 a[180:181], v50 offset:8
  s_add_u32 m0, s26, 151552
  s_add_u32 s33, s29, 122880
  v_mfma_f32_16x16x32_bf16 v[188:191], a[220:223], v[84:87], v[188:191]
  buffer_load_dwordx4 v64, s[12:15], s33 offen lds
  v_mfma_f32_16x16x32_bf16 v[192:195], a[192:195], v[88:91], v[192:195]
  ds_read_b64_tr_b16 a[182:183], v50 offset:2056
  v_mfma_f32_16x16x32_bf16 v[196:199], a[196:199], v[88:91], v[196:199]
  ds_read_b64_tr_b16 a[184:185], v51 offset:0
  v_mfma_f32_16x16x32_bf16 v[200:203], a[200:203], v[88:91], v[200:203]
  v_mfma_f32_16x16x32_bf16 v[204:207], a[204:207], v[88:91], v[204:207]
  ds_read_b64_tr_b16 a[186:187], v51 offset:2048
  v_mfma_f32_16x16x32_bf16 v[208:211], a[208:211], v[88:91], v[208:211]
  ds_read_b64_tr_b16 a[188:189], v51 offset:8
  s_add_u32 m0, s26, 155648
  s_add_u32 s33, s29, 163840
  v_mfma_f32_16x16x32_bf16 v[212:215], a[212:215], v[88:91], v[212:215]
  buffer_load_dwordx4 v64, s[12:15], s33 offen lds
  v_mfma_f32_16x16x32_bf16 v[216:219], a[216:219], v[88:91], v[216:219]
  ds_read_b64_tr_b16 a[190:191], v51 offset:2056
  v_mfma_f32_16x16x32_bf16 v[220:223], a[220:223], v[88:91], v[220:223]
  v_mfma_f32_16x16x32_bf16 v[224:227], a[192:195], v[92:95], v[224:227]
  s_add_u32 m0, s26, 65536
  v_mfma_f32_16x16x32_bf16 v[228:231], a[196:199], v[92:95], v[228:231]
  buffer_load_dwordx4 v65, s[16:19], s30 offen lds
  v_mfma_f32_16x16x32_bf16 v[232:235], a[200:203], v[92:95], v[232:235]
  v_mfma_f32_16x16x32_bf16 v[236:239], a[204:207], v[92:95], v[236:239]
  v_mfma_f32_16x16x32_bf16 v[240:243], a[208:211], v[92:95], v[240:243]
  v_mfma_f32_16x16x32_bf16 v[244:247], a[212:215], v[92:95], v[244:247]
  v_mfma_f32_16x16x32_bf16 v[248:251], a[216:219], v[92:95], v[248:251]
  v_mfma_f32_16x16x32_bf16 v[252:255], a[220:223], v[92:95], v[252:255]
  s_waitcnt lgkmcnt(0)
  v_mfma_f32_16x16x32_bf16 v[96:99], a[160:163], a[224:227], v[96:99]
  ds_read_b128 v[76:79], v57 offset:0
  v_mfma_f32_16x16x32_bf16 v[100:103], a[164:167], a[224:227], v[100:103]
  ds_read_b64_tr_b16 a[192:193], v48 offset:16384
  s_add_u32 m0, s26, 69632
  s_add_u32 s33, s30, 65536
  v_mfma_f32_16x16x32_bf16 v[104:107], a[168:171], a[224:227], v[104:107]
  buffer_load_dwordx4 v65, s[16:19], s33 offen lds
  v_mfma_f32_16x16x32_bf16 v[108:111], a[172:175], a[224:227], v[108:111]
  ds_read_b64_tr_b16 a[194:195], v48 offset:18432
  v_mfma_f32_16x16x32_bf16 v[112:115], a[176:179], a[224:227], v[112:115]
  ds_read_b128 v[80:83], v57 offset:2048
  v_mfma_f32_16x16x32_bf16 v[116:119], a[180:183], a[224:227], v[116:119]
  v_mfma_f32_16x16x32_bf16 v[120:123], a[184:187], a[224:227], v[120:123]
  ds_read_b64_tr_b16 a[196:197], v48 offset:16392
  v_mfma_f32_16x16x32_bf16 v[124:127], a[188:191], a[224:227], v[124:127]
  ds_read_b64_tr_b16 a[198:199], v48 offset:18440
  s_add_u32 m0, s26, 73728
  s_add_u32 s33, s30, 131072
  v_mfma_f32_16x16x32_bf16 v[128:131], a[160:163], a[228:231], v[128:131]
  buffer_load_dwordx4 v65, s[16:19], s33 offen lds
  v_mfma_f32_16x16x32_bf16 v[132:135], a[164:167], a[228:231], v[132:135]
  ds_read_b128 v[84:87], v57 offset:4096
  v_mfma_f32_16x16x32_bf16 v[136:139], a[168:171], a[228:231], v[136:139]
  ds_read_b64_tr_b16 a[200:201], v49 offset:16384
  v_mfma_f32_16x16x32_bf16 v[140:143], a[172:175], a[228:231], v[140:143]
  v_mfma_f32_16x16x32_bf16 v[144:147], a[176:179], a[228:231], v[144:147]
  ds_read_b64_tr_b16 a[202:203], v49 offset:18432
  v_mfma_f32_16x16x32_bf16 v[148:151], a[180:183], a[228:231], v[148:151]
  ds_read_b128 v[88:91], v57 offset:6144
  s_add_u32 m0, s26, 77824
  s_add_u32 s33, s30, 196608
  v_mfma_f32_16x16x32_bf16 v[152:155], a[184:187], a[228:231], v[152:155]
  buffer_load_dwordx4 v65, s[16:19], s33 offen lds
  v_mfma_f32_16x16x32_bf16 v[156:159], a[188:191], a[228:231], v[156:159]
  ds_read_b64_tr_b16 a[204:205], v49 offset:16392
  v_mfma_f32_16x16x32_bf16 v[160:163], a[160:163], a[232:235], v[160:163]
  ds_read_b64_tr_b16 a[206:207], v49 offset:18440
  v_mfma_f32_16x16x32_bf16 v[164:167], a[164:167], a[232:235], v[164:167]
  v_mfma_f32_16x16x32_bf16 v[168:171], a[168:171], a[232:235], v[168:171]
  ds_read_b128 v[92:95], v57 offset:8192
  v_mfma_f32_16x16x32_bf16 v[172:175], a[172:175], a[232:235], v[172:175]
  ds_read_b64_tr_b16 a[208:209], v50 offset:16384
  s_add_u32 m0, s26, 81920
  s_add_u32 s33, s30, 262144
  v_mfma_f32_16x16x32_bf16 v[176:179], a[176:179], a[232:235], v[176:179]
  buffer_load_dwordx4 v65, s[16:19], s33 offen lds
  v_mfma_f32_16x16x32_bf16 v[180:183], a[180:183], a[232:235], v[180:183]
  ds_read_b64_tr_b16 a[210:211], v50 offset:18432
  v_mfma_f32_16x16x32_bf16 v[184:187], a[184:187], a[232:235], v[184:187]
  ds_read_b64_tr_b16 a[212:213], v50 offset:16392
  s_add_u32 m0, s26, 86016
  s_add_u32 s33, s30, 327680
  v_mfma_f32_16x16x32_bf16 v[188:191], a[188:191], a[232:235], v[188:191]
  buffer_load_dwordx4 v65, s[16:19], s33 offen lds
  v_mfma_f32_16x16x32_bf16 v[192:195], a[160:163], a[236:239], v[192:195]
  ds_read_b64_tr_b16 a[214:215], v50 offset:18440
  v_mfma_f32_16x16x32_bf16 v[196:199], a[164:167], a[236:239], v[196:199]
  ds_read_b64_tr_b16 a[216:217], v51 offset:16384
  v_mfma_f32_16x16x32_bf16 v[200:203], a[168:171], a[236:239], v[200:203]
  v_mfma_f32_16x16x32_bf16 v[204:207], a[172:175], a[236:239], v[204:207]
  ds_read_b64_tr_b16 a[218:219], v51 offset:18432
  v_mfma_f32_16x16x32_bf16 v[208:211], a[176:179], a[236:239], v[208:211]
  ds_read_b64_tr_b16 a[220:221], v51 offset:16392
  s_add_u32 m0, s26, 90112
  s_add_u32 s33, s30, 393216
  v_mfma_f32_16x16x32_bf16 v[212:215], a[180:183], a[236:239], v[212:215]
  buffer_load_dwordx4 v65, s[16:19], s33 offen lds
  v_mfma_f32_16x16x32_bf16 v[216:219], a[184:187], a[236:239], v[216:219]
  ds_read_b64_tr_b16 a[222:223], v51 offset:18440
  v_mfma_f32_16x16x32_bf16 v[220:223], a[188:191], a[236:239], v[220:223]
  v_mfma_f32_16x16x32_bf16 v[224:227], a[160:163], a[240:243], v[224:227]
  v_mfma_f32_16x16x32_bf16 v[228:231], a[164:167], a[240:243], v[228:231]
  s_add_u32 m0, s26, 94208
  s_add_u32 s33, s30, 458752
  v_mfma_f32_16x16x32_bf16 v[232:235], a[168:171], a[240:243], v[232:235]
  buffer_load_dwordx4 v65, s[16:19], s33 offen lds
  s_add_u32 s29, s29, 128
  s_add_u32 s30, s30, 524288
  s_cmp_eq_u32 s29, 1280
  s_cselect_b32 s29, 0, s29
  s_cselect_b32 s33, 5242880, 0
  s_sub_u32 s30, s30, s33
  v_mfma_f32_16x16x32_bf16 v[236:239], a[172:175], a[240:243], v[236:239]
  v_mfma_f32_16x16x32_bf16 v[240:243], a[176:179], a[240:243], v[240:243]
  v_mfma_f32_16x16x32_bf16 v[244:247], a[180:183], a[240:243], v[244:247]
  v_mfma_f32_16x16x32_bf16 v[248:251], a[184:187], a[240:243], v[248:251]
  v_mfma_f32_16x16x32_bf16 v[252:255], a[188:191], a[240:243], v[252:255]
  s_waitcnt vmcnt(13) lgkmcnt(0)
  s_barrier
  v_mfma_f32_16x16x32_bf16 v[96:99], a[192:195], v[76:79], v[96:99]
  ds_read_b128 a[224:227], v56 offset:20480
  v_mfma_f32_16x16x32_bf16 v[100:103], a[196:199], v[76:79], v[100:103]
  ds_read_b64_tr_b16 a[160:161], v48 offset:32768
  s_add_u32 m0, s26, 98304
  v_mfma_f32_16x16x32_bf16 v[104:107], a[200:203], v[76:79], v[104:107]
  buffer_load_dwordx4 v64, s[12:15], s29 offen lds
  v_mfma_f32_16x16x32_bf16 v[108:111], a[204:207], v[76:79], v[108:111]
  ds_read_b64_tr_b16 a[162:163], v48 offset:34816
  v_mfma_f32_16x16x32_bf16 v[112:115], a[208:211], v[76:79], v[112:115]
  ds_read_b128 a[228:231], v56 offset:22528
  v_mfma_f32_16x16x32_bf16 v[116:119], a[212:215], v[76:79], v[116:119]
  v_mfma_f32_16x16x32_bf16 v[120:123], a[216:219], v[76:79], v[120:123]
  ds_read_b64_tr_b16 a[164:165], v48 offset:32776
  v_mfma_f32_16x16x32_bf16 v[124:127], a[220:223], v[76:79], v[124:127]
  ds_read_b64_tr_b16 a[166:167], v48 offset:34824
  s_add_u32 m0, s26, 102400
  s_add_u32 s33, s29, 40960
  v_mfma_f32_16x16x32_bf16 v[128:131], a[192:195], v[80:83], v[128:131]
  buffer_load_dwordx4 v64, s[12:15], s33 offen lds
  v_mfma_f32_16x16x32_bf16 v[132:135], a[196:199], v[80:83], v[132:135]
  ds_read_b128 a[232:235], v56 offset:24576
  v_mfma_f32_16x16x32_bf16 v[136:139], a[200:203], v[80:83], v[136:139]
  ds_read_b64_tr_b16 a[168:169], v49 offset:32768
  v_mfma_f32_16x16x32_bf16 v[140:143], a[204:207], v[80:83], v[140:143]
  v_mfma_f32_16x16x32_bf16 v[144:147], a[208:211], v[80:83], v[144:147]
  ds_read_b64_tr_b16 a[170:171], v49 offset:34816
  v_mfma_f32_16x16x32_bf16 v[148:151], a[212:215], v[80:83], v[148:151]
  ds_read_b128 a[236:239], v56 offset:26624
  s_add_u32 m0, s26, 106496
  s_add_u32 s33, s29, 81920
  v_mfma_f32_16x16x32_bf16 v[152:155], a[216:219], v[80:83], v[152:155]
  buffer_load_dwordx4 v64, s[12:15], s33 offen lds
  v_mfma_f32_16x16x32_bf16 v[156:159], a[220:223], v[80:83], v[156:159]
  ds_read_b64_tr_b16 a[172:173], v49 offset:32776
  v_mfma_f32_16x16x32_bf16 v[160:163], a[192:195], v[84:87], v[160:163]
  ds_read_b64_tr_b16 a[174:175], v49 offset:34824
  v_mfma_f32_16x16x32_bf16 v[164:167], a[196:199], v[84:87], v[164:167]
  v_mfma_f32_16x16x32_bf16 v[168:171], a[200:203], v[84:87], v[168:171]
  ds_read_b128 a[240:243], v56 offset:28672
  v_mfma_f32_16x16x32_bf16 v[172:175], a[204:207], v[84:87], v[172:175]
  ds_read_b64_tr_b16 a[176:177], v50 offset:32768
  v_mfma_f32_16x16x32_bf16 v[176:179], a[208:211], v[84:87], v[176:179]
  v_mfma_f32_16x16x32_bf16 v[180:183], a[212:215], v[84:87], v[180:183]
  ds_read_b64_tr_b16 a[178:179], v50 offset:34816
  v_mfma_f32_16x16x32_bf16 v[184:187], a[216:219], v[84:87], v[184:187]
  ds_read_b64_tr_b16 a[180:181], v50 offset:32776
  s_add_u32 m0, s26, 110592
  s_add_u32 s33, s29, 122880
  v_mfma_f32_16x16x32_bf16 v[188:191], a[220:223], v[84:87], v[188:191]
  buffer_load_dwordx4 v64, s[12:15], s33 offen lds
  v_mfma_f32_16x16x32_bf16 v[192:195], a[192:195], v[88:91], v[192:195]
  ds_read_b64_tr_b16 a[182:183], v50 offset:34824
  v_mfma_f32_16x16x32_bf16 v[196:199], a[196:199], v[88:91], v[196:199]
  ds_read_b64_tr_b16 a[184:185], v51 offset:32768
  v_mfma_f32_16x16x32_bf16 v[200:203], a[200:203], v[88:91], v[200:203]
  v_mfma_f32_16x16x32_bf16 v[204:207], a[204:207], v[88:91], v[204:207]
  ds_read_b64_tr_b16 a[186:187], v51 offset:34816
  v_mfma_f32_16x16x32_bf16 v[208:211], a[208:211], v[88:91], v[208:211]
  ds_read_b64_tr_b16 a[188:189], v51 offset:32776
  s_add_u32 m0, s26, 114688
  s_add_u32 s33, s29, 163840
  v_mfma_f32_16x16x32_bf16 v[212:215], a[212:215], v[88:91], v[212:215]
  buffer_load_dwordx4 v64, s[12:15], s33 offen lds
  v_mfma_f32_16x16x32_bf16 v[216:219], a[216:219], v[88:91], v[216:219]
  ds_read_b64_tr_b16 a[190:191], v51 offset:34824
  v_mfma_f32_16x16x32_bf16 v[220:223], a[220:223], v[88:91], v[220:223]
  v_mfma_f32_16x16x32_bf16 v[224:227], a[192:195], v[92:95], v[224:227]
  s_add_u32 m0, s26, 0
  v_mfma_f32_16x16x32_bf16 v[228:231], a[196:199], v[92:95], v[228:231]
  buffer_load_dwordx4 v65, s[16:19], s30 offen lds
  v_mfma_f32_16x16x32_bf16 v[232:235], a[200:203], v[92:95], v[232:235]
  v_mfma_f32_16x16x32_bf16 v[236:239], a[204:207], v[92:95], v[236:239]
  v_mfma_f32_16x16x32_bf16 v[240:243], a[208:211], v[92:95], v[240:243]
  v_mfma_f32_16x16x32_bf16 v[244:247], a[212:215], v[92:95], v[244:247]
  v_mfma_f32_16x16x32_bf16 v[248:251], a[216:219], v[92:95], v[248:251]
  v_mfma_f32_16x16x32_bf16 v[252:255], a[220:223], v[92:95], v[252:255]
  s_waitcnt lgkmcnt(0)
  v_mfma_f32_16x16x32_bf16 v[96:99], a[160:163], a[224:227], v[96:99]
  ds_read_b128 v[76:79], v57 offset:20480
  v_mfma_f32_16x16x32_bf16 v[100:103], a[164:167], a[224:227], v[100:103]
  ds_read_b64_tr_b16 a[192:193], v48 offset:49152
  s_add_u32 m0, s26, 4096
  s_add_u32 s33, s30, 65536
  v_mfma_f32_16x16x32_bf16 v[104:107], a[168:171], a[224:227], v[104:107]
  buffer_load_dwordx4 v65, s[16:19], s33 offen lds
  v_mfma_f32_16x16x32_bf16 v[108:111], a[172:175], a[224:227], v[108:111]
  ds_read_b64_tr_b16 a[194:195], v48 offset:51200
  v_mfma_f32_16x16x32_bf16 v[112:115], a[176:179], a[224:227], v[112:115]
  ds_read_b128 v[80:83], v57 offset:22528
  v_mfma_f32_16x16x32_bf16 v[116:119], a[180:183], a[224:227], v[116:119]
  v_mfma_f32_16x16x32_bf16 v[120:123], a[184:187], a[224:227], v[120:123]
  ds_read_b64_tr_b16 a[196:197], v48 offset:49160
  v_mfma_f32_16x16x32_bf16 v[124:127], a[188:191], a[224:227], v[124:127]
  ds_read_b64_tr_b16 a[198:199], v48 offset:51208
  s_add_u32 m0, s26, 8192
  s_add_u32 s33, s30, 131072
  v_mfma_f32_16x16x32_bf16 v[128:131], a[160:163], a[228:231], v[128:131]
  buffer_load_dwordx4 v65, s[16:19], s33 offen lds
  v_mfma_f32_16x16x32_bf16 v[132:135], a[164:167], a[228:231], v[132:135]
  ds_read_b128 v[84:87], v57 offset:24576
  v_mfma_f32_16x16x32_bf16 v[136:139], a[168:171], a[228:231], v[136:139]
  ds_read_b64_tr_b16 a[200:201], v49 offset:49152
  v_mfma_f32_16x16x32_bf16 v[140:143], a[172:175], a[228:231], v[140:143]
  v_mfma_f32_16x16x32_bf16 v[144:147], a[176:179], a[228:231], v[144:147]
  ds_read_b64_tr_b16 a[202:203], v49 offset:51200
  v_mfma_f32_16x16x32_bf16 v[148:151], a[180:183], a[228:231], v[148:151]
  ds_read_b128 v[88:91], v57 offset:26624
  s_add_u32 m0, s26, 12288
  s_add_u32 s33, s30, 196608
  v_mfma_f32_16x16x32_bf16 v[152:155], a[184:187], a[228:231], v[152:155]
  buffer_load_dwordx4 v65, s[16:19], s33 offen lds
  v_mfma_f32_16x16x32_bf16 v[156:159], a[188:191], a[228:231], v[156:159]
  ds_read_b64_tr_b16 a[204:205], v49 offset:49160
  v_mfma_f32_16x16x32_bf16 v[160:163], a[160:163], a[232:235], v[160:163]
  ds_read_b64_tr_b16 a[206:207], v49 offset:51208
  v_mfma_f32_16x16x32_bf16 v[164:167], a[164:167], a[232:235], v[164:167]
  v_mfma_f32_16x16x32_bf16 v[168:171], a[168:171], a[232:235], v[168:171]
  ds_read_b128 v[92:95], v57 offset:28672
  v_mfma_f32_16x16x32_bf16 v[172:175], a[172:175], a[232:235], v[172:175]
  ds_read_b64_tr_b16 a[208:209], v50 offset:49152
  s_add_u32 m0, s26, 16384
  s_add_u32 s33, s30, 262144
  v_mfma_f32_16x16x32_bf16 v[176:179], a[176:179], a[232:235], v[176:179]
  buffer_load_dwordx4 v65, s[16:19], s33 offen lds
  v_mfma_f32_16x16x32_bf16 v[180:183], a[180:183], a[232:235], v[180:183]
  ds_read_b64_tr_b16 a[210:211], v50 offset:51200
  v_mfma_f32_16x16x32_bf16 v[184:187], a[184:187], a[232:235], v[184:187]
  ds_read_b64_tr_b16 a[212:213], v50 offset:49160
  s_add_u32 m0, s26, 20480
  s_add_u32 s33, s30, 327680
  v_mfma_f32_16x16x32_bf16 v[188:191], a[188:191], a[232:235], v[188:191]
  buffer_load_dwordx4 v65, s[16:19], s33 offen lds
  v_mfma_f32_16x16x32_bf16 v[192:195], a[160:163], a[236:239], v[192:195]
  ds_read_b64_tr_b16 a[214:215], v50 offset:51208
  v_mfma_f32_16x16x32_bf16 v[196:199], a[164:167], a[236:239], v[196:199]
  ds_read_b64_tr_b16 a[216:217], v51 offset:49152
  v_mfma_f32_16x16x32_bf16 v[200:203], a[168:171], a[236:239], v[200:203]
  v_mfma_f32_16x16x32_bf16 v[204:207], a[172:175], a[236:239], v[204:207]
  ds_read_b64_tr_b16 a[218:219], v51 offset:51200
  v_mfma_f32_16x16x32_bf16 v[208:211], a[176:179], a[236:239], v[208:211]
  ds_read_b64_tr_b16 a[220:221], v51 offset:49160
  s_add_u32 m0, s26, 24576
  s_add_u32 s33, s30, 393216
  v_mfma_f32_16x16x32_bf16 v[212:215], a[180:183], a[236:239], v[212:215]
  buffer_load_dwordx4 v65, s[16:19], s33 offen lds
  v_mfma_f32_16x16x32_bf16 v[216:219], a[184:187], a[236:239], v[216:219]
  ds_read_b64_tr_b16 a[222:223], v51 offset:51208
  v_mfma_f32_16x16x32_bf16 v[220:223], a[188:191], a[236:239], v[220:223]
  v_mfma_f32_16x16x32_bf16 v[224:227], a[160:163], a[240:243], v[224:227]
  v_mfma_f32_16x16x32_bf16 v[228:231], a[164:167], a[240:243], v[228:231]
  s_add_u32 m0, s26, 28672
  s_add_u32 s33, s30, 458752
  v_mfma_f32_16x16x32_bf16 v[232:235], a[168:171], a[240:243], v[232:235]
  buffer_load_dwordx4 v65, s[16:19], s33 offen lds
  s_add_u32 s29, s29, 128
  s_add_u32 s30, s30, 524288
  s_cmp_eq_u32 s29, 1280
  s_cselect_b32 s29, 0, s29
  s_cselect_b32 s33, 5242880, 0
  s_sub_u32 s30, s30, s33
  v_mfma_f32_16x16x32_bf16 v[236:239], a[172:175], a[240:243], v[236:239]
  v_mfma_f32_16x16x32_bf16 v[240:243], a[176:179], a[240:243], v[240:243]
  v_mfma_f32_16x16x32_bf16 v[244:247], a[180:183], a[240:243], v[244:247]
  v_mfma_f32_16x16x32_bf16 v[248:251], a[184:187], a[240:243], v[248:251]
  v_mfma_f32_16x16x32_bf16 v[252:255], a[188:191], a[240:243], v[252:255]
  s_waitcnt vmcnt(13) lgkmcnt(0)
  s_barrier
  v_mfma_f32_16x16x32_bf16 v[96:99], a[192:195], v[76:79], v[96:99]
  ds_read_b128 a[224:227], v56 offset:40960
  v_mfma_f32_16x16x32_bf16 v[100:103], a[196:199], v[76:79], v[100:103]
  ds_read_b64_tr_b16 a[160:161], v52 offset:0
  s_add_u32 m0, s26, 118784
  v_mfma_f32_16x16x32_bf16 v[104:107], a[200:203], v[76:79], v[104:107]
  buffer_load_dwordx4 v64, s[12:15], s29 offen lds
  v_mfma_f32_16x16x32_bf16 v[108:111], a[204:207], v[76:79], v[108:111]
  ds_read_b64_tr_b16 a[162:163], v52 offset:2048
  v_mfma_f32_16x16x32_bf16 v[112:115], a[208:211], v[76:79], v[112:115]
  ds_read_b128 a[228:231], v56 offset:43008
  v_mfma_f32_16x16x32_bf16 v[116:119], a[212:215], v[76:79], v[116:119]
  v_mfma_f32_16x16x32_bf16 v[120:123], a[216:219], v[76:79], v[120:123]
  ds_read_b64_tr_b16 a[164:165], v52 offset:8
  v_mfma_f32_16x16x32_bf16 v[124:127], a[220:223], v[76:79], v[124:127]
  ds_read_b64_tr_b16 a[166:167], v52 offset:2056
  s_add_u32 m0, s26, 122880
  s_add_u32 s33, s29, 40960
  v_mfma_f32_16x16x32_bf16 v[128:131], a[192:195], v[80:83], v[128:131]
  buffer_load_dwordx4 v64, s[12:15], s33 offen lds
  v_mfma_f32_16x16x32_bf16 v[132:135], a[196:199], v[80:83], v[132:135]
  ds_read_b128 a[232:235], v56 offset:45056
  v_mfma_f32_16x16x32_bf16 v[136:139], a[200:203], v[80:83], v[136:139]
  ds_read_b64_tr_b16 a[168:169], v53 offset:0
  v_mfma_f32_16x16x32_bf16 v[140:143], a[204:207], v[80:83], v[140:143]
  v_mfma_f32_16x16x32_bf16 v[144:147], a[208:211], v[80:83], v[144:147]
  ds_read_b64_tr_b16 a[170:171], v53 offset:2048
  v_mfma_f32_16x16x32_bf16 v[148:151], a[212:215], v[80:83], v[148:151]
  ds_read_b128 a[236:239], v56 offset:47104
  s_add_u32 m0, s26, 126976
  s_add_u32 s33, s29, 81920
  v_mfma_f32_16x16x32_bf16 v[152:155], a[216:219], v[80:83], v[152:155]
  buffer_load_dwordx4 v64, s[12:15], s33 offen lds
  v_mfma_f32_16x16x32_bf16 v[156:159], a[220:223], v[80:83], v[156:159]
  ds_read_b64_tr_b16 a[172:173], v53 offset:8
  v_mfma_f32_16x16x32_bf16 v[160:163], a[192:195], v[84:87], v[160:163]
  ds_read_b64_tr_b16 a[174:175], v53 offset:2056
  v_mfma_f32_16x16x32_bf16 v[164:167], a[196:199], v[84:87], v[164:167]
  v_mfma_f32_16x16x32_bf16 v[168:171], a[200:203], v[84:87], v[168:171]
  ds_read_b128 a[240:243], v56 offset:49152
  v_mfma_f32_16x16x32_bf16 v[172:175], a[204:207], v[84:87], v[172:175]
  ds_read_b64_tr_b16 a[176:177], v54 offset:0
  v_mfma_f32_16x16x32_bf16 v[176:179], a[208:211], v[84:87], v[176:179]
  v_mfma_f32_16x16x32_bf16 v[180:183], a[212:215], v[84:87], v[180:183]
  ds_read_b64_tr_b16 a[178:179], v54 offset:2048
  v_mfma_f32_16x16x32_bf16 v[184:187], a[216:219], v[84:87], v[184:187]
  ds_read_b64_tr_b16 a[180:181], v54 offset:8
  s_add_u32 m0, s26, 131072
  s_add_u32 s33, s29, 122880
  v_mfma_f32_16x16x32_bf16 v[188:191], a[220:223], v[84:87], v[188:191]
  buffer_load_dwordx4 v64, s[12:15], s33 offen lds
  v_mfma_f32_16x16x32_bf16 v[192:195], a[192:195], v[88:91], v[192:195]
  ds_read_b64_tr_b16 a[182:183], v54 offset:2056
  v_mfma_f32_16x16x32_bf16 v[196:199], a[196:199], v[88:91], v[196:199]
  ds_read_b64_tr_b16 a[184:185], v55 offset:0
  v_mfma_f32_16x16x32_bf16 v[200:203], a[200:203], v[88:91], v[200:203]
  v_mfma_f32_16x16x32_bf16 v[204:207], a[204:207], v[88:91], v[204:207]
  ds_read_b64_tr_b16 a[186:187], v55 offset:2048
  v_mfma_f32_16x16x32_bf16 v[208:211], a[208:211], v[88:91], v[208:211]
  ds_read_b64_tr_b16 a[188:189], v55 offset:8
  s_add_u32 m0, s26, 135168
  s_add_u32 s33, s29, 163840
  v_mfma_f32_16x16x32_bf16 v[212:215], a[212:215], v[88:91], v[212:215]
  buffer_load_dwordx4 v64, s[12:15], s33 offen lds
  v_mfma_f32_16x16x32_bf16 v[216:219], a[216:219], v[88:91], v[216:219]
  ds_read_b64_tr_b16 a[190:191], v55 offset:2056
  v_mfma_f32_16x16x32_bf16 v[220:223], a[220:223], v[88:91], v[220:223]
  v_mfma_f32_16x16x32_bf16 v[224:227], a[192:195], v[92:95], v[224:227]
  s_add_u32 m0, s26, 32768
  v_mfma_f32_16x16x32_bf16 v[228:231], a[196:199], v[92:95], v[228:231]
  buffer_load_dwordx4 v65, s[16:19], s30 offen lds
  v_mfma_f32_16x16x32_bf16 v[232:235], a[200:203], v[92:95], v[232:235]
  v_mfma_f32_16x16x32_bf16 v[236:239], a[204:207], v[92:95], v[236:239]
  v_mfma_f32_16x16x32_bf16 v[240:243], a[208:211], v[92:95], v[240:243]
  v_mfma_f32_16x16x32_bf16 v[244:247], a[212:215], v[92:95], v[244:247]
  v_mfma_f32_16x16x32_bf16 v[248:251], a[216:219], v[92:95], v[248:251]
  v_mfma_f32_16x16x32_bf16 v[252:255], a[220:223], v[92:95], v[252:255]
  s_waitcnt lgkmcnt(0)
  v_mfma_f32_16x16x32_bf16 v[96:99], a[160:163], a[224:227], v[96:99]
  ds_read_b128 v[76:79], v57 offset:40960
  v_mfma_f32_16x16x32_bf16 v[100:103], a[164:167], a[224:227], v[100:103]
  ds_read_b64_tr_b16 a[192:193], v52 offset:16384
  s_add_u32 m0, s26, 36864
  s_add_u32 s33, s30, 65536
  v_mfma_f32_16x16x32_bf16 v[104:107], a[168:171], a[224:227], v[104:107]
  buffer_load_dwordx4 v65, s[16:19], s33 offen lds
  v_mfma_f32_16x16x32_bf16 v[108:111], a[172:175], a[224:227], v[108:111]
  ds_read_b64_tr_b16 a[194:195], v52 offset:18432
  v_mfma_f32_16x16x32_bf16 v[112:115], a[176:179], a[224:227], v[112:115]
  ds_read_b128 v[80:83], v57 offset:43008
  v_mfma_f32_16x16x32_bf16 v[116:119], a[180:183], a[224:227], v[116:119]
  v_mfma_f32_16x16x32_bf16 v[120:123], a[184:187], a[224:227], v[120:123]
  ds_read_b64_tr_b16 a[196:197], v52 offset:16392
  v_mfma_f32_16x16x32_bf16 v[124:127], a[188:191], a[224:227], v[124:127]
  ds_read_b64_tr_b16 a[198:199], v52 offset:18440
  s_add_u32 m0, s26, 40960
  s_add_u32 s33, s30, 131072
  v_mfma_f32_16x16x32_bf16 v[128:131], a[160:163], a[228:231], v[128:131]
  buffer_load_dwordx4 v65, s[16:19], s33 offen lds
  v_mfma_f32_16x16x32_bf16 v[132:135], a[164:167], a[228:231], v[132:135]
  ds_read_b128 v[84:87], v57 offset:45056
  v_mfma_f32_16x16x32_bf16 v[136:139], a[168:171], a[228:231], v[136:139]
  ds_read_b64_tr_b16 a[200:201], v53 offset:16384
  v_mfma_f32_16x16x32_bf16 v[140:143], a[172:175], a[228:231], v[140:143]
  v_mfma_f32_16x16x32_bf16 v[144:147], a[176:179], a[228:231], v[144:147]
  ds_read_b64_tr_b16 a[202:203], v53 offset:18432
  v_mfma_f32_16x16x32_bf16 v[148:151], a[180:183], a[228:231], v[148:151]
  ds_read_b128 v[88:91], v57 offset:47104
  s_add_u32 m0, s26, 45056
  s_add_u32 s33, s30, 196608
  v_mfma_f32_16x16x32_bf16 v[152:155], a[184:187], a[228:231], v[152:155]
  buffer_load_dwordx4 v65, s[16:19], s33 offen lds
  v_mfma_f32_16x16x32_bf16 v[156:159], a[188:191], a[228:231], v[156:159]
  ds_read_b64_tr_b16 a[204:205], v53 offset:16392
  v_mfma_f32_16x16x32_bf16 v[160:163], a[160:163], a[232:235], v[160:163]
  ds_read_b64_tr_b16 a[206:207], v53 offset:18440
  v_mfma_f32_16x16x32_bf16 v[164:167], a[164:167], a[232:235], v[164:167]
  v_mfma_f32_16x16x32_bf16 v[168:171], a[168:171], a[232:235], v[168:171]
  ds_read_b128 v[92:95], v57 offset:49152
  v_mfma_f32_16x16x32_bf16 v[172:175], a[172:175], a[232:235], v[172:175]
  ds_read_b64_tr_b16 a[208:209], v54 offset:16384
  s_add_u32 m0, s26, 49152
  s_add_u32 s33, s30, 262144
  v_mfma_f32_16x16x32_bf16 v[176:179], a[176:179], a[232:235], v[176:179]
  buffer_load_dwordx4 v65, s[16:19], s33 offen lds
  v_mfma_f32_16x16x32_bf16 v[180:183], a[180:183], a[232:235], v[180:183]
  ds_read_b64_tr_b16 a[210:211], v54 offset:18432
  v_mfma_f32_16x16x32_bf16 v[184:187], a[184:187], a[232:235], v[184:187]
  ds_read_b64_tr_b16 a[212:213], v54 offset:16392
  s_add_u32 m0, s26, 53248
  s_add_u32 s33, s30, 327680
  v_mfma_f32_16x16x32_bf16 v[188:191], a[188:191], a[232:235], v[188:191]
  buffer_load_dwordx4 v65, s[16:19], s33 offen lds
  v_mfma_f32_16x16x32_bf16 v[192:195], a[160:163], a[236:239], v[192:195]
  ds_read_b64_tr_b16 a[214:215], v54 offset:18440
  v_mfma_f32_16x16x32_bf16 v[196:199], a[164:167], a[236:239], v[196:199]
  ds_read_b64_tr_b16 a[216:217], v55 offset:16384
  v_mfma_f32_16x16x32_bf16 v[200:203], a[168:171], a[236:239], v[200:203]
  v_mfma_f32_16x16x32_bf16 v[204:207], a[172:175], a[236:239], v[204:207]
  ds_read_b64_tr_b16 a[218:219], v55 offset:18432
  v_mfma_f32_16x16x32_bf16 v[208:211], a[176:179], a[236:239], v[208:211]
  ds_read_b64_tr_b16 a[220:221], v55 offset:16392
  s_add_u32 m0, s26, 57344
  s_add_u32 s33, s30, 393216
  v_mfma_f32_16x16x32_bf16 v[212:215], a[180:183], a[236:239], v[212:215]
  buffer_load_dwordx4 v65, s[16:19], s33 offen lds
  v_mfma_f32_16x16x32_bf16 v[216:219], a[184:187], a[236:239], v[216:219]
  ds_read_b64_tr_b16 a[222:223], v55 offset:18440
  v_mfma_f32_16x16x32_bf16 v[220:223], a[188:191], a[236:239], v[220:223]
  v_mfma_f32_16x16x32_bf16 v[224:227], a[160:163], a[240:243], v[224:227]
  v_mfma_f32_16x16x32_bf16 v[228:231], a[164:167], a[240:243], v[228:231]
  s_add_u32 m0, s26, 61440
  s_add_u32 s33, s30, 458752
  v_mfma_f32_16x16x32_bf16 v[232:235], a[168:171], a[240:243], v[232:235]
  buffer_load_dwordx4 v65, s[16:19], s33 offen lds
  s_add_u32 s29, s29, 128
  s_add_u32 s30, s30, 524288
  s_cmp_eq_u32 s29, 1280
  s_cselect_b32 s29, 0, s29
  s_cselect_b32 s33, 5242880, 0
  s_sub_u32 s30, s30, s33
  v_mfma_f32_16x16x32_bf16 v[236:239], a[172:175], a[240:243], v[236:239]
  v_mfma_f32_16x16x32_bf16 v[240:243], a[176:179], a[240:243], v[240:243]
  v_mfma_f32_16x16x32_bf16 v[244:247], a[180:183], a[240:243], v[244:247]
  v_mfma_f32_16x16x32_bf16 v[248:251], a[184:187], a[240:243], v[248:251]
  v_mfma_f32_16x16x32_bf16 v[252:255], a[188:191], a[240:243], v[252:255]
  s_waitcnt vmcnt(13) lgkmcnt(0)
  s_barrier
  v_mfma_f32_16x16x32_bf16 v[96:99], a[192:195], v[76:79], v[96:99]
  ds_read_b128 a[224:227], v56 offset:0
  v_mfma_f32_16x16x32_bf16 v[100:103], a[196:199], v[76:79], v[100:103]
  ds_read_b64_tr_b16 a[160:161], v48 offset:0
  s_add_u32 m0, s26, 139264
  v_mfma_f32_16x16x32_bf16 v[104:107], a[200:203], v[76:79], v[104:107]
  buffer_load_dwordx4 v64, s[12:15], s29 offen lds
  v_mfma_f32_16x16x32_bf16 v[108:111], a[204:207], v[76:79], v[108:111]
  ds_read_b64_tr_b16 a[162:163], v48 offset:2048
  v_mfma_f32_16x16x32_bf16 v[112:115], a[208:211], v[76:79], v[112:115]
  ds_read_b128 a[228:231], v56 offset:2048
  v_mfma_f32_16x16x32_bf16 v[116:119], a[212:215], v[76:79], v[116:119]
  v_mfma_f32_16x16x32_bf16 v[120:123], a[216:219], v[76:79], v[120:123]
  ds_read_b64_tr_b16 a[164:165], v48 offset:8
  v_mfma_f32_16x16x32_bf16 v[124:127], a[220:223], v[76:79], v[124:127]
  ds_read_b64_tr_b16 a[166:167], v48 offset:2056
  s_add_u32 m0, s26, 143360
  s_add_u32 s33, s29, 40960
  v_mfma_f32_16x16x32_bf16 v[128:131], a[192:195], v[80:83], v[128:131]
  buffer_load_dwordx4 v64, s[12:15], s33 offen lds
  v_mfma_f32_16x16x32_bf16 v[132:135], a[196:199], v[80:83], v[132:135]
  ds_read_b128 a[232:235], v56 offset:4096
  v_mfma_f32_16x16x32_bf16 v[136:139], a[200:203], v[80:83], v[136:139]
  ds_read_b64_tr_b16 a[168:169], v49 offset:0
  v_mfma_f32_16x16x32_bf16 v[140:143], a[204:207], v[80:83], v[140:143]
  v_mfma_f32_16x16x32_bf16 v[144:147], a[208:211], v[80:83], v[144:147]
  ds_read_b64_tr_b16 a[170:171], v49 offset:2048
  v_mfma_f32_16x16x32_bf16 v[148:151], a[212:215], v[80:83], v[148:151]
  ds_read_b128 a[236:239], v56 offset:6144
  s_add_u32 m0, s26, 147456
  s_add_u32 s33, s29, 81920
  v_mfma_f32_16x16x32_bf16 v[152:155], a[216:219], v[80:83], v[152:155]
  buffer_load_dwordx4 v64, s[12:15], s33 offen lds
  v_mfma_f32_16x16x32_bf16 v[156:159], a[220:223], v[80:83], v[156:159]
  ds_read_b64_tr_b16 a[172:173], v49 offset:8
  v_mfma_f32_16x16x32_bf16 v[160:163], a[192:195], v[84:87], v[160:163]
  ds_read_b64_tr_b16 a[174:175], v49 offset:2056
  v_mfma_f32_16x16x32_bf16 v[164:167], a[196:199], v[84:87], v[164:167]
  v_mfma_f32_16x16x32_bf16 v[168:171], a[200:203], v[84:87], v[168:171]
  ds_read_b128 a[240:243], v56 offset:8192
  v_mfma_f32_16x16x32_bf16 v[172:175], a[204:207], v[84:87], v[172:175]
  ds_read_b64_tr_b16 a[176:177], v50 offset:0
  v_mfma_f32_16x16x32_bf16 v[176:179], a[208:211], v[84:87], v[176:179]
  v_mfma_f32_16x16x32_bf16 v[180:183], a[212:215], v[84:87], v[180:183]
  ds_read_b64_tr_b16 a[178:179], v50 offset:2048
  v_mfma_f32_16x16x32_bf16 v[184:187], a[216:219], v[84:87], v[184:187]
  ds_read_b64_tr_b16 a[180:181], v50 offset:8
  s_add_u32 m0, s26, 151552
  s_add_u32 s33, s29, 122880
  v_mfma_f32_16x16x32_bf16 v[188:191], a[220:223], v[84:87], v[188:191]
  buffer_load_dwordx4 v64, s[12:15], s33 offen lds
  v_mfma_f32_16x16x32_bf16 v[192:195], a[192:195], v[88:91], v[192:195]
  ds_read_b64_tr_b16 a[182:183], v50 offset:2056
  v_mfma_f32_16x16x32_bf16 v[196:199], a[196:199], v[88:91], v[196:199]
  ds_read_b64_tr_b16 a[184:185], v51 offset:0
  v_mfma_f32_16x16x32_bf16 v[200:203], a[200:203], v[88:91], v[200:203]
  v_mfma_f32_16x16x32_bf16 v[204:207], a[204:207], v[88:91], v[204:207]
  ds_read_b64_tr_b16 a[186:187], v51 offset:2048
  v_mfma_f32_16x16x32_bf16 v[208:211], a[208:211], v[88:91], v[208:211]
  ds_read_b64_tr_b16 a[188:189], v51 offset:8
  s_add_u32 m0, s26, 155648
  s_add_u32 s33, s29, 163840
  v_mfma_f32_16x16x32_bf16 v[212:215], a[212:215], v[88:91], v[212:215]
  buffer_load_dwordx4 v64, s[12:15], s33 offen lds
  v_mfma_f32_16x16x32_bf16 v[216:219], a[216:219], v[88:91], v[216:219]
  ds_read_b64_tr_b16 a[190:191], v51 offset:2056
  v_mfma_f32_16x16x32_bf16 v[220:223], a[220:223], v[88:91], v[220:223]
  v_mfma_f32_16x16x32_bf16 v[224:227], a[192:195], v[92:95], v[224:227]
  s_add_u32 m0, s26, 65536
  v_mfma_f32_16x16x32_bf16 v[228:231], a[196:199], v[92:95], v[228:231]
  buffer_load_dwordx4 v65, s[16:19], s30 offen lds
  v_mfma_f32_16x16x32_bf16 v[232:235], a[200:203], v[92:95], v[232:235]
  v_mfma_f32_16x16x32_bf16 v[236:239], a[204:207], v[92:95], v[236:239]
  v_mfma_f32_16x16x32_bf16 v[240:243], a[208:211], v[92:95], v[240:243]
  v_mfma_f32_16x16x32_bf16 v[244:247], a[212:215], v[92:95], v[244:247]
  v_mfma_f32_16x16x32_bf16 v[248:251], a[216:219], v[92:95], v[248:251]
  v_mfma_f32_16x16x32_bf16 v[252:255], a[220:223], v[92:95], v[252:255]
  s_waitcnt lgkmcnt(0)
  v_mfma_f32_16x16x32_bf16 v[96:99], a[160:163], a[224:227], v[96:99]
  ds_read_b128 v[76:79], v57 offset:0
  v_mfma_f32_16x16x32_bf16 v[100:103], a[164:167], a[224:227], v[100:103]
  ds_read_b64_tr_b16 a[192:193], v48 offset:16384
  s_add_u32 m0, s26, 69632
  s_add_u32 s33, s30, 65536
  v_mfma_f32_16x16x32_bf16 v[104:107], a[168:171], a[224:227], v[104:107]
  buffer_load_dwordx4 v65, s[16:19], s33 offen lds
  v_mfma_f32_16x16x32_bf16 v[108:111], a[172:175], a[224:227], v[108:111]
  ds_read_b64_tr_b16 a[194:195], v48 offset:18432
  v_mfma_f32_16x16x32_bf16 v[112:115], a[176:179], a[224:227], v[112:115]
  ds_read_b128 v[80:83], v57 offset:2048
  v_mfma_f32_16x16x32_bf16 v[116:119], a[180:183], a[224:227], v[116:119]
  v_mfma_f32_16x16x32_bf16 v[120:123], a[184:187], a[224:227], v[120:123]
  ds_read_b64_tr_b16 a[196:197], v48 offset:16392
  v_mfma_f32_16x16x32_bf16 v[124:127], a[188:191], a[224:227], v[124:127]
  ds_read_b64_tr_b16 a[198:199], v48 offset:18440
  s_add_u32 m0, s26, 73728
  s_add_u32 s33, s30, 131072
  v_mfma_f32_16x16x32_bf16 v[128:131], a[160:163], a[228:231], v[128:131]
  buffer_load_dwordx4 v65, s[16:19], s33 offen lds
  v_mfma_f32_16x16x32_bf16 v[132:135], a[164:167], a[228:231], v[132:135]
  ds_read_b128 v[84:87], v57 offset:4096
  v_mfma_f32_16x16x32_bf16 v[136:139], a[168:171], a[228:231], v[136:139]
  ds_read_b64_tr_b16 a[200:201], v49 offset:16384
  v_mfma_f32_16x16x32_bf16 v[140:143], a[172:175], a[228:231], v[140:143]
  v_mfma_f32_16x16x32_bf16 v[144:147], a[176:179], a[228:231], v[144:147]
  ds_read_b64_tr_b16 a[202:203], v49 offset:18432
  v_mfma_f32_16x16x32_bf16 v[148:151], a[180:183], a[228:231], v[148:151]
  ds_read_b128 v[88:91], v57 offset:6144
  s_add_u32 m0, s26, 77824
  s_add_u32 s33, s30, 196608
  v_mfma_f32_16x16x32_bf16 v[152:155], a[184:187], a[228:231], v[152:155]
  buffer_load_dwordx4 v65, s[16:19], s33 offen lds
  v_mfma_f32_16x16x32_bf16 v[156:159], a[188:191], a[228:231], v[156:159]
  ds_read_b64_tr_b16 a[204:205], v49 offset:16392
  v_mfma_f32_16x16x32_bf16 v[160:163], a[160:163], a[232:235], v[160:163]
  ds_read_b64_tr_b16 a[206:207], v49 offset:18440
  v_mfma_f32_16x16x32_bf16 v[164:167], a[164:167], a[232:235], v[164:167]
  v_mfma_f32_16x16x32_bf16 v[168:171], a[168:171], a[232:235], v[168:171]
  ds_read_b128 v[92:95], v57 offset:8192
  v_mfma_f32_16x16x32_bf16 v[172:175], a[172:175], a[232:235], v[172:175]
  ds_read_b64_tr_b16 a[208:209], v50 offset:16384
  s_add_u32 m0, s26, 81920
  s_add_u32 s33, s30, 262144
  v_mfma_f32_16x16x32_bf16 v[176:179], a[176:179], a[232:235], v[176:179]
  buffer_load_dwordx4 v65, s[16:19], s33 offen lds
  v_mfma_f32_16x16x32_bf16 v[180:183], a[180:183], a[232:235], v[180:183]
  ds_read_b64_tr_b16 a[210:211], v50 offset:18432
  v_mfma_f32_16x16x32_bf16 v[184:187], a[184:187], a[232:235], v[184:187]
  ds_read_b64_tr_b16 a[212:213], v50 offset:16392
  s_add_u32 m0, s26, 86016
  s_add_u32 s33, s30, 327680
  v_mfma_f32_16x16x32_bf16 v[188:191], a[188:191], a[232:235], v[188:191]
  buffer_load_dwordx4 v65, s[16:19], s33 offen lds
  v_mfma_f32_16x16x32_bf16 v[192:195], a[160:163], a[236:239], v[192:195]
  ds_read_b64_tr_b16 a[214:215], v50 offset:18440
  v_mfma_f32_16x16x32_bf16 v[196:199], a[164:167], a[236:239], v[196:199]
  ds_read_b64_tr_b16 a[216:217], v51 offset:16384
  v_mfma_f32_16x16x32_bf16 v[200:203], a[168:171], a[236:239], v[200:203]
  v_mfma_f32_16x16x32_bf16 v[204:207], a[172:175], a[236:239], v[204:207]
  ds_read_b64_tr_b16 a[218:219], v51 offset:18432
  v_mfma_f32_16x16x32_bf16 v[208:211], a[176:179], a[236:239], v[208:211]
  ds_read_b64_tr_b16 a[220:221], v51 offset:16392
  s_add_u32 m0, s26, 90112
  s_add_u32 s33, s30, 393216
  v_mfma_f32_16x16x32_bf16 v[212:215], a[180:183], a[236:239], v[212:215]
  buffer_load_dwordx4 v65, s[16:19], s33 offen lds
  v_mfma_f32_16x16x32_bf16 v[216:219], a[184:187], a[236:239], v[216:219]
  ds_read_b64_tr_b16 a[222:223], v51 offset:18440
  v_mfma_f32_16x16x32_bf16 v[220:223], a[188:191], a[236:239], v[220:223]
  v_mfma_f32_16x16x32_bf16 v[224:227], a[160:163], a[240:243], v[224:227]
  v_mfma_f32_16x16x32_bf16 v[228:231], a[164:167], a[240:243], v[228:231]
  s_add_u32 m0, s26, 94208
  s_add_u32 s33, s30, 458752
  v_mfma_f32_16x16x32_bf16 v[232:235], a[168:171], a[240:243], v[232:235]
  buffer_load_dwordx4 v65, s[16:19], s33 offen lds
  s_add_u32 s29, s29, 128
  s_add_u32 s30, s30, 524288
  s_cmp_eq_u32 s29, 1280
  s_cselect_b32 s29, 0, s29
  s_cselect_b32 s33, 5242880, 0
  s_sub_u32 s30, s30, s33
  v_mfma_f32_16x16x32_bf16 v[236:239], a[172:175], a[240:243], v[236:239]
  v_mfma_f32_16x16x32_bf16 v[240:243], a[176:179], a[240:243], v[240:243]
  v_mfma_f32_16x16x32_bf16 v[244:247], a[180:183], a[240:243], v[244:247]
  v_mfma_f32_16x16x32_bf16 v[248:251], a[184:187], a[240:243], v[248:251]
  v_mfma_f32_16x16x32_bf16 v[252:255], a[188:191], a[240:243], v[252:255]
  s_waitcnt vmcnt(13) lgkmcnt(0)
  s_barrier
  v_mfma_f32_16x16x32_bf16 v[96:99], a[192:195], v[76:79], v[96:99]
  ds_read_b128 a[224:227], v56 offset:20480
  v_mfma_f32_16x16x32_bf16 v[100:103], a[196:199], v[76:79], v[100:103]
  ds_read_b64_tr_b16 a[160:161], v48 offset:32768
  s_add_u32 m0, s25, 0
  v_mfma_f32_16x16x32_bf16 v[104:107], a[200:203], v[76:79], v[104:107]
  buffer_load_dwordx4 v58, s[4:7], s27 offen nt lds
  v_mfma_f32_16x16x32_bf16 v[108:111], a[204:207], v[76:79], v[108:111]
  ds_read_b64_tr_b16 a[162:163], v48 offset:34816
  v_mfma_f32_16x16x32_bf16 v[112:115], a[208:211], v[76:79], v[112:115]
  ds_read_b128 a[228:231], v56 offset:22528
  v_mfma_f32_16x16x32_bf16 v[116:119], a[212:215], v[76:79], v[116:119]
  v_mfma_f32_16x16x32_bf16 v[120:123], a[216:219], v[76:79], v[120:123]
  ds_read_b64_tr_b16 a[164:165], v48 offset:32776
  v_mfma_f32_16x16x32_bf16 v[124:127], a[220:223], v[76:79], v[124:127]
  ds_read_b64_tr_b16 a[166:167], v48 offset:34824
  v_mfma_f32_16x16x32_bf16 v[128:131], a[192:195], v[80:83], v[128:131]
  v_mfma_f32_16x16x32_bf16 v[132:135], a[196:199], v[80:83], v[132:135]
  ds_read_b128 a[232:235], v56 offset:24576
  v_mfma_f32_16x16x32_bf16 v[136:139], a[200:203], v[80:83], v[136:139]
  ds_read_b64_tr_b16 a[168:169], v49 offset:32768
  v_mfma_f32_16x16x32_bf16 v[140:143], a[204:207], v[80:83], v[140:143]
  buffer_load_dwordx4 v59, s[4:7], s27 offen offset:1024 nt lds
  v_mfma_f32_16x16x32_bf16 v[144:147], a[208:211], v[80:83], v[144:147]
  ds_read_b64_tr_b16 a[170:171], v49 offset:34816
  v_mfma_f32_16x16x32_bf16 v[148:151], a[212:215], v[80:83], v[148:151]
  ds_read_b128 a[236:239], v56 offset:26624
  v_mfma_f32_16x16x32_bf16 v[152:155], a[216:219], v[80:83], v[152:155]
  v_mfma_f32_16x16x32_bf16 v[156:159], a[220:223], v[80:83], v[156:159]
  ds_read_b64_tr_b16 a[172:173], v49 offset:32776
  v_mfma_f32_16x16x32_bf16 v[160:163], a[192:195], v[84:87], v[160:163]
  ds_read_b64_tr_b16 a[174:175], v49 offset:34824
  v_mfma_f32_16x16x32_bf16 v[164:167], a[196:199], v[84:87], v[164:167]
  v_mfma_f32_16x16x32_bf16 v[168:171], a[200:203], v[84:87], v[168:171]
  ds_read_b128 a[240:243], v56 offset:28672
  v_mfma_f32_16x16x32_bf16 v[172:175], a[204:207], v[84:87], v[172:175]
  ds_read_b64_tr_b16 a[176:177], v50 offset:32768
  v_mfma_f32_16x16x32_bf16 v[176:179], a[208:211], v[84:87], v[176:179]
  v_mfma_f32_16x16x32_bf16 v[180:183], a[212:215], v[84:87], v[180:183]
  ds_read_b64_tr_b16 a[178:179], v50 offset:34816
  v_mfma_f32_16x16x32_bf16 v[184:187], a[216:219], v[84:87], v[184:187]
  ds_read_b64_tr_b16 a[180:181], v50 offset:32776
  v_mfma_f32_16x16x32_bf16 v[188:191], a[220:223], v[84:87], v[188:191]
  buffer_load_dwordx4 v60, s[4:7], s27 offen offset:2048 nt lds
  v_mfma_f32_16x16x32_bf16 v[192:195], a[192:195], v[88:91], v[192:195]
  ds_read_b64_tr_b16 a[182:183], v50 offset:34824
  v_mfma_f32_16x16x32_bf16 v[196:199], a[196:199], v[88:91], v[196:199]
  ds_read_b64_tr_b16 a[184:185], v51 offset:32768
  v_mfma_f32_16x16x32_bf16 v[200:203], a[200:203], v[88:91], v[200:203]
  v_mfma_f32_16x16x32_bf16 v[204:207], a[204:207], v[88:91], v[204:207]
  ds_read_b64_tr_b16 a[186:187], v51 offset:34816
  v_mfma_f32_16x16x32_bf16 v[208:211], a[208:211], v[88:91], v[208:211]
  ds_read_b64_tr_b16 a[188:189], v51 offset:32776
  v_mfma_f32_16x16x32_bf16 v[212:215], a[212:215], v[88:91], v[212:215]
  v_mfma_f32_16x16x32_bf16 v[216:219], a[216:219], v[88:91], v[216:219]
  ds_read_b64_tr_b16 a[190:191], v51 offset:34824
  v_mfma_f32_16x16x32_bf16 v[220:223], a[220:223], v[88:91], v[220:223]
  buffer_load_dwordx4 v61, s[4:7], s27 offen offset:3072 nt lds
  s_add_u32 s27, s27, 8192
  v_mfma_f32_16x16x32_bf16 v[224:227], a[192:195], v[92:95], v[224:227]
  v_mfma_f32_16x16x32_bf16 v[228:231], a[196:199], v[92:95], v[228:231]
  v_mfma_f32_16x16x32_bf16 v[232:235], a[200:203], v[92:95], v[232:235]
  v_mfma_f32_16x16x32_bf16 v[236:239], a[204:207], v[92:95], v[236:239]
  v_mfma_f32_16x16x32_bf16 v[240:243], a[208:211], v[92:95], v[240:243]
  v_mfma_f32_16x16x32_bf16 v[244:247], a[212:215], v[92:95], v[244:247]
  v_mfma_f32_16x16x32_bf16 v[248:251], a[216:219], v[92:95], v[248:251]
  v_mfma_f32_16x16x32_bf16 v[252:255], a[220:223], v[92:95], v[252:255]
  s_waitcnt lgkmcnt(0)
  v_mfma_f32_16x16x32_bf16 v[96:99], a[160:163], a[224:227], v[96:99]
  ds_read_b128 v[76:79], v57 offset:20480
  v_mfma_f32_16x16x32_bf16 v[100:103], a[164:167], a[224:227], v[100:103]
  ds_read_b64_tr_b16 a[192:193], v48 offset:49152
  s_add_u32 m0, s25, 16384
  v_mfma_f32_16x16x32_bf16 v[104:107], a[168:171], a[224:227], v[104:107]
  buffer_load_dwordx4 v62, s[8:11], s28 offen nt lds
  v_mfma_f32_16x16x32_bf16 v[108:111], a[172:175], a[224:227], v[108:111]
  ds_read_b64_tr_b16 a[194:195], v48 offset:51200
  v_mfma_f32_16x16x32_bf16 v[112:115], a[176:179], a[224:227], v[112:115]
  ds_read_b128 v[80:83], v57 offset:22528
  v_mfma_f32_16x16x32_bf16 v[116:119], a[180:183], a[224:227], v[116:119]
  v_mfma_f32_16x16x32_bf16 v[120:123], a[184:187], a[224:227], v[120:123]
  ds_read_b64_tr_b16 a[196:197], v48 offset:49160
  v_mfma_f32_16x16x32_bf16 v[124:127], a[188:191], a[224:227], v[124:127]
  ds_read_b64_tr_b16 a[198:199], v48 offset:51208
  v_mfma_f32_16x16x32_bf16 v[128:131], a[160:163], a[228:231], v[128:131]
  v_mfma_f32_16x16x32_bf16 v[132:135], a[164:167], a[228:231], v[132:135]
  ds_read_b128 v[84:87], v57 offset:24576
  v_mfma_f32_16x16x32_bf16 v[136:139], a[168:171], a[228:231], v[136:139]
  ds_read_b64_tr_b16 a[200:201], v49 offset:49152
  v_mfma_f32_16x16x32_bf16 v[140:143], a[172:175], a[228:231], v[140:143]
  buffer_load_dwordx4 v63, s[8:11], s28 offen offset:1024 nt lds
  v_mfma_f32_16x16x32_bf16 v[144:147], a[176:179], a[228:231], v[144:147]
  ds_read_b64_tr_b16 a[202:203], v49 offset:51200
  v_mfma_f32_16x16x32_bf16 v[148:151], a[180:183], a[228:231], v[148:151]
  ds_read_b128 v[88:91], v57 offset:26624
  v_mfma_f32_16x16x32_bf16 v[152:155], a[184:187], a[228:231], v[152:155]
  v_mfma_f32_16x16x32_bf16 v[156:159], a[188:191], a[228:231], v[156:159]
  ds_read_b64_tr_b16 a[204:205], v49 offset:49160
  v_mfma_f32_16x16x32_bf16 v[160:163], a[160:163], a[232:235], v[160:163]
  ds_read_b64_tr_b16 a[206:207], v49 offset:51208
  v_mfma_f32_16x16x32_bf16 v[164:167], a[164:167], a[232:235], v[164:167]
  v_mfma_f32_16x16x32_bf16 v[168:171], a[168:171], a[232:235], v[168:171]
  ds_read_b128 v[92:95], v57 offset:28672
  v_mfma_f32_16x16x32_bf16 v[172:175], a[172:175], a[232:235], v[172:175]
  ds_read_b64_tr_b16 a[208:209], v50 offset:49152
  v_mfma_f32_16x16x32_bf16 v[176:179], a[176:179], a[232:235], v[176:179]
  v_mfma_f32_16x16x32_bf16 v[180:183], a[180:183], a[232:235], v[180:183]
  ds_read_b64_tr_b16 a[210:211], v50 offset:51200
  v_mfma_f32_16x16x32_bf16 v[184:187], a[184:187], a[232:235], v[184:187]
  ds_read_b64_tr_b16 a[212:213], v50 offset:49160
  v_mfma_f32_16x16x32_bf16 v[188:191], a[188:191], a[232:235], v[188:191]
  buffer_load_dwordx4 v62, s[8:11], s28 offen offset:2048 nt lds
  v_mfma_f32_16x16x32_bf16 v[192:195], a[160:163], a[236:239], v[192:195]
  ds_read_b64_tr_b16 a[214:215], v50 offset:51208
  v_mfma_f32_16x16x32_bf16 v[196:199], a[164:167], a[236:239], v[196:199]
  ds_read_b64_tr_b16 a[216:217], v51 offset:49152
  v_mfma_f32_16x16x32_bf16 v[200:203], a[168:171], a[236:239], v[200:203]
  v_mfma_f32_16x16x32_bf16 v[204:207], a[172:175], a[236:239], v[204:207]
  ds_read_b64_tr_b16 a[218:219], v51 offset:51200
  v_mfma_f32_16x16x32_bf16 v[208:211], a[176:179], a[236:239], v[208:211]
  ds_read_b64_tr_b16 a[220:221], v51 offset:49160
  v_mfma_f32_16x16x32_bf16 v[212:215], a[180:183], a[236:239], v[212:215]
  v_mfma_f32_16x16x32_bf16 v[216:219], a[184:187], a[236:239], v[216:219]
  ds_read_b64_tr_b16 a[222:223], v51 offset:51208
  v_mfma_f32_16x16x32_bf16 v[220:223], a[188:191], a[236:239], v[220:223]
  buffer_load_dwordx4 v63, s[8:11], s28 offen offset:3072 nt lds
  s_add_u32 s28, s28, 8192
  v_mfma_f32_16x16x32_bf16 v[224:227], a[160:163], a[240:243], v[224:227]
  v_mfma_f32_16x16x32_bf16 v[228:231], a[164:167], a[240:243], v[228:231]
  v_mfma_f32_16x16x32_bf16 v[232:235], a[168:171], a[240:243], v[232:235]
  v_mfma_f32_16x16x32_bf16 v[236:239], a[172:175], a[240:243], v[236:239]
  v_mfma_f32_16x16x32_bf16 v[240:243], a[176:179], a[240:243], v[240:243]
  v_mfma_f32_16x16x32_bf16 v[244:247], a[180:183], a[240:243], v[244:247]
  v_mfma_f32_16x16x32_bf16 v[248:251], a[184:187], a[240:243], v[248:251]
  v_mfma_f32_16x16x32_bf16 v[252:255], a[188:191], a[240:243], v[252:255]
  s_waitcnt vmcnt(8) lgkmcnt(0)
  s_barrier
  v_mfma_f32_16x16x32_bf16 v[96:99], a[192:195], v[76:79], v[96:99]
  ds_read_b128 a[224:227], v56 offset:40960
  v_mfma_f32_16x16x32_bf16 v[100:103], a[196:199], v[76:79], v[100:103]
  ds_read_b64_tr_b16 a[160:161], v52 offset:0
  s_add_u32 m0, s25, 32768
  v_mfma_f32_16x16x32_bf16 v[104:107], a[200:203], v[76:79], v[104:107]
  buffer_load_dwordx4 v58, s[4:7], s27 offen nt lds
  v_mfma_f32_16x16x32_bf16 v[108:111], a[204:207], v[76:79], v[108:111]
  ds_read_b64_tr_b16 a[162:163], v52 offset:2048
  v_mfma_f32_16x16x32_bf16 v[112:115], a[208:211], v[76:79], v[112:115]
  ds_read_b128 a[228:231], v56 offset:43008
  v_mfma_f32_16x16x32_bf16 v[116:119], a[212:215], v[76:79], v[116:119]
  v_mfma_f32_16x16x32_bf16 v[120:123], a[216:219], v[76:79], v[120:123]
  ds_read_b64_tr_b16 a[164:165], v52 offset:8
  v_mfma_f32_16x16x32_bf16 v[124:127], a[220:223], v[76:79], v[124:127]
  ds_read_b64_tr_b16 a[166:167], v52 offset:2056
  v_mfma_f32_16x16x32_bf16 v[128:131], a[192:195], v[80:83], v[128:131]
  v_mfma_f32_16x16x32_bf16 v[132:135], a[196:199], v[80:83], v[132:135]
  ds_read_b128 a[232:235], v56 offset:45056
  v_mfma_f32_16x16x32_bf16 v[136:139], a[200:203], v[80:83], v[136:139]
  ds_read_b64_tr_b16 a[168:169], v53 offset:0
  v_mfma_f32_16x16x32_bf16 v[140:143], a[204:207], v[80:83], v[140:143]
  buffer_load_dwordx4 v59, s[4:7], s27 offen offset:1024 nt lds
  v_mfma_f32_16x16x32_bf16 v[144:147], a[208:211], v[80:83], v[144:147]
  ds_read_b64_tr_b16 a[170:171], v53 offset:2048
  v_mfma_f32_16x16x32_bf16 v[148:151], a[212:215], v[80:83], v[148:151]
  ds_read_b128 a[236:239], v56 offset:47104
  v_mfma_f32_16x16x32_bf16 v[152:155], a[216:219], v[80:83], v[152:155]
  v_mfma_f32_16x16x32_bf16 v[156:159], a[220:223], v[80:83], v[156:159]
  ds_read_b64_tr_b16 a[172:173], v53 offset:8
  v_mfma_f32_16x16x32_bf16 v[160:163], a[192:195], v[84:87], v[160:163]
  ds_read_b64_tr_b16 a[174:175], v53 offset:2056
  v_mfma_f32_16x16x32_bf16 v[164:167], a[196:199], v[84:87], v[164:167]
  v_mfma_f32_16x16x32_bf16 v[168:171], a[200:203], v[84:87], v[168:171]
  ds_read_b128 a[240:243], v56 offset:49152
  v_mfma_f32_16x16x32_bf16 v[172:175], a[204:207], v[84:87], v[172:175]
  ds_read_b64_tr_b16 a[176:177], v54 offset:0
  v_mfma_f32_16x16x32_bf16 v[176:179], a[208:211], v[84:87], v[176:179]
  v_mfma_f32_16x16x32_bf16 v[180:183], a[212:215], v[84:87], v[180:183]
  ds_read_b64_tr_b16 a[178:179], v54 offset:2048
  v_mfma_f32_16x16x32_bf16 v[184:187], a[216:219], v[84:87], v[184:187]
  ds_read_b64_tr_b16 a[180:181], v54 offset:8
  v_mfma_f32_16x16x32_bf16 v[188:191], a[220:223], v[84:87], v[188:191]
  buffer_load_dwordx4 v60, s[4:7], s27 offen offset:2048 nt lds
  v_mfma_f32_16x16x32_bf16 v[192:195], a[192:195], v[88:91], v[192:195]
  ds_read_b64_tr_b16 a[182:183], v54 offset:2056
  v_mfma_f32_16x16x32_bf16 v[196:199], a[196:199], v[88:91], v[196:199]
  ds_read_b64_tr_b16 a[184:185], v55 offset:0
  v_mfma_f32_16x16x32_bf16 v[200:203], a[200:203], v[88:91], v[200:203]
  v_mfma_f32_16x16x32_bf16 v[204:207], a[204:207], v[88:91], v[204:207]
  ds_read_b64_tr_b16 a[186:187], v55 offset:2048
  v_mfma_f32_16x16x32_bf16 v[208:211], a[208:211], v[88:91], v[208:211]
  ds_read_b64_tr_b16 a[188:189], v55 offset:8
  v_mfma_f32_16x16x32_bf16 v[212:215], a[212:215], v[88:91], v[212:215]
  v_mfma_f32_16x16x32_bf16 v[216:219], a[216:219], v[88:91], v[216:219]
  ds_read_b64_tr_b16 a[190:191], v55 offset:2056
  v_mfma_f32_16x16x32_bf16 v[220:223], a[220:223], v[88:91], v[220:223]
  buffer_load_dwordx4 v61, s[4:7], s27 offen offset:3072 nt lds
  s_add_u32 s27, s27, 8192
  v_mfma_f32_16x16x32_bf16 v[224:227], a[192:195], v[92:95], v[224:227]
  v_mfma_f32_16x16x32_bf16 v[228:231], a[196:199], v[92:95], v[228:231]
  v_mfma_f32_16x16x32_bf16 v[232:235], a[200:203], v[92:95], v[232:235]
  v_mfma_f32_16x16x32_bf16 v[236:239], a[204:207], v[92:95], v[236:239]
  v_mfma_f32_16x16x32_bf16 v[240:243], a[208:211], v[92:95], v[240:243]
  v_mfma_f32_16x16x32_bf16 v[244:247], a[212:215], v[92:95], v[244:247]
  v_mfma_f32_16x16x32_bf16 v[248:251], a[216:219], v[92:95], v[248:251]
  v_mfma_f32_16x16x32_bf16 v[252:255], a[220:223], v[92:95], v[252:255]
  s_waitcnt lgkmcnt(0)
  v_mfma_f32_16x16x32_bf16 v[96:99], a[160:163], a[224:227], v[96:99]
  ds_read_b128 v[76:79], v57 offset:40960
  v_mfma_f32_16x16x32_bf16 v[100:103], a[164:167], a[224:227], v[100:103]
  ds_read_b64_tr_b16 a[192:193], v52 offset:16384
  s_add_u32 m0, s25, 49152
  v_mfma_f32_16x16x32_bf16 v[104:107], a[168:171], a[224:227], v[104:107]
  buffer_load_dwordx4 v62, s[8:11], s28 offen nt lds
  v_mfma_f32_16x16x32_bf16 v[108:111], a[172:175], a[224:227], v[108:111]
  ds_read_b64_tr_b16 a[194:195], v52 offset:18432
  v_mfma_f32_16x16x32_bf16 v[112:115], a[176:179], a[224:227], v[112:115]
  ds_read_b128 v[80:83], v57 offset:43008
  v_mfma_f32_16x16x32_bf16 v[116:119], a[180:183], a[224:227], v[116:119]
  v_mfma_f32_16x16x32_bf16 v[120:123], a[184:187], a[224:227], v[120:123]
  ds_read_b64_tr_b16 a[196:197], v52 offset:16392
  v_mfma_f32_16x16x32_bf16 v[124:127], a[188:191], a[224:227], v[124:127]
  ds_read_b64_tr_b16 a[198:199], v52 offset:18440
  v_mfma_f32_16x16x32_bf16 v[128:131], a[160:163], a[228:231], v[128:131]
  v_mfma_f32_16x16x32_bf16 v[132:135], a[164:167], a[228:231], v[132:135]
  ds_read_b128 v[84:87], v57 offset:45056
  v_mfma_f32_16x16x32_bf16 v[136:139], a[168:171], a[228:231], v[136:139]
  ds_read_b64_tr_b16 a[200:201], v53 offset:16384
  v_mfma_f32_16x16x32_bf16 v[140:143], a[172:175], a[228:231], v[140:143]
  buffer_load_dwordx4 v63, s[8:11], s28 offen offset:1024 nt lds
  v_mfma_f32_16x16x32_bf16 v[144:147], a[176:179], a[228:231], v[144:147]
  ds_read_b64_tr_b16 a[202:203], v53 offset:18432
  v_mfma_f32_16x16x32_bf16 v[148:151], a[180:183], a[228:231], v[148:151]
  ds_read_b128 v[88:91], v57 offset:47104
  v_mfma_f32_16x16x32_bf16 v[152:155], a[184:187], a[228:231], v[152:155]
  v_mfma_f32_16x16x32_bf16 v[156:159], a[188:191], a[228:231], v[156:159]
  ds_read_b64_tr_b16 a[204:205], v53 offset:16392
  v_mfma_f32_16x16x32_bf16 v[160:163], a[160:163], a[232:235], v[160:163]
  ds_read_b64_tr_b16 a[206:207], v53 offset:18440
  v_mfma_f32_16x16x32_bf16 v[164:167], a[164:167], a[232:235], v[164:167]
  v_mfma_f32_16x16x32_bf16 v[168:171], a[168:171], a[232:235], v[168:171]
  ds_read_b128 v[92:95], v57 offset:49152
  v_mfma_f32_16x16x32_bf16 v[172:175], a[172:175], a[232:235], v[172:175]
  ds_read_b64_tr_b16 a[208:209], v54 offset:16384
  v_mfma_f32_16x16x32_bf16 v[176:179], a[176:179], a[232:235], v[176:179]
  v_mfma_f32_16x16x32_bf16 v[180:183], a[180:183], a[232:235], v[180:183]
  ds_read_b64_tr_b16 a[210:211], v54 offset:18432
  v_mfma_f32_16x16x32_bf16 v[184:187], a[184:187], a[232:235], v[184:187]
  ds_read_b64_tr_b16 a[212:213], v54 offset:16392
  v_mfma_f32_16x16x32_bf16 v[188:191], a[188:191], a[232:235], v[188:191]
  buffer_load_dwordx4 v62, s[8:11], s28 offen offset:2048 nt lds
  v_mfma_f32_16x16x32_bf16 v[192:195], a[160:163], a[236:239], v[192:195]
  ds_read_b64_tr_b16 a[214:215], v54 offset:18440
  v_mfma_f32_16x16x32_bf16 v[196:199], a[164:167], a[236:239], v[196:199]
  ds_read_b64_tr_b16 a[216:217], v55 offset:16384
  v_mfma_f32_16x16x32_bf16 v[200:203], a[168:171], a[236:239], v[200:203]
  v_mfma_f32_16x16x32_bf16 v[204:207], a[172:175], a[236:239], v[204:207]
  ds_read_b64_tr_b16 a[218:219], v55 offset:18432
  v_mfma_f32_16x16x32_bf16 v[208:211], a[176:179], a[236:239], v[208:211]
  ds_read_b64_tr_b16 a[220:221], v55 offset:16392
  v_mfma_f32_16x16x32_bf16 v[212:215], a[180:183], a[236:239], v[212:215]
  v_mfma_f32_16x16x32_bf16 v[216:219], a[184:187], a[236:239], v[216:219]
  ds_read_b64_tr_b16 a[222:223], v55 offset:18440
  v_mfma_f32_16x16x32_bf16 v[220:223], a[188:191], a[236:239], v[220:223]
  buffer_load_dwordx4 v63, s[8:11], s28 offen offset:3072 nt lds
  s_add_u32 s28, s28, 8192
  v_mfma_f32_16x16x32_bf16 v[224:227], a[160:163], a[240:243], v[224:227]
  v_mfma_f32_16x16x32_bf16 v[228:231], a[164:167], a[240:243], v[228:231]
  v_mfma_f32_16x16x32_bf16 v[232:235], a[168:171], a[240:243], v[232:235]
  v_mfma_f32_16x16x32_bf16 v[236:239], a[172:175], a[240:243], v[236:239]
  v_mfma_f32_16x16x32_bf16 v[240:243], a[176:179], a[240:243], v[240:243]
  v_mfma_f32_16x16x32_bf16 v[244:247], a[180:183], a[240:243], v[244:247]
  v_mfma_f32_16x16x32_bf16 v[248:251], a[184:187], a[240:243], v[248:251]
  v_mfma_f32_16x16x32_bf16 v[252:255], a[188:191], a[240:243], v[252:255]
  s_waitcnt lgkmcnt(0)
  s_barrier
  v_mfma_f32_16x16x32_bf16 v[96:99], a[192:195], v[76:79], v[96:99]
  v_mfma_f32_16x16x32_bf16 v[100:103], a[196:199], v[76:79], v[100:103]
  v_mfma_f32_16x16x32_bf16 v[104:107], a[200:203], v[76:79], v[104:107]
  v_mfma_f32_16x16x32_bf16 v[108:111], a[204:207], v[76:79], v[108:111]
  v_mfma_f32_16x16x32_bf16 v[112:115], a[208:211], v[76:79], v[112:115]
  v_mfma_f32_16x16x32_bf16 v[116:119], a[212:215], v[76:79], v[116:119]
  v_mfma_f32_16x16x32_bf16 v[120:123], a[216:219], v[76:79], v[120:123]
  v_mfma_f32_16x16x32_bf16 v[124:127], a[220:223], v[76:79], v[124:127]
  v_mfma_f32_16x16x32_bf16 v[128:131], a[192:195], v[80:83], v[128:131]
  v_mfma_f32_16x16x32_bf16 v[132:135], a[196:199], v[80:83], v[132:135]
  v_mfma_f32_16x16x32_bf16 v[136:139], a[200:203], v[80:83], v[136:139]
  v_mfma_f32_16x16x32_bf16 v[140:143], a[204:207], v[80:83], v[140:143]
  v_mfma_f32_16x16x32_bf16 v[144:147], a[208:211], v[80:83], v[144:147]
  v_mfma_f32_16x16x32_bf16 v[148:151], a[212:215], v[80:83], v[148:151]
  v_mfma_f32_16x16x32_bf16 v[152:155], a[216:219], v[80:83], v[152:155]
  v_mfma_f32_16x16x32_bf16 v[156:159], a[220:223], v[80:83], v[156:159]
  v_mfma_f32_16x16x32_bf16 v[160:163], a[192:195], v[84:87], v[160:163]
  v_mfma_f32_16x16x32_bf16 v[164:167], a[196:199], v[84:87], v[164:167]
  v_mfma_f32_16x16x32_bf16 v[168:171], a[200:203], v[84:87], v[168:171]
  v_mfma_f32_16x16x32_bf16 v[172:175], a[204:207], v[84:87], v[172:175]
  v_mfma_f32_16x16x32_bf16 v[176:179], a[208:211], v[84:87], v[176:179]
  v_mfma_f32_16x16x32_bf16 v[180:183], a[212:215], v[84:87], v[180:183]
  v_mfma_f32_16x16x32_bf16 v[184:187], a[216:219], v[84:87], v[184:187]
  v_mfma_f32_16x16x32_bf16 v[188:191], a[220:223], v[84:87], v[188:191]
  v_mfma_f32_16x16x32_bf16 v[192:195], a[192:195], v[88:91], v[192:195]
  v_mfma_f32_16x16x32_bf16 v[196:199], a[196:199], v[88:91], v[196:199]
  v_mfma_f32_16x16x32_bf16 v[200:203], a[200:203], v[88:91], v[200:203]
  v_mfma_f32_16x16x32_bf16 v[204:207], a[204:207], v[88:91], v[204:207]
  v_mfma_f32_16x16x32_bf16 v[208:211], a[208:211], v[88:91], v[208:211]
  v_mfma_f32_16x16x32_bf16 v[212:215], a[212:215], v[88:91], v[212:215]
  v_mfma_f32_16x16x32_bf16 v[216:219], a[216:219], v[88:91], v[216:219]
  v_mfma_f32_16x16x32_bf16 v[220:223], a[220:223], v[88:91], v[220:223]
  v_mfma_f32_16x16x32_bf16 v[224:227], a[192:195], v[92:95], v[224:227]
  v_mfma_f32_16x16x32_bf16 v[228:231], a[196:199], v[92:95], v[228:231]
  v_mfma_f32_16x16x32_bf16 v[232:235], a[200:203], v[92:95], v[232:235]
  v_mfma_f32_16x16x32_bf16 v[236:239], a[204:207], v[92:95], v[236:239]
  v_mfma_f32_16x16x32_bf16 v[240:243], a[208:211], v[92:95], v[240:243]
  v_mfma_f32_16x16x32_bf16 v[244:247], a[212:215], v[92:95], v[244:247]
  v_mfma_f32_16x16x32_bf16 v[248:251], a[216:219], v[92:95], v[248:251]
  v_mfma_f32_16x16x32_bf16 v[252:255], a[220:223], v[92:95], v[252:255]
concat_heads__mha_block_cached__mha_block_cached__near_ridge_kernel_conv:
  s_add_u32 s30, s30, 4096
  s_cmp_eq_u32 s70, 1
  s_cselect_b32 s14, 0, s14
  s_cselect_b32 s18, 0, s18
  s_add_u32 s70, s70, 1
  s_nop 7
  v_pk_mul_f32 v[96:97], v[96:97], s[58:59]
  v_pk_mul_f32 v[98:99], v[98:99], s[58:59]
  v_pk_mul_f32 v[100:101], v[100:101], s[58:59]
  v_pk_mul_f32 v[102:103], v[102:103], s[58:59]
  v_pk_mul_f32 v[104:105], v[104:105], s[58:59]
  v_pk_mul_f32 v[106:107], v[106:107], s[58:59]
  v_pk_mul_f32 v[108:109], v[108:109], s[58:59]
  v_pk_mul_f32 v[110:111], v[110:111], s[58:59]
  v_pk_mul_f32 v[112:113], v[112:113], s[58:59]
  v_pk_mul_f32 v[114:115], v[114:115], s[58:59]
  v_pk_mul_f32 v[116:117], v[116:117], s[58:59]
  v_pk_mul_f32 v[118:119], v[118:119], s[58:59]
  v_pk_mul_f32 v[120:121], v[120:121], s[58:59]
  v_pk_mul_f32 v[122:123], v[122:123], s[58:59]
  v_pk_mul_f32 v[124:125], v[124:125], s[58:59]
  v_pk_mul_f32 v[126:127], v[126:127], s[58:59]
  v_cvt_pk_bf16_f32 v68, v96, v97
  v_cvt_pk_bf16_f32 v69, v98, v99
  v_cvt_pk_bf16_f32 v70, v100, v101
  v_cvt_pk_bf16_f32 v71, v102, v103
  v_cvt_pk_bf16_f32 v72, v104, v105
  v_cvt_pk_bf16_f32 v73, v106, v107
  v_cvt_pk_bf16_f32 v74, v108, v109
  v_cvt_pk_bf16_f32 v75, v110, v111
  v_cvt_pk_bf16_f32 v76, v112, v113
  v_cvt_pk_bf16_f32 v77, v114, v115
  v_cvt_pk_bf16_f32 v78, v116, v117
  v_cvt_pk_bf16_f32 v79, v118, v119
  v_cvt_pk_bf16_f32 v80, v120, v121
  v_cvt_pk_bf16_f32 v81, v122, v123
  v_cvt_pk_bf16_f32 v82, v124, v125
  v_cvt_pk_bf16_f32 v83, v126, v127
  v_pk_mul_f32 v[128:129], v[128:129], s[58:59]
  v_pk_mul_f32 v[130:131], v[130:131], s[58:59]
  v_pk_mul_f32 v[132:133], v[132:133], s[58:59]
  v_pk_mul_f32 v[134:135], v[134:135], s[58:59]
  v_pk_mul_f32 v[136:137], v[136:137], s[58:59]
  v_pk_mul_f32 v[138:139], v[138:139], s[58:59]
  v_pk_mul_f32 v[140:141], v[140:141], s[58:59]
  v_pk_mul_f32 v[142:143], v[142:143], s[58:59]
  v_pk_mul_f32 v[144:145], v[144:145], s[58:59]
  v_pk_mul_f32 v[146:147], v[146:147], s[58:59]
  v_pk_mul_f32 v[148:149], v[148:149], s[58:59]
  v_pk_mul_f32 v[150:151], v[150:151], s[58:59]
  v_pk_mul_f32 v[152:153], v[152:153], s[58:59]
  v_pk_mul_f32 v[154:155], v[154:155], s[58:59]
  v_pk_mul_f32 v[156:157], v[156:157], s[58:59]
  v_pk_mul_f32 v[158:159], v[158:159], s[58:59]
  v_cvt_pk_bf16_f32 v84, v128, v129
  v_cvt_pk_bf16_f32 v85, v130, v131
  v_cvt_pk_bf16_f32 v86, v132, v133
  v_cvt_pk_bf16_f32 v87, v134, v135
  v_cvt_pk_bf16_f32 v88, v136, v137
  v_cvt_pk_bf16_f32 v89, v138, v139
  v_cvt_pk_bf16_f32 v90, v140, v141
  v_cvt_pk_bf16_f32 v91, v142, v143
  v_cvt_pk_bf16_f32 v92, v144, v145
  v_cvt_pk_bf16_f32 v93, v146, v147
  v_cvt_pk_bf16_f32 v94, v148, v149
  v_cvt_pk_bf16_f32 v95, v150, v151
  v_cvt_pk_bf16_f32 v96, v152, v153
  v_cvt_pk_bf16_f32 v97, v154, v155
  v_cvt_pk_bf16_f32 v98, v156, v157
  v_cvt_pk_bf16_f32 v99, v158, v159
  v_pk_mul_f32 v[160:161], v[160:161], s[58:59]
  v_pk_mul_f32 v[162:163], v[162:163], s[58:59]
  v_pk_mul_f32 v[164:165], v[164:165], s[58:59]
  v_pk_mul_f32 v[166:167], v[166:167], s[58:59]
  v_pk_mul_f32 v[168:169], v[168:169], s[58:59]
  v_pk_mul_f32 v[170:171], v[170:171], s[58:59]
  v_pk_mul_f32 v[172:173], v[172:173], s[58:59]
  v_pk_mul_f32 v[174:175], v[174:175], s[58:59]
  v_pk_mul_f32 v[176:177], v[176:177], s[58:59]
  v_pk_mul_f32 v[178:179], v[178:179], s[58:59]
  v_pk_mul_f32 v[180:181], v[180:181], s[58:59]
  v_pk_mul_f32 v[182:183], v[182:183], s[58:59]
  v_pk_mul_f32 v[184:185], v[184:185], s[58:59]
  v_pk_mul_f32 v[186:187], v[186:187], s[58:59]
  v_pk_mul_f32 v[188:189], v[188:189], s[58:59]
  v_pk_mul_f32 v[190:191], v[190:191], s[58:59]
  v_cvt_pk_bf16_f32 v100, v160, v161
  v_cvt_pk_bf16_f32 v101, v162, v163
  v_cvt_pk_bf16_f32 v102, v164, v165
  v_cvt_pk_bf16_f32 v103, v166, v167
  v_cvt_pk_bf16_f32 v104, v168, v169
  v_cvt_pk_bf16_f32 v105, v170, v171
  v_cvt_pk_bf16_f32 v106, v172, v173
  v_cvt_pk_bf16_f32 v107, v174, v175
  v_cvt_pk_bf16_f32 v108, v176, v177
  v_cvt_pk_bf16_f32 v109, v178, v179
  v_cvt_pk_bf16_f32 v110, v180, v181
  v_cvt_pk_bf16_f32 v111, v182, v183
  v_cvt_pk_bf16_f32 v112, v184, v185
  v_cvt_pk_bf16_f32 v113, v186, v187
  v_cvt_pk_bf16_f32 v114, v188, v189
  v_cvt_pk_bf16_f32 v115, v190, v191
  v_pk_mul_f32 v[192:193], v[192:193], s[58:59]
  v_pk_mul_f32 v[194:195], v[194:195], s[58:59]
  v_pk_mul_f32 v[196:197], v[196:197], s[58:59]
  v_pk_mul_f32 v[198:199], v[198:199], s[58:59]
  v_pk_mul_f32 v[200:201], v[200:201], s[58:59]
  v_pk_mul_f32 v[202:203], v[202:203], s[58:59]
  v_pk_mul_f32 v[204:205], v[204:205], s[58:59]
  v_pk_mul_f32 v[206:207], v[206:207], s[58:59]
  v_pk_mul_f32 v[208:209], v[208:209], s[58:59]
  v_pk_mul_f32 v[210:211], v[210:211], s[58:59]
  v_pk_mul_f32 v[212:213], v[212:213], s[58:59]
  v_pk_mul_f32 v[214:215], v[214:215], s[58:59]
  v_pk_mul_f32 v[216:217], v[216:217], s[58:59]
  v_pk_mul_f32 v[218:219], v[218:219], s[58:59]
  v_pk_mul_f32 v[220:221], v[220:221], s[58:59]
  v_pk_mul_f32 v[222:223], v[222:223], s[58:59]
  v_cvt_pk_bf16_f32 v116, v192, v193
  v_cvt_pk_bf16_f32 v117, v194, v195
  v_cvt_pk_bf16_f32 v118, v196, v197
  v_cvt_pk_bf16_f32 v119, v198, v199
  v_cvt_pk_bf16_f32 v120, v200, v201
  v_cvt_pk_bf16_f32 v121, v202, v203
  v_cvt_pk_bf16_f32 v122, v204, v205
  v_cvt_pk_bf16_f32 v123, v206, v207
  v_cvt_pk_bf16_f32 v124, v208, v209
  v_cvt_pk_bf16_f32 v125, v210, v211
  v_cvt_pk_bf16_f32 v126, v212, v213
  v_cvt_pk_bf16_f32 v127, v214, v215
  v_cvt_pk_bf16_f32 v128, v216, v217
  v_cvt_pk_bf16_f32 v129, v218, v219
  v_cvt_pk_bf16_f32 v130, v220, v221
  v_cvt_pk_bf16_f32 v131, v222, v223
  v_pk_mul_f32 v[224:225], v[224:225], s[58:59]
  v_pk_mul_f32 v[226:227], v[226:227], s[58:59]
  v_pk_mul_f32 v[228:229], v[228:229], s[58:59]
  v_pk_mul_f32 v[230:231], v[230:231], s[58:59]
  v_pk_mul_f32 v[232:233], v[232:233], s[58:59]
  v_pk_mul_f32 v[234:235], v[234:235], s[58:59]
  v_pk_mul_f32 v[236:237], v[236:237], s[58:59]
  v_pk_mul_f32 v[238:239], v[238:239], s[58:59]
  v_pk_mul_f32 v[240:241], v[240:241], s[58:59]
  v_pk_mul_f32 v[242:243], v[242:243], s[58:59]
  v_pk_mul_f32 v[244:245], v[244:245], s[58:59]
  v_pk_mul_f32 v[246:247], v[246:247], s[58:59]
  v_pk_mul_f32 v[248:249], v[248:249], s[58:59]
  v_pk_mul_f32 v[250:251], v[250:251], s[58:59]
  v_pk_mul_f32 v[252:253], v[252:253], s[58:59]
  v_pk_mul_f32 v[254:255], v[254:255], s[58:59]
  v_cvt_pk_bf16_f32 v132, v224, v225
  v_cvt_pk_bf16_f32 v133, v226, v227
  v_cvt_pk_bf16_f32 v134, v228, v229
  v_cvt_pk_bf16_f32 v135, v230, v231
  v_cvt_pk_bf16_f32 v136, v232, v233
  v_cvt_pk_bf16_f32 v137, v234, v235
  v_cvt_pk_bf16_f32 v138, v236, v237
  v_cvt_pk_bf16_f32 v139, v238, v239
  v_cvt_pk_bf16_f32 v140, v240, v241
  v_cvt_pk_bf16_f32 v141, v242, v243
  v_cvt_pk_bf16_f32 v142, v244, v245
  v_cvt_pk_bf16_f32 v143, v246, v247
  v_cvt_pk_bf16_f32 v144, v248, v249
  v_cvt_pk_bf16_f32 v145, v250, v251
  v_cvt_pk_bf16_f32 v146, v252, v253
  v_cvt_pk_bf16_f32 v147, v254, v255
  v_mov_b32 v172, 0
  v_mov_b32 v173, 0
  v_mov_b32 v174, 0
  v_mov_b32 v175, 0
  v_mov_b32 v176, 0
  v_mov_b32 v177, 0
  v_mov_b32 v178, 0
  v_mov_b32 v179, 0
  v_mov_b32 v180, 0
  v_mov_b32 v181, 0
  v_mov_b32 v182, 0
  v_mov_b32 v183, 0
  v_mov_b32 v184, 0
  v_mov_b32 v185, 0
  v_mov_b32 v186, 0
  v_mov_b32 v187, 0
  v_mov_b32 v188, 0
  v_mov_b32 v189, 0
  v_mov_b32 v190, 0
  v_mov_b32 v191, 0
  v_mov_b32 v8, 0
  v_mov_b32 v9, 0
  v_mov_b32 v10, 0
  v_mov_b32 v11, 0
  v_mov_b32 v12, 0
  s_mov_b32 s50, 0
  s_mov_b32 s48, s29
  s_mov_b32 s49, s30
  s_cmp_eq_u32 s70, 2
  s_cbranch_scc0 concat_heads__mha_block_cached__mha_block_cached__near_ridge_kernel_att
  s_waitcnt vmcnt(16)
  s_barrier
  s_cmp_eq_u32 s24, 0
  s_cbranch_scc0 concat_heads__mha_block_cached__mha_block_cached__near_ridge_kernel_sg1
  s_lshl_b32 s87, s66, 1
  s_add_u32 s87, s87, 0
  s_lshl_b32 s87, s87, 4
  v_mov_b32 v1, 1
  v_mov_b32 v2, s87
  s_mov_b64 exec, 1
  buffer_atomic_add v1, v2, s[76:79], 0 offen sc1
  s_mov_b64 exec, -1
concat_heads__mha_block_cached__mha_block_cached__near_ridge_kernel_sg1:
concat_heads__mha_block_cached__mha_block_cached__near_ridge_kernel_att:
  s_waitcnt vmcnt(8)
  s_barrier
  ds_read_b128 a[160:163], v16 offset:0
  ds_read_b128 a[176:179], v20 offset:0
  ds_read_b128 a[164:167], v17 offset:0
  ds_read_b128 a[180:183], v21 offset:0
  ds_read_b128 a[168:171], v18 offset:0
  ds_read_b128 a[184:187], v22 offset:0
  ds_read_b128 a[172:175], v19 offset:0
  ds_read_b128 a[188:191], v23 offset:0
  ds_read_b64_tr_b16 a[192:193], v32 offset:0
  ds_read_b64_tr_b16 a[194:195], v32 offset:4096
  ds_read_b64_tr_b16 a[196:197], v33 offset:0
  ds_read_b64_tr_b16 a[198:199], v33 offset:4096
  ds_read_b64_tr_b16 a[200:201], v34 offset:0
  ds_read_b64_tr_b16 a[202:203], v34 offset:4096
  ds_read_b64_tr_b16 a[204:205], v35 offset:0
  ds_read_b64_tr_b16 a[206:207], v35 offset:4096
  ds_read_b64_tr_b16 a[208:209], v36 offset:0
  ds_read_b64_tr_b16 a[210:211], v36 offset:4096
  ds_read_b64_tr_b16 a[212:213], v37 offset:0
  ds_read_b64_tr_b16 a[214:215], v37 offset:4096
  ds_read_b64_tr_b16 a[216:217], v38 offset:0
  ds_read_b64_tr_b16 a[218:219], v38 offset:4096
  ds_read_b64_tr_b16 a[220:221], v39 offset:0
  ds_read_b64_tr_b16 a[222:223], v39 offset:4096
  s_waitcnt lgkmcnt(15)
  v_mfma_f32_16x16x32_bf16 v[148:151], a[160:163], v[68:71], v[172:175]
  s_add_u32 m0, s25, 65536
  v_mfma_f32_16x16x32_bf16 v[152:155], a[176:179], v[68:71], v[172:175]
  buffer_load_dwordx4 v58, s[4:7], s27 offen nt lds
  buffer_load_dwordx4 v59, s[4:7], s27 offen offset:1024 nt lds
  v_mfma_f32_16x16x32_bf16 v[148:151], a[164:167], v[72:75], v[148:151]
  buffer_load_dwordx4 v60, s[4:7], s27 offen offset:2048 nt lds
  v_mfma_f32_16x16x32_bf16 v[152:155], a[180:183], v[72:75], v[152:155]
  buffer_load_dwordx4 v61, s[4:7], s27 offen offset:3072 nt lds
  s_add_u32 s27, s27, 8192
  s_add_u32 m0, s25, 81920
  v_mfma_f32_16x16x32_bf16 v[148:151], a[168:171], v[76:79], v[148:151]
  buffer_load_dwordx4 v62, s[8:11], s28 offen nt lds
  v_mfma_f32_16x16x32_bf16 v[152:155], a[184:187], v[76:79], v[152:155]
  buffer_load_dwordx4 v63, s[8:11], s28 offen offset:1024 nt lds
  v_mfma_f32_16x16x32_bf16 v[148:151], a[172:175], v[80:83], v[148:151]
  buffer_load_dwordx4 v62, s[8:11], s28 offen offset:2048 nt lds
  v_mfma_f32_16x16x32_bf16 v[152:155], a[188:191], v[80:83], v[152:155]
  buffer_load_dwordx4 v63, s[8:11], s28 offen offset:3072 nt lds
  s_add_u32 s28, s28, 8192
  v_mfma_f32_16x16x32_bf16 v[156:159], a[160:163], v[84:87], v[176:179]
  s_waitcnt vmcnt(8) lgkmcnt(0)
  s_barrier
  s_nop 7
  v_exp_f32 v148, v148
  v_exp_f32 v149, v149
  v_add_f32 v8, v8, v148
  s_add_u32 m0, s25, 98304
  v_mfma_f32_16x16x32_bf16 v[160:163], a[176:179], v[84:87], v[176:179]
  ds_read_b128 v[200:203], v16 offset:32768
  ds_read_b128 v[216:219], v20 offset:32768
  buffer_load_dwordx4 v58, s[4:7], s27 offen nt lds
  v_exp_f32 v150, v150
  v_add_f32 v8, v8, v149
  v_cvt_pk_bf16_f32 v164, v148, v149
  v_mfma_f32_16x16x32_bf16 v[156:159], a[164:167], v[88:91], v[156:159]
  buffer_load_dwordx4 v59, s[4:7], s27 offen offset:1024 nt lds
  v_exp_f32 v151, v151
  v_add_f32 v8, v8, v150
  v_mfma_f32_16x16x32_bf16 v[160:163], a[180:183], v[88:91], v[160:163]
  ds_read_b128 v[204:207], v17 offset:32768
  v_exp_f32 v152, v152
  v_add_f32 v8, v8, v151
  v_cvt_pk_bf16_f32 v165, v150, v151
  v_mfma_f32_16x16x32_bf16 v[156:159], a[168:171], v[92:95], v[156:159]
  buffer_load_dwordx4 v60, s[4:7], s27 offen offset:2048 nt lds
  v_exp_f32 v153, v153
  v_add_f32 v8, v8, v152
  v_exp_f32 v154, v154
  v_mfma_f32_16x16x32_bf16 v[160:163], a[184:187], v[92:95], v[160:163]
  ds_read_b128 v[220:223], v21 offset:32768
  v_add_f32 v8, v8, v153
  v_cvt_pk_bf16_f32 v166, v152, v153
  v_mfma_f32_16x16x32_bf16 v[156:159], a[172:175], v[96:99], v[156:159]
  buffer_load_dwordx4 v61, s[4:7], s27 offen offset:3072 nt lds
  v_exp_f32 v155, v155
  v_add_f32 v8, v8, v154
  s_nop 0
  s_add_u32 s27, s27, 8192
  v_mfma_f32_16x16x32_bf16 v[160:163], a[188:191], v[96:99], v[160:163]
  ds_read_b128 v[208:211], v18 offset:32768
  v_add_f32 v8, v8, v155
  v_cvt_pk_bf16_f32 v167, v154, v155
  v_mfma_f32_16x16x32_bf16 v[148:151], a[160:163], v[100:103], v[180:183]
  s_nop 7
  v_exp_f32 v156, v156
  v_mfma_f32_16x16x32_bf16 v[152:155], a[176:179], v[100:103], v[180:183]
  ds_read_b128 v[224:227], v22 offset:32768
  v_add_f32 v9, v9, v156
  s_add_u32 m0, s25, 114688
  v_mfma_f32_16x16x32_bf16 v[148:151], a[164:167], v[104:107], v[148:151]
  buffer_load_dwordx4 v62, s[8:11], s28 offen nt lds
  v_exp_f32 v157, v157
  v_mfma_f32_16x16x32_bf16 v[152:155], a[180:183], v[104:107], v[152:155]
  ds_read_b128 v[212:215], v19 offset:32768
  v_add_f32 v9, v9, v157
  v_cvt_pk_bf16_f32 v168, v156, v157
  v_mfma_f32_16x16x32_bf16 v[148:151], a[168:171], v[108:111], v[148:151]
  buffer_load_dwordx4 v63, s[8:11], s28 offen offset:1024 nt lds
  v_exp_f32 v158, v158
  v_mfma_f32_16x16x32_bf16 v[152:155], a[184:187], v[108:111], v[152:155]
  ds_read_b128 v[228:231], v23 offset:32768
  v_add_f32 v9, v9, v158
  v_mfma_f32_16x16x32_bf16 v[148:151], a[172:175], v[112:115], v[148:151]
  v_exp_f32 v159, v159
  v_mfma_f32_16x16x32_bf16 v[152:155], a[188:191], v[112:115], v[152:155]
  v_add_f32 v9, v9, v159
  v_cvt_pk_bf16_f32 v169, v158, v159
  v_mfma_f32_16x16x32_bf16 a[0:3], a[192:195], v[164:167], 0
  buffer_load_dwordx4 v62, s[8:11], s28 offen offset:2048 nt lds
  v_exp_f32 v160, v160
  v_mfma_f32_16x16x32_bf16 a[4:7], a[196:199], v[164:167], 0
  ds_read_b64_tr_b16 a[224:225], v32 offset:32768
  v_add_f32 v9, v9, v160
  v_mfma_f32_16x16x32_bf16 a[8:11], a[200:203], v[164:167], 0
  v_exp_f32 v161, v161
  v_mfma_f32_16x16x32_bf16 a[12:15], a[204:207], v[164:167], 0
  ds_read_b64_tr_b16 a[226:227], v32 offset:36864
  v_add_f32 v9, v9, v161
  v_cvt_pk_bf16_f32 v170, v160, v161
  v_mfma_f32_16x16x32_bf16 a[16:19], a[208:211], v[164:167], 0
  buffer_load_dwordx4 v63, s[8:11], s28 offen offset:3072 nt lds
  v_exp_f32 v162, v162
  s_add_u32 s28, s28, 8192
  v_mfma_f32_16x16x32_bf16 a[20:23], a[212:215], v[164:167], 0
  ds_read_b64_tr_b16 a[228:229], v33 offset:32768
  v_add_f32 v9, v9, v162
  v_mfma_f32_16x16x32_bf16 a[24:27], a[216:219], v[164:167], 0
  v_exp_f32 v163, v163
  v_mfma_f32_16x16x32_bf16 a[28:31], a[220:223], v[164:167], 0
  v_add_f32 v9, v9, v163
  v_cvt_pk_bf16_f32 v171, v162, v163
  v_mfma_f32_16x16x32_bf16 v[156:159], a[160:163], v[116:119], v[184:187]
  v_exp_f32 v148, v148
  v_mfma_f32_16x16x32_bf16 v[160:163], a[176:179], v[116:119], v[184:187]
  ds_read_b64_tr_b16 a[230:231], v33 offset:36864
  v_add_f32 v10, v10, v148
  s_add_u32 m0, s25, 0
  v_mfma_f32_16x16x32_bf16 v[156:159], a[164:167], v[120:123], v[156:159]
  buffer_load_dwordx4 v58, s[4:7], s27 offen nt lds
  v_exp_f32 v149, v149
  v_mfma_f32_16x16x32_bf16 v[160:163], a[180:183], v[120:123], v[160:163]
  ds_read_b64_tr_b16 a[232:233], v34 offset:32768
  v_add_f32 v10, v10, v149
  v_cvt_pk_bf16_f32 v164, v148, v149
  v_mfma_f32_16x16x32_bf16 v[156:159], a[168:171], v[124:127], v[156:159]
  buffer_load_dwordx4 v59, s[4:7], s27 offen offset:1024 nt lds
  v_exp_f32 v150, v150
  v_mfma_f32_16x16x32_bf16 v[160:163], a[184:187], v[124:127], v[160:163]
  ds_read_b64_tr_b16 a[234:235], v34 offset:36864
  v_add_f32 v10, v10, v150
  v_mfma_f32_16x16x32_bf16 v[156:159], a[172:175], v[128:131], v[156:159]
  v_exp_f32 v151, v151
  v_mfma_f32_16x16x32_bf16 v[160:163], a[188:191], v[128:131], v[160:163]
  ds_read_b64_tr_b16 a[236:237], v35 offset:32768
  v_add_f32 v10, v10, v151
  v_cvt_pk_bf16_f32 v165, v150, v151
  v_mfma_f32_16x16x32_bf16 a[32:35], a[192:195], v[168:171], 0
  buffer_load_dwordx4 v60, s[4:7], s27 offen offset:2048 nt lds
  v_exp_f32 v152, v152
  v_mfma_f32_16x16x32_bf16 a[36:39], a[196:199], v[168:171], 0
  ds_read_b64_tr_b16 a[238:239], v35 offset:36864
  v_add_f32 v10, v10, v152
  v_mfma_f32_16x16x32_bf16 a[40:43], a[200:203], v[168:171], 0
  v_exp_f32 v153, v153
  v_mfma_f32_16x16x32_bf16 a[44:47], a[204:207], v[168:171], 0
  ds_read_b64_tr_b16 a[240:241], v36 offset:32768
  v_add_f32 v10, v10, v153
  v_cvt_pk_bf16_f32 v166, v152, v153
  v_mfma_f32_16x16x32_bf16 a[48:51], a[208:211], v[168:171], 0
  buffer_load_dwordx4 v61, s[4:7], s27 offen offset:3072 nt lds
  v_exp_f32 v154, v154
  s_add_u32 s27, s27, 8192
  v_mfma_f32_16x16x32_bf16 a[52:55], a[212:215], v[168:171], 0
  ds_read_b64_tr_b16 a[242:243], v36 offset:36864
  v_add_f32 v10, v10, v154
  v_mfma_f32_16x16x32_bf16 a[56:59], a[216:219], v[168:171], 0
  v_exp_f32 v155, v155
  v_mfma_f32_16x16x32_bf16 a[60:63], a[220:223], v[168:171], 0
  v_add_f32 v10, v10, v155
  v_cvt_pk_bf16_f32 v167, v154, v155
  v_mfma_f32_16x16x32_bf16 v[148:151], a[160:163], v[132:135], v[188:191]
  v_exp_f32 v156, v156
  v_mfma_f32_16x16x32_bf16 v[152:155], a[176:179], v[132:135], v[188:191]
  ds_read_b64_tr_b16 a[244:245], v37 offset:32768
  v_add_f32 v11, v11, v156
  s_add_u32 m0, s25, 16384
  v_mfma_f32_16x16x32_bf16 v[148:151], a[164:167], v[136:139], v[148:151]
  buffer_load_dwordx4 v62, s[8:11], s28 offen nt lds
  v_exp_f32 v157, v157
  v_mfma_f32_16x16x32_bf16 v[152:155], a[180:183], v[136:139], v[152:155]
  ds_read_b64_tr_b16 a[246:247], v37 offset:36864
  v_add_f32 v11, v11, v157
  v_cvt_pk_bf16_f32 v168, v156, v157
  v_mfma_f32_16x16x32_bf16 v[148:151], a[168:171], v[140:143], v[148:151]
  buffer_load_dwordx4 v63, s[8:11], s28 offen offset:1024 nt lds
  v_exp_f32 v158, v158
  v_mfma_f32_16x16x32_bf16 v[152:155], a[184:187], v[140:143], v[152:155]
  ds_read_b64_tr_b16 a[248:249], v38 offset:32768
  v_add_f32 v11, v11, v158
  v_mfma_f32_16x16x32_bf16 v[148:151], a[172:175], v[144:147], v[148:151]
  v_exp_f32 v159, v159
  v_mfma_f32_16x16x32_bf16 v[152:155], a[188:191], v[144:147], v[152:155]
  v_add_f32 v11, v11, v159
  v_cvt_pk_bf16_f32 v169, v158, v159
  v_mfma_f32_16x16x32_bf16 a[64:67], a[192:195], v[164:167], 0
  buffer_load_dwordx4 v62, s[8:11], s28 offen offset:2048 nt lds
  v_exp_f32 v160, v160
  v_mfma_f32_16x16x32_bf16 a[68:71], a[196:199], v[164:167], 0
  ds_read_b64_tr_b16 a[250:251], v38 offset:36864
  v_add_f32 v11, v11, v160
  v_mfma_f32_16x16x32_bf16 a[72:75], a[200:203], v[164:167], 0
  v_exp_f32 v161, v161
  v_mfma_f32_16x16x32_bf16 a[76:79], a[204:207], v[164:167], 0
  ds_read_b64_tr_b16 a[252:253], v39 offset:32768
  v_add_f32 v11, v11, v161
  v_cvt_pk_bf16_f32 v170, v160, v161
  v_mfma_f32_16x16x32_bf16 a[80:83], a[208:211], v[164:167], 0
  buffer_load_dwordx4 v63, s[8:11], s28 offen offset:3072 nt lds
  v_exp_f32 v162, v162
  s_add_u32 s28, s28, 8192
  v_mfma_f32_16x16x32_bf16 a[84:87], a[212:215], v[164:167], 0
  ds_read_b64_tr_b16 a[254:255], v39 offset:36864
  v_add_f32 v11, v11, v162
  v_mfma_f32_16x16x32_bf16 a[88:91], a[216:219], v[164:167], 0
  v_exp_f32 v163, v163
  v_mfma_f32_16x16x32_bf16 a[92:95], a[220:223], v[164:167], 0
  v_add_f32 v11, v11, v163
  v_cvt_pk_bf16_f32 v171, v162, v163
  s_waitcnt lgkmcnt(15)
  v_mfma_f32_16x16x32_bf16 v[156:159], v[200:203], v[68:71], v[172:175]
  v_exp_f32 v148, v148
  v_mfma_f32_16x16x32_bf16 v[160:163], v[216:219], v[68:71], v[172:175]
  v_add_f32 v12, v12, v148
  v_mfma_f32_16x16x32_bf16 v[156:159], v[204:207], v[72:75], v[156:159]
  v_exp_f32 v149, v149
  v_mfma_f32_16x16x32_bf16 v[160:163], v[220:223], v[72:75], v[160:163]
  v_add_f32 v12, v12, v149
  v_cvt_pk_bf16_f32 v164, v148, v149
  v_mfma_f32_16x16x32_bf16 v[156:159], v[208:211], v[76:79], v[156:159]
  v_exp_f32 v150, v150
  v_mfma_f32_16x16x32_bf16 v[160:163], v[224:227], v[76:79], v[160:163]
  v_add_f32 v12, v12, v150
  v_mfma_f32_16x16x32_bf16 v[156:159], v[212:215], v[80:83], v[156:159]
  v_exp_f32 v151, v151
  v_mfma_f32_16x16x32_bf16 v[160:163], v[228:231], v[80:83], v[160:163]
  v_add_f32 v12, v12, v151
  v_cvt_pk_bf16_f32 v165, v150, v151
  v_mfma_f32_16x16x32_bf16 a[96:99], a[192:195], v[168:171], 0
  v_exp_f32 v152, v152
  v_mfma_f32_16x16x32_bf16 a[100:103], a[196:199], v[168:171], 0
  v_add_f32 v12, v12, v152
  v_mfma_f32_16x16x32_bf16 a[104:107], a[200:203], v[168:171], 0
  v_exp_f32 v153, v153
  v_mfma_f32_16x16x32_bf16 a[108:111], a[204:207], v[168:171], 0
  v_add_f32 v12, v12, v153
  v_cvt_pk_bf16_f32 v166, v152, v153
  v_mfma_f32_16x16x32_bf16 a[112:115], a[208:211], v[168:171], 0
  v_exp_f32 v154, v154
  v_mfma_f32_16x16x32_bf16 a[116:119], a[212:215], v[168:171], 0
  v_add_f32 v12, v12, v154
  v_mfma_f32_16x16x32_bf16 a[120:123], a[216:219], v[168:171], 0
  v_exp_f32 v155, v155
  v_mfma_f32_16x16x32_bf16 a[124:127], a[220:223], v[168:171], 0
  v_add_f32 v12, v12, v155
  v_cvt_pk_bf16_f32 v167, v154, v155
  v_mfma_f32_16x16x32_bf16 v[148:151], v[200:203], v[84:87], v[176:179]
  s_waitcnt vmcnt(16) lgkmcnt(0)
  s_barrier
  v_exp_f32 v156, v156
  v_mfma_f32_16x16x32_bf16 v[152:155], v[216:219], v[84:87], v[176:179]
  ds_read_b128 a[160:163], v24 offset:0
  v_add_f32 v8, v8, v156
  s_add_u32 m0, s25, 32768
  v_mfma_f32_16x16x32_bf16 v[148:151], v[204:207], v[88:91], v[148:151]
  buffer_load_dwordx4 v58, s[4:7], s27 offen nt lds
  v_exp_f32 v157, v157
  v_mfma_f32_16x16x32_bf16 v[152:155], v[220:223], v[88:91], v[152:155]
  ds_read_b128 a[176:179], v28 offset:0
  v_add_f32 v8, v8, v157
  v_cvt_pk_bf16_f32 v168, v156, v157
  v_mfma_f32_16x16x32_bf16 v[148:151], v[208:211], v[92:95], v[148:151]
  buffer_load_dwordx4 v59, s[4:7], s27 offen offset:1024 nt lds
  v_exp_f32 v158, v158
  v_mfma_f32_16x16x32_bf16 v[152:155], v[224:227], v[92:95], v[152:155]
  v_add_f32 v8, v8, v158
  v_mfma_f32_16x16x32_bf16 v[148:151], v[212:215], v[96:99], v[148:151]
  v_exp_f32 v159, v159
  v_mfma_f32_16x16x32_bf16 v[152:155], v[228:231], v[96:99], v[152:155]
  ds_read_b128 a[164:167], v25 offset:0
  v_add_f32 v8, v8, v159
  v_cvt_pk_bf16_f32 v169, v158, v159
  v_mfma_f32_16x16x32_bf16 a[128:131], a[192:195], v[164:167], 0
  buffer_load_dwordx4 v60, s[4:7], s27 offen offset:2048 nt lds
  v_exp_f32 v160, v160
  v_mfma_f32_16x16x32_bf16 a[132:135], a[196:199], v[164:167], 0
  ds_read_b128 a[180:183], v29 offset:0
  v_add_f32 v8, v8, v160
  v_mfma_f32_16x16x32_bf16 a[136:139], a[200:203], v[164:167], 0
  v_exp_f32 v161, v161
  v_mfma_f32_16x16x32_bf16 a[140:143], a[204:207], v[164:167], 0
  v_add_f32 v8, v8, v161
  v_cvt_pk_bf16_f32 v170, v160, v161
  v_mfma_f32_16x16x32_bf16 a[144:147], a[208:211], v[164:167], 0
  buffer_load_dwordx4 v61, s[4:7], s27 offen offset:3072 nt lds
  v_exp_f32 v162, v162
  s_add_u32 s27, s27, 8192
  v_mfma_f32_16x16x32_bf16 a[148:151], a[212:215], v[164:167], 0
  ds_read_b128 a[168:171], v26 offset:0
  v_add_f32 v8, v8, v162
  v_mfma_f32_16x16x32_bf16 a[152:155], a[216:219], v[164:167], 0
  v_exp_f32 v163, v163
  v_mfma_f32_16x16x32_bf16 a[156:159], a[220:223], v[164:167], 0
  v_add_f32 v8, v8, v163
  v_cvt_pk_bf16_f32 v171, v162, v163
  v_mfma_f32_16x16x32_bf16 v[156:159], v[200:203], v[100:103], v[180:183]
  v_exp_f32 v148, v148
  v_mfma_f32_16x16x32_bf16 v[160:163], v[216:219], v[100:103], v[180:183]
  ds_read_b128 a[184:187], v30 offset:0
  v_add_f32 v9, v9, v148
  v_mfma_f32_16x16x32_bf16 v[156:159], v[204:207], v[104:107], v[156:159]
  v_exp_f32 v149, v149
  v_mfma_f32_16x16x32_bf16 v[160:163], v[220:223], v[104:107], v[160:163]
  ds_read_b128 a[172:175], v27 offset:0
  v_add_f32 v9, v9, v149
  v_cvt_pk_bf16_f32 v164, v148, v149
  v_mfma_f32_16x16x32_bf16 v[156:159], v[208:211], v[108:111], v[156:159]
  v_exp_f32 v150, v150
  v_mfma_f32_16x16x32_bf16 v[160:163], v[224:227], v[108:111], v[160:163]
  ds_read_b128 a[188:191], v31 offset:0
  v_add_f32 v9, v9, v150
  v_mfma_f32_16x16x32_bf16 v[156:159], v[212:215], v[112:115], v[156:159]
  v_exp_f32 v151, v151
  v_mfma_f32_16x16x32_bf16 v[160:163], v[228:231], v[112:115], v[160:163]
  v_add_f32 v9, v9, v151
  v_cvt_pk_bf16_f32 v165, v150, v151
  v_mfma_f32_16x16x32_bf16 a[0:3], a[224:227], v[168:171], a[0:3]
  v_exp_f32 v152, v152
  v_mfma_f32_16x16x32_bf16 a[4:7], a[228:231], v[168:171], a[4:7]
  ds_read_b64_tr_b16 a[192:193], v40 offset:0
  v_add_f32 v9, v9, v152
  v_mfma_f32_16x16x32_bf16 a[8:11], a[232:235], v[168:171], a[8:11]
  v_exp_f32 v153, v153
  v_mfma_f32_16x16x32_bf16 a[12:15], a[236:239], v[168:171], a[12:15]
  ds_read_b64_tr_b16 a[194:195], v40 offset:4096
  v_add_f32 v9, v9, v153
  v_cvt_pk_bf16_f32 v166, v152, v153
  v_mfma_f32_16x16x32_bf16 a[16:19], a[240:243], v[168:171], a[16:19]
  v_exp_f32 v154, v154
  v_mfma_f32_16x16x32_bf16 a[20:23], a[244:247], v[168:171], a[20:23]
  ds_read_b64_tr_b16 a[196:197], v41 offset:0
  v_add_f32 v9, v9, v154
  v_mfma_f32_16x16x32_bf16 a[24:27], a[248:251], v[168:171], a[24:27]
  v_exp_f32 v155, v155
  v_mfma_f32_16x16x32_bf16 a[28:31], a[252:255], v[168:171], a[28:31]
  v_add_f32 v9, v9, v155
  v_cvt_pk_bf16_f32 v167, v154, v155
  v_mfma_f32_16x16x32_bf16 v[148:151], v[200:203], v[116:119], v[184:187]
  v_exp_f32 v156, v156
  v_mfma_f32_16x16x32_bf16 v[152:155], v[216:219], v[116:119], v[184:187]
  ds_read_b64_tr_b16 a[198:199], v41 offset:4096
  v_add_f32 v10, v10, v156
  s_add_u32 m0, s25, 49152
  v_mfma_f32_16x16x32_bf16 v[148:151], v[204:207], v[120:123], v[148:151]
  buffer_load_dwordx4 v62, s[8:11], s28 offen nt lds
  v_exp_f32 v157, v157
  v_mfma_f32_16x16x32_bf16 v[152:155], v[220:223], v[120:123], v[152:155]
  ds_read_b64_tr_b16 a[200:201], v42 offset:0
  v_add_f32 v10, v10, v157
  v_cvt_pk_bf16_f32 v168, v156, v157
  v_mfma_f32_16x16x32_bf16 v[148:151], v[208:211], v[124:127], v[148:151]
  buffer_load_dwordx4 v63, s[8:11], s28 offen offset:1024 nt lds
  v_exp_f32 v158, v158
  v_mfma_f32_16x16x32_bf16 v[152:155], v[224:227], v[124:127], v[152:155]
  ds_read_b64_tr_b16 a[202:203], v42 offset:4096
  v_add_f32 v10, v10, v158
  v_mfma_f32_16x16x32_bf16 v[148:151], v[212:215], v[128:131], v[148:151]
  v_exp_f32 v159, v159
  v_mfma_f32_16x16x32_bf16 v[152:155], v[228:231], v[128:131], v[152:155]
  ds_read_b64_tr_b16 a[204:205], v43 offset:0
  v_add_f32 v10, v10, v159
  v_cvt_pk_bf16_f32 v169, v158, v159
  v_mfma_f32_16x16x32_bf16 a[32:35], a[224:227], v[164:167], a[32:35]
  buffer_load_dwordx4 v62, s[8:11], s28 offen offset:2048 nt lds
  v_exp_f32 v160, v160
  v_mfma_f32_16x16x32_bf16 a[36:39], a[228:231], v[164:167], a[36:39]
  ds_read_b64_tr_b16 a[206:207], v43 offset:4096
  v_add_f32 v10, v10, v160
  v_mfma_f32_16x16x32_bf16 a[40:43], a[232:235], v[164:167], a[40:43]
  v_exp_f32 v161, v161
  v_mfma_f32_16x16x32_bf16 a[44:47], a[236:239], v[164:167], a[44:47]
  ds_read_b64_tr_b16 a[208:209], v44 offset:0
  v_add_f32 v10, v10, v161
  v_cvt_pk_bf16_f32 v170, v160, v161
  v_mfma_f32_16x16x32_bf16 a[48:51], a[240:243], v[164:167], a[48:51]
  buffer_load_dwordx4 v63, s[8:11], s28 offen offset:3072 nt lds
  v_exp_f32 v162, v162
  s_add_u32 s28, s28, 8192
  v_mfma_f32_16x16x32_bf16 a[52:55], a[244:247], v[164:167], a[52:55]
  ds_read_b64_tr_b16 a[210:211], v44 offset:4096
  v_add_f32 v10, v10, v162
  v_mfma_f32_16x16x32_bf16 a[56:59], a[248:251], v[164:167], a[56:59]
  v_exp_f32 v163, v163
  v_mfma_f32_16x16x32_bf16 a[60:63], a[252:255], v[164:167], a[60:63]
  v_add_f32 v10, v10, v163
  v_cvt_pk_bf16_f32 v171, v162, v163
  v_mfma_f32_16x16x32_bf16 v[156:159], v[200:203], v[132:135], v[188:191]
  v_exp_f32 v148, v148
  v_mfma_f32_16x16x32_bf16 v[160:163], v[216:219], v[132:135], v[188:191]
  ds_read_b64_tr_b16 a[212:213], v45 offset:0
  v_add_f32 v11, v11, v148
  v_mfma_f32_16x16x32_bf16 v[156:159], v[204:207], v[136:139], v[156:159]
  v_exp_f32 v149, v149
  v_mfma_f32_16x16x32_bf16 v[160:163], v[220:223], v[136:139], v[160:163]
  ds_read_b64_tr_b16 a[214:215], v45 offset:4096
  v_add_f32 v11, v11, v149
  v_cvt_pk_bf16_f32 v164, v148, v149
  v_mfma_f32_16x16x32_bf16 v[156:159], v[208:211], v[140:143], v[156:159]
  v_exp_f32 v150, v150
  v_mfma_f32_16x16x32_bf16 v[160:163], v[224:227], v[140:143], v[160:163]
  ds_read_b64_tr_b16 a[216:217], v46 offset:0
  v_add_f32 v11, v11, v150
  v_mfma_f32_16x16x32_bf16 v[156:159], v[212:215], v[144:147], v[156:159]
  v_exp_f32 v151, v151
  v_mfma_f32_16x16x32_bf16 v[160:163], v[228:231], v[144:147], v[160:163]
  v_add_f32 v11, v11, v151
  v_cvt_pk_bf16_f32 v165, v150, v151
  v_mfma_f32_16x16x32_bf16 a[64:67], a[224:227], v[168:171], a[64:67]
  v_exp_f32 v152, v152
  v_mfma_f32_16x16x32_bf16 a[68:71], a[228:231], v[168:171], a[68:71]
  ds_read_b64_tr_b16 a[218:219], v46 offset:4096
  v_add_f32 v11, v11, v152
  v_mfma_f32_16x16x32_bf16 a[72:75], a[232:235], v[168:171], a[72:75]
  v_exp_f32 v153, v153
  v_mfma_f32_16x16x32_bf16 a[76:79], a[236:239], v[168:171], a[76:79]
  ds_read_b64_tr_b16 a[220:221], v47 offset:0
  v_add_f32 v11, v11, v153
  v_cvt_pk_bf16_f32 v166, v152, v153
  v_mfma_f32_16x16x32_bf16 a[80:83], a[240:243], v[168:171], a[80:83]
  v_exp_f32 v154, v154
  v_mfma_f32_16x16x32_bf16 a[84:87], a[244:247], v[168:171], a[84:87]
  ds_read_b64_tr_b16 a[222:223], v47 offset:4096
  v_add_f32 v11, v11, v154
  v_mfma_f32_16x16x32_bf16 a[88:91], a[248:251], v[168:171], a[88:91]
  v_exp_f32 v155, v155
  v_mfma_f32_16x16x32_bf16 a[92:95], a[252:255], v[168:171], a[92:95]
  v_add_f32 v11, v11, v155
  v_cvt_pk_bf16_f32 v167, v154, v155
  s_waitcnt lgkmcnt(15)
  v_mfma_f32_16x16x32_bf16 v[148:151], a[160:163], v[68:71], v[172:175]
  v_exp_f32 v156, v156
  v_mfma_f32_16x16x32_bf16 v[152:155], a[176:179], v[68:71], v[172:175]
  v_add_f32 v12, v12, v156
  v_mfma_f32_16x16x32_bf16 v[148:151], a[164:167], v[72:75], v[148:151]
  v_exp_f32 v157, v157
  v_mfma_f32_16x16x32_bf16 v[152:155], a[180:183], v[72:75], v[152:155]
  v_add_f32 v12, v12, v157
  v_cvt_pk_bf16_f32 v168, v156, v157
  v_mfma_f32_16x16x32_bf16 v[148:151], a[168:171], v[76:79], v[148:151]
  v_exp_f32 v158, v158
  v_mfma_f32_16x16x32_bf16 v[152:155], a[184:187], v[76:79], v[152:155]
  v_add_f32 v12, v12, v158
  v_mfma_f32_16x16x32_bf16 v[148:151], a[172:175], v[80:83], v[148:151]
  v_exp_f32 v159, v159
  v_mfma_f32_16x16x32_bf16 v[152:155], a[188:191], v[80:83], v[152:155]
  v_add_f32 v12, v12, v159
  v_cvt_pk_bf16_f32 v169, v158, v159
  v_mfma_f32_16x16x32_bf16 a[96:99], a[224:227], v[164:167], a[96:99]
  v_exp_f32 v160, v160
  v_mfma_f32_16x16x32_bf16 a[100:103], a[228:231], v[164:167], a[100:103]
  v_add_f32 v12, v12, v160
  v_mfma_f32_16x16x32_bf16 a[104:107], a[232:235], v[164:167], a[104:107]
  v_exp_f32 v161, v161
  v_mfma_f32_16x16x32_bf16 a[108:111], a[236:239], v[164:167], a[108:111]
  v_add_f32 v12, v12, v161
  v_cvt_pk_bf16_f32 v170, v160, v161
  v_mfma_f32_16x16x32_bf16 a[112:115], a[240:243], v[164:167], a[112:115]
  v_exp_f32 v162, v162
  v_mfma_f32_16x16x32_bf16 a[116:119], a[244:247], v[164:167], a[116:119]
  v_add_f32 v12, v12, v162
  v_mfma_f32_16x16x32_bf16 a[120:123], a[248:251], v[164:167], a[120:123]
  v_exp_f32 v163, v163
  v_mfma_f32_16x16x32_bf16 a[124:127], a[252:255], v[164:167], a[124:127]
  v_add_f32 v12, v12, v163
  v_cvt_pk_bf16_f32 v171, v162, v163
  v_mfma_f32_16x16x32_bf16 v[156:159], a[160:163], v[84:87], v[176:179]
  s_waitcnt vmcnt(16) lgkmcnt(0)
  s_barrier
  v_exp_f32 v148, v148
  v_mfma_f32_16x16x32_bf16 v[160:163], a[176:179], v[84:87], v[176:179]
  ds_read_b128 v[200:203], v24 offset:32768
  v_add_f32 v8, v8, v148
  s_add_u32 m0, s25, 65536
  v_mfma_f32_16x16x32_bf16 v[156:159], a[164:167], v[88:91], v[156:159]
  buffer_load_dwordx4 v58, s[4:7], s27 offen nt lds
  v_exp_f32 v149, v149
  v_mfma_f32_16x16x32_bf16 v[160:163], a[180:183], v[88:91], v[160:163]
  ds_read_b128 v[216:219], v28 offset:32768
  v_add_f32 v8, v8, v149
  v_cvt_pk_bf16_f32 v164, v148, v149
  v_mfma_f32_16x16x32_bf16 v[156:159], a[168:171], v[92:95], v[156:159]
  buffer_load_dwordx4 v59, s[4:7], s27 offen offset:1024 nt lds
  v_exp_f32 v150, v150
  v_mfma_f32_16x16x32_bf16 v[160:163], a[184:187], v[92:95], v[160:163]
  v_add_f32 v8, v8, v150
  v_mfma_f32_16x16x32_bf16 v[156:159], a[172:175], v[96:99], v[156:159]
  v_exp_f32 v151, v151
  v_mfma_f32_16x16x32_bf16 v[160:163], a[188:191], v[96:99], v[160:163]
  ds_read_b128 v[204:207], v25 offset:32768
  v_add_f32 v8, v8, v151
  v_cvt_pk_bf16_f32 v165, v150, v151
  v_mfma_f32_16x16x32_bf16 a[128:131], a[224:227], v[168:171], a[128:131]
  buffer_load_dwordx4 v60, s[4:7], s27 offen offset:2048 nt lds
  v_exp_f32 v152, v152
  v_mfma_f32_16x16x32_bf16 a[132:135], a[228:231], v[168:171], a[132:135]
  ds_read_b128 v[220:223], v29 offset:32768
  v_add_f32 v8, v8, v152
  v_mfma_f32_16x16x32_bf16 a[136:139], a[232:235], v[168:171], a[136:139]
  v_exp_f32 v153, v153
  v_mfma_f32_16x16x32_bf16 a[140:143], a[236:239], v[168:171], a[140:143]
  v_add_f32 v8, v8, v153
  v_cvt_pk_bf16_f32 v166, v152, v153
  v_mfma_f32_16x16x32_bf16 a[144:147], a[240:243], v[168:171], a[144:147]
  buffer_load_dwordx4 v61, s[4:7], s27 offen offset:3072 nt lds
  v_exp_f32 v154, v154
  s_add_u32 s27, s27, 8192
  v_mfma_f32_16x16x32_bf16 a[148:151], a[244:247], v[168:171], a[148:151]
  ds_read_b128 v[208:211], v26 offset:32768
  v_add_f32 v8, v8, v154
  v_mfma_f32_16x16x32_bf16 a[152:155], a[248:251], v[168:171], a[152:155]
  v_exp_f32 v155, v155
  v_mfma_f32_16x16x32_bf16 a[156:159], a[252:255], v[168:171], a[156:159]
  v_add_f32 v8, v8, v155
  v_cvt_pk_bf16_f32 v167, v154, v155
  v_mfma_f32_16x16x32_bf16 v[148:151], a[160:163], v[100:103], v[180:183]
  v_exp_f32 v156, v156
  v_mfma_f32_16x16x32_bf16 v[152:155], a[176:179], v[100:103], v[180:183]
  ds_read_b128 v[224:227], v30 offset:32768
  v_add_f32 v9, v9, v156
  v_mfma_f32_16x16x32_bf16 v[148:151], a[164:167], v[104:107], v[148:151]
  v_exp_f32 v157, v157
  v_mfma_f32_16x16x32_bf16 v[152:155], a[180:183], v[104:107], v[152:155]
  ds_read_b128 v[212:215], v27 offset:32768
  v_add_f32 v9, v9, v157
  v_cvt_pk_bf16_f32 v168, v156, v157
  v_mfma_f32_16x16x32_bf16 v[148:151], a[168:171], v[108:111], v[148:151]
  v_exp_f32 v158, v158
  v_mfma_f32_16x16x32_bf16 v[152:155], a[184:187], v[108:111], v[152:155]
  ds_read_b128 v[228:231], v31 offset:32768
  v_add_f32 v9, v9, v158
  v_mfma_f32_16x16x32_bf16 v[148:151], a[172:175], v[112:115], v[148:151]
  v_exp_f32 v159, v159
  v_mfma_f32_16x16x32_bf16 v[152:155], a[188:191], v[112:115], v[152:155]
  v_add_f32 v9, v9, v159
  v_cvt_pk_bf16_f32 v169, v158, v159
  v_mfma_f32_16x16x32_bf16 a[0:3], a[192:195], v[164:167], a[0:3]
  v_exp_f32 v160, v160
  v_mfma_f32_16x16x32_bf16 a[4:7], a[196:199], v[164:167], a[4:7]
  ds_read_b64_tr_b16 a[224:225], v40 offset:32768
  v_add_f32 v9, v9, v160
  v_mfma_f32_16x16x32_bf16 a[8:11], a[200:203], v[164:167], a[8:11]
  v_exp_f32 v161, v161
  v_mfma_f32_16x16x32_bf16 a[12:15], a[204:207], v[164:167], a[12:15]
  ds_read_b64_tr_b16 a[226:227], v40 offset:36864
  v_add_f32 v9, v9, v161
  v_cvt_pk_bf16_f32 v170, v160, v161
  v_mfma_f32_16x16x32_bf16 a[16:19], a[208:211], v[164:167], a[16:19]
  v_exp_f32 v162, v162
  v_mfma_f32_16x16x32_bf16 a[20:23], a[212:215], v[164:167], a[20:23]
  ds_read_b64_tr_b16 a[228:229], v41 offset:32768
  v_add_f32 v9, v9, v162
  v_mfma_f32_16x16x32_bf16 a[24:27], a[216:219], v[164:167], a[24:27]
  v_exp_f32 v163, v163
  v_mfma_f32_16x16x32_bf16 a[28:31], a[220:223], v[164:167], a[28:31]
  v_add_f32 v9, v9, v163
  v_cvt_pk_bf16_f32 v171, v162, v163
  v_mfma_f32_16x16x32_bf16 v[156:159], a[160:163], v[116:119], v[184:187]
  v_exp_f32 v148, v148
  v_mfma_f32_16x16x32_bf16 v[160:163], a[176:179], v[116:119], v[184:187]
  ds_read_b64_tr_b16 a[230:231], v41 offset:36864
  v_add_f32 v10, v10, v148
  s_add_u32 m0, s25, 81920
  v_mfma_f32_16x16x32_bf16 v[156:159], a[164:167], v[120:123], v[156:159]
  buffer_load_dwordx4 v62, s[8:11], s28 offen nt lds
  v_exp_f32 v149, v149
  v_mfma_f32_16x16x32_bf16 v[160:163], a[180:183], v[120:123], v[160:163]
  ds_read_b64_tr_b16 a[232:233], v42 offset:32768
  v_add_f32 v10, v10, v149
  v_cvt_pk_bf16_f32 v164, v148, v149
  v_mfma_f32_16x16x32_bf16 v[156:159], a[168:171], v[124:127], v[156:159]
  buffer_load_dwordx4 v63, s[8:11], s28 offen offset:1024 nt lds
  v_exp_f32 v150, v150
  v_mfma_f32_16x16x32_bf16 v[160:163], a[184:187], v[124:127], v[160:163]
  ds_read_b64_tr_b16 a[234:235], v42 offset:36864
  v_add_f32 v10, v10, v150
  v_mfma_f32_16x16x32_bf16 v[156:159], a[172:175], v[128:131], v[156:159]
  v_exp_f32 v151, v151
  v_mfma_f32_16x16x32_bf16 v[160:163], a[188:191], v[128:131], v[160:163]
  ds_read_b64_tr_b16 a[236:237], v43 offset:32768
  v_add_f32 v10, v10, v151
  v_cvt_pk_bf16_f32 v165, v150, v151
  v_mfma_f32_16x16x32_bf16 a[32:35], a[192:195], v[168:171], a[32:35]
  buffer_load_dwordx4 v62, s[8:11], s28 offen offset:2048 nt lds
  v_exp_f32 v152, v152
  v_mfma_f32_16x16x32_bf16 a[36:39], a[196:199], v[168:171], a[36:39]
  ds_read_b64_tr_b16 a[238:239], v43 offset:36864
  v_add_f32 v10, v10, v152
  v_mfma_f32_16x16x32_bf16 a[40:43], a[200:203], v[168:171], a[40:43]
  v_exp_f32 v153, v153
  v_mfma_f32_16x16x32_bf16 a[44:47], a[204:207], v[168:171], a[44:47]
  ds_read_b64_tr_b16 a[240:241], v44 offset:32768
  v_add_f32 v10, v10, v153
  v_cvt_pk_bf16_f32 v166, v152, v153
  v_mfma_f32_16x16x32_bf16 a[48:51], a[208:211], v[168:171], a[48:51]
  buffer_load_dwordx4 v63, s[8:11], s28 offen offset:3072 nt lds
  v_exp_f32 v154, v154
  s_add_u32 s28, s28, 8192
  v_mfma_f32_16x16x32_bf16 a[52:55], a[212:215], v[168:171], a[52:55]
  ds_read_b64_tr_b16 a[242:243], v44 offset:36864
  v_add_f32 v10, v10, v154
  v_mfma_f32_16x16x32_bf16 a[56:59], a[216:219], v[168:171], a[56:59]
  v_exp_f32 v155, v155
  v_mfma_f32_16x16x32_bf16 a[60:63], a[220:223], v[168:171], a[60:63]
  v_add_f32 v10, v10, v155
  v_cvt_pk_bf16_f32 v167, v154, v155
  v_mfma_f32_16x16x32_bf16 v[148:151], a[160:163], v[132:135], v[188:191]
  v_exp_f32 v156, v156
  v_mfma_f32_16x16x32_bf16 v[152:155], a[176:179], v[132:135], v[188:191]
  ds_read_b64_tr_b16 a[244:245], v45 offset:32768
  v_add_f32 v11, v11, v156
  v_mfma_f32_16x16x32_bf16 v[148:151], a[164:167], v[136:139], v[148:151]
  v_exp_f32 v157, v157
  v_mfma_f32_16x16x32_bf16 v[152:155], a[180:183], v[136:139], v[152:155]
  ds_read_b64_tr_b16 a[246:247], v45 offset:36864
  v_add_f32 v11, v11, v157
  v_cvt_pk_bf16_f32 v168, v156, v157
  v_mfma_f32_16x16x32_bf16 v[148:151], a[168:171], v[140:143], v[148:151]
  v_exp_f32 v158, v158
  v_mfma_f32_16x16x32_bf16 v[152:155], a[184:187], v[140:143], v[152:155]
  ds_read_b64_tr_b16 a[248:249], v46 offset:32768
  v_add_f32 v11, v11, v158
  v_mfma_f32_16x16x32_bf16 v[148:151], a[172:175], v[144:147], v[148:151]
  v_exp_f32 v159, v159
  v_mfma_f32_16x16x32_bf16 v[152:155], a[188:191], v[144:147], v[152:155]
  v_add_f32 v11, v11, v159
  v_cvt_pk_bf16_f32 v169, v158, v159
  v_mfma_f32_16x16x32_bf16 a[64:67], a[192:195], v[164:167], a[64:67]
  v_exp_f32 v160, v160
  v_mfma_f32_16x16x32_bf16 a[68:71], a[196:199], v[164:167], a[68:71]
  ds_read_b64_tr_b16 a[250:251], v46 offset:36864
  v_add_f32 v11, v11, v160
  v_mfma_f32_16x16x32_bf16 a[72:75], a[200:203], v[164:167], a[72:75]
  v_exp_f32 v161, v161
  v_mfma_f32_16x16x32_bf16 a[76:79], a[204:207], v[164:167], a[76:79]
  ds_read_b64_tr_b16 a[252:253], v47 offset:32768
  v_add_f32 v11, v11, v161
  v_cvt_pk_bf16_f32 v170, v160, v161
  v_mfma_f32_16x16x32_bf16 a[80:83], a[208:211], v[164:167], a[80:83]
  v_exp_f32 v162, v162
  v_mfma_f32_16x16x32_bf16 a[84:87], a[212:215], v[164:167], a[84:87]
  ds_read_b64_tr_b16 a[254:255], v47 offset:36864
  v_add_f32 v11, v11, v162
  v_mfma_f32_16x16x32_bf16 a[88:91], a[216:219], v[164:167], a[88:91]
  v_exp_f32 v163, v163
  v_mfma_f32_16x16x32_bf16 a[92:95], a[220:223], v[164:167], a[92:95]
  v_add_f32 v11, v11, v163
  v_cvt_pk_bf16_f32 v171, v162, v163
  s_waitcnt lgkmcnt(15)
  v_mfma_f32_16x16x32_bf16 v[156:159], v[200:203], v[68:71], v[172:175]
  v_exp_f32 v148, v148
  v_mfma_f32_16x16x32_bf16 v[160:163], v[216:219], v[68:71], v[172:175]
  v_add_f32 v12, v12, v148
  v_mfma_f32_16x16x32_bf16 v[156:159], v[204:207], v[72:75], v[156:159]
  v_exp_f32 v149, v149
  v_mfma_f32_16x16x32_bf16 v[160:163], v[220:223], v[72:75], v[160:163]
  v_add_f32 v12, v12, v149
  v_cvt_pk_bf16_f32 v164, v148, v149
  v_mfma_f32_16x16x32_bf16 v[156:159], v[208:211], v[76:79], v[156:159]
  v_exp_f32 v150, v150
  v_mfma_f32_16x16x32_bf16 v[160:163], v[224:227], v[76:79], v[160:163]
  v_add_f32 v12, v12, v150
  v_mfma_f32_16x16x32_bf16 v[156:159], v[212:215], v[80:83], v[156:159]
  v_exp_f32 v151, v151
  v_mfma_f32_16x16x32_bf16 v[160:163], v[228:231], v[80:83], v[160:163]
  v_add_f32 v12, v12, v151
  v_cvt_pk_bf16_f32 v165, v150, v151
  v_mfma_f32_16x16x32_bf16 a[96:99], a[192:195], v[168:171], a[96:99]
  v_exp_f32 v152, v152
  v_mfma_f32_16x16x32_bf16 a[100:103], a[196:199], v[168:171], a[100:103]
  v_add_f32 v12, v12, v152
  v_mfma_f32_16x16x32_bf16 a[104:107], a[200:203], v[168:171], a[104:107]
  v_exp_f32 v153, v153
  v_mfma_f32_16x16x32_bf16 a[108:111], a[204:207], v[168:171], a[108:111]
  v_add_f32 v12, v12, v153
  v_cvt_pk_bf16_f32 v166, v152, v153
  v_mfma_f32_16x16x32_bf16 a[112:115], a[208:211], v[168:171], a[112:115]
  v_exp_f32 v154, v154
  v_mfma_f32_16x16x32_bf16 a[116:119], a[212:215], v[168:171], a[116:119]
  v_add_f32 v12, v12, v154
  v_mfma_f32_16x16x32_bf16 a[120:123], a[216:219], v[168:171], a[120:123]
  v_exp_f32 v155, v155
  v_mfma_f32_16x16x32_bf16 a[124:127], a[220:223], v[168:171], a[124:127]
  v_add_f32 v12, v12, v155
  v_cvt_pk_bf16_f32 v167, v154, v155
  s_mov_b32 s31, 6
concat_heads__mha_block_cached__mha_block_cached__near_ridge_kernel_loop:
  v_mfma_f32_16x16x32_bf16 v[148:151], v[200:203], v[84:87], v[176:179]
  s_waitcnt vmcnt(16) lgkmcnt(0)
  s_barrier
  v_exp_f32 v156, v156
  v_mfma_f32_16x16x32_bf16 v[152:155], v[216:219], v[84:87], v[176:179]
  ds_read_b128 a[160:163], v16 offset:0
  v_add_f32 v8, v8, v156
  s_add_u32 m0, s25, 98304
  v_mfma_f32_16x16x32_bf16 v[148:151], v[204:207], v[88:91], v[148:151]
  buffer_load_dwordx4 v58, s[4:7], s27 offen nt lds
  v_exp_f32 v157, v157
  v_mfma_f32_16x16x32_bf16 v[152:155], v[220:223], v[88:91], v[152:155]
  ds_read_b128 a[176:179], v20 offset:0
  v_add_f32 v8, v8, v157
  v_cvt_pk_bf16_f32 v168, v156, v157
  v_mfma_f32_16x16x32_bf16 v[148:151], v[208:211], v[92:95], v[148:151]
  buffer_load_dwordx4 v59, s[4:7], s27 offen offset:1024 nt lds
  v_exp_f32 v158, v158
  v_mfma_f32_16x16x32_bf16 v[152:155], v[224:227], v[92:95], v[152:155]
  v_add_f32 v8, v8, v158
  v_mfma_f32_16x16x32_bf16 v[148:151], v[212:215], v[96:99], v[148:151]
  v_exp_f32 v159, v159
  v_mfma_f32_16x16x32_bf16 v[152:155], v[228:231], v[96:99], v[152:155]
  ds_read_b128 a[164:167], v17 offset:0
  v_add_f32 v8, v8, v159
  v_cvt_pk_bf16_f32 v169, v158, v159
  v_mfma_f32_16x16x32_bf16 a[128:131], a[192:195], v[164:167], a[128:131]
  buffer_load_dwordx4 v60, s[4:7], s27 offen offset:2048 nt lds
  v_exp_f32 v160, v160
  v_mfma_f32_16x16x32_bf16 a[132:135], a[196:199], v[164:167], a[132:135]
  ds_read_b128 a[180:183], v21 offset:0
  v_add_f32 v8, v8, v160
  v_mfma_f32_16x16x32_bf16 a[136:139], a[200:203], v[164:167], a[136:139]
  v_exp_f32 v161, v161
  v_mfma_f32_16x16x32_bf16 a[140:143], a[204:207], v[164:167], a[140:143]
  v_add_f32 v8, v8, v161
  v_cvt_pk_bf16_f32 v170, v160, v161
  v_mfma_f32_16x16x32_bf16 a[144:147], a[208:211], v[164:167], a[144:147]
  buffer_load_dwordx4 v61, s[4:7], s27 offen offset:3072 nt lds
  v_exp_f32 v162, v162
  s_add_u32 s27, s27, 8192
  v_mfma_f32_16x16x32_bf16 a[148:151], a[212:215], v[164:167], a[148:151]
  ds_read_b128 a[168:171], v18 offset:0
  v_add_f32 v8, v8, v162
  v_mfma_f32_16x16x32_bf16 a[152:155], a[216:219], v[164:167], a[152:155]
  v_exp_f32 v163, v163
  v_mfma_f32_16x16x32_bf16 a[156:159], a[220:223], v[164:167], a[156:159]
  v_add_f32 v8, v8, v163
  v_cvt_pk_bf16_f32 v171, v162, v163
  v_mfma_f32_16x16x32_bf16 v[156:159], v[200:203], v[100:103], v[180:183]
  v_exp_f32 v148, v148
  v_mfma_f32_16x16x32_bf16 v[160:163], v[216:219], v[100:103], v[180:183]
  ds_read_b128 a[184:187], v22 offset:0
  v_add_f32 v9, v9, v148
  v_mfma_f32_16x16x32_bf16 v[156:159], v[204:207], v[104:107], v[156:159]
  v_exp_f32 v149, v149
  v_mfma_f32_16x16x32_bf16 v[160:163], v[220:223], v[104:107], v[160:163]
  ds_read_b128 a[172:175], v19 offset:0
  v_add_f32 v9, v9, v149
  v_cvt_pk_bf16_f32 v164, v148, v149
  v_mfma_f32_16x16x32_bf16 v[156:159], v[208:211], v[108:111], v[156:159]
  v_exp_f32 v150, v150
  v_mfma_f32_16x16x32_bf16 v[160:163], v[224:227], v[108:111], v[160:163]
  ds_read_b128 a[188:191], v23 offset:0
  v_add_f32 v9, v9, v150
  v_mfma_f32_16x16x32_bf16 v[156:159], v[212:215], v[112:115], v[156:159]
  v_exp_f32 v151, v151
  v_mfma_f32_16x16x32_bf16 v[160:163], v[228:231], v[112:115], v[160:163]
  v_add_f32 v9, v9, v151
  v_cvt_pk_bf16_f32 v165, v150, v151
  v_mfma_f32_16x16x32_bf16 a[0:3], a[224:227], v[168:171], a[0:3]
  v_exp_f32 v152, v152
  v_mfma_f32_16x16x32_bf16 a[4:7], a[228:231], v[168:171], a[4:7]
  ds_read_b64_tr_b16 a[192:193], v32 offset:0
  v_add_f32 v9, v9, v152
  v_mfma_f32_16x16x32_bf16 a[8:11], a[232:235], v[168:171], a[8:11]
  v_exp_f32 v153, v153
  v_mfma_f32_16x16x32_bf16 a[12:15], a[236:239], v[168:171], a[12:15]
  ds_read_b64_tr_b16 a[194:195], v32 offset:4096
  v_add_f32 v9, v9, v153
  v_cvt_pk_bf16_f32 v166, v152, v153
  v_mfma_f32_16x16x32_bf16 a[16:19], a[240:243], v[168:171], a[16:19]
  v_exp_f32 v154, v154
  v_mfma_f32_16x16x32_bf16 a[20:23], a[244:247], v[168:171], a[20:23]
  ds_read_b64_tr_b16 a[196:197], v33 offset:0
  v_add_f32 v9, v9, v154
  v_mfma_f32_16x16x32_bf16 a[24:27], a[248:251], v[168:171], a[24:27]
  v_exp_f32 v155, v155
  v_mfma_f32_16x16x32_bf16 a[28:31], a[252:255], v[168:171], a[28:31]
  v_add_f32 v9, v9, v155
  v_cvt_pk_bf16_f32 v167, v154, v155
  v_mfma_f32_16x16x32_bf16 v[148:151], v[200:203], v[116:119], v[184:187]
  v_exp_f32 v156, v156
  v_mfma_f32_16x16x32_bf16 v[152:155], v[216:219], v[116:119], v[184:187]
  ds_read_b64_tr_b16 a[198:199], v33 offset:4096
  v_add_f32 v10, v10, v156
  s_add_u32 m0, s25, 114688
  v_mfma_f32_16x16x32_bf16 v[148:151], v[204:207], v[120:123], v[148:151]
  buffer_load_dwordx4 v62, s[8:11], s28 offen nt lds
  v_exp_f32 v157, v157
  v_mfma_f32_16x16x32_bf16 v[152:155], v[220:223], v[120:123], v[152:155]
  ds_read_b64_tr_b16 a[200:201], v34 offset:0
  v_add_f32 v10, v10, v157
  v_cvt_pk_bf16_f32 v168, v156, v157
  v_mfma_f32_16x16x32_bf16 v[148:151], v[208:211], v[124:127], v[148:151]
  buffer_load_dwordx4 v63, s[8:11], s28 offen offset:1024 nt lds
  v_exp_f32 v158, v158
  v_mfma_f32_16x16x32_bf16 v[152:155], v[224:227], v[124:127], v[152:155]
  ds_read_b64_tr_b16 a[202:203], v34 offset:4096
  v_add_f32 v10, v10, v158
  v_mfma_f32_16x16x32_bf16 v[148:151], v[212:215], v[128:131], v[148:151]
  v_exp_f32 v159, v159
  v_mfma_f32_16x16x32_bf16 v[152:155], v[228:231], v[128:131], v[152:155]
  ds_read_b64_tr_b16 a[204:205], v35 offset:0
  v_add_f32 v10, v10, v159
  v_cvt_pk_bf16_f32 v169, v158, v159
  v_mfma_f32_16x16x32_bf16 a[32:35], a[224:227], v[164:167], a[32:35]
  buffer_load_dwordx4 v62, s[8:11], s28 offen offset:2048 nt lds
  v_exp_f32 v160, v160
  v_mfma_f32_16x16x32_bf16 a[36:39], a[228:231], v[164:167], a[36:39]
  ds_read_b64_tr_b16 a[206:207], v35 offset:4096
  v_add_f32 v10, v10, v160
  v_mfma_f32_16x16x32_bf16 a[40:43], a[232:235], v[164:167], a[40:43]
  v_exp_f32 v161, v161
  v_mfma_f32_16x16x32_bf16 a[44:47], a[236:239], v[164:167], a[44:47]
  ds_read_b64_tr_b16 a[208:209], v36 offset:0
  v_add_f32 v10, v10, v161
  v_cvt_pk_bf16_f32 v170, v160, v161
  v_mfma_f32_16x16x32_bf16 a[48:51], a[240:243], v[164:167], a[48:51]
  buffer_load_dwordx4 v63, s[8:11], s28 offen offset:3072 nt lds
  v_exp_f32 v162, v162
  s_add_u32 s28, s28, 8192
  v_mfma_f32_16x16x32_bf16 a[52:55], a[244:247], v[164:167], a[52:55]
  ds_read_b64_tr_b16 a[210:211], v36 offset:4096
  v_add_f32 v10, v10, v162
  v_mfma_f32_16x16x32_bf16 a[56:59], a[248:251], v[164:167], a[56:59]
  v_exp_f32 v163, v163
  v_mfma_f32_16x16x32_bf16 a[60:63], a[252:255], v[164:167], a[60:63]
  v_add_f32 v10, v10, v163
  v_cvt_pk_bf16_f32 v171, v162, v163
  v_mfma_f32_16x16x32_bf16 v[156:159], v[200:203], v[132:135], v[188:191]
  v_exp_f32 v148, v148
  v_mfma_f32_16x16x32_bf16 v[160:163], v[216:219], v[132:135], v[188:191]
  ds_read_b64_tr_b16 a[212:213], v37 offset:0
  v_add_f32 v11, v11, v148
  v_mfma_f32_16x16x32_bf16 v[156:159], v[204:207], v[136:139], v[156:159]
  v_exp_f32 v149, v149
  v_mfma_f32_16x16x32_bf16 v[160:163], v[220:223], v[136:139], v[160:163]
  ds_read_b64_tr_b16 a[214:215], v37 offset:4096
  v_add_f32 v11, v11, v149
  v_cvt_pk_bf16_f32 v164, v148, v149
  v_mfma_f32_16x16x32_bf16 v[156:159], v[208:211], v[140:143], v[156:159]
  v_exp_f32 v150, v150
  v_mfma_f32_16x16x32_bf16 v[160:163], v[224:227], v[140:143], v[160:163]
  ds_read_b64_tr_b16 a[216:217], v38 offset:0
  v_add_f32 v11, v11, v150
  v_mfma_f32_16x16x32_bf16 v[156:159], v[212:215], v[144:147], v[156:159]
  v_exp_f32 v151, v151
  v_mfma_f32_16x16x32_bf16 v[160:163], v[228:231], v[144:147], v[160:163]
  v_add_f32 v11, v11, v151
  v_cvt_pk_bf16_f32 v165, v150, v151
  v_mfma_f32_16x16x32_bf16 a[64:67], a[224:227], v[168:171], a[64:67]
  v_exp_f32 v152, v152
  v_mfma_f32_16x16x32_bf16 a[68:71], a[228:231], v[168:171], a[68:71]
  ds_read_b64_tr_b16 a[218:219], v38 offset:4096
  v_add_f32 v11, v11, v152
  v_mfma_f32_16x16x32_bf16 a[72:75], a[232:235], v[168:171], a[72:75]
  v_exp_f32 v153, v153
  v_mfma_f32_16x16x32_bf16 a[76:79], a[236:239], v[168:171], a[76:79]
  ds_read_b64_tr_b16 a[220:221], v39 offset:0
  v_add_f32 v11, v11, v153
  v_cvt_pk_bf16_f32 v166, v152, v153
  v_mfma_f32_16x16x32_bf16 a[80:83], a[240:243], v[168:171], a[80:83]
  v_exp_f32 v154, v154
  v_mfma_f32_16x16x32_bf16 a[84:87], a[244:247], v[168:171], a[84:87]
  ds_read_b64_tr_b16 a[222:223], v39 offset:4096
  v_add_f32 v11, v11, v154
  v_mfma_f32_16x16x32_bf16 a[88:91], a[248:251], v[168:171], a[88:91]
  v_exp_f32 v155, v155
  v_mfma_f32_16x16x32_bf16 a[92:95], a[252:255], v[168:171], a[92:95]
  v_add_f32 v11, v11, v155
  v_cvt_pk_bf16_f32 v167, v154, v155
  s_waitcnt lgkmcnt(15)
  v_mfma_f32_16x16x32_bf16 v[148:151], a[160:163], v[68:71], v[172:175]
  v_exp_f32 v156, v156
  v_mfma_f32_16x16x32_bf16 v[152:155], a[176:179], v[68:71], v[172:175]
  v_add_f32 v12, v12, v156
  v_mfma_f32_16x16x32_bf16 v[148:151], a[164:167], v[72:75], v[148:151]
  v_exp_f32 v157, v157
  v_mfma_f32_16x16x32_bf16 v[152:155], a[180:183], v[72:75], v[152:155]
  v_add_f32 v12, v12, v157
  v_cvt_pk_bf16_f32 v168, v156, v157
  v_mfma_f32_16x16x32_bf16 v[148:151], a[168:171], v[76:79], v[148:151]
  v_exp_f32 v158, v158
  v_mfma_f32_16x16x32_bf16 v[152:155], a[184:187], v[76:79], v[152:155]
  v_add_f32 v12, v12, v158
  v_mfma_f32_16x16x32_bf16 v[148:151], a[172:175], v[80:83], v[148:151]
  v_exp_f32 v159, v159
  v_mfma_f32_16x16x32_bf16 v[152:155], a[188:191], v[80:83], v[152:155]
  v_add_f32 v12, v12, v159
  v_cvt_pk_bf16_f32 v169, v158, v159
  v_mfma_f32_16x16x32_bf16 a[96:99], a[224:227], v[164:167], a[96:99]
  v_exp_f32 v160, v160
  v_mfma_f32_16x16x32_bf16 a[100:103], a[228:231], v[164:167], a[100:103]
  v_add_f32 v12, v12, v160
  v_mfma_f32_16x16x32_bf16 a[104:107], a[232:235], v[164:167], a[104:107]
  v_exp_f32 v161, v161
  v_mfma_f32_16x16x32_bf16 a[108:111], a[236:239], v[164:167], a[108:111]
  v_add_f32 v12, v12, v161
  v_cvt_pk_bf16_f32 v170, v160, v161
  v_mfma_f32_16x16x32_bf16 a[112:115], a[240:243], v[164:167], a[112:115]
  v_exp_f32 v162, v162
  v_mfma_f32_16x16x32_bf16 a[116:119], a[244:247], v[164:167], a[116:119]
  v_add_f32 v12, v12, v162
  v_mfma_f32_16x16x32_bf16 a[120:123], a[248:251], v[164:167], a[120:123]
  v_exp_f32 v163, v163
  v_mfma_f32_16x16x32_bf16 a[124:127], a[252:255], v[164:167], a[124:127]
  v_add_f32 v12, v12, v163
  v_cvt_pk_bf16_f32 v171, v162, v163
  v_mfma_f32_16x16x32_bf16 v[156:159], a[160:163], v[84:87], v[176:179]
  s_waitcnt vmcnt(16) lgkmcnt(0)
  s_barrier
  v_exp_f32 v148, v148
  v_mfma_f32_16x16x32_bf16 v[160:163], a[176:179], v[84:87], v[176:179]
  ds_read_b128 v[200:203], v16 offset:32768
  v_add_f32 v8, v8, v148
  s_add_u32 m0, s25, 0
  v_mfma_f32_16x16x32_bf16 v[156:159], a[164:167], v[88:91], v[156:159]
  buffer_load_dwordx4 v58, s[4:7], s27 offen nt lds
  v_exp_f32 v149, v149
  v_mfma_f32_16x16x32_bf16 v[160:163], a[180:183], v[88:91], v[160:163]
  ds_read_b128 v[216:219], v20 offset:32768
  v_add_f32 v8, v8, v149
  v_cvt_pk_bf16_f32 v164, v148, v149
  v_mfma_f32_16x16x32_bf16 v[156:159], a[168:171], v[92:95], v[156:159]
  buffer_load_dwordx4 v59, s[4:7], s27 offen offset:1024 nt lds
  v_exp_f32 v150, v150
  v_mfma_f32_16x16x32_bf16 v[160:163], a[184:187], v[92:95], v[160:163]
  v_add_f32 v8, v8, v150
  v_mfma_f32_16x16x32_bf16 v[156:159], a[172:175], v[96:99], v[156:159]
  v_exp_f32 v151, v151
  v_mfma_f32_16x16x32_bf16 v[160:163], a[188:191], v[96:99], v[160:163]
  ds_read_b128 v[204:207], v17 offset:32768
  v_add_f32 v8, v8, v151
  v_cvt_pk_bf16_f32 v165, v150, v151
  v_mfma_f32_16x16x32_bf16 a[128:131], a[224:227], v[168:171], a[128:131]
  buffer_load_dwordx4 v60, s[4:7], s27 offen offset:2048 nt lds
  v_exp_f32 v152, v152
  v_mfma_f32_16x16x32_bf16 a[132:135], a[228:231], v[168:171], a[132:135]
  ds_read_b128 v[220:223], v21 offset:32768
  v_add_f32 v8, v8, v152
  v_mfma_f32_16x16x32_bf16 a[136:139], a[232:235], v[168:171], a[136:139]
  v_exp_f32 v153, v153
  v_mfma_f32_16x16x32_bf16 a[140:143], a[236:239], v[168:171], a[140:143]
  v_add_f32 v8, v8, v153
  v_cvt_pk_bf16_f32 v166, v152, v153
  v_mfma_f32_16x16x32_bf16 a[144:147], a[240:243], v[168:171], a[144:147]
  buffer_load_dwordx4 v61, s[4:7], s27 offen offset:3072 nt lds
  v_exp_f32 v154, v154
  s_add_u32 s27, s27, 8192
  v_mfma_f32_16x16x32_bf16 a[148:151], a[244:247], v[168:171], a[148:151]
  ds_read_b128 v[208:211], v18 offset:32768
  v_add_f32 v8, v8, v154
  v_mfma_f32_16x16x32_bf16 a[152:155], a[248:251], v[168:171], a[152:155]
  v_exp_f32 v155, v155
  v_mfma_f32_16x16x32_bf16 a[156:159], a[252:255], v[168:171], a[156:159]
  v_add_f32 v8, v8, v155
  v_cvt_pk_bf16_f32 v167, v154, v155
  v_mfma_f32_16x16x32_bf16 v[148:151], a[160:163], v[100:103], v[180:183]
  v_exp_f32 v156, v156
  v_mfma_f32_16x16x32_bf16 v[152:155], a[176:179], v[100:103], v[180:183]
  ds_read_b128 v[224:227], v22 offset:32768
  v_add_f32 v9, v9, v156
  v_mfma_f32_16x16x32_bf16 v[148:151], a[164:167], v[104:107], v[148:151]
  v_exp_f32 v157, v157
  v_mfma_f32_16x16x32_bf16 v[152:155], a[180:183], v[104:107], v[152:155]
  ds_read_b128 v[212:215], v19 offset:32768
  v_add_f32 v9, v9, v157
  v_cvt_pk_bf16_f32 v168, v156, v157
  v_mfma_f32_16x16x32_bf16 v[148:151], a[168:171], v[108:111], v[148:151]
  v_exp_f32 v158, v158
  v_mfma_f32_16x16x32_bf16 v[152:155], a[184:187], v[108:111], v[152:155]
  ds_read_b128 v[228:231], v23 offset:32768
  v_add_f32 v9, v9, v158
  v_mfma_f32_16x16x32_bf16 v[148:151], a[172:175], v[112:115], v[148:151]
  v_exp_f32 v159, v159
  v_mfma_f32_16x16x32_bf16 v[152:155], a[188:191], v[112:115], v[152:155]
  v_add_f32 v9, v9, v159
  v_cvt_pk_bf16_f32 v169, v158, v159
  v_mfma_f32_16x16x32_bf16 a[0:3], a[192:195], v[164:167], a[0:3]
  v_exp_f32 v160, v160
  v_mfma_f32_16x16x32_bf16 a[4:7], a[196:199], v[164:167], a[4:7]
  ds_read_b64_tr_b16 a[224:225], v32 offset:32768
  v_add_f32 v9, v9, v160
  v_mfma_f32_16x16x32_bf16 a[8:11], a[200:203], v[164:167], a[8:11]
  v_exp_f32 v161, v161
  v_mfma_f32_16x16x32_bf16 a[12:15], a[204:207], v[164:167], a[12:15]
  ds_read_b64_tr_b16 a[226:227], v32 offset:36864
  v_add_f32 v9, v9, v161
  v_cvt_pk_bf16_f32 v170, v160, v161
  v_mfma_f32_16x16x32_bf16 a[16:19], a[208:211], v[164:167], a[16:19]
  v_exp_f32 v162, v162
  v_mfma_f32_16x16x32_bf16 a[20:23], a[212:215], v[164:167], a[20:23]
  ds_read_b64_tr_b16 a[228:229], v33 offset:32768
  v_add_f32 v9, v9, v162
  v_mfma_f32_16x16x32_bf16 a[24:27], a[216:219], v[164:167], a[24:27]
  v_exp_f32 v163, v163
  v_mfma_f32_16x16x32_bf16 a[28:31], a[220:223], v[164:167], a[28:31]
  v_add_f32 v9, v9, v163
  v_cvt_pk_bf16_f32 v171, v162, v163
  v_mfma_f32_16x16x32_bf16 v[156:159], a[160:163], v[116:119], v[184:187]
  v_exp_f32 v148, v148
  v_mfma_f32_16x16x32_bf16 v[160:163], a[176:179], v[116:119], v[184:187]
  ds_read_b64_tr_b16 a[230:231], v33 offset:36864
  v_add_f32 v10, v10, v148
  s_add_u32 m0, s25, 16384
  v_mfma_f32_16x16x32_bf16 v[156:159], a[164:167], v[120:123], v[156:159]
  buffer_load_dwordx4 v62, s[8:11], s28 offen nt lds
  v_exp_f32 v149, v149
  v_mfma_f32_16x16x32_bf16 v[160:163], a[180:183], v[120:123], v[160:163]
  ds_read_b64_tr_b16 a[232:233], v34 offset:32768
  v_add_f32 v10, v10, v149
  v_cvt_pk_bf16_f32 v164, v148, v149
  v_mfma_f32_16x16x32_bf16 v[156:159], a[168:171], v[124:127], v[156:159]
  buffer_load_dwordx4 v63, s[8:11], s28 offen offset:1024 nt lds
  v_exp_f32 v150, v150
  v_mfma_f32_16x16x32_bf16 v[160:163], a[184:187], v[124:127], v[160:163]
  ds_read_b64_tr_b16 a[234:235], v34 offset:36864
  v_add_f32 v10, v10, v150
  v_mfma_f32_16x16x32_bf16 v[156:159], a[172:175], v[128:131], v[156:159]
  v_exp_f32 v151, v151
  v_mfma_f32_16x16x32_bf16 v[160:163], a[188:191], v[128:131], v[160:163]
  ds_read_b64_tr_b16 a[236:237], v35 offset:32768
  v_add_f32 v10, v10, v151
  v_cvt_pk_bf16_f32 v165, v150, v151
  v_mfma_f32_16x16x32_bf16 a[32:35], a[192:195], v[168:171], a[32:35]
  buffer_load_dwordx4 v62, s[8:11], s28 offen offset:2048 nt lds
  v_exp_f32 v152, v152
  v_mfma_f32_16x16x32_bf16 a[36:39], a[196:199], v[168:171], a[36:39]
  ds_read_b64_tr_b16 a[238:239], v35 offset:36864
  v_add_f32 v10, v10, v152
  v_mfma_f32_16x16x32_bf16 a[40:43], a[200:203], v[168:171], a[40:43]
  v_exp_f32 v153, v153
  v_mfma_f32_16x16x32_bf16 a[44:47], a[204:207], v[168:171], a[44:47]
  ds_read_b64_tr_b16 a[240:241], v36 offset:32768
  v_add_f32 v10, v10, v153
  v_cvt_pk_bf16_f32 v166, v152, v153
  v_mfma_f32_16x16x32_bf16 a[48:51], a[208:211], v[168:171], a[48:51]
  buffer_load_dwordx4 v63, s[8:11], s28 offen offset:3072 nt lds
  v_exp_f32 v154, v154
  s_add_u32 s28, s28, 8192
  v_mfma_f32_16x16x32_bf16 a[52:55], a[212:215], v[168:171], a[52:55]
  ds_read_b64_tr_b16 a[242:243], v36 offset:36864
  v_add_f32 v10, v10, v154
  v_mfma_f32_16x16x32_bf16 a[56:59], a[216:219], v[168:171], a[56:59]
  v_exp_f32 v155, v155
  v_mfma_f32_16x16x32_bf16 a[60:63], a[220:223], v[168:171], a[60:63]
  v_add_f32 v10, v10, v155
  v_cvt_pk_bf16_f32 v167, v154, v155
  v_mfma_f32_16x16x32_bf16 v[148:151], a[160:163], v[132:135], v[188:191]
  v_exp_f32 v156, v156
  v_mfma_f32_16x16x32_bf16 v[152:155], a[176:179], v[132:135], v[188:191]
  ds_read_b64_tr_b16 a[244:245], v37 offset:32768
  v_add_f32 v11, v11, v156
  v_mfma_f32_16x16x32_bf16 v[148:151], a[164:167], v[136:139], v[148:151]
  v_exp_f32 v157, v157
  v_mfma_f32_16x16x32_bf16 v[152:155], a[180:183], v[136:139], v[152:155]
  ds_read_b64_tr_b16 a[246:247], v37 offset:36864
  v_add_f32 v11, v11, v157
  v_cvt_pk_bf16_f32 v168, v156, v157
  v_mfma_f32_16x16x32_bf16 v[148:151], a[168:171], v[140:143], v[148:151]
  v_exp_f32 v158, v158
  v_mfma_f32_16x16x32_bf16 v[152:155], a[184:187], v[140:143], v[152:155]
  ds_read_b64_tr_b16 a[248:249], v38 offset:32768
  v_add_f32 v11, v11, v158
  v_mfma_f32_16x16x32_bf16 v[148:151], a[172:175], v[144:147], v[148:151]
  v_exp_f32 v159, v159
  v_mfma_f32_16x16x32_bf16 v[152:155], a[188:191], v[144:147], v[152:155]
  v_add_f32 v11, v11, v159
  v_cvt_pk_bf16_f32 v169, v158, v159
  v_mfma_f32_16x16x32_bf16 a[64:67], a[192:195], v[164:167], a[64:67]
  v_exp_f32 v160, v160
  v_mfma_f32_16x16x32_bf16 a[68:71], a[196:199], v[164:167], a[68:71]
  ds_read_b64_tr_b16 a[250:251], v38 offset:36864
  v_add_f32 v11, v11, v160
  v_mfma_f32_16x16x32_bf16 a[72:75], a[200:203], v[164:167], a[72:75]
  v_exp_f32 v161, v161
  v_mfma_f32_16x16x32_bf16 a[76:79], a[204:207], v[164:167], a[76:79]
  ds_read_b64_tr_b16 a[252:253], v39 offset:32768
  v_add_f32 v11, v11, v161
  v_cvt_pk_bf16_f32 v170, v160, v161
  v_mfma_f32_16x16x32_bf16 a[80:83], a[208:211], v[164:167], a[80:83]
  v_exp_f32 v162, v162
  v_mfma_f32_16x16x32_bf16 a[84:87], a[212:215], v[164:167], a[84:87]
  ds_read_b64_tr_b16 a[254:255], v39 offset:36864
  v_add_f32 v11, v11, v162
  v_mfma_f32_16x16x32_bf16 a[88:91], a[216:219], v[164:167], a[88:91]
  v_exp_f32 v163, v163
  v_mfma_f32_16x16x32_bf16 a[92:95], a[220:223], v[164:167], a[92:95]
  v_add_f32 v11, v11, v163
  v_cvt_pk_bf16_f32 v171, v162, v163
  s_waitcnt lgkmcnt(15)
  v_mfma_f32_16x16x32_bf16 v[156:159], v[200:203], v[68:71], v[172:175]
  v_exp_f32 v148, v148
  v_mfma_f32_16x16x32_bf16 v[160:163], v[216:219], v[68:71], v[172:175]
  v_add_f32 v12, v12, v148
  v_mfma_f32_16x16x32_bf16 v[156:159], v[204:207], v[72:75], v[156:159]
  v_exp_f32 v149, v149
  v_mfma_f32_16x16x32_bf16 v[160:163], v[220:223], v[72:75], v[160:163]
  v_add_f32 v12, v12, v149
  v_cvt_pk_bf16_f32 v164, v148, v149
  v_mfma_f32_16x16x32_bf16 v[156:159], v[208:211], v[76:79], v[156:159]
  v_exp_f32 v150, v150
  v_mfma_f32_16x16x32_bf16 v[160:163], v[224:227], v[76:79], v[160:163]
  v_add_f32 v12, v12, v150
  v_mfma_f32_16x16x32_bf16 v[156:159], v[212:215], v[80:83], v[156:159]
  v_exp_f32 v151, v151
  v_mfma_f32_16x16x32_bf16 v[160:163], v[228:231], v[80:83], v[160:163]
  v_add_f32 v12, v12, v151
  v_cvt_pk_bf16_f32 v165, v150, v151
  v_mfma_f32_16x16x32_bf16 a[96:99], a[192:195], v[168:171], a[96:99]
  v_exp_f32 v152, v152
  v_mfma_f32_16x16x32_bf16 a[100:103], a[196:199], v[168:171], a[100:103]
  v_add_f32 v12, v12, v152
  v_mfma_f32_16x16x32_bf16 a[104:107], a[200:203], v[168:171], a[104:107]
  v_exp_f32 v153, v153
  v_mfma_f32_16x16x32_bf16 a[108:111], a[204:207], v[168:171], a[108:111]
  v_add_f32 v12, v12, v153
  v_cvt_pk_bf16_f32 v166, v152, v153
  v_mfma_f32_16x16x32_bf16 a[112:115], a[208:211], v[168:171], a[112:115]
  v_exp_f32 v154, v154
  v_mfma_f32_16x16x32_bf16 a[116:119], a[212:215], v[168:171], a[116:119]
  v_add_f32 v12, v12, v154
  v_mfma_f32_16x16x32_bf16 a[120:123], a[216:219], v[168:171], a[120:123]
  v_exp_f32 v155, v155
  v_mfma_f32_16x16x32_bf16 a[124:127], a[220:223], v[168:171], a[124:127]
  v_add_f32 v12, v12, v155
  v_cvt_pk_bf16_f32 v167, v154, v155
  v_mfma_f32_16x16x32_bf16 v[148:151], v[200:203], v[84:87], v[176:179]
  s_waitcnt vmcnt(16) lgkmcnt(0)
  s_barrier
  v_exp_f32 v156, v156
  v_mfma_f32_16x16x32_bf16 v[152:155], v[216:219], v[84:87], v[176:179]
  ds_read_b128 a[160:163], v24 offset:0
  v_add_f32 v8, v8, v156
  s_add_u32 m0, s25, 32768
  v_mfma_f32_16x16x32_bf16 v[148:151], v[204:207], v[88:91], v[148:151]
  buffer_load_dwordx4 v58, s[4:7], s27 offen nt lds
  v_exp_f32 v157, v157
  v_mfma_f32_16x16x32_bf16 v[152:155], v[220:223], v[88:91], v[152:155]
  ds_read_b128 a[176:179], v28 offset:0
  v_add_f32 v8, v8, v157
  v_cvt_pk_bf16_f32 v168, v156, v157
  v_mfma_f32_16x16x32_bf16 v[148:151], v[208:211], v[92:95], v[148:151]
  buffer_load_dwordx4 v59, s[4:7], s27 offen offset:1024 nt lds
  v_exp_f32 v158, v158
  v_mfma_f32_16x16x32_bf16 v[152:155], v[224:227], v[92:95], v[152:155]
  v_add_f32 v8, v8, v158
  v_mfma_f32_16x16x32_bf16 v[148:151], v[212:215], v[96:99], v[148:151]
  v_exp_f32 v159, v159
  v_mfma_f32_16x16x32_bf16 v[152:155], v[228:231], v[96:99], v[152:155]
  ds_read_b128 a[164:167], v25 offset:0
  v_add_f32 v8, v8, v159
  v_cvt_pk_bf16_f32 v169, v158, v159
  v_mfma_f32_16x16x32_bf16 a[128:131], a[192:195], v[164:167], a[128:131]
  buffer_load_dwordx4 v60, s[4:7], s27 offen offset:2048 nt lds
  v_exp_f32 v160, v160
  v_mfma_f32_16x16x32_bf16 a[132:135], a[196:199], v[164:167], a[132:135]
  ds_read_b128 a[180:183], v29 offset:0
  v_add_f32 v8, v8, v160
  v_mfma_f32_16x16x32_bf16 a[136:139], a[200:203], v[164:167], a[136:139]
  v_exp_f32 v161, v161
  v_mfma_f32_16x16x32_bf16 a[140:143], a[204:207], v[164:167], a[140:143]
  v_add_f32 v8, v8, v161
  v_cvt_pk_bf16_f32 v170, v160, v161
  v_mfma_f32_16x16x32_bf16 a[144:147], a[208:211], v[164:167], a[144:147]
  buffer_load_dwordx4 v61, s[4:7], s27 offen offset:3072 nt lds
  v_exp_f32 v162, v162
  s_add_u32 s27, s27, 8192
  v_mfma_f32_16x16x32_bf16 a[148:151], a[212:215], v[164:167], a[148:151]
  ds_read_b128 a[168:171], v26 offset:0
  v_add_f32 v8, v8, v162
  v_mfma_f32_16x16x32_bf16 a[152:155], a[216:219], v[164:167], a[152:155]
  v_exp_f32 v163, v163
  v_mfma_f32_16x16x32_bf16 a[156:159], a[220:223], v[164:167], a[156:159]
  v_add_f32 v8, v8, v163
  v_cvt_pk_bf16_f32 v171, v162, v163
  v_mfma_f32_16x16x32_bf16 v[156:159], v[200:203], v[100:103], v[180:183]
  v_exp_f32 v148, v148
  v_mfma_f32_16x16x32_bf16 v[160:163], v[216:219], v[100:103], v[180:183]
  ds_read_b128 a[184:187], v30 offset:0
  v_add_f32 v9, v9, v148
  v_mfma_f32_16x16x32_bf16 v[156:159], v[204:207], v[104:107], v[156:159]
  v_exp_f32 v149, v149
  v_mfma_f32_16x16x32_bf16 v[160:163], v[220:223], v[104:107], v[160:163]
  ds_read_b128 a[172:175], v27 offset:0
  v_add_f32 v9, v9, v149
  v_cvt_pk_bf16_f32 v164, v148, v149
  v_mfma_f32_16x16x32_bf16 v[156:159], v[208:211], v[108:111], v[156:159]
  v_exp_f32 v150, v150
  v_mfma_f32_16x16x32_bf16 v[160:163], v[224:227], v[108:111], v[160:163]
  ds_read_b128 a[188:191], v31 offset:0
  v_add_f32 v9, v9, v150
  v_mfma_f32_16x16x32_bf16 v[156:159], v[212:215], v[112:115], v[156:159]
  v_exp_f32 v151, v151
  v_mfma_f32_16x16x32_bf16 v[160:163], v[228:231], v[112:115], v[160:163]
  v_add_f32 v9, v9, v151
  v_cvt_pk_bf16_f32 v165, v150, v151
  v_mfma_f32_16x16x32_bf16 a[0:3], a[224:227], v[168:171], a[0:3]
  v_exp_f32 v152, v152
  v_mfma_f32_16x16x32_bf16 a[4:7], a[228:231], v[168:171], a[4:7]
  ds_read_b64_tr_b16 a[192:193], v40 offset:0
  v_add_f32 v9, v9, v152
  v_mfma_f32_16x16x32_bf16 a[8:11], a[232:235], v[168:171], a[8:11]
  v_exp_f32 v153, v153
  v_mfma_f32_16x16x32_bf16 a[12:15], a[236:239], v[168:171], a[12:15]
  ds_read_b64_tr_b16 a[194:195], v40 offset:4096
  v_add_f32 v9, v9, v153
  v_cvt_pk_bf16_f32 v166, v152, v153
  v_mfma_f32_16x16x32_bf16 a[16:19], a[240:243], v[168:171], a[16:19]
  v_exp_f32 v154, v154
  v_mfma_f32_16x16x32_bf16 a[20:23], a[244:247], v[168:171], a[20:23]
  ds_read_b64_tr_b16 a[196:197], v41 offset:0
  v_add_f32 v9, v9, v154
  v_mfma_f32_16x16x32_bf16 a[24:27], a[248:251], v[168:171], a[24:27]
  v_exp_f32 v155, v155
  v_mfma_f32_16x16x32_bf16 a[28:31], a[252:255], v[168:171], a[28:31]
  v_add_f32 v9, v9, v155
  v_cvt_pk_bf16_f32 v167, v154, v155
  v_mfma_f32_16x16x32_bf16 v[148:151], v[200:203], v[116:119], v[184:187]
  v_exp_f32 v156, v156
  v_mfma_f32_16x16x32_bf16 v[152:155], v[216:219], v[116:119], v[184:187]
  ds_read_b64_tr_b16 a[198:199], v41 offset:4096
  v_add_f32 v10, v10, v156
  s_add_u32 m0, s25, 49152
  v_mfma_f32_16x16x32_bf16 v[148:151], v[204:207], v[120:123], v[148:151]
  buffer_load_dwordx4 v62, s[8:11], s28 offen nt lds
  v_exp_f32 v157, v157
  v_mfma_f32_16x16x32_bf16 v[152:155], v[220:223], v[120:123], v[152:155]
  ds_read_b64_tr_b16 a[200:201], v42 offset:0
  v_add_f32 v10, v10, v157
  v_cvt_pk_bf16_f32 v168, v156, v157
  v_mfma_f32_16x16x32_bf16 v[148:151], v[208:211], v[124:127], v[148:151]
  buffer_load_dwordx4 v63, s[8:11], s28 offen offset:1024 nt lds
  v_exp_f32 v158, v158
  v_mfma_f32_16x16x32_bf16 v[152:155], v[224:227], v[124:127], v[152:155]
  ds_read_b64_tr_b16 a[202:203], v42 offset:4096
  v_add_f32 v10, v10, v158
  v_mfma_f32_16x16x32_bf16 v[148:151], v[212:215], v[128:131], v[148:151]
  v_exp_f32 v159, v159
  v_mfma_f32_16x16x32_bf16 v[152:155], v[228:231], v[128:131], v[152:155]
  ds_read_b64_tr_b16 a[204:205], v43 offset:0
  v_add_f32 v10, v10, v159
  v_cvt_pk_bf16_f32 v169, v158, v159
  v_mfma_f32_16x16x32_bf16 a[32:35], a[224:227], v[164:167], a[32:35]
  buffer_load_dwordx4 v62, s[8:11], s28 offen offset:2048 nt lds
  v_exp_f32 v160, v160
  v_mfma_f32_16x16x32_bf16 a[36:39], a[228:231], v[164:167], a[36:39]
  ds_read_b64_tr_b16 a[206:207], v43 offset:4096
  v_add_f32 v10, v10, v160
  v_mfma_f32_16x16x32_bf16 a[40:43], a[232:235], v[164:167], a[40:43]
  v_exp_f32 v161, v161
  v_mfma_f32_16x16x32_bf16 a[44:47], a[236:239], v[164:167], a[44:47]
  ds_read_b64_tr_b16 a[208:209], v44 offset:0
  v_add_f32 v10, v10, v161
  v_cvt_pk_bf16_f32 v170, v160, v161
  v_mfma_f32_16x16x32_bf16 a[48:51], a[240:243], v[164:167], a[48:51]
  buffer_load_dwordx4 v63, s[8:11], s28 offen offset:3072 nt lds
  v_exp_f32 v162, v162
  s_add_u32 s28, s28, 8192
  v_mfma_f32_16x16x32_bf16 a[52:55], a[244:247], v[164:167], a[52:55]
  ds_read_b64_tr_b16 a[210:211], v44 offset:4096
  v_add_f32 v10, v10, v162
  v_mfma_f32_16x16x32_bf16 a[56:59], a[248:251], v[164:167], a[56:59]
  v_exp_f32 v163, v163
  v_mfma_f32_16x16x32_bf16 a[60:63], a[252:255], v[164:167], a[60:63]
  v_add_f32 v10, v10, v163
  v_cvt_pk_bf16_f32 v171, v162, v163
  v_mfma_f32_16x16x32_bf16 v[156:159], v[200:203], v[132:135], v[188:191]
  v_exp_f32 v148, v148
  v_mfma_f32_16x16x32_bf16 v[160:163], v[216:219], v[132:135], v[188:191]
  ds_read_b64_tr_b16 a[212:213], v45 offset:0
  v_add_f32 v11, v11, v148
  v_mfma_f32_16x16x32_bf16 v[156:159], v[204:207], v[136:139], v[156:159]
  v_exp_f32 v149, v149
  v_mfma_f32_16x16x32_bf16 v[160:163], v[220:223], v[136:139], v[160:163]
  ds_read_b64_tr_b16 a[214:215], v45 offset:4096
  v_add_f32 v11, v11, v149
  v_cvt_pk_bf16_f32 v164, v148, v149
  v_mfma_f32_16x16x32_bf16 v[156:159], v[208:211], v[140:143], v[156:159]
  v_exp_f32 v150, v150
  v_mfma_f32_16x16x32_bf16 v[160:163], v[224:227], v[140:143], v[160:163]
  ds_read_b64_tr_b16 a[216:217], v46 offset:0
  v_add_f32 v11, v11, v150
  v_mfma_f32_16x16x32_bf16 v[156:159], v[212:215], v[144:147], v[156:159]
  v_exp_f32 v151, v151
  v_mfma_f32_16x16x32_bf16 v[160:163], v[228:231], v[144:147], v[160:163]
  v_add_f32 v11, v11, v151
  v_cvt_pk_bf16_f32 v165, v150, v151
  v_mfma_f32_16x16x32_bf16 a[64:67], a[224:227], v[168:171], a[64:67]
  v_exp_f32 v152, v152
  v_mfma_f32_16x16x32_bf16 a[68:71], a[228:231], v[168:171], a[68:71]
  ds_read_b64_tr_b16 a[218:219], v46 offset:4096
  v_add_f32 v11, v11, v152
  v_mfma_f32_16x16x32_bf16 a[72:75], a[232:235], v[168:171], a[72:75]
  v_exp_f32 v153, v153
  v_mfma_f32_16x16x32_bf16 a[76:79], a[236:239], v[168:171], a[76:79]
  ds_read_b64_tr_b16 a[220:221], v47 offset:0
  v_add_f32 v11, v11, v153
  v_cvt_pk_bf16_f32 v166, v152, v153
  v_mfma_f32_16x16x32_bf16 a[80:83], a[240:243], v[168:171], a[80:83]
  v_exp_f32 v154, v154
  v_mfma_f32_16x16x32_bf16 a[84:87], a[244:247], v[168:171], a[84:87]
  ds_read_b64_tr_b16 a[222:223], v47 offset:4096
  v_add_f32 v11, v11, v154
  v_mfma_f32_16x16x32_bf16 a[88:91], a[248:251], v[168:171], a[88:91]
  v_exp_f32 v155, v155
  v_mfma_f32_16x16x32_bf16 a[92:95], a[252:255], v[168:171], a[92:95]
  v_add_f32 v11, v11, v155
  v_cvt_pk_bf16_f32 v167, v154, v155
  s_waitcnt lgkmcnt(15)
  v_mfma_f32_16x16x32_bf16 v[148:151], a[160:163], v[68:71], v[172:175]
  v_exp_f32 v156, v156
  v_mfma_f32_16x16x32_bf16 v[152:155], a[176:179], v[68:71], v[172:175]
  v_add_f32 v12, v12, v156
  v_mfma_f32_16x16x32_bf16 v[148:151], a[164:167], v[72:75], v[148:151]
  v_exp_f32 v157, v157
  v_mfma_f32_16x16x32_bf16 v[152:155], a[180:183], v[72:75], v[152:155]
  v_add_f32 v12, v12, v157
  v_cvt_pk_bf16_f32 v168, v156, v157
  v_mfma_f32_16x16x32_bf16 v[148:151], a[168:171], v[76:79], v[148:151]
  v_exp_f32 v158, v158
  v_mfma_f32_16x16x32_bf16 v[152:155], a[184:187], v[76:79], v[152:155]
  v_add_f32 v12, v12, v158
  v_mfma_f32_16x16x32_bf16 v[148:151], a[172:175], v[80:83], v[148:151]
  v_exp_f32 v159, v159
  v_mfma_f32_16x16x32_bf16 v[152:155], a[188:191], v[80:83], v[152:155]
  v_add_f32 v12, v12, v159
  v_cvt_pk_bf16_f32 v169, v158, v159
  v_mfma_f32_16x16x32_bf16 a[96:99], a[224:227], v[164:167], a[96:99]
  v_exp_f32 v160, v160
  v_mfma_f32_16x16x32_bf16 a[100:103], a[228:231], v[164:167], a[100:103]
  v_add_f32 v12, v12, v160
  v_mfma_f32_16x16x32_bf16 a[104:107], a[232:235], v[164:167], a[104:107]
  v_exp_f32 v161, v161
  v_mfma_f32_16x16x32_bf16 a[108:111], a[236:239], v[164:167], a[108:111]
  v_add_f32 v12, v12, v161
  v_cvt_pk_bf16_f32 v170, v160, v161
  v_mfma_f32_16x16x32_bf16 a[112:115], a[240:243], v[164:167], a[112:115]
  v_exp_f32 v162, v162
  v_mfma_f32_16x16x32_bf16 a[116:119], a[244:247], v[164:167], a[116:119]
  v_add_f32 v12, v12, v162
  v_mfma_f32_16x16x32_bf16 a[120:123], a[248:251], v[164:167], a[120:123]
  v_exp_f32 v163, v163
  v_mfma_f32_16x16x32_bf16 a[124:127], a[252:255], v[164:167], a[124:127]
  v_add_f32 v12, v12, v163
  v_cvt_pk_bf16_f32 v171, v162, v163
  v_mfma_f32_16x16x32_bf16 v[156:159], a[160:163], v[84:87], v[176:179]
  s_waitcnt vmcnt(16) lgkmcnt(0)
  s_barrier
  v_exp_f32 v148, v148
  v_mfma_f32_16x16x32_bf16 v[160:163], a[176:179], v[84:87], v[176:179]
  ds_read_b128 v[200:203], v24 offset:32768
  v_add_f32 v8, v8, v148
  s_add_u32 m0, s25, 65536
  v_mfma_f32_16x16x32_bf16 v[156:159], a[164:167], v[88:91], v[156:159]
  buffer_load_dwordx4 v58, s[4:7], s27 offen nt lds
  v_exp_f32 v149, v149
  v_mfma_f32_16x16x32_bf16 v[160:163], a[180:183], v[88:91], v[160:163]
  ds_read_b128 v[216:219], v28 offset:32768
  v_add_f32 v8, v8, v149
  v_cvt_pk_bf16_f32 v164, v148, v149
  v_mfma_f32_16x16x32_bf16 v[156:159], a[168:171], v[92:95], v[156:159]
  buffer_load_dwordx4 v59, s[4:7], s27 offen offset:1024 nt lds
  v_exp_f32 v150, v150
  v_mfma_f32_16x16x32_bf16 v[160:163], a[184:187], v[92:95], v[160:163]
  v_add_f32 v8, v8, v150
  v_mfma_f32_16x16x32_bf16 v[156:159], a[172:175], v[96:99], v[156:159]
  v_exp_f32 v151, v151
  v_mfma_f32_16x16x32_bf16 v[160:163], a[188:191], v[96:99], v[160:163]
  ds_read_b128 v[204:207], v25 offset:32768
  v_add_f32 v8, v8, v151
  v_cvt_pk_bf16_f32 v165, v150, v151
  v_mfma_f32_16x16x32_bf16 a[128:131], a[224:227], v[168:171], a[128:131]
  buffer_load_dwordx4 v60, s[4:7], s27 offen offset:2048 nt lds
  v_exp_f32 v152, v152
  v_mfma_f32_16x16x32_bf16 a[132:135], a[228:231], v[168:171], a[132:135]
  ds_read_b128 v[220:223], v29 offset:32768
  v_add_f32 v8, v8, v152
  v_mfma_f32_16x16x32_bf16 a[136:139], a[232:235], v[168:171], a[136:139]
  v_exp_f32 v153, v153
  v_mfma_f32_16x16x32_bf16 a[140:143], a[236:239], v[168:171], a[140:143]
  v_add_f32 v8, v8, v153
  v_cvt_pk_bf16_f32 v166, v152, v153
  v_mfma_f32_16x16x32_bf16 a[144:147], a[240:243], v[168:171], a[144:147]
  buffer_load_dwordx4 v61, s[4:7], s27 offen offset:3072 nt lds
  v_exp_f32 v154, v154
  s_add_u32 s27, s27, 8192
  v_mfma_f32_16x16x32_bf16 a[148:151], a[244:247], v[168:171], a[148:151]
  ds_read_b128 v[208:211], v26 offset:32768
  v_add_f32 v8, v8, v154
  v_mfma_f32_16x16x32_bf16 a[152:155], a[248:251], v[168:171], a[152:155]
  v_exp_f32 v155, v155
  v_mfma_f32_16x16x32_bf16 a[156:159], a[252:255], v[168:171], a[156:159]
  v_add_f32 v8, v8, v155
  v_cvt_pk_bf16_f32 v167, v154, v155
  v_mfma_f32_16x16x32_bf16 v[148:151], a[160:163], v[100:103], v[180:183]
  v_exp_f32 v156, v156
  v_mfma_f32_16x16x32_bf16 v[152:155], a[176:179], v[100:103], v[180:183]
  ds_read_b128 v[224:227], v30 offset:32768
  v_add_f32 v9, v9, v156
  v_mfma_f32_16x16x32_bf16 v[148:151], a[164:167], v[104:107], v[148:151]
  v_exp_f32 v157, v157
  v_mfma_f32_16x16x32_bf16 v[152:155], a[180:183], v[104:107], v[152:155]
  ds_read_b128 v[212:215], v27 offset:32768
  v_add_f32 v9, v9, v157
  v_cvt_pk_bf16_f32 v168, v156, v157
  v_mfma_f32_16x16x32_bf16 v[148:151], a[168:171], v[108:111], v[148:151]
  v_exp_f32 v158, v158
  v_mfma_f32_16x16x32_bf16 v[152:155], a[184:187], v[108:111], v[152:155]
  ds_read_b128 v[228:231], v31 offset:32768
  v_add_f32 v9, v9, v158
  v_mfma_f32_16x16x32_bf16 v[148:151], a[172:175], v[112:115], v[148:151]
  v_exp_f32 v159, v159
  v_mfma_f32_16x16x32_bf16 v[152:155], a[188:191], v[112:115], v[152:155]
  v_add_f32 v9, v9, v159
  v_cvt_pk_bf16_f32 v169, v158, v159
  v_mfma_f32_16x16x32_bf16 a[0:3], a[192:195], v[164:167], a[0:3]
  v_exp_f32 v160, v160
  v_mfma_f32_16x16x32_bf16 a[4:7], a[196:199], v[164:167], a[4:7]
  ds_read_b64_tr_b16 a[224:225], v40 offset:32768
  v_add_f32 v9, v9, v160
  v_mfma_f32_16x16x32_bf16 a[8:11], a[200:203], v[164:167], a[8:11]
  v_exp_f32 v161, v161
  v_mfma_f32_16x16x32_bf16 a[12:15], a[204:207], v[164:167], a[12:15]
  ds_read_b64_tr_b16 a[226:227], v40 offset:36864
  v_add_f32 v9, v9, v161
  v_cvt_pk_bf16_f32 v170, v160, v161
  v_mfma_f32_16x16x32_bf16 a[16:19], a[208:211], v[164:167], a[16:19]
  v_exp_f32 v162, v162
  v_mfma_f32_16x16x32_bf16 a[20:23], a[212:215], v[164:167], a[20:23]
  ds_read_b64_tr_b16 a[228:229], v41 offset:32768
  v_add_f32 v9, v9, v162
  v_mfma_f32_16x16x32_bf16 a[24:27], a[216:219], v[164:167], a[24:27]
  v_exp_f32 v163, v163
  v_mfma_f32_16x16x32_bf16 a[28:31], a[220:223], v[164:167], a[28:31]
  v_add_f32 v9, v9, v163
  v_cvt_pk_bf16_f32 v171, v162, v163
  v_mfma_f32_16x16x32_bf16 v[156:159], a[160:163], v[116:119], v[184:187]
  v_exp_f32 v148, v148
  v_mfma_f32_16x16x32_bf16 v[160:163], a[176:179], v[116:119], v[184:187]
  ds_read_b64_tr_b16 a[230:231], v41 offset:36864
  v_add_f32 v10, v10, v148
  s_add_u32 m0, s25, 81920
  v_mfma_f32_16x16x32_bf16 v[156:159], a[164:167], v[120:123], v[156:159]
  buffer_load_dwordx4 v62, s[8:11], s28 offen nt lds
  v_exp_f32 v149, v149
  v_mfma_f32_16x16x32_bf16 v[160:163], a[180:183], v[120:123], v[160:163]
  ds_read_b64_tr_b16 a[232:233], v42 offset:32768
  v_add_f32 v10, v10, v149
  v_cvt_pk_bf16_f32 v164, v148, v149
  v_mfma_f32_16x16x32_bf16 v[156:159], a[168:171], v[124:127], v[156:159]
  buffer_load_dwordx4 v63, s[8:11], s28 offen offset:1024 nt lds
  v_exp_f32 v150, v150
  v_mfma_f32_16x16x32_bf16 v[160:163], a[184:187], v[124:127], v[160:163]
  ds_read_b64_tr_b16 a[234:235], v42 offset:36864
  v_add_f32 v10, v10, v150
  v_mfma_f32_16x16x32_bf16 v[156:159], a[172:175], v[128:131], v[156:159]
  v_exp_f32 v151, v151
  v_mfma_f32_16x16x32_bf16 v[160:163], a[188:191], v[128:131], v[160:163]
  ds_read_b64_tr_b16 a[236:237], v43 offset:32768
  v_add_f32 v10, v10, v151
  v_cvt_pk_bf16_f32 v165, v150, v151
  v_mfma_f32_16x16x32_bf16 a[32:35], a[192:195], v[168:171], a[32:35]
  buffer_load_dwordx4 v62, s[8:11], s28 offen offset:2048 nt lds
  v_exp_f32 v152, v152
  v_mfma_f32_16x16x32_bf16 a[36:39], a[196:199], v[168:171], a[36:39]
  ds_read_b64_tr_b16 a[238:239], v43 offset:36864
  v_add_f32 v10, v10, v152
  v_mfma_f32_16x16x32_bf16 a[40:43], a[200:203], v[168:171], a[40:43]
  v_exp_f32 v153, v153
  v_mfma_f32_16x16x32_bf16 a[44:47], a[204:207], v[168:171], a[44:47]
  ds_read_b64_tr_b16 a[240:241], v44 offset:32768
  v_add_f32 v10, v10, v153
  v_cvt_pk_bf16_f32 v166, v152, v153
  v_mfma_f32_16x16x32_bf16 a[48:51], a[208:211], v[168:171], a[48:51]
  buffer_load_dwordx4 v63, s[8:11], s28 offen offset:3072 nt lds
  v_exp_f32 v154, v154
  s_add_u32 s28, s28, 8192
  v_mfma_f32_16x16x32_bf16 a[52:55], a[212:215], v[168:171], a[52:55]
  ds_read_b64_tr_b16 a[242:243], v44 offset:36864
  v_add_f32 v10, v10, v154
  v_mfma_f32_16x16x32_bf16 a[56:59], a[216:219], v[168:171], a[56:59]
  v_exp_f32 v155, v155
  v_mfma_f32_16x16x32_bf16 a[60:63], a[220:223], v[168:171], a[60:63]
  v_add_f32 v10, v10, v155
  v_cvt_pk_bf16_f32 v167, v154, v155
  v_mfma_f32_16x16x32_bf16 v[148:151], a[160:163], v[132:135], v[188:191]
  v_exp_f32 v156, v156
  v_mfma_f32_16x16x32_bf16 v[152:155], a[176:179], v[132:135], v[188:191]
  ds_read_b64_tr_b16 a[244:245], v45 offset:32768
  v_add_f32 v11, v11, v156
  v_mfma_f32_16x16x32_bf16 v[148:151], a[164:167], v[136:139], v[148:151]
  v_exp_f32 v157, v157
  v_mfma_f32_16x16x32_bf16 v[152:155], a[180:183], v[136:139], v[152:155]
  ds_read_b64_tr_b16 a[246:247], v45 offset:36864
  v_add_f32 v11, v11, v157
  v_cvt_pk_bf16_f32 v168, v156, v157
  v_mfma_f32_16x16x32_bf16 v[148:151], a[168:171], v[140:143], v[148:151]
  v_exp_f32 v158, v158
  v_mfma_f32_16x16x32_bf16 v[152:155], a[184:187], v[140:143], v[152:155]
  ds_read_b64_tr_b16 a[248:249], v46 offset:32768
  v_add_f32 v11, v11, v158
  v_mfma_f32_16x16x32_bf16 v[148:151], a[172:175], v[144:147], v[148:151]
  v_exp_f32 v159, v159
  v_mfma_f32_16x16x32_bf16 v[152:155], a[188:191], v[144:147], v[152:155]
  v_add_f32 v11, v11, v159
  v_cvt_pk_bf16_f32 v169, v158, v159
  v_mfma_f32_16x16x32_bf16 a[64:67], a[192:195], v[164:167], a[64:67]
  v_exp_f32 v160, v160
  v_mfma_f32_16x16x32_bf16 a[68:71], a[196:199], v[164:167], a[68:71]
  ds_read_b64_tr_b16 a[250:251], v46 offset:36864
  v_add_f32 v11, v11, v160
  v_mfma_f32_16x16x32_bf16 a[72:75], a[200:203], v[164:167], a[72:75]
  v_exp_f32 v161, v161
  v_mfma_f32_16x16x32_bf16 a[76:79], a[204:207], v[164:167], a[76:79]
  ds_read_b64_tr_b16 a[252:253], v47 offset:32768
  v_add_f32 v11, v11, v161
  v_cvt_pk_bf16_f32 v170, v160, v161
  v_mfma_f32_16x16x32_bf16 a[80:83], a[208:211], v[164:167], a[80:83]
  v_exp_f32 v162, v162
  v_mfma_f32_16x16x32_bf16 a[84:87], a[212:215], v[164:167], a[84:87]
  ds_read_b64_tr_b16 a[254:255], v47 offset:36864
  v_add_f32 v11, v11, v162
  v_mfma_f32_16x16x32_bf16 a[88:91], a[216:219], v[164:167], a[88:91]
  v_exp_f32 v163, v163
  v_mfma_f32_16x16x32_bf16 a[92:95], a[220:223], v[164:167], a[92:95]
  v_add_f32 v11, v11, v163
  v_cvt_pk_bf16_f32 v171, v162, v163
  s_waitcnt lgkmcnt(15)
  v_mfma_f32_16x16x32_bf16 v[156:159], v[200:203], v[68:71], v[172:175]
  v_exp_f32 v148, v148
  v_mfma_f32_16x16x32_bf16 v[160:163], v[216:219], v[68:71], v[172:175]
  v_add_f32 v12, v12, v148
  v_mfma_f32_16x16x32_bf16 v[156:159], v[204:207], v[72:75], v[156:159]
  v_exp_f32 v149, v149
  v_mfma_f32_16x16x32_bf16 v[160:163], v[220:223], v[72:75], v[160:163]
  v_add_f32 v12, v12, v149
  v_cvt_pk_bf16_f32 v164, v148, v149
  v_mfma_f32_16x16x32_bf16 v[156:159], v[208:211], v[76:79], v[156:159]
  v_exp_f32 v150, v150
  v_mfma_f32_16x16x32_bf16 v[160:163], v[224:227], v[76:79], v[160:163]
  v_add_f32 v12, v12, v150
  v_mfma_f32_16x16x32_bf16 v[156:159], v[212:215], v[80:83], v[156:159]
  v_exp_f32 v151, v151
  v_mfma_f32_16x16x32_bf16 v[160:163], v[228:231], v[80:83], v[160:163]
  v_add_f32 v12, v12, v151
  v_cvt_pk_bf16_f32 v165, v150, v151
  v_mfma_f32_16x16x32_bf16 a[96:99], a[192:195], v[168:171], a[96:99]
  v_exp_f32 v152, v152
  v_mfma_f32_16x16x32_bf16 a[100:103], a[196:199], v[168:171], a[100:103]
  v_add_f32 v12, v12, v152
  v_mfma_f32_16x16x32_bf16 a[104:107], a[200:203], v[168:171], a[104:107]
  v_exp_f32 v153, v153
  v_mfma_f32_16x16x32_bf16 a[108:111], a[204:207], v[168:171], a[108:111]
  v_add_f32 v12, v12, v153
  v_cvt_pk_bf16_f32 v166, v152, v153
  v_mfma_f32_16x16x32_bf16 a[112:115], a[208:211], v[168:171], a[112:115]
  v_exp_f32 v154, v154
  v_mfma_f32_16x16x32_bf16 a[116:119], a[212:215], v[168:171], a[116:119]
  v_add_f32 v12, v12, v154
  v_mfma_f32_16x16x32_bf16 a[120:123], a[216:219], v[168:171], a[120:123]
  v_exp_f32 v155, v155
  v_mfma_f32_16x16x32_bf16 a[124:127], a[220:223], v[168:171], a[124:127]
  v_add_f32 v12, v12, v155
  v_cvt_pk_bf16_f32 v167, v154, v155
  s_sub_u32 s31, s31, 1
  s_cmp_lg_u32 s31, 0
  s_cbranch_scc1 concat_heads__mha_block_cached__mha_block_cached__near_ridge_kernel_loop
  v_mfma_f32_16x16x32_bf16 v[148:151], v[200:203], v[84:87], v[176:179]
  s_waitcnt vmcnt(16) lgkmcnt(0)
  s_barrier
  v_exp_f32 v156, v156
  v_mfma_f32_16x16x32_bf16 v[152:155], v[216:219], v[84:87], v[176:179]
  ds_read_b128 a[160:163], v16 offset:0
  v_add_f32 v8, v8, v156
  s_add_u32 m0, s25, 98304
  v_mfma_f32_16x16x32_bf16 v[148:151], v[204:207], v[88:91], v[148:151]
  buffer_load_dwordx4 v58, s[4:7], s27 offen nt lds
  v_exp_f32 v157, v157
  v_mfma_f32_16x16x32_bf16 v[152:155], v[220:223], v[88:91], v[152:155]
  ds_read_b128 a[176:179], v20 offset:0
  v_add_f32 v8, v8, v157
  v_cvt_pk_bf16_f32 v168, v156, v157
  v_mfma_f32_16x16x32_bf16 v[148:151], v[208:211], v[92:95], v[148:151]
  buffer_load_dwordx4 v59, s[4:7], s27 offen offset:1024 nt lds
  v_exp_f32 v158, v158
  v_mfma_f32_16x16x32_bf16 v[152:155], v[224:227], v[92:95], v[152:155]
  v_add_f32 v8, v8, v158
  v_mfma_f32_16x16x32_bf16 v[148:151], v[212:215], v[96:99], v[148:151]
  v_exp_f32 v159, v159
  v_mfma_f32_16x16x32_bf16 v[152:155], v[228:231], v[96:99], v[152:155]
  ds_read_b128 a[164:167], v17 offset:0
  v_add_f32 v8, v8, v159
  v_cvt_pk_bf16_f32 v169, v158, v159
  v_mfma_f32_16x16x32_bf16 a[128:131], a[192:195], v[164:167], a[128:131]
  buffer_load_dwordx4 v60, s[4:7], s27 offen offset:2048 nt lds
  v_exp_f32 v160, v160
  v_mfma_f32_16x16x32_bf16 a[132:135], a[196:199], v[164:167], a[132:135]
  ds_read_b128 a[180:183], v21 offset:0
  v_add_f32 v8, v8, v160
  v_mfma_f32_16x16x32_bf16 a[136:139], a[200:203], v[164:167], a[136:139]
  v_exp_f32 v161, v161
  v_mfma_f32_16x16x32_bf16 a[140:143], a[204:207], v[164:167], a[140:143]
  v_add_f32 v8, v8, v161
  v_cvt_pk_bf16_f32 v170, v160, v161
  v_mfma_f32_16x16x32_bf16 a[144:147], a[208:211], v[164:167], a[144:147]
  buffer_load_dwordx4 v61, s[4:7], s27 offen offset:3072 nt lds
  v_exp_f32 v162, v162
  s_add_u32 s27, s27, 8192
  v_mfma_f32_16x16x32_bf16 a[148:151], a[212:215], v[164:167], a[148:151]
  ds_read_b128 a[168:171], v18 offset:0
  v_add_f32 v8, v8, v162
  v_mfma_f32_16x16x32_bf16 a[152:155], a[216:219], v[164:167], a[152:155]
  v_exp_f32 v163, v163
  v_mfma_f32_16x16x32_bf16 a[156:159], a[220:223], v[164:167], a[156:159]
  v_add_f32 v8, v8, v163
  v_cvt_pk_bf16_f32 v171, v162, v163
  v_mfma_f32_16x16x32_bf16 v[156:159], v[200:203], v[100:103], v[180:183]
  v_exp_f32 v148, v148
  v_mfma_f32_16x16x32_bf16 v[160:163], v[216:219], v[100:103], v[180:183]
  ds_read_b128 a[184:187], v22 offset:0
  v_add_f32 v9, v9, v148
  v_mfma_f32_16x16x32_bf16 v[156:159], v[204:207], v[104:107], v[156:159]
  v_exp_f32 v149, v149
  v_mfma_f32_16x16x32_bf16 v[160:163], v[220:223], v[104:107], v[160:163]
  ds_read_b128 a[172:175], v19 offset:0
  v_add_f32 v9, v9, v149
  v_cvt_pk_bf16_f32 v164, v148, v149
  v_mfma_f32_16x16x32_bf16 v[156:159], v[208:211], v[108:111], v[156:159]
  v_exp_f32 v150, v150
  v_mfma_f32_16x16x32_bf16 v[160:163], v[224:227], v[108:111], v[160:163]
  ds_read_b128 a[188:191], v23 offset:0
  v_add_f32 v9, v9, v150
  v_mfma_f32_16x16x32_bf16 v[156:159], v[212:215], v[112:115], v[156:159]
  v_exp_f32 v151, v151
  v_mfma_f32_16x16x32_bf16 v[160:163], v[228:231], v[112:115], v[160:163]
  v_add_f32 v9, v9, v151
  v_cvt_pk_bf16_f32 v165, v150, v151
  v_mfma_f32_16x16x32_bf16 a[0:3], a[224:227], v[168:171], a[0:3]
  v_exp_f32 v152, v152
  v_mfma_f32_16x16x32_bf16 a[4:7], a[228:231], v[168:171], a[4:7]
  ds_read_b64_tr_b16 a[192:193], v32 offset:0
  v_add_f32 v9, v9, v152
  v_mfma_f32_16x16x32_bf16 a[8:11], a[232:235], v[168:171], a[8:11]
  v_exp_f32 v153, v153
  v_mfma_f32_16x16x32_bf16 a[12:15], a[236:239], v[168:171], a[12:15]
  ds_read_b64_tr_b16 a[194:195], v32 offset:4096
  v_add_f32 v9, v9, v153
  v_cvt_pk_bf16_f32 v166, v152, v153
  v_mfma_f32_16x16x32_bf16 a[16:19], a[240:243], v[168:171], a[16:19]
  v_exp_f32 v154, v154
  v_mfma_f32_16x16x32_bf16 a[20:23], a[244:247], v[168:171], a[20:23]
  ds_read_b64_tr_b16 a[196:197], v33 offset:0
  v_add_f32 v9, v9, v154
  v_mfma_f32_16x16x32_bf16 a[24:27], a[248:251], v[168:171], a[24:27]
  v_exp_f32 v155, v155
  v_mfma_f32_16x16x32_bf16 a[28:31], a[252:255], v[168:171], a[28:31]
  v_add_f32 v9, v9, v155
  v_cvt_pk_bf16_f32 v167, v154, v155
  v_mfma_f32_16x16x32_bf16 v[148:151], v[200:203], v[116:119], v[184:187]
  v_exp_f32 v156, v156
  v_mfma_f32_16x16x32_bf16 v[152:155], v[216:219], v[116:119], v[184:187]
  ds_read_b64_tr_b16 a[198:199], v33 offset:4096
  v_add_f32 v10, v10, v156
  s_add_u32 m0, s25, 114688
  v_mfma_f32_16x16x32_bf16 v[148:151], v[204:207], v[120:123], v[148:151]
  buffer_load_dwordx4 v62, s[8:11], s28 offen nt lds
  v_exp_f32 v157, v157
  v_mfma_f32_16x16x32_bf16 v[152:155], v[220:223], v[120:123], v[152:155]
  ds_read_b64_tr_b16 a[200:201], v34 offset:0
  v_add_f32 v10, v10, v157
  v_cvt_pk_bf16_f32 v168, v156, v157
  v_mfma_f32_16x16x32_bf16 v[148:151], v[208:211], v[124:127], v[148:151]
  buffer_load_dwordx4 v63, s[8:11], s28 offen offset:1024 nt lds
  v_exp_f32 v158, v158
  v_mfma_f32_16x16x32_bf16 v[152:155], v[224:227], v[124:127], v[152:155]
  ds_read_b64_tr_b16 a[202:203], v34 offset:4096
  v_add_f32 v10, v10, v158
  v_mfma_f32_16x16x32_bf16 v[148:151], v[212:215], v[128:131], v[148:151]
  v_exp_f32 v159, v159
  v_mfma_f32_16x16x32_bf16 v[152:155], v[228:231], v[128:131], v[152:155]
  ds_read_b64_tr_b16 a[204:205], v35 offset:0
  v_add_f32 v10, v10, v159
  v_cvt_pk_bf16_f32 v169, v158, v159
  v_mfma_f32_16x16x32_bf16 a[32:35], a[224:227], v[164:167], a[32:35]
  buffer_load_dwordx4 v62, s[8:11], s28 offen offset:2048 nt lds
  v_exp_f32 v160, v160
  v_mfma_f32_16x16x32_bf16 a[36:39], a[228:231], v[164:167], a[36:39]
  ds_read_b64_tr_b16 a[206:207], v35 offset:4096
  v_add_f32 v10, v10, v160
  v_mfma_f32_16x16x32_bf16 a[40:43], a[232:235], v[164:167], a[40:43]
  v_exp_f32 v161, v161
  v_mfma_f32_16x16x32_bf16 a[44:47], a[236:239], v[164:167], a[44:47]
  ds_read_b64_tr_b16 a[208:209], v36 offset:0
  v_add_f32 v10, v10, v161
  v_cvt_pk_bf16_f32 v170, v160, v161
  v_mfma_f32_16x16x32_bf16 a[48:51], a[240:243], v[164:167], a[48:51]
  buffer_load_dwordx4 v63, s[8:11], s28 offen offset:3072 nt lds
  v_exp_f32 v162, v162
  s_add_u32 s28, s28, 8192
  v_mfma_f32_16x16x32_bf16 a[52:55], a[244:247], v[164:167], a[52:55]
  ds_read_b64_tr_b16 a[210:211], v36 offset:4096
  v_add_f32 v10, v10, v162
  v_mfma_f32_16x16x32_bf16 a[56:59], a[248:251], v[164:167], a[56:59]
  v_exp_f32 v163, v163
  v_mfma_f32_16x16x32_bf16 a[60:63], a[252:255], v[164:167], a[60:63]
  v_add_f32 v10, v10, v163
  v_cvt_pk_bf16_f32 v171, v162, v163
  v_mfma_f32_16x16x32_bf16 v[156:159], v[200:203], v[132:135], v[188:191]
  v_exp_f32 v148, v148
  v_mfma_f32_16x16x32_bf16 v[160:163], v[216:219], v[132:135], v[188:191]
  ds_read_b64_tr_b16 a[212:213], v37 offset:0
  v_add_f32 v11, v11, v148
  v_mfma_f32_16x16x32_bf16 v[156:159], v[204:207], v[136:139], v[156:159]
  v_exp_f32 v149, v149
  v_mfma_f32_16x16x32_bf16 v[160:163], v[220:223], v[136:139], v[160:163]
  ds_read_b64_tr_b16 a[214:215], v37 offset:4096
  v_add_f32 v11, v11, v149
  v_cvt_pk_bf16_f32 v164, v148, v149
  v_mfma_f32_16x16x32_bf16 v[156:159], v[208:211], v[140:143], v[156:159]
  v_exp_f32 v150, v150
  v_mfma_f32_16x16x32_bf16 v[160:163], v[224:227], v[140:143], v[160:163]
  ds_read_b64_tr_b16 a[216:217], v38 offset:0
  v_add_f32 v11, v11, v150
  v_mfma_f32_16x16x32_bf16 v[156:159], v[212:215], v[144:147], v[156:159]
  v_exp_f32 v151, v151
  v_mfma_f32_16x16x32_bf16 v[160:163], v[228:231], v[144:147], v[160:163]
  v_add_f32 v11, v11, v151
  v_cvt_pk_bf16_f32 v165, v150, v151
  v_mfma_f32_16x16x32_bf16 a[64:67], a[224:227], v[168:171], a[64:67]
  v_exp_f32 v152, v152
  v_mfma_f32_16x16x32_bf16 a[68:71], a[228:231], v[168:171], a[68:71]
  ds_read_b64_tr_b16 a[218:219], v38 offset:4096
  v_add_f32 v11, v11, v152
  v_mfma_f32_16x16x32_bf16 a[72:75], a[232:235], v[168:171], a[72:75]
  v_exp_f32 v153, v153
  v_mfma_f32_16x16x32_bf16 a[76:79], a[236:239], v[168:171], a[76:79]
  ds_read_b64_tr_b16 a[220:221], v39 offset:0
  v_add_f32 v11, v11, v153
  v_cvt_pk_bf16_f32 v166, v152, v153
  v_mfma_f32_16x16x32_bf16 a[80:83], a[240:243], v[168:171], a[80:83]
  v_exp_f32 v154, v154
  v_mfma_f32_16x16x32_bf16 a[84:87], a[244:247], v[168:171], a[84:87]
  ds_read_b64_tr_b16 a[222:223], v39 offset:4096
  v_add_f32 v11, v11, v154
  v_mfma_f32_16x16x32_bf16 a[88:91], a[248:251], v[168:171], a[88:91]
  v_exp_f32 v155, v155
  v_mfma_f32_16x16x32_bf16 a[92:95], a[252:255], v[168:171], a[92:95]
  v_add_f32 v11, v11, v155
  v_cvt_pk_bf16_f32 v167, v154, v155
  s_waitcnt lgkmcnt(15)
  v_mfma_f32_16x16x32_bf16 v[148:151], a[160:163], v[68:71], v[172:175]
  v_exp_f32 v156, v156
  v_mfma_f32_16x16x32_bf16 v[152:155], a[176:179], v[68:71], v[172:175]
  v_add_f32 v12, v12, v156
  v_mfma_f32_16x16x32_bf16 v[148:151], a[164:167], v[72:75], v[148:151]
  v_exp_f32 v157, v157
  v_mfma_f32_16x16x32_bf16 v[152:155], a[180:183], v[72:75], v[152:155]
  v_add_f32 v12, v12, v157
  v_cvt_pk_bf16_f32 v168, v156, v157
  v_mfma_f32_16x16x32_bf16 v[148:151], a[168:171], v[76:79], v[148:151]
  v_exp_f32 v158, v158
  v_mfma_f32_16x16x32_bf16 v[152:155], a[184:187], v[76:79], v[152:155]
  v_add_f32 v12, v12, v158
  v_mfma_f32_16x16x32_bf16 v[148:151], a[172:175], v[80:83], v[148:151]
  v_exp_f32 v159, v159
  v_mfma_f32_16x16x32_bf16 v[152:155], a[188:191], v[80:83], v[152:155]
  v_add_f32 v12, v12, v159
  v_cvt_pk_bf16_f32 v169, v158, v159
  v_mfma_f32_16x16x32_bf16 a[96:99], a[224:227], v[164:167], a[96:99]
  v_exp_f32 v160, v160
  v_mfma_f32_16x16x32_bf16 a[100:103], a[228:231], v[164:167], a[100:103]
  v_add_f32 v12, v12, v160
  v_mfma_f32_16x16x32_bf16 a[104:107], a[232:235], v[164:167], a[104:107]
  v_exp_f32 v161, v161
  v_mfma_f32_16x16x32_bf16 a[108:111], a[236:239], v[164:167], a[108:111]
  v_add_f32 v12, v12, v161
  v_cvt_pk_bf16_f32 v170, v160, v161
  v_mfma_f32_16x16x32_bf16 a[112:115], a[240:243], v[164:167], a[112:115]
  v_exp_f32 v162, v162
  v_mfma_f32_16x16x32_bf16 a[116:119], a[244:247], v[164:167], a[116:119]
  v_add_f32 v12, v12, v162
  v_mfma_f32_16x16x32_bf16 a[120:123], a[248:251], v[164:167], a[120:123]
  v_exp_f32 v163, v163
  v_mfma_f32_16x16x32_bf16 a[124:127], a[252:255], v[164:167], a[124:127]
  v_add_f32 v12, v12, v163
  v_cvt_pk_bf16_f32 v171, v162, v163
  v_mfma_f32_16x16x32_bf16 v[156:159], a[160:163], v[84:87], v[176:179]
  s_waitcnt vmcnt(16) lgkmcnt(0)
  s_barrier
  v_exp_f32 v148, v148
  v_mfma_f32_16x16x32_bf16 v[160:163], a[176:179], v[84:87], v[176:179]
  ds_read_b128 v[200:203], v16 offset:32768
  v_add_f32 v8, v8, v148
  s_add_u32 m0, s26, 139264
  v_mfma_f32_16x16x32_bf16 v[156:159], a[164:167], v[88:91], v[156:159]
  buffer_load_dwordx4 v64, s[12:15], s29 offen lds
  v_exp_f32 v149, v149
  v_mfma_f32_16x16x32_bf16 v[160:163], a[180:183], v[88:91], v[160:163]
  ds_read_b128 v[216:219], v20 offset:32768
  v_add_f32 v8, v8, v149
  v_cvt_pk_bf16_f32 v164, v148, v149
  v_mfma_f32_16x16x32_bf16 v[156:159], a[168:171], v[92:95], v[156:159]
  v_exp_f32 v150, v150
  v_mfma_f32_16x16x32_bf16 v[160:163], a[184:187], v[92:95], v[160:163]
  v_add_f32 v8, v8, v150
  v_mfma_f32_16x16x32_bf16 v[156:159], a[172:175], v[96:99], v[156:159]
  v_exp_f32 v151, v151
  v_mfma_f32_16x16x32_bf16 v[160:163], a[188:191], v[96:99], v[160:163]
  ds_read_b128 v[204:207], v17 offset:32768
  v_add_f32 v8, v8, v151
  v_cvt_pk_bf16_f32 v165, v150, v151
  s_add_u32 m0, s26, 143360
  s_add_u32 s33, s29, 40960
  v_mfma_f32_16x16x32_bf16 a[128:131], a[224:227], v[168:171], a[128:131]
  buffer_load_dwordx4 v64, s[12:15], s33 offen lds
  v_exp_f32 v152, v152
  v_mfma_f32_16x16x32_bf16 a[132:135], a[228:231], v[168:171], a[132:135]
  ds_read_b128 v[220:223], v21 offset:32768
  v_add_f32 v8, v8, v152
  v_mfma_f32_16x16x32_bf16 a[136:139], a[232:235], v[168:171], a[136:139]
  v_exp_f32 v153, v153
  v_mfma_f32_16x16x32_bf16 a[140:143], a[236:239], v[168:171], a[140:143]
  v_add_f32 v8, v8, v153
  v_cvt_pk_bf16_f32 v166, v152, v153
  v_mfma_f32_16x16x32_bf16 a[144:147], a[240:243], v[168:171], a[144:147]
  v_exp_f32 v154, v154
  v_mfma_f32_16x16x32_bf16 a[148:151], a[244:247], v[168:171], a[148:151]
  ds_read_b128 v[208:211], v18 offset:32768
  v_add_f32 v8, v8, v154
  v_mfma_f32_16x16x32_bf16 a[152:155], a[248:251], v[168:171], a[152:155]
  v_exp_f32 v155, v155
  v_mfma_f32_16x16x32_bf16 a[156:159], a[252:255], v[168:171], a[156:159]
  v_add_f32 v8, v8, v155
  v_cvt_pk_bf16_f32 v167, v154, v155
  v_mfma_f32_16x16x32_bf16 v[148:151], a[160:163], v[100:103], v[180:183]
  v_exp_f32 v156, v156
  v_mfma_f32_16x16x32_bf16 v[152:155], a[176:179], v[100:103], v[180:183]
  ds_read_b128 v[224:227], v22 offset:32768
  v_add_f32 v9, v9, v156
  v_mfma_f32_16x16x32_bf16 v[148:151], a[164:167], v[104:107], v[148:151]
  v_exp_f32 v157, v157
  v_mfma_f32_16x16x32_bf16 v[152:155], a[180:183], v[104:107], v[152:155]
  ds_read_b128 v[212:215], v19 offset:32768
  v_add_f32 v9, v9, v157
  v_cvt_pk_bf16_f32 v168, v156, v157
  v_mfma_f32_16x16x32_bf16 v[148:151], a[168:171], v[108:111], v[148:151]
  v_exp_f32 v158, v158
  v_mfma_f32_16x16x32_bf16 v[152:155], a[184:187], v[108:111], v[152:155]
  ds_read_b128 v[228:231], v23 offset:32768
  v_add_f32 v9, v9, v158
  v_mfma_f32_16x16x32_bf16 v[148:151], a[172:175], v[112:115], v[148:151]
  v_exp_f32 v159, v159
  v_mfma_f32_16x16x32_bf16 v[152:155], a[188:191], v[112:115], v[152:155]
  v_add_f32 v9, v9, v159
  v_cvt_pk_bf16_f32 v169, v158, v159
  v_mfma_f32_16x16x32_bf16 a[0:3], a[192:195], v[164:167], a[0:3]
  v_exp_f32 v160, v160
  v_mfma_f32_16x16x32_bf16 a[4:7], a[196:199], v[164:167], a[4:7]
  ds_read_b64_tr_b16 a[224:225], v32 offset:32768
  v_add_f32 v9, v9, v160
  v_mfma_f32_16x16x32_bf16 a[8:11], a[200:203], v[164:167], a[8:11]
  v_exp_f32 v161, v161
  v_mfma_f32_16x16x32_bf16 a[12:15], a[204:207], v[164:167], a[12:15]
  ds_read_b64_tr_b16 a[226:227], v32 offset:36864
  v_add_f32 v9, v9, v161
  v_cvt_pk_bf16_f32 v170, v160, v161
  v_mfma_f32_16x16x32_bf16 a[16:19], a[208:211], v[164:167], a[16:19]
  v_exp_f32 v162, v162
  v_mfma_f32_16x16x32_bf16 a[20:23], a[212:215], v[164:167], a[20:23]
  ds_read_b64_tr_b16 a[228:229], v33 offset:32768
  v_add_f32 v9, v9, v162
  v_mfma_f32_16x16x32_bf16 a[24:27], a[216:219], v[164:167], a[24:27]
  v_exp_f32 v163, v163
  v_mfma_f32_16x16x32_bf16 a[28:31], a[220:223], v[164:167], a[28:31]
  v_add_f32 v9, v9, v163
  v_cvt_pk_bf16_f32 v171, v162, v163
  v_mfma_f32_16x16x32_bf16 v[156:159], a[160:163], v[116:119], v[184:187]
  v_exp_f32 v148, v148
  v_mfma_f32_16x16x32_bf16 v[160:163], a[176:179], v[116:119], v[184:187]
  ds_read_b64_tr_b16 a[230:231], v33 offset:36864
  v_add_f32 v10, v10, v148
  s_add_u32 m0, s26, 147456
  s_add_u32 s33, s29, 81920
  v_mfma_f32_16x16x32_bf16 v[156:159], a[164:167], v[120:123], v[156:159]
  buffer_load_dwordx4 v64, s[12:15], s33 offen lds
  v_exp_f32 v149, v149
  v_mfma_f32_16x16x32_bf16 v[160:163], a[180:183], v[120:123], v[160:163]
  ds_read_b64_tr_b16 a[232:233], v34 offset:32768
  v_add_f32 v10, v10, v149
  v_cvt_pk_bf16_f32 v164, v148, v149
  v_mfma_f32_16x16x32_bf16 v[156:159], a[168:171], v[124:127], v[156:159]
  v_exp_f32 v150, v150
  v_mfma_f32_16x16x32_bf16 v[160:163], a[184:187], v[124:127], v[160:163]
  ds_read_b64_tr_b16 a[234:235], v34 offset:36864
  v_add_f32 v10, v10, v150
  s_add_u32 m0, s26, 151552
  s_add_u32 s33, s29, 122880
  v_mfma_f32_16x16x32_bf16 v[156:159], a[172:175], v[128:131], v[156:159]
  buffer_load_dwordx4 v64, s[12:15], s33 offen lds
  v_exp_f32 v151, v151
  v_mfma_f32_16x16x32_bf16 v[160:163], a[188:191], v[128:131], v[160:163]
  ds_read_b64_tr_b16 a[236:237], v35 offset:32768
  v_add_f32 v10, v10, v151
  v_cvt_pk_bf16_f32 v165, v150, v151
  v_mfma_f32_16x16x32_bf16 a[32:35], a[192:195], v[168:171], a[32:35]
  v_exp_f32 v152, v152
  v_mfma_f32_16x16x32_bf16 a[36:39], a[196:199], v[168:171], a[36:39]
  ds_read_b64_tr_b16 a[238:239], v35 offset:36864
  v_add_f32 v10, v10, v152
  v_mfma_f32_16x16x32_bf16 a[40:43], a[200:203], v[168:171], a[40:43]
  v_exp_f32 v153, v153
  v_mfma_f32_16x16x32_bf16 a[44:47], a[204:207], v[168:171], a[44:47]
  ds_read_b64_tr_b16 a[240:241], v36 offset:32768
  v_add_f32 v10, v10, v153
  v_cvt_pk_bf16_f32 v166, v152, v153
  s_add_u32 m0, s26, 155648
  s_add_u32 s33, s29, 163840
  v_mfma_f32_16x16x32_bf16 a[48:51], a[208:211], v[168:171], a[48:51]
  buffer_load_dwordx4 v64, s[12:15], s33 offen lds
  v_exp_f32 v154, v154
  v_mfma_f32_16x16x32_bf16 a[52:55], a[212:215], v[168:171], a[52:55]
  ds_read_b64_tr_b16 a[242:243], v36 offset:36864
  v_add_f32 v10, v10, v154
  v_mfma_f32_16x16x32_bf16 a[56:59], a[216:219], v[168:171], a[56:59]
  v_exp_f32 v155, v155
  v_mfma_f32_16x16x32_bf16 a[60:63], a[220:223], v[168:171], a[60:63]
  v_add_f32 v10, v10, v155
  v_cvt_pk_bf16_f32 v167, v154, v155
  v_mfma_f32_16x16x32_bf16 v[148:151], a[160:163], v[132:135], v[188:191]
  v_exp_f32 v156, v156
  v_mfma_f32_16x16x32_bf16 v[152:155], a[176:179], v[132:135], v[188:191]
  ds_read_b64_tr_b16 a[244:245], v37 offset:32768
  v_add_f32 v11, v11, v156
  v_mfma_f32_16x16x32_bf16 v[148:151], a[164:167], v[136:139], v[148:151]
  v_exp_f32 v157, v157
  v_mfma_f32_16x16x32_bf16 v[152:155], a[180:183], v[136:139], v[152:155]
  ds_read_b64_tr_b16 a[246:247], v37 offset:36864
  v_add_f32 v11, v11, v157
  v_cvt_pk_bf16_f32 v168, v156, v157
  v_mfma_f32_16x16x32_bf16 v[148:151], a[168:171], v[140:143], v[148:151]
  v_exp_f32 v158, v158
  v_mfma_f32_16x16x32_bf16 v[152:155], a[184:187], v[140:143], v[152:155]
  ds_read_b64_tr_b16 a[248:249], v38 offset:32768
  v_add_f32 v11, v11, v158
  v_mfma_f32_16x16x32_bf16 v[148:151], a[172:175], v[144:147], v[148:151]
  v_exp_f32 v159, v159
  v_mfma_f32_16x16x32_bf16 v[152:155], a[188:191], v[144:147], v[152:155]
  v_add_f32 v11, v11, v159
  v_cvt_pk_bf16_f32 v169, v158, v159
  v_mfma_f32_16x16x32_bf16 a[64:67], a[192:195], v[164:167], a[64:67]
  v_exp_f32 v160, v160
  v_mfma_f32_16x16x32_bf16 a[68:71], a[196:199], v[164:167], a[68:71]
  ds_read_b64_tr_b16 a[250:251], v38 offset:36864
  v_add_f32 v11, v11, v160
  v_mfma_f32_16x16x32_bf16 a[72:75], a[200:203], v[164:167], a[72:75]
  v_exp_f32 v161, v161
  v_mfma_f32_16x16x32_bf16 a[76:79], a[204:207], v[164:167], a[76:79]
  ds_read_b64_tr_b16 a[252:253], v39 offset:32768
  v_add_f32 v11, v11, v161
  v_cvt_pk_bf16_f32 v170, v160, v161
  v_mfma_f32_16x16x32_bf16 a[80:83], a[208:211], v[164:167], a[80:83]
  v_exp_f32 v162, v162
  v_mfma_f32_16x16x32_bf16 a[84:87], a[212:215], v[164:167], a[84:87]
  ds_read_b64_tr_b16 a[254:255], v39 offset:36864
  v_add_f32 v11, v11, v162
  v_mfma_f32_16x16x32_bf16 a[88:91], a[216:219], v[164:167], a[88:91]
  v_exp_f32 v163, v163
  v_mfma_f32_16x16x32_bf16 a[92:95], a[220:223], v[164:167], a[92:95]
  v_add_f32 v11, v11, v163
  v_cvt_pk_bf16_f32 v171, v162, v163
  s_waitcnt lgkmcnt(15)
  v_mfma_f32_16x16x32_bf16 v[156:159], v[200:203], v[68:71], v[172:175]
  v_exp_f32 v148, v148
  v_mfma_f32_16x16x32_bf16 v[160:163], v[216:219], v[68:71], v[172:175]
  v_add_f32 v12, v12, v148
  v_mfma_f32_16x16x32_bf16 v[156:159], v[204:207], v[72:75], v[156:159]
  v_exp_f32 v149, v149
  v_mfma_f32_16x16x32_bf16 v[160:163], v[220:223], v[72:75], v[160:163]
  v_add_f32 v12, v12, v149
  v_cvt_pk_bf16_f32 v164, v148, v149
  v_mfma_f32_16x16x32_bf16 v[156:159], v[208:211], v[76:79], v[156:159]
  v_exp_f32 v150, v150
  v_mfma_f32_16x16x32_bf16 v[160:163], v[224:227], v[76:79], v[160:163]
  v_add_f32 v12, v12, v150
  v_mfma_f32_16x16x32_bf16 v[156:159], v[212:215], v[80:83], v[156:159]
  v_exp_f32 v151, v151
  v_mfma_f32_16x16x32_bf16 v[160:163], v[228:231], v[80:83], v[160:163]
  v_add_f32 v12, v12, v151
  v_cvt_pk_bf16_f32 v165, v150, v151
  v_mfma_f32_16x16x32_bf16 a[96:99], a[192:195], v[168:171], a[96:99]
  v_exp_f32 v152, v152
  v_mfma_f32_16x16x32_bf16 a[100:103], a[196:199], v[168:171], a[100:103]
  v_add_f32 v12, v12, v152
  v_mfma_f32_16x16x32_bf16 a[104:107], a[200:203], v[168:171], a[104:107]
  v_exp_f32 v153, v153
  v_mfma_f32_16x16x32_bf16 a[108:111], a[204:207], v[168:171], a[108:111]
  v_add_f32 v12, v12, v153
  v_cvt_pk_bf16_f32 v166, v152, v153
  v_mfma_f32_16x16x32_bf16 a[112:115], a[208:211], v[168:171], a[112:115]
  v_exp_f32 v154, v154
  v_mfma_f32_16x16x32_bf16 a[116:119], a[212:215], v[168:171], a[116:119]
  v_add_f32 v12, v12, v154
  v_mfma_f32_16x16x32_bf16 a[120:123], a[216:219], v[168:171], a[120:123]
  v_exp_f32 v155, v155
  v_mfma_f32_16x16x32_bf16 a[124:127], a[220:223], v[168:171], a[124:127]
  v_add_f32 v12, v12, v155
  v_cvt_pk_bf16_f32 v167, v154, v155
  v_mfma_f32_16x16x32_bf16 v[148:151], v[200:203], v[84:87], v[176:179]
  s_waitcnt vmcnt(13) lgkmcnt(0)
  s_barrier
  v_exp_f32 v156, v156
  v_mfma_f32_16x16x32_bf16 v[152:155], v[216:219], v[84:87], v[176:179]
  ds_read_b128 a[160:163], v24 offset:0
  v_add_f32 v8, v8, v156
  v_mfma_f32_16x16x32_bf16 v[148:151], v[204:207], v[88:91], v[148:151]
  v_exp_f32 v157, v157
  v_mfma_f32_16x16x32_bf16 v[152:155], v[220:223], v[88:91], v[152:155]
  ds_read_b128 a[176:179], v28 offset:0
  v_add_f32 v8, v8, v157
  v_cvt_pk_bf16_f32 v168, v156, v157
  v_mfma_f32_16x16x32_bf16 v[148:151], v[208:211], v[92:95], v[148:151]
  v_exp_f32 v158, v158
  v_mfma_f32_16x16x32_bf16 v[152:155], v[224:227], v[92:95], v[152:155]
  v_add_f32 v8, v8, v158
  v_mfma_f32_16x16x32_bf16 v[148:151], v[212:215], v[96:99], v[148:151]
  v_exp_f32 v159, v159
  v_mfma_f32_16x16x32_bf16 v[152:155], v[228:231], v[96:99], v[152:155]
  ds_read_b128 a[164:167], v25 offset:0
  v_add_f32 v8, v8, v159
  v_cvt_pk_bf16_f32 v169, v158, v159
  v_mfma_f32_16x16x32_bf16 a[128:131], a[192:195], v[164:167], a[128:131]
  v_exp_f32 v160, v160
  v_mfma_f32_16x16x32_bf16 a[132:135], a[196:199], v[164:167], a[132:135]
  ds_read_b128 a[180:183], v29 offset:0
  v_add_f32 v8, v8, v160
  v_mfma_f32_16x16x32_bf16 a[136:139], a[200:203], v[164:167], a[136:139]
  v_exp_f32 v161, v161
  v_mfma_f32_16x16x32_bf16 a[140:143], a[204:207], v[164:167], a[140:143]
  v_add_f32 v8, v8, v161
  v_cvt_pk_bf16_f32 v170, v160, v161
  v_mfma_f32_16x16x32_bf16 a[144:147], a[208:211], v[164:167], a[144:147]
  v_exp_f32 v162, v162
  v_mfma_f32_16x16x32_bf16 a[148:151], a[212:215], v[164:167], a[148:151]
  ds_read_b128 a[168:171], v26 offset:0
  v_add_f32 v8, v8, v162
  v_mfma_f32_16x16x32_bf16 a[152:155], a[216:219], v[164:167], a[152:155]
  v_exp_f32 v163, v163
  v_mfma_f32_16x16x32_bf16 a[156:159], a[220:223], v[164:167], a[156:159]
  v_add_f32 v8, v8, v163
  v_cvt_pk_bf16_f32 v171, v162, v163
  v_mfma_f32_16x16x32_bf16 v[156:159], v[200:203], v[100:103], v[180:183]
  v_exp_f32 v148, v148
  v_mfma_f32_16x16x32_bf16 v[160:163], v[216:219], v[100:103], v[180:183]
  ds_read_b128 a[184:187], v30 offset:0
  v_add_f32 v9, v9, v148
  v_mfma_f32_16x16x32_bf16 v[156:159], v[204:207], v[104:107], v[156:159]
  v_exp_f32 v149, v149
  v_mfma_f32_16x16x32_bf16 v[160:163], v[220:223], v[104:107], v[160:163]
  ds_read_b128 a[172:175], v27 offset:0
  v_add_f32 v9, v9, v149
  v_cvt_pk_bf16_f32 v164, v148, v149
  v_mfma_f32_16x16x32_bf16 v[156:159], v[208:211], v[108:111], v[156:159]
  v_exp_f32 v150, v150
  v_mfma_f32_16x16x32_bf16 v[160:163], v[224:227], v[108:111], v[160:163]
  ds_read_b128 a[188:191], v31 offset:0
  v_add_f32 v9, v9, v150
  v_mfma_f32_16x16x32_bf16 v[156:159], v[212:215], v[112:115], v[156:159]
  v_exp_f32 v151, v151
  v_mfma_f32_16x16x32_bf16 v[160:163], v[228:231], v[112:115], v[160:163]
  v_add_f32 v9, v9, v151
  v_cvt_pk_bf16_f32 v165, v150, v151
  v_mfma_f32_16x16x32_bf16 a[0:3], a[224:227], v[168:171], a[0:3]
  v_exp_f32 v152, v152
  v_mfma_f32_16x16x32_bf16 a[4:7], a[228:231], v[168:171], a[4:7]
  ds_read_b64_tr_b16 a[192:193], v40 offset:0
  v_add_f32 v9, v9, v152
  v_mfma_f32_16x16x32_bf16 a[8:11], a[232:235], v[168:171], a[8:11]
  v_exp_f32 v153, v153
  v_mfma_f32_16x16x32_bf16 a[12:15], a[236:239], v[168:171], a[12:15]
  ds_read_b64_tr_b16 a[194:195], v40 offset:4096
  v_add_f32 v9, v9, v153
  v_cvt_pk_bf16_f32 v166, v152, v153
  v_mfma_f32_16x16x32_bf16 a[16:19], a[240:243], v[168:171], a[16:19]
  v_exp_f32 v154, v154
  v_mfma_f32_16x16x32_bf16 a[20:23], a[244:247], v[168:171], a[20:23]
  ds_read_b64_tr_b16 a[196:197], v41 offset:0
  v_add_f32 v9, v9, v154
  v_mfma_f32_16x16x32_bf16 a[24:27], a[248:251], v[168:171], a[24:27]
  v_exp_f32 v155, v155
  v_mfma_f32_16x16x32_bf16 a[28:31], a[252:255], v[168:171], a[28:31]
  v_add_f32 v9, v9, v155
  v_cvt_pk_bf16_f32 v167, v154, v155
  v_mfma_f32_16x16x32_bf16 v[148:151], v[200:203], v[116:119], v[184:187]
  v_exp_f32 v156, v156
  v_mfma_f32_16x16x32_bf16 v[152:155], v[216:219], v[116:119], v[184:187]
  ds_read_b64_tr_b16 a[198:199], v41 offset:4096
  v_add_f32 v10, v10, v156
  v_mfma_f32_16x16x32_bf16 v[148:151], v[204:207], v[120:123], v[148:151]
  v_exp_f32 v157, v157
  v_mfma_f32_16x16x32_bf16 v[152:155], v[220:223], v[120:123], v[152:155]
  ds_read_b64_tr_b16 a[200:201], v42 offset:0
  v_add_f32 v10, v10, v157
  v_cvt_pk_bf16_f32 v168, v156, v157
  v_mfma_f32_16x16x32_bf16 v[148:151], v[208:211], v[124:127], v[148:151]
  v_exp_f32 v158, v158
  v_mfma_f32_16x16x32_bf16 v[152:155], v[224:227], v[124:127], v[152:155]
  ds_read_b64_tr_b16 a[202:203], v42 offset:4096
  v_add_f32 v10, v10, v158
  v_mfma_f32_16x16x32_bf16 v[148:151], v[212:215], v[128:131], v[148:151]
  v_exp_f32 v159, v159
  v_mfma_f32_16x16x32_bf16 v[152:155], v[228:231], v[128:131], v[152:155]
  ds_read_b64_tr_b16 a[204:205], v43 offset:0
  v_add_f32 v10, v10, v159
  v_cvt_pk_bf16_f32 v169, v158, v159
  v_mfma_f32_16x16x32_bf16 a[32:35], a[224:227], v[164:167], a[32:35]
  v_exp_f32 v160, v160
  v_mfma_f32_16x16x32_bf16 a[36:39], a[228:231], v[164:167], a[36:39]
  ds_read_b64_tr_b16 a[206:207], v43 offset:4096
  v_add_f32 v10, v10, v160
  v_mfma_f32_16x16x32_bf16 a[40:43], a[232:235], v[164:167], a[40:43]
  v_exp_f32 v161, v161
  v_mfma_f32_16x16x32_bf16 a[44:47], a[236:239], v[164:167], a[44:47]
  ds_read_b64_tr_b16 a[208:209], v44 offset:0
  v_add_f32 v10, v10, v161
  v_cvt_pk_bf16_f32 v170, v160, v161
  v_mfma_f32_16x16x32_bf16 a[48:51], a[240:243], v[164:167], a[48:51]
  v_exp_f32 v162, v162
  v_mfma_f32_16x16x32_bf16 a[52:55], a[244:247], v[164:167], a[52:55]
  ds_read_b64_tr_b16 a[210:211], v44 offset:4096
  v_add_f32 v10, v10, v162
  v_mfma_f32_16x16x32_bf16 a[56:59], a[248:251], v[164:167], a[56:59]
  v_exp_f32 v163, v163
  v_mfma_f32_16x16x32_bf16 a[60:63], a[252:255], v[164:167], a[60:63]
  v_add_f32 v10, v10, v163
  v_cvt_pk_bf16_f32 v171, v162, v163
  v_mfma_f32_16x16x32_bf16 v[156:159], v[200:203], v[132:135], v[188:191]
  v_exp_f32 v148, v148
  v_mfma_f32_16x16x32_bf16 v[160:163], v[216:219], v[132:135], v[188:191]
  ds_read_b64_tr_b16 a[212:213], v45 offset:0
  v_add_f32 v11, v11, v148
  v_mfma_f32_16x16x32_bf16 v[156:159], v[204:207], v[136:139], v[156:159]
  v_exp_f32 v149, v149
  v_mfma_f32_16x16x32_bf16 v[160:163], v[220:223], v[136:139], v[160:163]
  ds_read_b64_tr_b16 a[214:215], v45 offset:4096
  v_add_f32 v11, v11, v149
  v_cvt_pk_bf16_f32 v164, v148, v149
  v_mfma_f32_16x16x32_bf16 v[156:159], v[208:211], v[140:143], v[156:159]
  v_exp_f32 v150, v150
  v_mfma_f32_16x16x32_bf16 v[160:163], v[224:227], v[140:143], v[160:163]
  ds_read_b64_tr_b16 a[216:217], v46 offset:0
  v_add_f32 v11, v11, v150
  v_mfma_f32_16x16x32_bf16 v[156:159], v[212:215], v[144:147], v[156:159]
  v_exp_f32 v151, v151
  v_mfma_f32_16x16x32_bf16 v[160:163], v[228:231], v[144:147], v[160:163]
  v_add_f32 v11, v11, v151
  v_cvt_pk_bf16_f32 v165, v150, v151
  v_mfma_f32_16x16x32_bf16 a[64:67], a[224:227], v[168:171], a[64:67]
  v_exp_f32 v152, v152
  v_mfma_f32_16x16x32_bf16 a[68:71], a[228:231], v[168:171], a[68:71]
  ds_read_b64_tr_b16 a[218:219], v46 offset:4096
  v_add_f32 v11, v11, v152
  v_mfma_f32_16x16x32_bf16 a[72:75], a[232:235], v[168:171], a[72:75]
  v_exp_f32 v153, v153
  v_mfma_f32_16x16x32_bf16 a[76:79], a[236:239], v[168:171], a[76:79]
  ds_read_b64_tr_b16 a[220:221], v47 offset:0
  v_add_f32 v11, v11, v153
  v_cvt_pk_bf16_f32 v166, v152, v153
  v_mfma_f32_16x16x32_bf16 a[80:83], a[240:243], v[168:171], a[80:83]
  v_exp_f32 v154, v154
  v_mfma_f32_16x16x32_bf16 a[84:87], a[244:247], v[168:171], a[84:87]
  ds_read_b64_tr_b16 a[222:223], v47 offset:4096
  v_add_f32 v11, v11, v154
  v_mfma_f32_16x16x32_bf16 a[88:91], a[248:251], v[168:171], a[88:91]
  v_exp_f32 v155, v155
  v_mfma_f32_16x16x32_bf16 a[92:95], a[252:255], v[168:171], a[92:95]
  v_add_f32 v11, v11, v155
  v_cvt_pk_bf16_f32 v167, v154, v155
  s_waitcnt lgkmcnt(15)
  v_mfma_f32_16x16x32_bf16 v[148:151], a[160:163], v[68:71], v[172:175]
  v_exp_f32 v156, v156
  v_mfma_f32_16x16x32_bf16 v[152:155], a[176:179], v[68:71], v[172:175]
  v_add_f32 v12, v12, v156
  v_mfma_f32_16x16x32_bf16 v[148:151], a[164:167], v[72:75], v[148:151]
  v_exp_f32 v157, v157
  v_mfma_f32_16x16x32_bf16 v[152:155], a[180:183], v[72:75], v[152:155]
  v_add_f32 v12, v12, v157
  v_cvt_pk_bf16_f32 v168, v156, v157
  v_mfma_f32_16x16x32_bf16 v[148:151], a[168:171], v[76:79], v[148:151]
  v_exp_f32 v158, v158
  v_mfma_f32_16x16x32_bf16 v[152:155], a[184:187], v[76:79], v[152:155]
  v_add_f32 v12, v12, v158
  v_mfma_f32_16x16x32_bf16 v[148:151], a[172:175], v[80:83], v[148:151]
  v_exp_f32 v159, v159
  v_mfma_f32_16x16x32_bf16 v[152:155], a[188:191], v[80:83], v[152:155]
  v_add_f32 v12, v12, v159
  v_cvt_pk_bf16_f32 v169, v158, v159
  v_mfma_f32_16x16x32_bf16 a[96:99], a[224:227], v[164:167], a[96:99]
  v_exp_f32 v160, v160
  v_mfma_f32_16x16x32_bf16 a[100:103], a[228:231], v[164:167], a[100:103]
  v_add_f32 v12, v12, v160
  v_mfma_f32_16x16x32_bf16 a[104:107], a[232:235], v[164:167], a[104:107]
  v_exp_f32 v161, v161
  v_mfma_f32_16x16x32_bf16 a[108:111], a[236:239], v[164:167], a[108:111]
  v_add_f32 v12, v12, v161
  v_cvt_pk_bf16_f32 v170, v160, v161
  v_mfma_f32_16x16x32_bf16 a[112:115], a[240:243], v[164:167], a[112:115]
  v_exp_f32 v162, v162
  v_mfma_f32_16x16x32_bf16 a[116:119], a[244:247], v[164:167], a[116:119]
  v_add_f32 v12, v12, v162
  v_mfma_f32_16x16x32_bf16 a[120:123], a[248:251], v[164:167], a[120:123]
  v_exp_f32 v163, v163
  v_mfma_f32_16x16x32_bf16 a[124:127], a[252:255], v[164:167], a[124:127]
  v_add_f32 v12, v12, v163
  v_cvt_pk_bf16_f32 v171, v162, v163
  v_mfma_f32_16x16x32_bf16 v[156:159], a[160:163], v[84:87], v[176:179]
  s_waitcnt vmcnt(5) lgkmcnt(0)
  s_barrier
  v_exp_f32 v148, v148
  v_mfma_f32_16x16x32_bf16 v[160:163], a[176:179], v[84:87], v[176:179]
  ds_read_b128 v[200:203], v24 offset:32768
  v_add_f32 v8, v8, v148
  s_add_u32 m0, s26, 65536
  v_mfma_f32_16x16x32_bf16 v[156:159], a[164:167], v[88:91], v[156:159]
  buffer_load_dwordx4 v65, s[16:19], s30 offen lds
  v_exp_f32 v149, v149
  v_mfma_f32_16x16x32_bf16 v[160:163], a[180:183], v[88:91], v[160:163]
  ds_read_b128 v[216:219], v28 offset:32768
  v_add_f32 v8, v8, v149
  v_cvt_pk_bf16_f32 v164, v148, v149
  s_add_u32 m0, s26, 69632
  s_add_u32 s33, s30, 65536
  v_mfma_f32_16x16x32_bf16 v[156:159], a[168:171], v[92:95], v[156:159]
  buffer_load_dwordx4 v65, s[16:19], s33 offen lds
  v_exp_f32 v150, v150
  v_mfma_f32_16x16x32_bf16 v[160:163], a[184:187], v[92:95], v[160:163]
  v_add_f32 v8, v8, v150
  v_mfma_f32_16x16x32_bf16 v[156:159], a[172:175], v[96:99], v[156:159]
  v_exp_f32 v151, v151
  v_mfma_f32_16x16x32_bf16 v[160:163], a[188:191], v[96:99], v[160:163]
  ds_read_b128 v[204:207], v25 offset:32768
  v_add_f32 v8, v8, v151
  v_cvt_pk_bf16_f32 v165, v150, v151
  s_add_u32 m0, s26, 73728
  s_add_u32 s33, s30, 131072
  v_mfma_f32_16x16x32_bf16 a[128:131], a[224:227], v[168:171], a[128:131]
  buffer_load_dwordx4 v65, s[16:19], s33 offen lds
  v_exp_f32 v152, v152
  v_mfma_f32_16x16x32_bf16 a[132:135], a[228:231], v[168:171], a[132:135]
  ds_read_b128 v[220:223], v29 offset:32768
  v_add_f32 v8, v8, v152
  v_mfma_f32_16x16x32_bf16 a[136:139], a[232:235], v[168:171], a[136:139]
  v_exp_f32 v153, v153
  v_mfma_f32_16x16x32_bf16 a[140:143], a[236:239], v[168:171], a[140:143]
  v_add_f32 v8, v8, v153
  v_cvt_pk_bf16_f32 v166, v152, v153
  s_add_u32 m0, s26, 77824
  s_add_u32 s33, s30, 196608
  v_mfma_f32_16x16x32_bf16 a[144:147], a[240:243], v[168:171], a[144:147]
  buffer_load_dwordx4 v65, s[16:19], s33 offen lds
  v_exp_f32 v154, v154
  v_mfma_f32_16x16x32_bf16 a[148:151], a[244:247], v[168:171], a[148:151]
  ds_read_b128 v[208:211], v26 offset:32768
  v_add_f32 v8, v8, v154
  v_mfma_f32_16x16x32_bf16 a[152:155], a[248:251], v[168:171], a[152:155]
  v_exp_f32 v155, v155
  v_mfma_f32_16x16x32_bf16 a[156:159], a[252:255], v[168:171], a[156:159]
  v_add_f32 v8, v8, v155
  v_cvt_pk_bf16_f32 v167, v154, v155
  v_mfma_f32_16x16x32_bf16 v[148:151], a[160:163], v[100:103], v[180:183]
  v_exp_f32 v156, v156
  v_mfma_f32_16x16x32_bf16 v[152:155], a[176:179], v[100:103], v[180:183]
  ds_read_b128 v[224:227], v30 offset:32768
  v_add_f32 v9, v9, v156
  v_mfma_f32_16x16x32_bf16 v[148:151], a[164:167], v[104:107], v[148:151]
  v_exp_f32 v157, v157
  v_mfma_f32_16x16x32_bf16 v[152:155], a[180:183], v[104:107], v[152:155]
  ds_read_b128 v[212:215], v27 offset:32768
  v_add_f32 v9, v9, v157
  v_cvt_pk_bf16_f32 v168, v156, v157
  v_mfma_f32_16x16x32_bf16 v[148:151], a[168:171], v[108:111], v[148:151]
  v_exp_f32 v158, v158
  v_mfma_f32_16x16x32_bf16 v[152:155], a[184:187], v[108:111], v[152:155]
  ds_read_b128 v[228:231], v31 offset:32768
  v_add_f32 v9, v9, v158
  v_mfma_f32_16x16x32_bf16 v[148:151], a[172:175], v[112:115], v[148:151]
  v_exp_f32 v159, v159
  v_mfma_f32_16x16x32_bf16 v[152:155], a[188:191], v[112:115], v[152:155]
  v_add_f32 v9, v9, v159
  v_cvt_pk_bf16_f32 v169, v158, v159
  v_mfma_f32_16x16x32_bf16 a[0:3], a[192:195], v[164:167], a[0:3]
  v_exp_f32 v160, v160
  v_mfma_f32_16x16x32_bf16 a[4:7], a[196:199], v[164:167], a[4:7]
  ds_read_b64_tr_b16 a[224:225], v40 offset:32768
  v_add_f32 v9, v9, v160
  v_mfma_f32_16x16x32_bf16 a[8:11], a[200:203], v[164:167], a[8:11]
  v_exp_f32 v161, v161
  v_mfma_f32_16x16x32_bf16 a[12:15], a[204:207], v[164:167], a[12:15]
  ds_read_b64_tr_b16 a[226:227], v40 offset:36864
  v_add_f32 v9, v9, v161
  v_cvt_pk_bf16_f32 v170, v160, v161
  v_mfma_f32_16x16x32_bf16 a[16:19], a[208:211], v[164:167], a[16:19]
  v_exp_f32 v162, v162
  v_mfma_f32_16x16x32_bf16 a[20:23], a[212:215], v[164:167], a[20:23]
  ds_read_b64_tr_b16 a[228:229], v41 offset:32768
  v_add_f32 v9, v9, v162
  v_mfma_f32_16x16x32_bf16 a[24:27], a[216:219], v[164:167], a[24:27]
  v_exp_f32 v163, v163
  v_mfma_f32_16x16x32_bf16 a[28:31], a[220:223], v[164:167], a[28:31]
  v_add_f32 v9, v9, v163
  v_cvt_pk_bf16_f32 v171, v162, v163
  v_mfma_f32_16x16x32_bf16 v[156:159], a[160:163], v[116:119], v[184:187]
  v_exp_f32 v148, v148
  v_mfma_f32_16x16x32_bf16 v[160:163], a[176:179], v[116:119], v[184:187]
  ds_read_b64_tr_b16 a[230:231], v41 offset:36864
  v_add_f32 v10, v10, v148
  s_add_u32 m0, s26, 81920
  s_add_u32 s33, s30, 262144
  v_mfma_f32_16x16x32_bf16 v[156:159], a[164:167], v[120:123], v[156:159]
  buffer_load_dwordx4 v65, s[16:19], s33 offen lds
  v_exp_f32 v149, v149
  v_mfma_f32_16x16x32_bf16 v[160:163], a[180:183], v[120:123], v[160:163]
  ds_read_b64_tr_b16 a[232:233], v42 offset:32768
  v_add_f32 v10, v10, v149
  v_cvt_pk_bf16_f32 v164, v148, v149
  s_add_u32 m0, s26, 86016
  s_add_u32 s33, s30, 327680
  v_mfma_f32_16x16x32_bf16 v[156:159], a[168:171], v[124:127], v[156:159]
  buffer_load_dwordx4 v65, s[16:19], s33 offen lds
  v_exp_f32 v150, v150
  v_mfma_f32_16x16x32_bf16 v[160:163], a[184:187], v[124:127], v[160:163]
  ds_read_b64_tr_b16 a[234:235], v42 offset:36864
  v_add_f32 v10, v10, v150
  v_mfma_f32_16x16x32_bf16 v[156:159], a[172:175], v[128:131], v[156:159]
  v_exp_f32 v151, v151
  v_mfma_f32_16x16x32_bf16 v[160:163], a[188:191], v[128:131], v[160:163]
  ds_read_b64_tr_b16 a[236:237], v43 offset:32768
  v_add_f32 v10, v10, v151
  v_cvt_pk_bf16_f32 v165, v150, v151
  s_add_u32 m0, s26, 90112
  s_add_u32 s33, s30, 393216
  v_mfma_f32_16x16x32_bf16 a[32:35], a[192:195], v[168:171], a[32:35]
  buffer_load_dwordx4 v65, s[16:19], s33 offen lds
  v_exp_f32 v152, v152
  v_mfma_f32_16x16x32_bf16 a[36:39], a[196:199], v[168:171], a[36:39]
  ds_read_b64_tr_b16 a[238:239], v43 offset:36864
  v_add_f32 v10, v10, v152
  v_mfma_f32_16x16x32_bf16 a[40:43], a[200:203], v[168:171], a[40:43]
  v_exp_f32 v153, v153
  v_mfma_f32_16x16x32_bf16 a[44:47], a[204:207], v[168:171], a[44:47]
  ds_read_b64_tr_b16 a[240:241], v44 offset:32768
  v_add_f32 v10, v10, v153
  v_cvt_pk_bf16_f32 v166, v152, v153
  s_add_u32 m0, s26, 94208
  s_add_u32 s33, s30, 458752
  v_mfma_f32_16x16x32_bf16 a[48:51], a[208:211], v[168:171], a[48:51]
  buffer_load_dwordx4 v65, s[16:19], s33 offen lds
  v_exp_f32 v154, v154
  s_add_u32 s29, s29, 128
  s_add_u32 s30, s30, 524288
  s_cmp_eq_u32 s29, 1280
  s_cselect_b32 s29, 0, s29
  s_cselect_b32 s33, 5242880, 0
  s_sub_u32 s30, s30, s33
  v_mfma_f32_16x16x32_bf16 a[52:55], a[212:215], v[168:171], a[52:55]
  ds_read_b64_tr_b16 a[242:243], v44 offset:36864
  v_add_f32 v10, v10, v154
  v_mfma_f32_16x16x32_bf16 a[56:59], a[216:219], v[168:171], a[56:59]
  v_exp_f32 v155, v155
  v_mfma_f32_16x16x32_bf16 a[60:63], a[220:223], v[168:171], a[60:63]
  v_add_f32 v10, v10, v155
  v_cvt_pk_bf16_f32 v167, v154, v155
  v_mfma_f32_16x16x32_bf16 v[148:151], a[160:163], v[132:135], v[188:191]
  v_exp_f32 v156, v156
  v_mfma_f32_16x16x32_bf16 v[152:155], a[176:179], v[132:135], v[188:191]
  ds_read_b64_tr_b16 a[244:245], v45 offset:32768
  v_add_f32 v11, v11, v156
  v_mfma_f32_16x16x32_bf16 v[148:151], a[164:167], v[136:139], v[148:151]
  v_exp_f32 v157, v157
  v_mfma_f32_16x16x32_bf16 v[152:155], a[180:183], v[136:139], v[152:155]
  ds_read_b64_tr_b16 a[246:247], v45 offset:36864
  v_add_f32 v11, v11, v157
  v_cvt_pk_bf16_f32 v168, v156, v157
  v_mfma_f32_16x16x32_bf16 v[148:151], a[168:171], v[140:143], v[148:151]
  v_exp_f32 v158, v158
  v_mfma_f32_16x16x32_bf16 v[152:155], a[184:187], v[140:143], v[152:155]
  ds_read_b64_tr_b16 a[248:249], v46 offset:32768
  v_add_f32 v11, v11, v158
  v_mfma_f32_16x16x32_bf16 v[148:151], a[172:175], v[144:147], v[148:151]
  v_exp_f32 v159, v159
  v_mfma_f32_16x16x32_bf16 v[152:155], a[188:191], v[144:147], v[152:155]
  v_add_f32 v11, v11, v159
  v_cvt_pk_bf16_f32 v169, v158, v159
  v_mfma_f32_16x16x32_bf16 a[64:67], a[192:195], v[164:167], a[64:67]
  v_exp_f32 v160, v160
  v_mfma_f32_16x16x32_bf16 a[68:71], a[196:199], v[164:167], a[68:71]
  ds_read_b64_tr_b16 a[250:251], v46 offset:36864
  v_add_f32 v11, v11, v160
  v_mfma_f32_16x16x32_bf16 a[72:75], a[200:203], v[164:167], a[72:75]
  v_exp_f32 v161, v161
  v_mfma_f32_16x16x32_bf16 a[76:79], a[204:207], v[164:167], a[76:79]
  ds_read_b64_tr_b16 a[252:253], v47 offset:32768
  v_add_f32 v11, v11, v161
  v_cvt_pk_bf16_f32 v170, v160, v161
  v_mfma_f32_16x16x32_bf16 a[80:83], a[208:211], v[164:167], a[80:83]
  v_exp_f32 v162, v162
  v_mfma_f32_16x16x32_bf16 a[84:87], a[212:215], v[164:167], a[84:87]
  ds_read_b64_tr_b16 a[254:255], v47 offset:36864
  v_add_f32 v11, v11, v162
  v_mfma_f32_16x16x32_bf16 a[88:91], a[216:219], v[164:167], a[88:91]
  v_exp_f32 v163, v163
  v_mfma_f32_16x16x32_bf16 a[92:95], a[220:223], v[164:167], a[92:95]
  v_add_f32 v11, v11, v163
  v_cvt_pk_bf16_f32 v171, v162, v163
  s_waitcnt lgkmcnt(15)
  v_mfma_f32_16x16x32_bf16 v[156:159], v[200:203], v[68:71], v[172:175]
  v_exp_f32 v148, v148
  v_mfma_f32_16x16x32_bf16 v[160:163], v[216:219], v[68:71], v[172:175]
  v_add_f32 v12, v12, v148
  v_mfma_f32_16x16x32_bf16 v[156:159], v[204:207], v[72:75], v[156:159]
  v_exp_f32 v149, v149
  v_mfma_f32_16x16x32_bf16 v[160:163], v[220:223], v[72:75], v[160:163]
  v_add_f32 v12, v12, v149
  v_cvt_pk_bf16_f32 v164, v148, v149
  v_mfma_f32_16x16x32_bf16 v[156:159], v[208:211], v[76:79], v[156:159]
  v_exp_f32 v150, v150
  v_mfma_f32_16x16x32_bf16 v[160:163], v[224:227], v[76:79], v[160:163]
  v_add_f32 v12, v12, v150
  v_mfma_f32_16x16x32_bf16 v[156:159], v[212:215], v[80:83], v[156:159]
  v_exp_f32 v151, v151
  v_mfma_f32_16x16x32_bf16 v[160:163], v[228:231], v[80:83], v[160:163]
  v_add_f32 v12, v12, v151
  v_cvt_pk_bf16_f32 v165, v150, v151
  v_mfma_f32_16x16x32_bf16 a[96:99], a[192:195], v[168:171], a[96:99]
  v_exp_f32 v152, v152
  v_mfma_f32_16x16x32_bf16 a[100:103], a[196:199], v[168:171], a[100:103]
  v_add_f32 v12, v12, v152
  v_mfma_f32_16x16x32_bf16 a[104:107], a[200:203], v[168:171], a[104:107]
  v_exp_f32 v153, v153
  v_mfma_f32_16x16x32_bf16 a[108:111], a[204:207], v[168:171], a[108:111]
  v_add_f32 v12, v12, v153
  v_cvt_pk_bf16_f32 v166, v152, v153
  v_mfma_f32_16x16x32_bf16 a[112:115], a[208:211], v[168:171], a[112:115]
  v_exp_f32 v154, v154
  v_mfma_f32_16x16x32_bf16 a[116:119], a[212:215], v[168:171], a[116:119]
  v_add_f32 v12, v12, v154
  v_mfma_f32_16x16x32_bf16 a[120:123], a[216:219], v[168:171], a[120:123]
  v_exp_f32 v155, v155
  v_mfma_f32_16x16x32_bf16 a[124:127], a[220:223], v[168:171], a[124:127]
  v_add_f32 v12, v12, v155
  v_cvt_pk_bf16_f32 v167, v154, v155
  v_mfma_f32_16x16x32_bf16 v[148:151], v[200:203], v[84:87], v[176:179]
  s_waitcnt lgkmcnt(0)
  s_barrier
  v_exp_f32 v156, v156
  s_add_u32 m0, s26, 98304
  v_mfma_f32_16x16x32_bf16 v[152:155], v[216:219], v[84:87], v[176:179]
  buffer_load_dwordx4 v64, s[12:15], s29 offen lds
  v_add_f32 v8, v8, v156
  v_mfma_f32_16x16x32_bf16 v[148:151], v[204:207], v[88:91], v[148:151]
  v_exp_f32 v157, v157
  v_mfma_f32_16x16x32_bf16 v[152:155], v[220:223], v[88:91], v[152:155]
  v_add_f32 v8, v8, v157
  v_cvt_pk_bf16_f32 v168, v156, v157
  s_add_u32 m0, s26, 102400
  s_add_u32 s33, s29, 40960
  v_mfma_f32_16x16x32_bf16 v[148:151], v[208:211], v[92:95], v[148:151]
  buffer_load_dwordx4 v64, s[12:15], s33 offen lds
  v_exp_f32 v158, v158
  v_mfma_f32_16x16x32_bf16 v[152:155], v[224:227], v[92:95], v[152:155]
  v_add_f32 v8, v8, v158
  v_mfma_f32_16x16x32_bf16 v[148:151], v[212:215], v[96:99], v[148:151]
  v_exp_f32 v159, v159
  v_mfma_f32_16x16x32_bf16 v[152:155], v[228:231], v[96:99], v[152:155]
  v_add_f32 v8, v8, v159
  v_cvt_pk_bf16_f32 v169, v158, v159
  s_add_u32 m0, s26, 106496
  s_add_u32 s33, s29, 81920
  v_mfma_f32_16x16x32_bf16 a[128:131], a[192:195], v[164:167], a[128:131]
  buffer_load_dwordx4 v64, s[12:15], s33 offen lds
  v_exp_f32 v160, v160
  v_mfma_f32_16x16x32_bf16 a[132:135], a[196:199], v[164:167], a[132:135]
  v_add_f32 v8, v8, v160
  s_add_u32 m0, s26, 110592
  s_add_u32 s33, s29, 122880
  v_mfma_f32_16x16x32_bf16 a[136:139], a[200:203], v[164:167], a[136:139]
  buffer_load_dwordx4 v64, s[12:15], s33 offen lds
  v_exp_f32 v161, v161
  v_mfma_f32_16x16x32_bf16 a[140:143], a[204:207], v[164:167], a[140:143]
  v_add_f32 v8, v8, v161
  v_cvt_pk_bf16_f32 v170, v160, v161
  v_mfma_f32_16x16x32_bf16 a[144:147], a[208:211], v[164:167], a[144:147]
  v_exp_f32 v162, v162
  s_add_u32 m0, s26, 114688
  s_add_u32 s33, s29, 163840
  v_mfma_f32_16x16x32_bf16 a[148:151], a[212:215], v[164:167], a[148:151]
  buffer_load_dwordx4 v64, s[12:15], s33 offen lds
  v_add_f32 v8, v8, v162
  v_mfma_f32_16x16x32_bf16 a[152:155], a[216:219], v[164:167], a[152:155]
  v_exp_f32 v163, v163
  v_mfma_f32_16x16x32_bf16 a[156:159], a[220:223], v[164:167], a[156:159]
  v_add_f32 v8, v8, v163
  v_cvt_pk_bf16_f32 v171, v162, v163
  v_mfma_f32_16x16x32_bf16 v[156:159], v[200:203], v[100:103], v[180:183]
  v_exp_f32 v148, v148
  s_add_u32 m0, s26, 0
  v_mfma_f32_16x16x32_bf16 v[160:163], v[216:219], v[100:103], v[180:183]
  buffer_load_dwordx4 v65, s[16:19], s30 offen lds
  v_add_f32 v9, v9, v148
  v_mfma_f32_16x16x32_bf16 v[156:159], v[204:207], v[104:107], v[156:159]
  v_exp_f32 v149, v149
  v_mfma_f32_16x16x32_bf16 v[160:163], v[220:223], v[104:107], v[160:163]
  v_add_f32 v9, v9, v149
  v_cvt_pk_bf16_f32 v164, v148, v149
  s_add_u32 m0, s26, 4096
  s_add_u32 s33, s30, 65536
  v_mfma_f32_16x16x32_bf16 v[156:159], v[208:211], v[108:111], v[156:159]
  buffer_load_dwordx4 v65, s[16:19], s33 offen lds
  v_exp_f32 v150, v150
  v_mfma_f32_16x16x32_bf16 v[160:163], v[224:227], v[108:111], v[160:163]
  v_add_f32 v9, v9, v150
  v_mfma_f32_16x16x32_bf16 v[156:159], v[212:215], v[112:115], v[156:159]
  v_exp_f32 v151, v151
  v_mfma_f32_16x16x32_bf16 v[160:163], v[228:231], v[112:115], v[160:163]
  v_add_f32 v9, v9, v151
  v_cvt_pk_bf16_f32 v165, v150, v151
  s_add_u32 m0, s26, 8192
  s_add_u32 s33, s30, 131072
  v_mfma_f32_16x16x32_bf16 a[0:3], a[224:227], v[168:171], a[0:3]
  buffer_load_dwordx4 v65, s[16:19], s33 offen lds
  v_exp_f32 v152, v152
  v_mfma_f32_16x16x32_bf16 a[4:7], a[228:231], v[168:171], a[4:7]
  v_add_f32 v9, v9, v152
  v_mfma_f32_16x16x32_bf16 a[8:11], a[232:235], v[168:171], a[8:11]
  v_exp_f32 v153, v153
  v_mfma_f32_16x16x32_bf16 a[12:15], a[236:239], v[168:171], a[12:15]
  v_add_f32 v9, v9, v153
  v_cvt_pk_bf16_f32 v166, v152, v153
  s_add_u32 m0, s26, 12288
  s_add_u32 s33, s30, 196608
  v_mfma_f32_16x16x32_bf16 a[16:19], a[240:243], v[168:171], a[16:19]
  buffer_load_dwordx4 v65, s[16:19], s33 offen lds
  v_exp_f32 v154, v154
  v_mfma_f32_16x16x32_bf16 a[20:23], a[244:247], v[168:171], a[20:23]
  v_add_f32 v9, v9, v154
  v_mfma_f32_16x16x32_bf16 a[24:27], a[248:251], v[168:171], a[24:27]
  v_exp_f32 v155, v155
  v_mfma_f32_16x16x32_bf16 a[28:31], a[252:255], v[168:171], a[28:31]
  v_add_f32 v9, v9, v155
  v_cvt_pk_bf16_f32 v167, v154, v155
  v_mfma_f32_16x16x32_bf16 v[148:151], v[200:203], v[116:119], v[184:187]
  v_exp_f32 v156, v156
  s_add_u32 m0, s26, 16384
  s_add_u32 s33, s30, 262144
  v_mfma_f32_16x16x32_bf16 v[152:155], v[216:219], v[116:119], v[184:187]
  buffer_load_dwordx4 v65, s[16:19], s33 offen lds
  v_add_f32 v10, v10, v156
  v_mfma_f32_16x16x32_bf16 v[148:151], v[204:207], v[120:123], v[148:151]
  v_exp_f32 v157, v157
  v_mfma_f32_16x16x32_bf16 v[152:155], v[220:223], v[120:123], v[152:155]
  v_add_f32 v10, v10, v157
  v_cvt_pk_bf16_f32 v168, v156, v157
  s_add_u32 m0, s26, 20480
  s_add_u32 s33, s30, 327680
  v_mfma_f32_16x16x32_bf16 v[148:151], v[208:211], v[124:127], v[148:151]
  buffer_load_dwordx4 v65, s[16:19], s33 offen lds
  v_exp_f32 v158, v158
  v_mfma_f32_16x16x32_bf16 v[152:155], v[224:227], v[124:127], v[152:155]
  v_add_f32 v10, v10, v158
  v_mfma_f32_16x16x32_bf16 v[148:151], v[212:215], v[128:131], v[148:151]
  v_exp_f32 v159, v159
  v_mfma_f32_16x16x32_bf16 v[152:155], v[228:231], v[128:131], v[152:155]
  v_add_f32 v10, v10, v159
  v_cvt_pk_bf16_f32 v169, v158, v159
  s_add_u32 m0, s26, 24576
  s_add_u32 s33, s30, 393216
  v_mfma_f32_16x16x32_bf16 a[32:35], a[224:227], v[164:167], a[32:35]
  buffer_load_dwordx4 v65, s[16:19], s33 offen lds
  v_exp_f32 v160, v160
  v_mfma_f32_16x16x32_bf16 a[36:39], a[228:231], v[164:167], a[36:39]
  v_add_f32 v10, v10, v160
  v_mfma_f32_16x16x32_bf16 a[40:43], a[232:235], v[164:167], a[40:43]
  v_exp_f32 v161, v161
  v_mfma_f32_16x16x32_bf16 a[44:47], a[236:239], v[164:167], a[44:47]
  v_add_f32 v10, v10, v161
  v_cvt_pk_bf16_f32 v170, v160, v161
  s_add_u32 m0, s26, 28672
  s_add_u32 s33, s30, 458752
  v_mfma_f32_16x16x32_bf16 a[48:51], a[240:243], v[164:167], a[48:51]
  buffer_load_dwordx4 v65, s[16:19], s33 offen lds
  v_exp_f32 v162, v162
  s_add_u32 s29, s29, 128
  s_add_u32 s30, s30, 524288
  s_cmp_eq_u32 s29, 1280
  s_cselect_b32 s29, 0, s29
  s_cselect_b32 s33, 5242880, 0
  s_sub_u32 s30, s30, s33
  v_mfma_f32_16x16x32_bf16 a[52:55], a[244:247], v[164:167], a[52:55]
  v_add_f32 v10, v10, v162
  v_mfma_f32_16x16x32_bf16 a[56:59], a[248:251], v[164:167], a[56:59]
  v_exp_f32 v163, v163
  v_mfma_f32_16x16x32_bf16 a[60:63], a[252:255], v[164:167], a[60:63]
  v_add_f32 v10, v10, v163
  v_cvt_pk_bf16_f32 v171, v162, v163
  v_mfma_f32_16x16x32_bf16 v[156:159], v[200:203], v[132:135], v[188:191]
  v_exp_f32 v148, v148
  v_mfma_f32_16x16x32_bf16 v[160:163], v[216:219], v[132:135], v[188:191]
  v_add_f32 v11, v11, v148
  v_mfma_f32_16x16x32_bf16 v[156:159], v[204:207], v[136:139], v[156:159]
  v_exp_f32 v149, v149
  v_mfma_f32_16x16x32_bf16 v[160:163], v[220:223], v[136:139], v[160:163]
  v_add_f32 v11, v11, v149
  v_cvt_pk_bf16_f32 v164, v148, v149
  v_mfma_f32_16x16x32_bf16 v[156:159], v[208:211], v[140:143], v[156:159]
  v_exp_f32 v150, v150
  v_mfma_f32_16x16x32_bf16 v[160:163], v[224:227], v[140:143], v[160:163]
  v_add_f32 v11, v11, v150
  v_mfma_f32_16x16x32_bf16 v[156:159], v[212:215], v[144:147], v[156:159]
  v_exp_f32 v151, v151
  v_mfma_f32_16x16x32_bf16 v[160:163], v[228:231], v[144:147], v[160:163]
  v_add_f32 v11, v11, v151
  v_cvt_pk_bf16_f32 v165, v150, v151
  v_mfma_f32_16x16x32_bf16 a[64:67], a[224:227], v[168:171], a[64:67]
  v_exp_f32 v152, v152
  v_mfma_f32_16x16x32_bf16 a[68:71], a[228:231], v[168:171], a[68:71]
  v_add_f32 v11, v11, v152
  v_mfma_f32_16x16x32_bf16 a[72:75], a[232:235], v[168:171], a[72:75]
  v_exp_f32 v153, v153
  v_mfma_f32_16x16x32_bf16 a[76:79], a[236:239], v[168:171], a[76:79]
  v_add_f32 v11, v11, v153
  v_cvt_pk_bf16_f32 v166, v152, v153
  v_mfma_f32_16x16x32_bf16 a[80:83], a[240:243], v[168:171], a[80:83]
  v_exp_f32 v154, v154
  v_mfma_f32_16x16x32_bf16 a[84:87], a[244:247], v[168:171], a[84:87]
  v_add_f32 v11, v11, v154
  v_mfma_f32_16x16x32_bf16 a[88:91], a[248:251], v[168:171], a[88:91]
  v_exp_f32 v155, v155
  v_mfma_f32_16x16x32_bf16 a[92:95], a[252:255], v[168:171], a[92:95]
  v_add_f32 v11, v11, v155
  v_cvt_pk_bf16_f32 v167, v154, v155
  s_nop 1
  v_mfma_f32_16x16x32_bf16 a[96:99], a[224:227], v[164:167], a[96:99]
  v_exp_f32 v156, v156
  v_exp_f32 v157, v157
  v_add_f32 v12, v12, v156
  v_mfma_f32_16x16x32_bf16 a[100:103], a[228:231], v[164:167], a[100:103]
  v_exp_f32 v158, v158
  v_add_f32 v12, v12, v157
  v_cvt_pk_bf16_f32 v168, v156, v157
  v_mfma_f32_16x16x32_bf16 a[104:107], a[232:235], v[164:167], a[104:107]
  v_exp_f32 v159, v159
  v_add_f32 v12, v12, v158
  v_mfma_f32_16x16x32_bf16 a[108:111], a[236:239], v[164:167], a[108:111]
  v_exp_f32 v160, v160
  v_add_f32 v12, v12, v159
  v_cvt_pk_bf16_f32 v169, v158, v159
  v_mfma_f32_16x16x32_bf16 a[112:115], a[240:243], v[164:167], a[112:115]
  v_exp_f32 v161, v161
  v_add_f32 v12, v12, v160
  v_exp_f32 v162, v162
  v_mfma_f32_16x16x32_bf16 a[116:119], a[244:247], v[164:167], a[116:119]
  v_add_f32 v12, v12, v161
  v_cvt_pk_bf16_f32 v170, v160, v161
  v_mfma_f32_16x16x32_bf16 a[120:123], a[248:251], v[164:167], a[120:123]
  v_exp_f32 v163, v163
  v_add_f32 v12, v12, v162
  s_nop 0
  v_mfma_f32_16x16x32_bf16 a[124:127], a[252:255], v[164:167], a[124:127]
  v_add_f32 v12, v12, v163
  v_cvt_pk_bf16_f32 v171, v162, v163
  s_nop 1
  v_mfma_f32_16x16x32_bf16 a[128:131], a[224:227], v[168:171], a[128:131]
  v_mfma_f32_16x16x32_bf16 a[132:135], a[228:231], v[168:171], a[132:135]
  v_mfma_f32_16x16x32_bf16 a[136:139], a[232:235], v[168:171], a[136:139]
  v_mfma_f32_16x16x32_bf16 a[140:143], a[236:239], v[168:171], a[140:143]
  v_mfma_f32_16x16x32_bf16 a[144:147], a[240:243], v[168:171], a[144:147]
  v_mfma_f32_16x16x32_bf16 a[148:151], a[244:247], v[168:171], a[148:151]
  v_mfma_f32_16x16x32_bf16 a[152:155], a[248:251], v[168:171], a[152:155]
  v_mfma_f32_16x16x32_bf16 a[156:159], a[252:255], v[168:171], a[156:159]
  v_mov_b32 v1, v8
  s_nop 1
  v_permlane32_swap_b32 v1, v8
  s_nop 1
  v_add_f32 v8, v8, v1
  v_mov_b32 v1, v8
  s_nop 1
  v_permlane16_swap_b32 v1, v8
  s_nop 1
  v_add_f32 v8, v8, v1
  v_mov_b32 v1, v9
  s_nop 1
  v_permlane32_swap_b32 v1, v9
  s_nop 1
  v_add_f32 v9, v9, v1
  v_mov_b32 v1, v9
  s_nop 1
  v_permlane16_swap_b32 v1, v9
  s_nop 1
  v_add_f32 v9, v9, v1
  v_mov_b32 v1, v10
  s_nop 1
  v_permlane32_swap_b32 v1, v10
  s_nop 1
  v_add_f32 v10, v10, v1
  v_mov_b32 v1, v10
  s_nop 1
  v_permlane16_swap_b32 v1, v10
  s_nop 1
  v_add_f32 v10, v10, v1
  v_mov_b32 v1, v11
  s_nop 1
  v_permlane32_swap_b32 v1, v11
  s_nop 1
  v_add_f32 v11, v11, v1
  v_mov_b32 v1, v11
  s_nop 1
  v_permlane16_swap_b32 v1, v11
  s_nop 1
  v_add_f32 v11, v11, v1
  v_mov_b32 v1, v12
  s_nop 1
  v_permlane32_swap_b32 v1, v12
  s_nop 1
  v_add_f32 v12, v12, v1
  v_mov_b32 v1, v12
  s_nop 1
  v_permlane16_swap_b32 v1, v12
  s_nop 1
  v_add_f32 v12, v12, v1
  s_mov_b32 s34, 0x21800000
  s_mov_b32 s35, 0x5d800000
  s_mov_b64 s[52:53], -1
  v_cmp_le_f32 s[54:55], s34, v8
  v_cmp_ge_f32 s[56:57], s35, v8
  s_nop 3
  s_and_b64 s[52:53], s[52:53], s[54:55]
  s_and_b64 s[52:53], s[52:53], s[56:57]
  v_cmp_le_f32 s[54:55], s34, v9
  v_cmp_ge_f32 s[56:57], s35, v9
  s_nop 3
  s_and_b64 s[52:53], s[52:53], s[54:55]
  s_and_b64 s[52:53], s[52:53], s[56:57]
  v_cmp_le_f32 s[54:55], s34, v10
  v_cmp_ge_f32 s[56:57], s35, v10
  s_nop 3
  s_and_b64 s[52:53], s[52:53], s[54:55]
  s_and_b64 s[52:53], s[52:53], s[56:57]
  v_cmp_le_f32 s[54:55], s34, v11
  v_cmp_ge_f32 s[56:57], s35, v11
  s_nop 3
  s_and_b64 s[52:53], s[52:53], s[54:55]
  s_and_b64 s[52:53], s[52:53], s[56:57]
  v_cmp_le_f32 s[54:55], s34, v12
  v_cmp_ge_f32 s[56:57], s35, v12
  s_nop 3
  s_and_b64 s[52:53], s[52:53], s[54:55]
  s_and_b64 s[52:53], s[52:53], s[56:57]
  s_cmp_eq_u64 s[52:53], -1
  s_cselect_b32 s36, 0, 1
  v_mov_b32 v2, s36
  s_lshl_b32 s35, s24, 2
  s_add_u32 s35, s35, 159744
  v_mov_b32 v3, s35
  ds_write_b32 v3, v2
  s_waitcnt lgkmcnt(0)
  s_barrier
  v_mov_b32 v3, 159744
  ds_read_b128 v[4:7], v3
  s_waitcnt lgkmcnt(0)
  v_or3_b32 v4, v4, v5, v6
  v_or_b32 v4, v4, v7
  s_nop 0
  v_readfirstlane_b32 s36, v4
  s_nop 3
  s_andn2_b32 s36, s36, s50
  s_cmp_lg_u32 s36, 0
  s_cbranch_scc1 concat_heads__mha_block_cached__mha_block_cached__near_ridge_kernel_slow
  v_rcp_f32 v8, v8
  v_rcp_f32 v9, v9
  v_rcp_f32 v10, v10
  v_rcp_f32 v11, v11
  v_rcp_f32 v12, v12
  s_cmp_eq_u32 s32, 1
  s_cbranch_scc1 concat_heads__mha_block_cached__mha_block_cached__near_ridge_kernel_final
  s_mov_b32 s32, 1
  s_add_u32 s4, s4, 4194304
  s_addc_u32 s5, s5, 0
  s_add_u32 s8, s8, 4194304
  s_addc_u32 s9, s9, 0
  s_mov_b32 s27, 0
  s_mov_b32 s28, 0
  s_waitcnt vmcnt(13)
  s_barrier
  ds_read_b128 a[224:227], v56 offset:40960
  ds_read_b64_tr_b16 a[160:161], v52 offset:0
  ds_read_b64_tr_b16 a[162:163], v52 offset:2048
  ds_read_b128 a[228:231], v56 offset:43008
  ds_read_b64_tr_b16 a[164:165], v52 offset:8
  ds_read_b64_tr_b16 a[166:167], v52 offset:2056
  ds_read_b128 a[232:235], v56 offset:45056
  ds_read_b64_tr_b16 a[168:169], v53 offset:0
  ds_read_b64_tr_b16 a[170:171], v53 offset:2048
  ds_read_b128 a[236:239], v56 offset:47104
  ds_read_b64_tr_b16 a[172:173], v53 offset:8
  ds_read_b64_tr_b16 a[174:175], v53 offset:2056
  ds_read_b128 a[240:243], v56 offset:49152
  ds_read_b64_tr_b16 a[176:177], v54 offset:0
  ds_read_b64_tr_b16 a[178:179], v54 offset:2048
  ds_read_b64_tr_b16 a[180:181], v54 offset:8
  ds_read_b64_tr_b16 a[182:183], v54 offset:2056
  ds_read_b64_tr_b16 a[184:185], v55 offset:0
  ds_read_b64_tr_b16 a[186:187], v55 offset:2048
  ds_read_b64_tr_b16 a[188:189], v55 offset:8
  ds_read_b64_tr_b16 a[190:191], v55 offset:2056
  s_add_u32 m0, s26, 118784
  s_nop 0
  buffer_load_dwordx4 v64, s[12:15], s29 offen lds
  s_add_u32 m0, s26, 122880
  s_add_u32 s33, s29, 40960
  buffer_load_dwordx4 v64, s[12:15], s33 offen lds
  s_add_u32 m0, s26, 126976
  s_add_u32 s33, s29, 81920
  buffer_load_dwordx4 v64, s[12:15], s33 offen lds
  s_add_u32 m0, s26, 131072
  s_add_u32 s33, s29, 122880
  buffer_load_dwordx4 v64, s[12:15], s33 offen lds
  s_add_u32 m0, s26, 135168
  s_add_u32 s33, s29, 163840
  buffer_load_dwordx4 v64, s[12:15], s33 offen lds
  s_add_u32 m0, s26, 32768
  s_nop 0
  buffer_load_dwordx4 v65, s[16:19], s30 offen lds
  s_waitcnt lgkmcnt(0)
  v_mfma_f32_16x16x32_bf16 v[96:99], a[160:163], a[224:227], 0
  ds_read_b128 v[76:79], v57 offset:40960
  v_mfma_f32_16x16x32_bf16 v[100:103], a[164:167], a[224:227], 0
  ds_read_b64_tr_b16 a[192:193], v52 offset:16384
  s_add_u32 s39, s37, 0
  s_add_u32 m0, s26, 36864
  s_add_u32 s33, s30, 65536
  v_mfma_f32_16x16x32_bf16 v[104:107], a[168:171], a[224:227], 0
  buffer_load_dwordx4 v65, s[16:19], s33 offen lds
  v_accvgpr_read_b32 v68, a0
  v_mfma_f32_16x16x32_bf16 v[108:111], a[172:175], a[224:227], 0
  ds_read_b64_tr_b16 a[194:195], v52 offset:18432
  v_accvgpr_read_b32 v69, a1
  v_mfma_f32_16x16x32_bf16 v[112:115], a[176:179], a[224:227], 0
  ds_read_b128 v[80:83], v57 offset:43008
  v_mfma_f32_16x16x32_bf16 v[116:119], a[180:183], a[224:227], 0
  v_accvgpr_read_b32 v70, a2
  v_mfma_f32_16x16x32_bf16 v[120:123], a[184:187], a[224:227], 0
  ds_read_b64_tr_b16 a[196:197], v52 offset:16392
  v_accvgpr_read_b32 v71, a3
  v_mfma_f32_16x16x32_bf16 v[124:127], a[188:191], a[224:227], 0
  ds_read_b64_tr_b16 a[198:199], v52 offset:18440
  v_mfma_f32_16x16x32_bf16 v[128:131], a[160:163], a[228:231], 0
  v_accvgpr_read_b32 v72, a4
  v_mfma_f32_16x16x32_bf16 v[132:135], a[164:167], a[228:231], 0
  ds_read_b128 v[84:87], v57 offset:45056
  v_accvgpr_read_b32 v73, a5
  v_mfma_f32_16x16x32_bf16 v[136:139], a[168:171], a[228:231], 0
  ds_read_b64_tr_b16 a[200:201], v53 offset:16384
  v_accvgpr_read_b32 v74, a6
  s_add_u32 m0, s26, 40960
  s_add_u32 s33, s30, 131072
  v_mfma_f32_16x16x32_bf16 v[140:143], a[172:175], a[228:231], 0
  buffer_load_dwordx4 v65, s[16:19], s33 offen lds
  v_mfma_f32_16x16x32_bf16 v[144:147], a[176:179], a[228:231], 0
  ds_read_b64_tr_b16 a[202:203], v53 offset:18432
  v_accvgpr_read_b32 v75, a7
  v_mfma_f32_16x16x32_bf16 v[148:151], a[180:183], a[228:231], 0
  ds_read_b128 v[88:91], v57 offset:47104
  v_mul_f32 v68, v8, v68
  s_add_u32 m0, s26, 45056
  s_add_u32 s33, s30, 196608
  v_mfma_f32_16x16x32_bf16 v[152:155], a[184:187], a[228:231], 0
  buffer_load_dwordx4 v65, s[16:19], s33 offen lds
  v_mfma_f32_16x16x32_bf16 v[156:159], a[188:191], a[228:231], 0
  ds_read_b64_tr_b16 a[204:205], v53 offset:16392
  v_mul_f32 v69, v8, v69
  v_mfma_f32_16x16x32_bf16 v[160:163], a[160:163], a[232:235], 0
  ds_read_b64_tr_b16 a[206:207], v53 offset:18440
  v_mul_f32 v70, v8, v70
  v_mfma_f32_16x16x32_bf16 v[164:167], a[164:167], a[232:235], 0
  v_mul_f32 v71, v8, v71
  s_add_u32 m0, s26, 49152
  s_add_u32 s33, s30, 262144
  v_mfma_f32_16x16x32_bf16 v[168:171], a[168:171], a[232:235], 0
  ds_read_b128 v[92:95], v57 offset:49152
  buffer_load_dwordx4 v65, s[16:19], s33 offen lds
  v_mfma_f32_16x16x32_bf16 v[172:175], a[172:175], a[232:235], 0
  ds_read_b64_tr_b16 a[208:209], v54 offset:16384
  v_mul_f32 v72, v8, v72
  v_mfma_f32_16x16x32_bf16 v[176:179], a[176:179], a[232:235], 0
  v_mul_f32 v73, v8, v73
  v_mfma_f32_16x16x32_bf16 v[180:183], a[180:183], a[232:235], 0
  ds_read_b64_tr_b16 a[210:211], v54 offset:18432
  v_mfma_f32_16x16x32_bf16 v[184:187], a[184:187], a[232:235], 0
  ds_read_b64_tr_b16 a[212:213], v54 offset:16392
  v_mul_f32 v74, v8, v74
  s_add_u32 m0, s26, 53248
  s_add_u32 s33, s30, 327680
  v_mfma_f32_16x16x32_bf16 v[188:191], a[188:191], a[232:235], 0
  buffer_load_dwordx4 v65, s[16:19], s33 offen lds
  v_mul_f32 v75, v8, v75
  v_mfma_f32_16x16x32_bf16 v[192:195], a[160:163], a[236:239], 0
  ds_read_b64_tr_b16 a[214:215], v54 offset:18440
  v_cvt_pk_bf16_f32 v4, v68, v69
  v_mfma_f32_16x16x32_bf16 v[196:199], a[164:167], a[236:239], 0
  ds_read_b64_tr_b16 a[216:217], v55 offset:16384
  v_mfma_f32_16x16x32_bf16 v[200:203], a[168:171], a[236:239], 0
  v_cvt_pk_bf16_f32 v5, v70, v71
  v_mfma_f32_16x16x32_bf16 v[204:207], a[172:175], a[236:239], 0
  ds_read_b64_tr_b16 a[218:219], v55 offset:18432
  v_cvt_pk_bf16_f32 v6, v72, v73
  v_mfma_f32_16x16x32_bf16 v[208:211], a[176:179], a[236:239], 0
  ds_read_b64_tr_b16 a[220:221], v55 offset:16392
  v_mfma_f32_16x16x32_bf16 v[212:215], a[180:183], a[236:239], 0
  v_cvt_pk_bf16_f32 v7, v74, v75
  v_mfma_f32_16x16x32_bf16 v[216:219], a[184:187], a[236:239], 0
  ds_read_b64_tr_b16 a[222:223], v55 offset:18440
  buffer_store_dwordx4 v[4:7], v66, s[20:23], s39 offen offset:0 sc1
  v_mfma_f32_16x16x32_bf16 v[220:223], a[188:191], a[236:239], 0
  v_accvgpr_read_b32 v68, a8
  s_add_u32 m0, s26, 57344
  s_add_u32 s33, s30, 393216
  v_mfma_f32_16x16x32_bf16 v[224:227], a[160:163], a[240:243], 0
  buffer_load_dwordx4 v65, s[16:19], s33 offen lds
  v_mfma_f32_16x16x32_bf16 v[228:231], a[164:167], a[240:243], 0
  v_accvgpr_read_b32 v69, a9
  v_mfma_f32_16x16x32_bf16 v[232:235], a[168:171], a[240:243], 0
  v_accvgpr_read_b32 v70, a10
  s_add_u32 m0, s26, 61440
  s_add_u32 s33, s30, 458752
  v_mfma_f32_16x16x32_bf16 v[236:239], a[172:175], a[240:243], 0
  buffer_load_dwordx4 v65, s[16:19], s33 offen lds
  s_add_u32 s29, s29, 128
  s_add_u32 s30, s30, 524288
  s_cmp_eq_u32 s29, 1280
  s_cselect_b32 s29, 0, s29
  s_cselect_b32 s33, 5242880, 0
  s_sub_u32 s30, s30, s33
  v_mfma_f32_16x16x32_bf16 v[240:243], a[176:179], a[240:243], 0
  v_accvgpr_read_b32 v71, a11
  v_mfma_f32_16x16x32_bf16 v[244:247], a[180:183], a[240:243], 0
  v_accvgpr_read_b32 v72, a12
  v_mfma_f32_16x16x32_bf16 v[248:251], a[184:187], a[240:243], 0
  v_mfma_f32_16x16x32_bf16 v[252:255], a[188:191], a[240:243], 0
  s_waitcnt vmcnt(14) lgkmcnt(0)
  s_barrier
  v_mfma_f32_16x16x32_bf16 v[96:99], a[192:195], v[76:79], v[96:99]
  ds_read_b128 a[224:227], v56 offset:0
  v_mfma_f32_16x16x32_bf16 v[100:103], a[196:199], v[76:79], v[100:103]
  ds_read_b64_tr_b16 a[160:161], v48 offset:0
  v_accvgpr_read_b32 v73, a13
  s_add_u32 m0, s26, 139264
  v_mfma_f32_16x16x32_bf16 v[104:107], a[200:203], v[76:79], v[104:107]
  buffer_load_dwordx4 v64, s[12:15], s29 offen lds
  v_accvgpr_read_b32 v74, a14
  v_mfma_f32_16x16x32_bf16 v[108:111], a[204:207], v[76:79], v[108:111]
  ds_read_b64_tr_b16 a[162:163], v48 offset:2048
  v_accvgpr_read_b32 v75, a15
  v_mfma_f32_16x16x32_bf16 v[112:115], a[208:211], v[76:79], v[112:115]
  ds_read_b128 a[228:231], v56 offset:2048
  v_mfma_f32_16x16x32_bf16 v[116:119], a[212:215], v[76:79], v[116:119]
  v_mul_f32 v68, v8, v68
  v_mfma_f32_16x16x32_bf16 v[120:123], a[216:219], v[76:79], v[120:123]
  ds_read_b64_tr_b16 a[164:165], v48 offset:8
  v_mul_f32 v69, v8, v69
  v_mfma_f32_16x16x32_bf16 v[124:127], a[220:223], v[76:79], v[124:127]
  ds_read_b64_tr_b16 a[166:167], v48 offset:2056
  v_mfma_f32_16x16x32_bf16 v[128:131], a[192:195], v[80:83], v[128:131]
  v_mul_f32 v70, v8, v70
  v_mfma_f32_16x16x32_bf16 v[132:135], a[196:199], v[80:83], v[132:135]
  ds_read_b128 a[232:235], v56 offset:4096
  v_mul_f32 v71, v8, v71
  v_mfma_f32_16x16x32_bf16 v[136:139], a[200:203], v[80:83], v[136:139]
  ds_read_b64_tr_b16 a[168:169], v49 offset:0
  v_mul_f32 v72, v8, v72
  s_add_u32 m0, s26, 143360
  s_add_u32 s33, s29, 40960
  v_mfma_f32_16x16x32_bf16 v[140:143], a[204:207], v[80:83], v[140:143]
  buffer_load_dwordx4 v64, s[12:15], s33 offen lds
  v_mfma_f32_16x16x32_bf16 v[144:147], a[208:211], v[80:83], v[144:147]
  ds_read_b64_tr_b16 a[170:171], v49 offset:2048
  v_mul_f32 v73, v8, v73
  v_mfma_f32_16x16x32_bf16 v[148:151], a[212:215], v[80:83], v[148:151]
  ds_read_b128 a[236:239], v56 offset:6144
  v_mul_f32 v74, v8, v74
  s_add_u32 m0, s26, 147456
  s_add_u32 s33, s29, 81920
  v_mfma_f32_16x16x32_bf16 v[152:155], a[216:219], v[80:83], v[152:155]
  buffer_load_dwordx4 v64, s[12:15], s33 offen lds
  v_mfma_f32_16x16x32_bf16 v[156:159], a[220:223], v[80:83], v[156:159]
  ds_read_b64_tr_b16 a[172:173], v49 offset:8
  v_mul_f32 v75, v8, v75
  v_mfma_f32_16x16x32_bf16 v[160:163], a[192:195], v[84:87], v[160:163]
  ds_read_b64_tr_b16 a[174:175], v49 offset:2056
  v_cvt_pk_bf16_f32 v4, v68, v69
  v_mfma_f32_16x16x32_bf16 v[164:167], a[196:199], v[84:87], v[164:167]
  v_cvt_pk_bf16_f32 v5, v70, v71
  v_mfma_f32_16x16x32_bf16 v[168:171], a[200:203], v[84:87], v[168:171]
  ds_read_b128 a[240:243], v56 offset:8192
  v_mfma_f32_16x16x32_bf16 v[172:175], a[204:207], v[84:87], v[172:175]
  ds_read_b64_tr_b16 a[176:177], v50 offset:0
  v_cvt_pk_bf16_f32 v6, v72, v73
  v_mfma_f32_16x16x32_bf16 v[176:179], a[208:211], v[84:87], v[176:179]
  v_cvt_pk_bf16_f32 v7, v74, v75
  s_add_u32 m0, s26, 151552
  s_add_u32 s33, s29, 122880
  v_mfma_f32_16x16x32_bf16 v[180:183], a[212:215], v[84:87], v[180:183]
  ds_read_b64_tr_b16 a[178:179], v50 offset:2048
  buffer_load_dwordx4 v64, s[12:15], s33 offen lds
  v_mfma_f32_16x16x32_bf16 v[184:187], a[216:219], v[84:87], v[184:187]
  ds_read_b64_tr_b16 a[180:181], v50 offset:8
  buffer_store_dwordx4 v[4:7], v66, s[20:23], s39 offen offset:1024 sc1
  v_mfma_f32_16x16x32_bf16 v[188:191], a[220:223], v[84:87], v[188:191]
  v_accvgpr_read_b32 v68, a16
  v_mfma_f32_16x16x32_bf16 v[192:195], a[192:195], v[88:91], v[192:195]
  ds_read_b64_tr_b16 a[182:183], v50 offset:2056
  v_accvgpr_read_b32 v69, a17
  v_mfma_f32_16x16x32_bf16 v[196:199], a[196:199], v[88:91], v[196:199]
  ds_read_b64_tr_b16 a[184:185], v51 offset:0
  v_mfma_f32_16x16x32_bf16 v[200:203], a[200:203], v[88:91], v[200:203]
  v_accvgpr_read_b32 v70, a18
  v_mfma_f32_16x16x32_bf16 v[204:207], a[204:207], v[88:91], v[204:207]
  ds_read_b64_tr_b16 a[186:187], v51 offset:2048
  v_accvgpr_read_b32 v71, a19
  v_mfma_f32_16x16x32_bf16 v[208:211], a[208:211], v[88:91], v[208:211]
  ds_read_b64_tr_b16 a[188:189], v51 offset:8
  v_mfma_f32_16x16x32_bf16 v[212:215], a[212:215], v[88:91], v[212:215]
  v_accvgpr_read_b32 v72, a20
  v_mfma_f32_16x16x32_bf16 v[216:219], a[216:219], v[88:91], v[216:219]
  ds_read_b64_tr_b16 a[190:191], v51 offset:2056
  v_accvgpr_read_b32 v73, a21
  v_mfma_f32_16x16x32_bf16 v[220:223], a[220:223], v[88:91], v[220:223]
  v_accvgpr_read_b32 v74, a22
  s_add_u32 m0, s26, 155648
  s_add_u32 s33, s29, 163840
  v_mfma_f32_16x16x32_bf16 v[224:227], a[192:195], v[92:95], v[224:227]
  buffer_load_dwordx4 v64, s[12:15], s33 offen lds
  v_mfma_f32_16x16x32_bf16 v[228:231], a[196:199], v[92:95], v[228:231]
  v_accvgpr_read_b32 v75, a23
  v_mfma_f32_16x16x32_bf16 v[232:235], a[200:203], v[92:95], v[232:235]
  v_mul_f32 v68, v8, v68
  s_add_u32 m0, s26, 65536
  v_mfma_f32_16x16x32_bf16 v[236:239], a[204:207], v[92:95], v[236:239]
  buffer_load_dwordx4 v65, s[16:19], s30 offen lds
  v_mfma_f32_16x16x32_bf16 v[240:243], a[208:211], v[92:95], v[240:243]
  v_mul_f32 v69, v8, v69
  v_mfma_f32_16x16x32_bf16 v[244:247], a[212:215], v[92:95], v[244:247]
  v_mul_f32 v70, v8, v70
  v_mfma_f32_16x16x32_bf16 v[248:251], a[216:219], v[92:95], v[248:251]
  v_mfma_f32_16x16x32_bf16 v[252:255], a[220:223], v[92:95], v[252:255]
  s_waitcnt lgkmcnt(0)
  v_mfma_f32_16x16x32_bf16 v[96:99], a[160:163], a[224:227], v[96:99]
  ds_read_b128 v[76:79], v57 offset:0
  v_mfma_f32_16x16x32_bf16 v[100:103], a[164:167], a[224:227], v[100:103]
  ds_read_b64_tr_b16 a[192:193], v48 offset:16384
  v_mul_f32 v71, v8, v71
  s_add_u32 m0, s26, 69632
  s_add_u32 s33, s30, 65536
  v_mfma_f32_16x16x32_bf16 v[104:107], a[168:171], a[224:227], v[104:107]
  buffer_load_dwordx4 v65, s[16:19], s33 offen lds
  v_mul_f32 v72, v8, v72
  v_mfma_f32_16x16x32_bf16 v[108:111], a[172:175], a[224:227], v[108:111]
  ds_read_b64_tr_b16 a[194:195], v48 offset:18432
  v_mul_f32 v73, v8, v73
  v_mfma_f32_16x16x32_bf16 v[112:115], a[176:179], a[224:227], v[112:115]
  ds_read_b128 v[80:83], v57 offset:2048
  v_mfma_f32_16x16x32_bf16 v[116:119], a[180:183], a[224:227], v[116:119]
  v_mul_f32 v74, v8, v74
  v_mfma_f32_16x16x32_bf16 v[120:123], a[184:187], a[224:227], v[120:123]
  ds_read_b64_tr_b16 a[196:197], v48 offset:16392
  v_mul_f32 v75, v8, v75
  v_mfma_f32_16x16x32_bf16 v[124:127], a[188:191], a[224:227], v[124:127]
  ds_read_b64_tr_b16 a[198:199], v48 offset:18440
  v_mfma_f32_16x16x32_bf16 v[128:131], a[160:163], a[228:231], v[128:131]
  v_cvt_pk_bf16_f32 v4, v68, v69
  v_mfma_f32_16x16x32_bf16 v[132:135], a[164:167], a[228:231], v[132:135]
  ds_read_b128 v[84:87], v57 offset:4096
  v_cvt_pk_bf16_f32 v5, v70, v71
  v_mfma_f32_16x16x32_bf16 v[136:139], a[168:171], a[228:231], v[136:139]
  ds_read_b64_tr_b16 a[200:201], v49 offset:16384
  v_cvt_pk_bf16_f32 v6, v72, v73
  s_add_u32 m0, s26, 73728
  s_add_u32 s33, s30, 131072
  v_mfma_f32_16x16x32_bf16 v[140:143], a[172:175], a[228:231], v[140:143]
  buffer_load_dwordx4 v65, s[16:19], s33 offen lds
  v_mfma_f32_16x16x32_bf16 v[144:147], a[176:179], a[228:231], v[144:147]
  ds_read_b64_tr_b16 a[202:203], v49 offset:18432
  v_cvt_pk_bf16_f32 v7, v74, v75
  v_mfma_f32_16x16x32_bf16 v[148:151], a[180:183], a[228:231], v[148:151]
  ds_read_b128 v[88:91], v57 offset:6144
  buffer_store_dwordx4 v[4:7], v66, s[20:23], s39 offen offset:2048 sc1
  s_add_u32 m0, s26, 77824
  s_add_u32 s33, s30, 196608
  v_mfma_f32_16x16x32_bf16 v[152:155], a[184:187], a[228:231], v[152:155]
  buffer_load_dwordx4 v65, s[16:19], s33 offen lds
  v_mfma_f32_16x16x32_bf16 v[156:159], a[188:191], a[228:231], v[156:159]
  ds_read_b64_tr_b16 a[204:205], v49 offset:16392
  v_accvgpr_read_b32 v68, a24
  v_mfma_f32_16x16x32_bf16 v[160:163], a[160:163], a[232:235], v[160:163]
  ds_read_b64_tr_b16 a[206:207], v49 offset:18440
  v_accvgpr_read_b32 v69, a25
  v_mfma_f32_16x16x32_bf16 v[164:167], a[164:167], a[232:235], v[164:167]
  v_accvgpr_read_b32 v70, a26
  s_add_u32 m0, s26, 81920
  s_add_u32 s33, s30, 262144
  v_mfma_f32_16x16x32_bf16 v[168:171], a[168:171], a[232:235], v[168:171]
  ds_read_b128 v[92:95], v57 offset:8192
  buffer_load_dwordx4 v65, s[16:19], s33 offen lds
  v_mfma_f32_16x16x32_bf16 v[172:175], a[172:175], a[232:235], v[172:175]
  ds_read_b64_tr_b16 a[208:209], v50 offset:16384
  v_accvgpr_read_b32 v71, a27
  v_mfma_f32_16x16x32_bf16 v[176:179], a[176:179], a[232:235], v[176:179]
  v_accvgpr_read_b32 v72, a28
  v_mfma_f32_16x16x32_bf16 v[180:183], a[180:183], a[232:235], v[180:183]
  ds_read_b64_tr_b16 a[210:211], v50 offset:18432
  v_mfma_f32_16x16x32_bf16 v[184:187], a[184:187], a[232:235], v[184:187]
  ds_read_b64_tr_b16 a[212:213], v50 offset:16392
  v_accvgpr_read_b32 v73, a29
  s_add_u32 m0, s26, 86016
  s_add_u32 s33, s30, 327680
  v_mfma_f32_16x16x32_bf16 v[188:191], a[188:191], a[232:235], v[188:191]
  buffer_load_dwordx4 v65, s[16:19], s33 offen lds
  v_accvgpr_read_b32 v74, a30
  v_mfma_f32_16x16x32_bf16 v[192:195], a[160:163], a[236:239], v[192:195]
  ds_read_b64_tr_b16 a[214:215], v50 offset:18440
  v_accvgpr_read_b32 v75, a31
  v_mfma_f32_16x16x32_bf16 v[196:199], a[164:167], a[236:239], v[196:199]
  ds_read_b64_tr_b16 a[216:217], v51 offset:16384
  v_mfma_f32_16x16x32_bf16 v[200:203], a[168:171], a[236:239], v[200:203]
  v_mul_f32 v68, v8, v68
  v_mfma_f32_16x16x32_bf16 v[204:207], a[172:175], a[236:239], v[204:207]
  ds_read_b64_tr_b16 a[218:219], v51 offset:18432
  v_mul_f32 v69, v8, v69
  v_mfma_f32_16x16x32_bf16 v[208:211], a[176:179], a[236:239], v[208:211]
  ds_read_b64_tr_b16 a[220:221], v51 offset:16392
  v_mfma_f32_16x16x32_bf16 v[212:215], a[180:183], a[236:239], v[212:215]
  v_mul_f32 v70, v8, v70
  v_mfma_f32_16x16x32_bf16 v[216:219], a[184:187], a[236:239], v[216:219]
  ds_read_b64_tr_b16 a[222:223], v51 offset:18440
  v_mul_f32 v71, v8, v71
  v_mfma_f32_16x16x32_bf16 v[220:223], a[188:191], a[236:239], v[220:223]
  v_mul_f32 v72, v8, v72
  s_add_u32 m0, s26, 90112
  s_add_u32 s33, s30, 393216
  v_mfma_f32_16x16x32_bf16 v[224:227], a[160:163], a[240:243], v[224:227]
  buffer_load_dwordx4 v65, s[16:19], s33 offen lds
  v_mfma_f32_16x16x32_bf16 v[228:231], a[164:167], a[240:243], v[228:231]
  v_mul_f32 v73, v8, v73
  v_mfma_f32_16x16x32_bf16 v[232:235], a[168:171], a[240:243], v[232:235]
  v_mul_f32 v74, v8, v74
  s_add_u32 m0, s26, 94208
  s_add_u32 s33, s30, 458752
  v_mfma_f32_16x16x32_bf16 v[236:239], a[172:175], a[240:243], v[236:239]
  buffer_load_dwordx4 v65, s[16:19], s33 offen lds
  s_add_u32 s29, s29, 128
  s_add_u32 s30, s30, 524288
  s_cmp_eq_u32 s29, 1280
  s_cselect_b32 s29, 0, s29
  s_cselect_b32 s33, 5242880, 0
  s_sub_u32 s30, s30, s33
  v_mfma_f32_16x16x32_bf16 v[240:243], a[176:179], a[240:243], v[240:243]
  v_mul_f32 v75, v8, v75
  v_mfma_f32_16x16x32_bf16 v[244:247], a[180:183], a[240:243], v[244:247]
  v_cvt_pk_bf16_f32 v4, v68, v69
  v_mfma_f32_16x16x32_bf16 v[248:251], a[184:187], a[240:243], v[248:251]
  v_mfma_f32_16x16x32_bf16 v[252:255], a[188:191], a[240:243], v[252:255]
  s_waitcnt vmcnt(15) lgkmcnt(0)
  s_barrier
  v_mfma_f32_16x16x32_bf16 v[96:99], a[192:195], v[76:79], v[96:99]
  ds_read_b128 a[224:227], v56 offset:20480
  v_mfma_f32_16x16x32_bf16 v[100:103], a[196:199], v[76:79], v[100:103]
  ds_read_b64_tr_b16 a[160:161], v48 offset:32768
  v_cvt_pk_bf16_f32 v5, v70, v71
  s_add_u32 m0, s26, 98304
  v_mfma_f32_16x16x32_bf16 v[104:107], a[200:203], v[76:79], v[104:107]
  buffer_load_dwordx4 v64, s[12:15], s29 offen lds
  v_cvt_pk_bf16_f32 v6, v72, v73
  v_mfma_f32_16x16x32_bf16 v[108:111], a[204:207], v[76:79], v[108:111]
  ds_read_b64_tr_b16 a[162:163], v48 offset:34816
  v_cvt_pk_bf16_f32 v7, v74, v75
  v_mfma_f32_16x16x32_bf16 v[112:115], a[208:211], v[76:79], v[112:115]
  ds_read_b128 a[228:231], v56 offset:22528
  v_mfma_f32_16x16x32_bf16 v[116:119], a[212:215], v[76:79], v[116:119]
  buffer_store_dwordx4 v[4:7], v66, s[20:23], s39 offen offset:3072 sc1
  v_mfma_f32_16x16x32_bf16 v[120:123], a[216:219], v[76:79], v[120:123]
  ds_read_b64_tr_b16 a[164:165], v48 offset:32776
  s_add_u32 s39, s37, 131072
  v_mfma_f32_16x16x32_bf16 v[124:127], a[220:223], v[76:79], v[124:127]
  ds_read_b64_tr_b16 a[166:167], v48 offset:34824
  v_mfma_f32_16x16x32_bf16 v[128:131], a[192:195], v[80:83], v[128:131]
  v_accvgpr_read_b32 v68, a32
  v_mfma_f32_16x16x32_bf16 v[132:135], a[196:199], v[80:83], v[132:135]
  ds_read_b128 a[232:235], v56 offset:24576
  v_accvgpr_read_b32 v69, a33
  v_mfma_f32_16x16x32_bf16 v[136:139], a[200:203], v[80:83], v[136:139]
  ds_read_b64_tr_b16 a[168:169], v49 offset:32768
  v_accvgpr_read_b32 v70, a34
  s_add_u32 m0, s26, 102400
  s_add_u32 s33, s29, 40960
  v_mfma_f32_16x16x32_bf16 v[140:143], a[204:207], v[80:83], v[140:143]
  buffer_load_dwordx4 v64, s[12:15], s33 offen lds
  v_mfma_f32_16x16x32_bf16 v[144:147], a[208:211], v[80:83], v[144:147]
  ds_read_b64_tr_b16 a[170:171], v49 offset:34816
  v_accvgpr_read_b32 v71, a35
  v_mfma_f32_16x16x32_bf16 v[148:151], a[212:215], v[80:83], v[148:151]
  ds_read_b128 a[236:239], v56 offset:26624
  v_accvgpr_read_b32 v72, a36
  s_add_u32 m0, s26, 106496
  s_add_u32 s33, s29, 81920
  v_mfma_f32_16x16x32_bf16 v[152:155], a[216:219], v[80:83], v[152:155]
  buffer_load_dwordx4 v64, s[12:15], s33 offen lds
  v_mfma_f32_16x16x32_bf16 v[156:159], a[220:223], v[80:83], v[156:159]
  ds_read_b64_tr_b16 a[172:173], v49 offset:32776
  v_accvgpr_read_b32 v73, a37
  v_mfma_f32_16x16x32_bf16 v[160:163], a[192:195], v[84:87], v[160:163]
  ds_read_b64_tr_b16 a[174:175], v49 offset:34824
  v_accvgpr_read_b32 v74, a38
  v_mfma_f32_16x16x32_bf16 v[164:167], a[196:199], v[84:87], v[164:167]
  v_accvgpr_read_b32 v75, a39
  v_mfma_f32_16x16x32_bf16 v[168:171], a[200:203], v[84:87], v[168:171]
  ds_read_b128 a[240:243], v56 offset:28672
  v_mfma_f32_16x16x32_bf16 v[172:175], a[204:207], v[84:87], v[172:175]
  ds_read_b64_tr_b16 a[176:177], v50 offset:32768
  v_mul_f32 v68, v9, v68
  v_mfma_f32_16x16x32_bf16 v[176:179], a[208:211], v[84:87], v[176:179]
  v_mul_f32 v69, v9, v69
  s_add_u32 m0, s26, 110592
  s_add_u32 s33, s29, 122880
  v_mfma_f32_16x16x32_bf16 v[180:183], a[212:215], v[84:87], v[180:183]
  ds_read_b64_tr_b16 a[178:179], v50 offset:34816
  buffer_load_dwordx4 v64, s[12:15], s33 offen lds
  v_mfma_f32_16x16x32_bf16 v[184:187], a[216:219], v[84:87], v[184:187]
  ds_read_b64_tr_b16 a[180:181], v50 offset:32776
  v_mul_f32 v70, v9, v70
  v_mfma_f32_16x16x32_bf16 v[188:191], a[220:223], v[84:87], v[188:191]
  v_mul_f32 v71, v9, v71
  v_mfma_f32_16x16x32_bf16 v[192:195], a[192:195], v[88:91], v[192:195]
  ds_read_b64_tr_b16 a[182:183], v50 offset:34824
  v_mul_f32 v72, v9, v72
  v_mfma_f32_16x16x32_bf16 v[196:199], a[196:199], v[88:91], v[196:199]
  ds_read_b64_tr_b16 a[184:185], v51 offset:32768
  v_mfma_f32_16x16x32_bf16 v[200:203], a[200:203], v[88:91], v[200:203]
  v_mul_f32 v73, v9, v73
  v_mfma_f32_16x16x32_bf16 v[204:207], a[204:207], v[88:91], v[204:207]
  ds_read_b64_tr_b16 a[186:187], v51 offset:34816
  v_mul_f32 v74, v9, v74
  v_mfma_f32_16x16x32_bf16 v[208:211], a[208:211], v[88:91], v[208:211]
  ds_read_b64_tr_b16 a[188:189], v51 offset:32776
  v_mfma_f32_16x16x32_bf16 v[212:215], a[212:215], v[88:91], v[212:215]
  v_mul_f32 v75, v9, v75
  v_mfma_f32_16x16x32_bf16 v[216:219], a[216:219], v[88:91], v[216:219]
  ds_read_b64_tr_b16 a[190:191], v51 offset:34824
  v_cvt_pk_bf16_f32 v4, v68, v69
  v_mfma_f32_16x16x32_bf16 v[220:223], a[220:223], v[88:91], v[220:223]
  v_cvt_pk_bf16_f32 v5, v70, v71
  s_add_u32 m0, s26, 114688
  s_add_u32 s33, s29, 163840
  v_mfma_f32_16x16x32_bf16 v[224:227], a[192:195], v[92:95], v[224:227]
  buffer_load_dwordx4 v64, s[12:15], s33 offen lds
  v_mfma_f32_16x16x32_bf16 v[228:231], a[196:199], v[92:95], v[228:231]
  v_cvt_pk_bf16_f32 v6, v72, v73
  v_mfma_f32_16x16x32_bf16 v[232:235], a[200:203], v[92:95], v[232:235]
  v_cvt_pk_bf16_f32 v7, v74, v75
  s_add_u32 m0, s26, 0
  v_mfma_f32_16x16x32_bf16 v[236:239], a[204:207], v[92:95], v[236:239]
  buffer_load_dwordx4 v65, s[16:19], s30 offen lds
  v_mfma_f32_16x16x32_bf16 v[240:243], a[208:211], v[92:95], v[240:243]
  buffer_store_dwordx4 v[4:7], v66, s[20:23], s39 offen offset:0 sc1
  v_mfma_f32_16x16x32_bf16 v[244:247], a[212:215], v[92:95], v[244:247]
  v_accvgpr_read_b32 v68, a40
  v_mfma_f32_16x16x32_bf16 v[248:251], a[216:219], v[92:95], v[248:251]
  v_mfma_f32_16x16x32_bf16 v[252:255], a[220:223], v[92:95], v[252:255]
  s_waitcnt lgkmcnt(0)
  v_mfma_f32_16x16x32_bf16 v[96:99], a[160:163], a[224:227], v[96:99]
  ds_read_b128 v[76:79], v57 offset:20480
  v_mfma_f32_16x16x32_bf16 v[100:103], a[164:167], a[224:227], v[100:103]
  ds_read_b64_tr_b16 a[192:193], v48 offset:49152
  v_accvgpr_read_b32 v69, a41
  s_add_u32 m0, s26, 4096
  s_add_u32 s33, s30, 65536
  v_mfma_f32_16x16x32_bf16 v[104:107], a[168:171], a[224:227], v[104:107]
  buffer_load_dwordx4 v65, s[16:19], s33 offen lds
  v_accvgpr_read_b32 v70, a42
  v_mfma_f32_16x16x32_bf16 v[108:111], a[172:175], a[224:227], v[108:111]
  ds_read_b64_tr_b16 a[194:195], v48 offset:51200
  v_accvgpr_read_b32 v71, a43
  v_mfma_f32_16x16x32_bf16 v[112:115], a[176:179], a[224:227], v[112:115]
  ds_read_b128 v[80:83], v57 offset:22528
  v_mfma_f32_16x16x32_bf16 v[116:119], a[180:183], a[224:227], v[116:119]
  v_accvgpr_read_b32 v72, a44
  v_mfma_f32_16x16x32_bf16 v[120:123], a[184:187], a[224:227], v[120:123]
  ds_read_b64_tr_b16 a[196:197], v48 offset:49160
  v_accvgpr_read_b32 v73, a45
  v_mfma_f32_16x16x32_bf16 v[124:127], a[188:191], a[224:227], v[124:127]
  ds_read_b64_tr_b16 a[198:199], v48 offset:51208
  v_mfma_f32_16x16x32_bf16 v[128:131], a[160:163], a[228:231], v[128:131]
  v_accvgpr_read_b32 v74, a46
  v_mfma_f32_16x16x32_bf16 v[132:135], a[164:167], a[228:231], v[132:135]
  ds_read_b128 v[84:87], v57 offset:24576
  v_accvgpr_read_b32 v75, a47
  v_mfma_f32_16x16x32_bf16 v[136:139], a[168:171], a[228:231], v[136:139]
  ds_read_b64_tr_b16 a[200:201], v49 offset:49152
  v_mul_f32 v68, v9, v68
  s_add_u32 m0, s26, 8192
  s_add_u32 s33, s30, 131072
  v_mfma_f32_16x16x32_bf16 v[140:143], a[172:175], a[228:231], v[140:143]
  buffer_load_dwordx4 v65, s[16:19], s33 offen lds
  v_mfma_f32_16x16x32_bf16 v[144:147], a[176:179], a[228:231], v[144:147]
  ds_read_b64_tr_b16 a[202:203], v49 offset:51200
  v_mul_f32 v69, v9, v69
  v_mfma_f32_16x16x32_bf16 v[148:151], a[180:183], a[228:231], v[148:151]
  ds_read_b128 v[88:91], v57 offset:26624
  v_mul_f32 v70, v9, v70
  s_add_u32 m0, s26, 12288
  s_add_u32 s33, s30, 196608
  v_mfma_f32_16x16x32_bf16 v[152:155], a[184:187], a[228:231], v[152:155]
  buffer_load_dwordx4 v65, s[16:19], s33 offen lds
  v_mfma_f32_16x16x32_bf16 v[156:159], a[188:191], a[228:231], v[156:159]
  ds_read_b64_tr_b16 a[204:205], v49 offset:49160
  v_mul_f32 v71, v9, v71
  v_mfma_f32_16x16x32_bf16 v[160:163], a[160:163], a[232:235], v[160:163]
  ds_read_b64_tr_b16 a[206:207], v49 offset:51208
  v_mul_f32 v72, v9, v72
  v_mfma_f32_16x16x32_bf16 v[164:167], a[164:167], a[232:235], v[164:167]
  v_mul_f32 v73, v9, v73
  s_add_u32 m0, s26, 16384
  s_add_u32 s33, s30, 262144
  v_mfma_f32_16x16x32_bf16 v[168:171], a[168:171], a[232:235], v[168:171]
  ds_read_b128 v[92:95], v57 offset:28672
  buffer_load_dwordx4 v65, s[16:19], s33 offen lds
  v_mfma_f32_16x16x32_bf16 v[172:175], a[172:175], a[232:235], v[172:175]
  ds_read_b64_tr_b16 a[208:209], v50 offset:49152
  v_mul_f32 v74, v9, v74
  v_mfma_f32_16x16x32_bf16 v[176:179], a[176:179], a[232:235], v[176:179]
  v_mul_f32 v75, v9, v75
  v_mfma_f32_16x16x32_bf16 v[180:183], a[180:183], a[232:235], v[180:183]
  ds_read_b64_tr_b16 a[210:211], v50 offset:51200
  v_mfma_f32_16x16x32_bf16 v[184:187], a[184:187], a[232:235], v[184:187]
  ds_read_b64_tr_b16 a[212:213], v50 offset:49160
  v_cvt_pk_bf16_f32 v4, v68, v69
  s_add_u32 m0, s26, 20480
  s_add_u32 s33, s30, 327680
  v_mfma_f32_16x16x32_bf16 v[188:191], a[188:191], a[232:235], v[188:191]
  buffer_load_dwordx4 v65, s[16:19], s33 offen lds
  v_cvt_pk_bf16_f32 v5, v70, v71
  v_mfma_f32_16x16x32_bf16 v[192:195], a[160:163], a[236:239], v[192:195]
  ds_read_b64_tr_b16 a[214:215], v50 offset:51208
  v_cvt_pk_bf16_f32 v6, v72, v73
  v_mfma_f32_16x16x32_bf16 v[196:199], a[164:167], a[236:239], v[196:199]
  ds_read_b64_tr_b16 a[216:217], v51 offset:49152
  v_mfma_f32_16x16x32_bf16 v[200:203], a[168:171], a[236:239], v[200:203]
  v_cvt_pk_bf16_f32 v7, v74, v75
  v_mfma_f32_16x16x32_bf16 v[204:207], a[172:175], a[236:239], v[204:207]
  ds_read_b64_tr_b16 a[218:219], v51 offset:51200
  buffer_store_dwordx4 v[4:7], v66, s[20:23], s39 offen offset:1024 sc1
  v_mfma_f32_16x16x32_bf16 v[208:211], a[176:179], a[236:239], v[208:211]
  ds_read_b64_tr_b16 a[220:221], v51 offset:49160
  v_mfma_f32_16x16x32_bf16 v[212:215], a[180:183], a[236:239], v[212:215]
  v_accvgpr_read_b32 v68, a48
  v_mfma_f32_16x16x32_bf16 v[216:219], a[184:187], a[236:239], v[216:219]
  ds_read_b64_tr_b16 a[222:223], v51 offset:51208
  v_accvgpr_read_b32 v69, a49
  v_mfma_f32_16x16x32_bf16 v[220:223], a[188:191], a[236:239], v[220:223]
  v_accvgpr_read_b32 v70, a50
  s_add_u32 m0, s26, 24576
  s_add_u32 s33, s30, 393216
  v_mfma_f32_16x16x32_bf16 v[224:227], a[160:163], a[240:243], v[224:227]
  buffer_load_dwordx4 v65, s[16:19], s33 offen lds
  v_mfma_f32_16x16x32_bf16 v[228:231], a[164:167], a[240:243], v[228:231]
  v_accvgpr_read_b32 v71, a51
  v_mfma_f32_16x16x32_bf16 v[232:235], a[168:171], a[240:243], v[232:235]
  v_accvgpr_read_b32 v72, a52
  s_add_u32 m0, s26, 28672
  s_add_u32 s33, s30, 458752
  v_mfma_f32_16x16x32_bf16 v[236:239], a[172:175], a[240:243], v[236:239]
  buffer_load_dwordx4 v65, s[16:19], s33 offen lds
  s_add_u32 s29, s29, 128
  s_add_u32 s30, s30, 524288
  s_cmp_eq_u32 s29, 1280
  s_cselect_b32 s29, 0, s29
  s_cselect_b32 s33, 5242880, 0
  s_sub_u32 s30, s30, s33
  v_mfma_f32_16x16x32_bf16 v[240:243], a[176:179], a[240:243], v[240:243]
  v_accvgpr_read_b32 v73, a53
  v_mfma_f32_16x16x32_bf16 v[244:247], a[180:183], a[240:243], v[244:247]
  v_accvgpr_read_b32 v74, a54
  v_mfma_f32_16x16x32_bf16 v[248:251], a[184:187], a[240:243], v[248:251]
  v_mfma_f32_16x16x32_bf16 v[252:255], a[188:191], a[240:243], v[252:255]
  s_waitcnt vmcnt(16) lgkmcnt(0)
  s_barrier
  v_mfma_f32_16x16x32_bf16 v[96:99], a[192:195], v[76:79], v[96:99]
  ds_read_b128 a[224:227], v56 offset:40960
  v_mfma_f32_16x16x32_bf16 v[100:103], a[196:199], v[76:79], v[100:103]
  ds_read_b64_tr_b16 a[160:161], v52 offset:0
  v_accvgpr_read_b32 v75, a55
  s_add_u32 m0, s26, 118784
  v_mfma_f32_16x16x32_bf16 v[104:107], a[200:203], v[76:79], v[104:107]
  buffer_load_dwordx4 v64, s[12:15], s29 offen lds
  v_mul_f32 v68, v9, v68
  v_mfma_f32_16x16x32_bf16 v[108:111], a[204:207], v[76:79], v[108:111]
  ds_read_b64_tr_b16 a[162:163], v52 offset:2048
  v_mul_f32 v69, v9, v69
  v_mfma_f32_16x16x32_bf16 v[112:115], a[208:211], v[76:79], v[112:115]
  ds_read_b128 a[228:231], v56 offset:43008
  v_mfma_f32_16x16x32_bf16 v[116:119], a[212:215], v[76:79], v[116:119]
  v_mul_f32 v70, v9, v70
  v_mfma_f32_16x16x32_bf16 v[120:123], a[216:219], v[76:79], v[120:123]
  ds_read_b64_tr_b16 a[164:165], v52 offset:8
  v_mul_f32 v71, v9, v71
  v_mfma_f32_16x16x32_bf16 v[124:127], a[220:223], v[76:79], v[124:127]
  ds_read_b64_tr_b16 a[166:167], v52 offset:2056
  v_mfma_f32_16x16x32_bf16 v[128:131], a[192:195], v[80:83], v[128:131]
  v_mul_f32 v72, v9, v72
  v_mfma_f32_16x16x32_bf16 v[132:135], a[196:199], v[80:83], v[132:135]
  ds_read_b128 a[232:235], v56 offset:45056
  v_mul_f32 v73, v9, v73
  v_mfma_f32_16x16x32_bf16 v[136:139], a[200:203], v[80:83], v[136:139]
  ds_read_b64_tr_b16 a[168:169], v53 offset:0
  v_mul_f32 v74, v9, v74
  s_add_u32 m0, s26, 122880
  s_add_u32 s33, s29, 40960
  v_mfma_f32_16x16x32_bf16 v[140:143], a[204:207], v[80:83], v[140:143]
  buffer_load_dwordx4 v64, s[12:15], s33 offen lds
  v_mfma_f32_16x16x32_bf16 v[144:147], a[208:211], v[80:83], v[144:147]
  ds_read_b64_tr_b16 a[170:171], v53 offset:2048
  v_mul_f32 v75, v9, v75
  v_mfma_f32_16x16x32_bf16 v[148:151], a[212:215], v[80:83], v[148:151]
  ds_read_b128 a[236:239], v56 offset:47104
  v_cvt_pk_bf16_f32 v4, v68, v69
  s_add_u32 m0, s26, 126976
  s_add_u32 s33, s29, 81920
  v_mfma_f32_16x16x32_bf16 v[152:155], a[216:219], v[80:83], v[152:155]
  buffer_load_dwordx4 v64, s[12:15], s33 offen lds
  v_mfma_f32_16x16x32_bf16 v[156:159], a[220:223], v[80:83], v[156:159]
  ds_read_b64_tr_b16 a[172:173], v53 offset:8
  v_cvt_pk_bf16_f32 v5, v70, v71
  v_mfma_f32_16x16x32_bf16 v[160:163], a[192:195], v[84:87], v[160:163]
  ds_read_b64_tr_b16 a[174:175], v53 offset:2056
  v_cvt_pk_bf16_f32 v6, v72, v73
  v_mfma_f32_16x16x32_bf16 v[164:167], a[196:199], v[84:87], v[164:167]
  v_cvt_pk_bf16_f32 v7, v74, v75
  v_mfma_f32_16x16x32_bf16 v[168:171], a[200:203], v[84:87], v[168:171]
  ds_read_b128 a[240:243], v56 offset:49152
  v_mfma_f32_16x16x32_bf16 v[172:175], a[204:207], v[84:87], v[172:175]
  ds_read_b64_tr_b16 a[176:177], v54 offset:0
  buffer_store_dwordx4 v[4:7], v66, s[20:23], s39 offen offset:2048 sc1
  v_mfma_f32_16x16x32_bf16 v[176:179], a[208:211], v[84:87], v[176:179]
  v_accvgpr_read_b32 v68, a56
  s_add_u32 m0, s26, 131072
  s_add_u32 s33, s29, 122880
  v_mfma_f32_16x16x32_bf16 v[180:183], a[212:215], v[84:87], v[180:183]
  ds_read_b64_tr_b16 a[178:179], v54 offset:2048
  buffer_load_dwordx4 v64, s[12:15], s33 offen lds
  v_mfma_f32_16x16x32_bf16 v[184:187], a[216:219], v[84:87], v[184:187]
  ds_read_b64_tr_b16 a[180:181], v54 offset:8
  v_accvgpr_read_b32 v69, a57
  v_mfma_f32_16x16x32_bf16 v[188:191], a[220:223], v[84:87], v[188:191]
  v_accvgpr_read_b32 v70, a58
  v_mfma_f32_16x16x32_bf16 v[192:195], a[192:195], v[88:91], v[192:195]
  ds_read_b64_tr_b16 a[182:183], v54 offset:2056
  v_accvgpr_read_b32 v71, a59
  v_mfma_f32_16x16x32_bf16 v[196:199], a[196:199], v[88:91], v[196:199]
  ds_read_b64_tr_b16 a[184:185], v55 offset:0
  v_mfma_f32_16x16x32_bf16 v[200:203], a[200:203], v[88:91], v[200:203]
  v_accvgpr_read_b32 v72, a60
  v_mfma_f32_16x16x32_bf16 v[204:207], a[204:207], v[88:91], v[204:207]
  ds_read_b64_tr_b16 a[186:187], v55 offset:2048
  v_accvgpr_read_b32 v73, a61
  v_mfma_f32_16x16x32_bf16 v[208:211], a[208:211], v[88:91], v[208:211]
  ds_read_b64_tr_b16 a[188:189], v55 offset:8
  v_mfma_f32_16x16x32_bf16 v[212:215], a[212:215], v[88:91], v[212:215]
  v_accvgpr_read_b32 v74, a62
  v_mfma_f32_16x16x32_bf16 v[216:219], a[216:219], v[88:91], v[216:219]
  ds_read_b64_tr_b16 a[190:191], v55 offset:2056
  v_accvgpr_read_b32 v75, a63
  v_mfma_f32_16x16x32_bf16 v[220:223], a[220:223], v[88:91], v[220:223]
  v_mul_f32 v68, v9, v68
  s_add_u32 m0, s26, 135168
  s_add_u32 s33, s29, 163840
  v_mfma_f32_16x16x32_bf16 v[224:227], a[192:195], v[92:95], v[224:227]
  buffer_load_dwordx4 v64, s[12:15], s33 offen lds
  v_mfma_f32_16x16x32_bf16 v[228:231], a[196:199], v[92:95], v[228:231]
  v_mul_f32 v69, v9, v69
  v_mfma_f32_16x16x32_bf16 v[232:235], a[200:203], v[92:95], v[232:235]
  v_mul_f32 v70, v9, v70
  s_add_u32 m0, s26, 32768
  v_mfma_f32_16x16x32_bf16 v[236:239], a[204:207], v[92:95], v[236:239]
  buffer_load_dwordx4 v65, s[16:19], s30 offen lds
  v_mfma_f32_16x16x32_bf16 v[240:243], a[208:211], v[92:95], v[240:243]
  v_mul_f32 v71, v9, v71
  v_mfma_f32_16x16x32_bf16 v[244:247], a[212:215], v[92:95], v[244:247]
  v_mul_f32 v72, v9, v72
  v_mfma_f32_16x16x32_bf16 v[248:251], a[216:219], v[92:95], v[248:251]
  v_mfma_f32_16x16x32_bf16 v[252:255], a[220:223], v[92:95], v[252:255]
  s_waitcnt lgkmcnt(0)
  v_mfma_f32_16x16x32_bf16 v[96:99], a[160:163], a[224:227], v[96:99]
  ds_read_b128 v[76:79], v57 offset:40960
  v_mfma_f32_16x16x32_bf16 v[100:103], a[164:167], a[224:227], v[100:103]
  ds_read_b64_tr_b16 a[192:193], v52 offset:16384
  v_mul_f32 v73, v9, v73
  s_add_u32 m0, s26, 36864
  s_add_u32 s33, s30, 65536
  v_mfma_f32_16x16x32_bf16 v[104:107], a[168:171], a[224:227], v[104:107]
  buffer_load_dwordx4 v65, s[16:19], s33 offen lds
  v_mul_f32 v74, v9, v74
  v_mfma_f32_16x16x32_bf16 v[108:111], a[172:175], a[224:227], v[108:111]
  ds_read_b64_tr_b16 a[194:195], v52 offset:18432
  v_mul_f32 v75, v9, v75
  v_mfma_f32_16x16x32_bf16 v[112:115], a[176:179], a[224:227], v[112:115]
  ds_read_b128 v[80:83], v57 offset:43008
  v_mfma_f32_16x16x32_bf16 v[116:119], a[180:183], a[224:227], v[116:119]
  v_cvt_pk_bf16_f32 v4, v68, v69
  v_mfma_f32_16x16x32_bf16 v[120:123], a[184:187], a[224:227], v[120:123]
  ds_read_b64_tr_b16 a[196:197], v52 offset:16392
  v_cvt_pk_bf16_f32 v5, v70, v71
  v_mfma_f32_16x16x32_bf16 v[124:127], a[188:191], a[224:227], v[124:127]
  ds_read_b64_tr_b16 a[198:199], v52 offset:18440
  v_mfma_f32_16x16x32_bf16 v[128:131], a[160:163], a[228:231], v[128:131]
  v_cvt_pk_bf16_f32 v6, v72, v73
  v_mfma_f32_16x16x32_bf16 v[132:135], a[164:167], a[228:231], v[132:135]
  ds_read_b128 v[84:87], v57 offset:45056
  v_cvt_pk_bf16_f32 v7, v74, v75
  v_mfma_f32_16x16x32_bf16 v[136:139], a[168:171], a[228:231], v[136:139]
  ds_read_b64_tr_b16 a[200:201], v53 offset:16384
  buffer_store_dwordx4 v[4:7], v66, s[20:23], s39 offen offset:3072 sc1
  s_add_u32 m0, s26, 40960
  s_add_u32 s33, s30, 131072
  v_mfma_f32_16x16x32_bf16 v[140:143], a[172:175], a[228:231], v[140:143]
  buffer_load_dwordx4 v65, s[16:19], s33 offen lds
  v_mfma_f32_16x16x32_bf16 v[144:147], a[176:179], a[228:231], v[144:147]
  ds_read_b64_tr_b16 a[202:203], v53 offset:18432
  s_add_u32 s39, s37, 262144
  v_mfma_f32_16x16x32_bf16 v[148:151], a[180:183], a[228:231], v[148:151]
  ds_read_b128 v[88:91], v57 offset:47104
  v_accvgpr_read_b32 v68, a64
  s_add_u32 m0, s26, 45056
  s_add_u32 s33, s30, 196608
  v_mfma_f32_16x16x32_bf16 v[152:155], a[184:187], a[228:231], v[152:155]
  buffer_load_dwordx4 v65, s[16:19], s33 offen lds
  v_mfma_f32_16x16x32_bf16 v[156:159], a[188:191], a[228:231], v[156:159]
  ds_read_b64_tr_b16 a[204:205], v53 offset:16392
  v_accvgpr_read_b32 v69, a65
  v_mfma_f32_16x16x32_bf16 v[160:163], a[160:163], a[232:235], v[160:163]
  ds_read_b64_tr_b16 a[206:207], v53 offset:18440
  v_accvgpr_read_b32 v70, a66
  v_mfma_f32_16x16x32_bf16 v[164:167], a[164:167], a[232:235], v[164:167]
  v_accvgpr_read_b32 v71, a67
  s_add_u32 m0, s26, 49152
  s_add_u32 s33, s30, 262144
  v_mfma_f32_16x16x32_bf16 v[168:171], a[168:171], a[232:235], v[168:171]
  ds_read_b128 v[92:95], v57 offset:49152
  buffer_load_dwordx4 v65, s[16:19], s33 offen lds
  v_mfma_f32_16x16x32_bf16 v[172:175], a[172:175], a[232:235], v[172:175]
  ds_read_b64_tr_b16 a[208:209], v54 offset:16384
  v_accvgpr_read_b32 v72, a68
  v_mfma_f32_16x16x32_bf16 v[176:179], a[176:179], a[232:235], v[176:179]
  v_accvgpr_read_b32 v73, a69
  v_mfma_f32_16x16x32_bf16 v[180:183], a[180:183], a[232:235], v[180:183]
  ds_read_b64_tr_b16 a[210:211], v54 offset:18432
  v_mfma_f32_16x16x32_bf16 v[184:187], a[184:187], a[232:235], v[184:187]
  ds_read_b64_tr_b16 a[212:213], v54 offset:16392
  v_accvgpr_read_b32 v74, a70
  s_add_u32 m0, s26, 53248
  s_add_u32 s33, s30, 327680
  v_mfma_f32_16x16x32_bf16 v[188:191], a[188:191], a[232:235], v[188:191]
  buffer_load_dwordx4 v65, s[16:19], s33 offen lds
  v_accvgpr_read_b32 v75, a71
  v_mfma_f32_16x16x32_bf16 v[192:195], a[160:163], a[236:239], v[192:195]
  ds_read_b64_tr_b16 a[214:215], v54 offset:18440
  v_mul_f32 v68, v10, v68
  v_mfma_f32_16x16x32_bf16 v[196:199], a[164:167], a[236:239], v[196:199]
  ds_read_b64_tr_b16 a[216:217], v55 offset:16384
  v_mfma_f32_16x16x32_bf16 v[200:203], a[168:171], a[236:239], v[200:203]
  v_mul_f32 v69, v10, v69
  v_mfma_f32_16x16x32_bf16 v[204:207], a[172:175], a[236:239], v[204:207]
  ds_read_b64_tr_b16 a[218:219], v55 offset:18432
  v_mul_f32 v70, v10, v70
  v_mfma_f32_16x16x32_bf16 v[208:211], a[176:179], a[236:239], v[208:211]
  ds_read_b64_tr_b16 a[220:221], v55 offset:16392
  v_mfma_f32_16x16x32_bf16 v[212:215], a[180:183], a[236:239], v[212:215]
  v_mul_f32 v71, v10, v71
  v_mfma_f32_16x16x32_bf16 v[216:219], a[184:187], a[236:239], v[216:219]
  ds_read_b64_tr_b16 a[222:223], v55 offset:18440
  v_mul_f32 v72, v10, v72
  v_mfma_f32_16x16x32_bf16 v[220:223], a[188:191], a[236:239], v[220:223]
  v_mul_f32 v73, v10, v73
  s_add_u32 m0, s26, 57344
  s_add_u32 s33, s30, 393216
  v_mfma_f32_16x16x32_bf16 v[224:227], a[160:163], a[240:243], v[224:227]
  buffer_load_dwordx4 v65, s[16:19], s33 offen lds
  v_mfma_f32_16x16x32_bf16 v[228:231], a[164:167], a[240:243], v[228:231]
  v_mul_f32 v74, v10, v74
  v_mfma_f32_16x16x32_bf16 v[232:235], a[168:171], a[240:243], v[232:235]
  v_mul_f32 v75, v10, v75
  s_add_u32 m0, s26, 61440
  s_add_u32 s33, s30, 458752
  v_mfma_f32_16x16x32_bf16 v[236:239], a[172:175], a[240:243], v[236:239]
  buffer_load_dwordx4 v65, s[16:19], s33 offen lds
  s_add_u32 s29, s29, 128
  s_add_u32 s30, s30, 524288
  s_cmp_eq_u32 s29, 1280
  s_cselect_b32 s29, 0, s29
  s_cselect_b32 s33, 5242880, 0
  s_sub_u32 s30, s30, s33
  v_mfma_f32_16x16x32_bf16 v[240:243], a[176:179], a[240:243], v[240:243]
  v_cvt_pk_bf16_f32 v4, v68, v69
  v_mfma_f32_16x16x32_bf16 v[244:247], a[180:183], a[240:243], v[244:247]
  v_cvt_pk_bf16_f32 v5, v70, v71
  v_mfma_f32_16x16x32_bf16 v[248:251], a[184:187], a[240:243], v[248:251]
  v_mfma_f32_16x16x32_bf16 v[252:255], a[188:191], a[240:243], v[252:255]
  s_waitcnt vmcnt(15) lgkmcnt(0)
  s_barrier
  v_mfma_f32_16x16x32_bf16 v[96:99], a[192:195], v[76:79], v[96:99]
  ds_read_b128 a[224:227], v56 offset:0
  v_mfma_f32_16x16x32_bf16 v[100:103], a[196:199], v[76:79], v[100:103]
  ds_read_b64_tr_b16 a[160:161], v48 offset:0
  v_cvt_pk_bf16_f32 v6, v72, v73
  s_add_u32 m0, s26, 139264
  v_mfma_f32_16x16x32_bf16 v[104:107], a[200:203], v[76:79], v[104:107]
  buffer_load_dwordx4 v64, s[12:15], s29 offen lds
  v_cvt_pk_bf16_f32 v7, v74, v75
  v_mfma_f32_16x16x32_bf16 v[108:111], a[204:207], v[76:79], v[108:111]
  ds_read_b64_tr_b16 a[162:163], v48 offset:2048
  buffer_store_dwordx4 v[4:7], v66, s[20:23], s39 offen offset:0 sc1
  v_mfma_f32_16x16x32_bf16 v[112:115], a[208:211], v[76:79], v[112:115]
  ds_read_b128 a[228:231], v56 offset:2048
  v_mfma_f32_16x16x32_bf16 v[116:119], a[212:215], v[76:79], v[116:119]
  v_accvgpr_read_b32 v68, a72
  v_mfma_f32_16x16x32_bf16 v[120:123], a[216:219], v[76:79], v[120:123]
  ds_read_b64_tr_b16 a[164:165], v48 offset:8
  v_accvgpr_read_b32 v69, a73
  v_mfma_f32_16x16x32_bf16 v[124:127], a[220:223], v[76:79], v[124:127]
  ds_read_b64_tr_b16 a[166:167], v48 offset:2056
  v_mfma_f32_16x16x32_bf16 v[128:131], a[192:195], v[80:83], v[128:131]
  v_accvgpr_read_b32 v70, a74
  v_mfma_f32_16x16x32_bf16 v[132:135], a[196:199], v[80:83], v[132:135]
  ds_read_b128 a[232:235], v56 offset:4096
  v_accvgpr_read_b32 v71, a75
  v_mfma_f32_16x16x32_bf16 v[136:139], a[200:203], v[80:83], v[136:139]
  ds_read_b64_tr_b16 a[168:169], v49 offset:0
  v_accvgpr_read_b32 v72, a76
  s_add_u32 m0, s26, 143360
  s_add_u32 s33, s29, 40960
  v_mfma_f32_16x16x32_bf16 v[140:143], a[204:207], v[80:83], v[140:143]
  buffer_load_dwordx4 v64, s[12:15], s33 offen lds
  v_mfma_f32_16x16x32_bf16 v[144:147], a[208:211], v[80:83], v[144:147]
  ds_read_b64_tr_b16 a[170:171], v49 offset:2048
  v_accvgpr_read_b32 v73, a77
  v_mfma_f32_16x16x32_bf16 v[148:151], a[212:215], v[80:83], v[148:151]
  ds_read_b128 a[236:239], v56 offset:6144
  v_accvgpr_read_b32 v74, a78
  s_add_u32 m0, s26, 147456
  s_add_u32 s33, s29, 81920
  v_mfma_f32_16x16x32_bf16 v[152:155], a[216:219], v[80:83], v[152:155]
  buffer_load_dwordx4 v64, s[12:15], s33 offen lds
  v_mfma_f32_16x16x32_bf16 v[156:159], a[220:223], v[80:83], v[156:159]
  ds_read_b64_tr_b16 a[172:173], v49 offset:8
  v_accvgpr_read_b32 v75, a79
  v_mfma_f32_16x16x32_bf16 v[160:163], a[192:195], v[84:87], v[160:163]
  ds_read_b64_tr_b16 a[174:175], v49 offset:2056
  v_mul_f32 v68, v10, v68
  v_mfma_f32_16x16x32_bf16 v[164:167], a[196:199], v[84:87], v[164:167]
  v_mul_f32 v69, v10, v69
  v_mfma_f32_16x16x32_bf16 v[168:171], a[200:203], v[84:87], v[168:171]
  ds_read_b128 a[240:243], v56 offset:8192
  v_mfma_f32_16x16x32_bf16 v[172:175], a[204:207], v[84:87], v[172:175]
  ds_read_b64_tr_b16 a[176:177], v50 offset:0
  v_mul_f32 v70, v10, v70
  v_mfma_f32_16x16x32_bf16 v[176:179], a[208:211], v[84:87], v[176:179]
  v_mul_f32 v71, v10, v71
  s_add_u32 m0, s26, 151552
  s_add_u32 s33, s29, 122880
  v_mfma_f32_16x16x32_bf16 v[180:183], a[212:215], v[84:87], v[180:183]
  ds_read_b64_tr_b16 a[178:179], v50 offset:2048
  buffer_load_dwordx4 v64, s[12:15], s33 offen lds
  v_mfma_f32_16x16x32_bf16 v[184:187], a[216:219], v[84:87], v[184:187]
  ds_read_b64_tr_b16 a[180:181], v50 offset:8
  v_mul_f32 v72, v10, v72
  v_mfma_f32_16x16x32_bf16 v[188:191], a[220:223], v[84:87], v[188:191]
  v_mul_f32 v73, v10, v73
  v_mfma_f32_16x16x32_bf16 v[192:195], a[192:195], v[88:91], v[192:195]
  ds_read_b64_tr_b16 a[182:183], v50 offset:2056
  v_mul_f32 v74, v10, v74
  v_mfma_f32_16x16x32_bf16 v[196:199], a[196:199], v[88:91], v[196:199]
  ds_read_b64_tr_b16 a[184:185], v51 offset:0
  v_mfma_f32_16x16x32_bf16 v[200:203], a[200:203], v[88:91], v[200:203]
  v_mul_f32 v75, v10, v75
  v_mfma_f32_16x16x32_bf16 v[204:207], a[204:207], v[88:91], v[204:207]
  ds_read_b64_tr_b16 a[186:187], v51 offset:2048
  v_cvt_pk_bf16_f32 v4, v68, v69
  v_mfma_f32_16x16x32_bf16 v[208:211], a[208:211], v[88:91], v[208:211]
  ds_read_b64_tr_b16 a[188:189], v51 offset:8
  v_mfma_f32_16x16x32_bf16 v[212:215], a[212:215], v[88:91], v[212:215]
  v_cvt_pk_bf16_f32 v5, v70, v71
  v_mfma_f32_16x16x32_bf16 v[216:219], a[216:219], v[88:91], v[216:219]
  ds_read_b64_tr_b16 a[190:191], v51 offset:2056
  v_cvt_pk_bf16_f32 v6, v72, v73
  v_mfma_f32_16x16x32_bf16 v[220:223], a[220:223], v[88:91], v[220:223]
  v_cvt_pk_bf16_f32 v7, v74, v75
  s_add_u32 m0, s26, 155648
  s_add_u32 s33, s29, 163840
  v_mfma_f32_16x16x32_bf16 v[224:227], a[192:195], v[92:95], v[224:227]
  buffer_load_dwordx4 v64, s[12:15], s33 offen lds
  v_mfma_f32_16x16x32_bf16 v[228:231], a[196:199], v[92:95], v[228:231]
  buffer_store_dwordx4 v[4:7], v66, s[20:23], s39 offen offset:1024 sc1
  v_mfma_f32_16x16x32_bf16 v[232:235], a[200:203], v[92:95], v[232:235]
  v_accvgpr_read_b32 v68, a80
  s_add_u32 m0, s26, 65536
  v_mfma_f32_16x16x32_bf16 v[236:239], a[204:207], v[92:95], v[236:239]
  buffer_load_dwordx4 v65, s[16:19], s30 offen lds
  v_mfma_f32_16x16x32_bf16 v[240:243], a[208:211], v[92:95], v[240:243]
  v_accvgpr_read_b32 v69, a81
  v_mfma_f32_16x16x32_bf16 v[244:247], a[212:215], v[92:95], v[244:247]
  v_accvgpr_read_b32 v70, a82
  v_mfma_f32_16x16x32_bf16 v[248:251], a[216:219], v[92:95], v[248:251]
  v_mfma_f32_16x16x32_bf16 v[252:255], a[220:223], v[92:95], v[252:255]
  s_waitcnt lgkmcnt(0)
  v_mfma_f32_16x16x32_bf16 v[96:99], a[160:163], a[224:227], v[96:99]
  ds_read_b128 v[76:79], v57 offset:0
  v_mfma_f32_16x16x32_bf16 v[100:103], a[164:167], a[224:227], v[100:103]
  ds_read_b64_tr_b16 a[192:193], v48 offset:16384
  v_accvgpr_read_b32 v71, a83
  s_add_u32 m0, s26, 69632
  s_add_u32 s33, s30, 65536
  v_mfma_f32_16x16x32_bf16 v[104:107], a[168:171], a[224:227], v[104:107]
  buffer_load_dwordx4 v65, s[16:19], s33 offen lds
  v_accvgpr_read_b32 v72, a84
  v_mfma_f32_16x16x32_bf16 v[108:111], a[172:175], a[224:227], v[108:111]
  ds_read_b64_tr_b16 a[194:195], v48 offset:18432
  v_accvgpr_read_b32 v73, a85
  v_mfma_f32_16x16x32_bf16 v[112:115], a[176:179], a[224:227], v[112:115]
  ds_read_b128 v[80:83], v57 offset:2048
  v_mfma_f32_16x16x32_bf16 v[116:119], a[180:183], a[224:227], v[116:119]
  v_accvgpr_read_b32 v74, a86
  v_mfma_f32_16x16x32_bf16 v[120:123], a[184:187], a[224:227], v[120:123]
  ds_read_b64_tr_b16 a[196:197], v48 offset:16392
  v_accvgpr_read_b32 v75, a87
  v_mfma_f32_16x16x32_bf16 v[124:127], a[188:191], a[224:227], v[124:127]
  ds_read_b64_tr_b16 a[198:199], v48 offset:18440
  v_mfma_f32_16x16x32_bf16 v[128:131], a[160:163], a[228:231], v[128:131]
  v_mul_f32 v68, v10, v68
  v_mfma_f32_16x16x32_bf16 v[132:135], a[164:167], a[228:231], v[132:135]
  ds_read_b128 v[84:87], v57 offset:4096
  v_mul_f32 v69, v10, v69
  v_mfma_f32_16x16x32_bf16 v[136:139], a[168:171], a[228:231], v[136:139]
  ds_read_b64_tr_b16 a[200:201], v49 offset:16384
  v_mul_f32 v70, v10, v70
  s_add_u32 m0, s26, 73728
  s_add_u32 s33, s30, 131072
  v_mfma_f32_16x16x32_bf16 v[140:143], a[172:175], a[228:231], v[140:143]
  buffer_load_dwordx4 v65, s[16:19], s33 offen lds
  v_mfma_f32_16x16x32_bf16 v[144:147], a[176:179], a[228:231], v[144:147]
  ds_read_b64_tr_b16 a[202:203], v49 offset:18432
  v_mul_f32 v71, v10, v71
  v_mfma_f32_16x16x32_bf16 v[148:151], a[180:183], a[228:231], v[148:151]
  ds_read_b128 v[88:91], v57 offset:6144
  v_mul_f32 v72, v10, v72
  s_add_u32 m0, s26, 77824
  s_add_u32 s33, s30, 196608
  v_mfma_f32_16x16x32_bf16 v[152:155], a[184:187], a[228:231], v[152:155]
  buffer_load_dwordx4 v65, s[16:19], s33 offen lds
  v_mfma_f32_16x16x32_bf16 v[156:159], a[188:191], a[228:231], v[156:159]
  ds_read_b64_tr_b16 a[204:205], v49 offset:16392
  v_mul_f32 v73, v10, v73
  v_mfma_f32_16x16x32_bf16 v[160:163], a[160:163], a[232:235], v[160:163]
  ds_read_b64_tr_b16 a[206:207], v49 offset:18440
  v_mul_f32 v74, v10, v74
  v_mfma_f32_16x16x32_bf16 v[164:167], a[164:167], a[232:235], v[164:167]
  v_mul_f32 v75, v10, v75
  s_add_u32 m0, s26, 81920
  s_add_u32 s33, s30, 262144
  v_mfma_f32_16x16x32_bf16 v[168:171], a[168:171], a[232:235], v[168:171]
  ds_read_b128 v[92:95], v57 offset:8192
  buffer_load_dwordx4 v65, s[16:19], s33 offen lds
  v_mfma_f32_16x16x32_bf16 v[172:175], a[172:175], a[232:235], v[172:175]
  ds_read_b64_tr_b16 a[208:209], v50 offset:16384
  v_cvt_pk_bf16_f32 v4, v68, v69
  v_mfma_f32_16x16x32_bf16 v[176:179], a[176:179], a[232:235], v[176:179]
  v_cvt_pk_bf16_f32 v5, v70, v71
  v_mfma_f32_16x16x32_bf16 v[180:183], a[180:183], a[232:235], v[180:183]
  ds_read_b64_tr_b16 a[210:211], v50 offset:18432
  v_mfma_f32_16x16x32_bf16 v[184:187], a[184:187], a[232:235], v[184:187]
  ds_read_b64_tr_b16 a[212:213], v50 offset:16392
  v_cvt_pk_bf16_f32 v6, v72, v73
  s_add_u32 m0, s26, 86016
  s_add_u32 s33, s30, 327680
  v_mfma_f32_16x16x32_bf16 v[188:191], a[188:191], a[232:235], v[188:191]
  buffer_load_dwordx4 v65, s[16:19], s33 offen lds
  v_cvt_pk_bf16_f32 v7, v74, v75
  v_mfma_f32_16x16x32_bf16 v[192:195], a[160:163], a[236:239], v[192:195]
  ds_read_b64_tr_b16 a[214:215], v50 offset:18440
  buffer_store_dwordx4 v[4:7], v66, s[20:23], s39 offen offset:2048 sc1
  v_mfma_f32_16x16x32_bf16 v[196:199], a[164:167], a[236:239], v[196:199]
  ds_read_b64_tr_b16 a[216:217], v51 offset:16384
  v_mfma_f32_16x16x32_bf16 v[200:203], a[168:171], a[236:239], v[200:203]
  v_accvgpr_read_b32 v68, a88
  v_mfma_f32_16x16x32_bf16 v[204:207], a[172:175], a[236:239], v[204:207]
  ds_read_b64_tr_b16 a[218:219], v51 offset:18432
  v_accvgpr_read_b32 v69, a89
  v_mfma_f32_16x16x32_bf16 v[208:211], a[176:179], a[236:239], v[208:211]
  ds_read_b64_tr_b16 a[220:221], v51 offset:16392
  v_mfma_f32_16x16x32_bf16 v[212:215], a[180:183], a[236:239], v[212:215]
  v_accvgpr_read_b32 v70, a90
  v_mfma_f32_16x16x32_bf16 v[216:219], a[184:187], a[236:239], v[216:219]
  ds_read_b64_tr_b16 a[222:223], v51 offset:18440
  v_accvgpr_read_b32 v71, a91
  v_mfma_f32_16x16x32_bf16 v[220:223], a[188:191], a[236:239], v[220:223]
  v_accvgpr_read_b32 v72, a92
  s_add_u32 m0, s26, 90112
  s_add_u32 s33, s30, 393216
  v_mfma_f32_16x16x32_bf16 v[224:227], a[160:163], a[240:243], v[224:227]
  buffer_load_dwordx4 v65, s[16:19], s33 offen lds
  v_mfma_f32_16x16x32_bf16 v[228:231], a[164:167], a[240:243], v[228:231]
  v_accvgpr_read_b32 v73, a93
  v_mfma_f32_16x16x32_bf16 v[232:235], a[168:171], a[240:243], v[232:235]
  v_accvgpr_read_b32 v74, a94
  s_add_u32 m0, s26, 94208
  s_add_u32 s33, s30, 458752
  v_mfma_f32_16x16x32_bf16 v[236:239], a[172:175], a[240:243], v[236:239]
  buffer_load_dwordx4 v65, s[16:19], s33 offen lds
  s_add_u32 s29, s29, 128
  s_add_u32 s30, s30, 524288
  s_cmp_eq_u32 s29, 1280
  s_cselect_b32 s29, 0, s29
  s_cselect_b32 s33, 5242880, 0
  s_sub_u32 s30, s30, s33
  v_mfma_f32_16x16x32_bf16 v[240:243], a[176:179], a[240:243], v[240:243]
  v_accvgpr_read_b32 v75, a95
  v_mfma_f32_16x16x32_bf16 v[244:247], a[180:183], a[240:243], v[244:247]
  v_mul_f32 v68, v10, v68
  v_mfma_f32_16x16x32_bf16 v[248:251], a[184:187], a[240:243], v[248:251]
  v_mfma_f32_16x16x32_bf16 v[252:255], a[188:191], a[240:243], v[252:255]
  s_waitcnt vmcnt(16) lgkmcnt(0)
  s_barrier
  v_mfma_f32_16x16x32_bf16 v[96:99], a[192:195], v[76:79], v[96:99]
  ds_read_b128 a[224:227], v56 offset:20480
  v_mfma_f32_16x16x32_bf16 v[100:103], a[196:199], v[76:79], v[100:103]
  ds_read_b64_tr_b16 a[160:161], v48 offset:32768
  v_mul_f32 v69, v10, v69
  s_add_u32 m0, s26, 98304
  v_mfma_f32_16x16x32_bf16 v[104:107], a[200:203], v[76:79], v[104:107]
  buffer_load_dwordx4 v64, s[12:15], s29 offen lds
  v_mul_f32 v70, v10, v70
  v_mfma_f32_16x16x32_bf16 v[108:111], a[204:207], v[76:79], v[108:111]
  ds_read_b64_tr_b16 a[162:163], v48 offset:34816
  v_mul_f32 v71, v10, v71
  v_mfma_f32_16x16x32_bf16 v[112:115], a[208:211], v[76:79], v[112:115]
  ds_read_b128 a[228:231], v56 offset:22528
  v_mfma_f32_16x16x32_bf16 v[116:119], a[212:215], v[76:79], v[116:119]
  v_mul_f32 v72, v10, v72
  v_mfma_f32_16x16x32_bf16 v[120:123], a[216:219], v[76:79], v[120:123]
  ds_read_b64_tr_b16 a[164:165], v48 offset:32776
  v_mul_f32 v73, v10, v73
  v_mfma_f32_16x16x32_bf16 v[124:127], a[220:223], v[76:79], v[124:127]
  ds_read_b64_tr_b16 a[166:167], v48 offset:34824
  v_mfma_f32_16x16x32_bf16 v[128:131], a[192:195], v[80:83], v[128:131]
  v_mul_f32 v74, v10, v74
  v_mfma_f32_16x16x32_bf16 v[132:135], a[196:199], v[80:83], v[132:135]
  ds_read_b128 a[232:235], v56 offset:24576
  v_mul_f32 v75, v10, v75
  v_mfma_f32_16x16x32_bf16 v[136:139], a[200:203], v[80:83], v[136:139]
  ds_read_b64_tr_b16 a[168:169], v49 offset:32768
  v_cvt_pk_bf16_f32 v4, v68, v69
  s_add_u32 m0, s26, 102400
  s_add_u32 s33, s29, 40960
  v_mfma_f32_16x16x32_bf16 v[140:143], a[204:207], v[80:83], v[140:143]
  buffer_load_dwordx4 v64, s[12:15], s33 offen lds
  v_mfma_f32_16x16x32_bf16 v[144:147], a[208:211], v[80:83], v[144:147]
  ds_read_b64_tr_b16 a[170:171], v49 offset:34816
  v_cvt_pk_bf16_f32 v5, v70, v71
  v_mfma_f32_16x16x32_bf16 v[148:151], a[212:215], v[80:83], v[148:151]
  ds_read_b128 a[236:239], v56 offset:26624
  v_cvt_pk_bf16_f32 v6, v72, v73
  s_add_u32 m0, s26, 106496
  s_add_u32 s33, s29, 81920
  v_mfma_f32_16x16x32_bf16 v[152:155], a[216:219], v[80:83], v[152:155]
  buffer_load_dwordx4 v64, s[12:15], s33 offen lds
  v_mfma_f32_16x16x32_bf16 v[156:159], a[220:223], v[80:83], v[156:159]
  ds_read_b64_tr_b16 a[172:173], v49 offset:32776
  v_cvt_pk_bf16_f32 v7, v74, v75
  v_mfma_f32_16x16x32_bf16 v[160:163], a[192:195], v[84:87], v[160:163]
  ds_read_b64_tr_b16 a[174:175], v49 offset:34824
  buffer_store_dwordx4 v[4:7], v66, s[20:23], s39 offen offset:3072 sc1
  v_mfma_f32_16x16x32_bf16 v[164:167], a[196:199], v[84:87], v[164:167]
  s_add_u32 s39, s37, 393216
  v_mfma_f32_16x16x32_bf16 v[168:171], a[200:203], v[84:87], v[168:171]
  ds_read_b128 a[240:243], v56 offset:28672
  v_mfma_f32_16x16x32_bf16 v[172:175], a[204:207], v[84:87], v[172:175]
  ds_read_b64_tr_b16 a[176:177], v50 offset:32768
  v_accvgpr_read_b32 v68, a96
  v_mfma_f32_16x16x32_bf16 v[176:179], a[208:211], v[84:87], v[176:179]
  v_accvgpr_read_b32 v69, a97
  s_add_u32 m0, s26, 110592
  s_add_u32 s33, s29, 122880
  v_mfma_f32_16x16x32_bf16 v[180:183], a[212:215], v[84:87], v[180:183]
  ds_read_b64_tr_b16 a[178:179], v50 offset:34816
  buffer_load_dwordx4 v64, s[12:15], s33 offen lds
  v_mfma_f32_16x16x32_bf16 v[184:187], a[216:219], v[84:87], v[184:187]
  ds_read_b64_tr_b16 a[180:181], v50 offset:32776
  v_accvgpr_read_b32 v70, a98
  v_mfma_f32_16x16x32_bf16 v[188:191], a[220:223], v[84:87], v[188:191]
  v_accvgpr_read_b32 v71, a99
  v_mfma_f32_16x16x32_bf16 v[192:195], a[192:195], v[88:91], v[192:195]
  ds_read_b64_tr_b16 a[182:183], v50 offset:34824
  v_accvgpr_read_b32 v72, a100
  v_mfma_f32_16x16x32_bf16 v[196:199], a[196:199], v[88:91], v[196:199]
  ds_read_b64_tr_b16 a[184:185], v51 offset:32768
  v_mfma_f32_16x16x32_bf16 v[200:203], a[200:203], v[88:91], v[200:203]
  v_accvgpr_read_b32 v73, a101
  v_mfma_f32_16x16x32_bf16 v[204:207], a[204:207], v[88:91], v[204:207]
  ds_read_b64_tr_b16 a[186:187], v51 offset:34816
  v_accvgpr_read_b32 v74, a102
  v_mfma_f32_16x16x32_bf16 v[208:211], a[208:211], v[88:91], v[208:211]
  ds_read_b64_tr_b16 a[188:189], v51 offset:32776
  v_mfma_f32_16x16x32_bf16 v[212:215], a[212:215], v[88:91], v[212:215]
  v_accvgpr_read_b32 v75, a103
  v_mfma_f32_16x16x32_bf16 v[216:219], a[216:219], v[88:91], v[216:219]
  ds_read_b64_tr_b16 a[190:191], v51 offset:34824
  v_mul_f32 v68, v11, v68
  v_mfma_f32_16x16x32_bf16 v[220:223], a[220:223], v[88:91], v[220:223]
  v_mul_f32 v69, v11, v69
  s_add_u32 m0, s26, 114688
  s_add_u32 s33, s29, 163840
  v_mfma_f32_16x16x32_bf16 v[224:227], a[192:195], v[92:95], v[224:227]
  buffer_load_dwordx4 v64, s[12:15], s33 offen lds
  v_mfma_f32_16x16x32_bf16 v[228:231], a[196:199], v[92:95], v[228:231]
  v_mul_f32 v70, v11, v70
  v_mfma_f32_16x16x32_bf16 v[232:235], a[200:203], v[92:95], v[232:235]
  v_mul_f32 v71, v11, v71
  s_add_u32 m0, s26, 0
  v_mfma_f32_16x16x32_bf16 v[236:239], a[204:207], v[92:95], v[236:239]
  buffer_load_dwordx4 v65, s[16:19], s30 offen lds
  v_mfma_f32_16x16x32_bf16 v[240:243], a[208:211], v[92:95], v[240:243]
  v_mul_f32 v72, v11, v72
  v_mfma_f32_16x16x32_bf16 v[244:247], a[212:215], v[92:95], v[244:247]
  v_mul_f32 v73, v11, v73
  v_mfma_f32_16x16x32_bf16 v[248:251], a[216:219], v[92:95], v[248:251]
  v_mfma_f32_16x16x32_bf16 v[252:255], a[220:223], v[92:95], v[252:255]
  s_waitcnt lgkmcnt(0)
  v_mfma_f32_16x16x32_bf16 v[96:99], a[160:163], a[224:227], v[96:99]
  ds_read_b128 v[76:79], v57 offset:20480
  v_mfma_f32_16x16x32_bf16 v[100:103], a[164:167], a[224:227], v[100:103]
  ds_read_b64_tr_b16 a[192:193], v48 offset:49152
  v_mul_f32 v74, v11, v74
  s_add_u32 m0, s26, 4096
  s_add_u32 s33, s30, 65536
  v_mfma_f32_16x16x32_bf16 v[104:107], a[168:171], a[224:227], v[104:107]
  buffer_load_dwordx4 v65, s[16:19], s33 offen lds
  v_mul_f32 v75, v11, v75
  v_mfma_f32_16x16x32_bf16 v[108:111], a[172:175], a[224:227], v[108:111]
  ds_read_b64_tr_b16 a[194:195], v48 offset:51200
  v_cvt_pk_bf16_f32 v4, v68, v69
  v_mfma_f32_16x16x32_bf16 v[112:115], a[176:179], a[224:227], v[112:115]
  ds_read_b128 v[80:83], v57 offset:22528
  v_mfma_f32_16x16x32_bf16 v[116:119], a[180:183], a[224:227], v[116:119]
  v_cvt_pk_bf16_f32 v5, v70, v71
  v_mfma_f32_16x16x32_bf16 v[120:123], a[184:187], a[224:227], v[120:123]
  ds_read_b64_tr_b16 a[196:197], v48 offset:49160
  v_cvt_pk_bf16_f32 v6, v72, v73
  v_mfma_f32_16x16x32_bf16 v[124:127], a[188:191], a[224:227], v[124:127]
  ds_read_b64_tr_b16 a[198:199], v48 offset:51208
  v_mfma_f32_16x16x32_bf16 v[128:131], a[160:163], a[228:231], v[128:131]
  v_cvt_pk_bf16_f32 v7, v74, v75
  v_mfma_f32_16x16x32_bf16 v[132:135], a[164:167], a[228:231], v[132:135]
  ds_read_b128 v[84:87], v57 offset:24576
  buffer_store_dwordx4 v[4:7], v66, s[20:23], s39 offen offset:0 sc1
  v_mfma_f32_16x16x32_bf16 v[136:139], a[168:171], a[228:231], v[136:139]
  ds_read_b64_tr_b16 a[200:201], v49 offset:49152
  v_accvgpr_read_b32 v68, a104
  s_add_u32 m0, s26, 8192
  s_add_u32 s33, s30, 131072
  v_mfma_f32_16x16x32_bf16 v[140:143], a[172:175], a[228:231], v[140:143]
  buffer_load_dwordx4 v65, s[16:19], s33 offen lds
  v_mfma_f32_16x16x32_bf16 v[144:147], a[176:179], a[228:231], v[144:147]
  ds_read_b64_tr_b16 a[202:203], v49 offset:51200
  v_accvgpr_read_b32 v69, a105
  v_mfma_f32_16x16x32_bf16 v[148:151], a[180:183], a[228:231], v[148:151]
  ds_read_b128 v[88:91], v57 offset:26624
  v_accvgpr_read_b32 v70, a106
  s_add_u32 m0, s26, 12288
  s_add_u32 s33, s30, 196608
  v_mfma_f32_16x16x32_bf16 v[152:155], a[184:187], a[228:231], v[152:155]
  buffer_load_dwordx4 v65, s[16:19], s33 offen lds
  v_mfma_f32_16x16x32_bf16 v[156:159], a[188:191], a[228:231], v[156:159]
  ds_read_b64_tr_b16 a[204:205], v49 offset:49160
  v_accvgpr_read_b32 v71, a107
  v_mfma_f32_16x16x32_bf16 v[160:163], a[160:163], a[232:235], v[160:163]
  ds_read_b64_tr_b16 a[206:207], v49 offset:51208
  v_accvgpr_read_b32 v72, a108
  v_mfma_f32_16x16x32_bf16 v[164:167], a[164:167], a[232:235], v[164:167]
  v_accvgpr_read_b32 v73, a109
  s_add_u32 m0, s26, 16384
  s_add_u32 s33, s30, 262144
  v_mfma_f32_16x16x32_bf16 v[168:171], a[168:171], a[232:235], v[168:171]
  ds_read_b128 v[92:95], v57 offset:28672
  buffer_load_dwordx4 v65, s[16:19], s33 offen lds
  v_mfma_f32_16x16x32_bf16 v[172:175], a[172:175], a[232:235], v[172:175]
  ds_read_b64_tr_b16 a[208:209], v50 offset:49152
  v_accvgpr_read_b32 v74, a110
  v_mfma_f32_16x16x32_bf16 v[176:179], a[176:179], a[232:235], v[176:179]
  v_accvgpr_read_b32 v75, a111
  v_mfma_f32_16x16x32_bf16 v[180:183], a[180:183], a[232:235], v[180:183]
  ds_read_b64_tr_b16 a[210:211], v50 offset:51200
  v_mfma_f32_16x16x32_bf16 v[184:187], a[184:187], a[232:235], v[184:187]
  ds_read_b64_tr_b16 a[212:213], v50 offset:49160
  v_mul_f32 v68, v11, v68
  s_add_u32 m0, s26, 20480
  s_add_u32 s33, s30, 327680
  v_mfma_f32_16x16x32_bf16 v[188:191], a[188:191], a[232:235], v[188:191]
  buffer_load_dwordx4 v65, s[16:19], s33 offen lds
  v_mul_f32 v69, v11, v69
  v_mfma_f32_16x16x32_bf16 v[192:195], a[160:163], a[236:239], v[192:195]
  ds_read_b64_tr_b16 a[214:215], v50 offset:51208
  v_mul_f32 v70, v11, v70
  v_mfma_f32_16x16x32_bf16 v[196:199], a[164:167], a[236:239], v[196:199]
  ds_read_b64_tr_b16 a[216:217], v51 offset:49152
  v_mfma_f32_16x16x32_bf16 v[200:203], a[168:171], a[236:239], v[200:203]
  v_mul_f32 v71, v11, v71
  v_mfma_f32_16x16x32_bf16 v[204:207], a[172:175], a[236:239], v[204:207]
  ds_read_b64_tr_b16 a[218:219], v51 offset:51200
  v_mul_f32 v72, v11, v72
  v_mfma_f32_16x16x32_bf16 v[208:211], a[176:179], a[236:239], v[208:211]
  ds_read_b64_tr_b16 a[220:221], v51 offset:49160
  v_mfma_f32_16x16x32_bf16 v[212:215], a[180:183], a[236:239], v[212:215]
  v_mul_f32 v73, v11, v73
  v_mfma_f32_16x16x32_bf16 v[216:219], a[184:187], a[236:239], v[216:219]
  ds_read_b64_tr_b16 a[222:223], v51 offset:51208
  v_mul_f32 v74, v11, v74
  v_mfma_f32_16x16x32_bf16 v[220:223], a[188:191], a[236:239], v[220:223]
  v_mul_f32 v75, v11, v75
  s_add_u32 m0, s26, 24576
  s_add_u32 s33, s30, 393216
  v_mfma_f32_16x16x32_bf16 v[224:227], a[160:163], a[240:243], v[224:227]
  buffer_load_dwordx4 v65, s[16:19], s33 offen lds
  v_mfma_f32_16x16x32_bf16 v[228:231], a[164:167], a[240:243], v[228:231]
  v_cvt_pk_bf16_f32 v4, v68, v69
  v_mfma_f32_16x16x32_bf16 v[232:235], a[168:171], a[240:243], v[232:235]
  v_cvt_pk_bf16_f32 v5, v70, v71
  s_add_u32 m0, s26, 28672
  s_add_u32 s33, s30, 458752
  v_mfma_f32_16x16x32_bf16 v[236:239], a[172:175], a[240:243], v[236:239]
  buffer_load_dwordx4 v65, s[16:19], s33 offen lds
  s_add_u32 s29, s29, 128
  s_add_u32 s30, s30, 524288
  s_cmp_eq_u32 s29, 1280
  s_cselect_b32 s29, 0, s29
  s_cselect_b32 s33, 5242880, 0
  s_sub_u32 s30, s30, s33
  v_mfma_f32_16x16x32_bf16 v[240:243], a[176:179], a[240:243], v[240:243]
  v_cvt_pk_bf16_f32 v6, v72, v73
  v_mfma_f32_16x16x32_bf16 v[244:247], a[180:183], a[240:243], v[244:247]
  v_cvt_pk_bf16_f32 v7, v74, v75
  v_mfma_f32_16x16x32_bf16 v[248:251], a[184:187], a[240:243], v[248:251]
  v_mfma_f32_16x16x32_bf16 v[252:255], a[188:191], a[240:243], v[252:255]
  s_waitcnt vmcnt(15) lgkmcnt(0)
  s_barrier
  v_mfma_f32_16x16x32_bf16 v[96:99], a[192:195], v[76:79], v[96:99]
  ds_read_b128 a[224:227], v56 offset:40960
  v_mfma_f32_16x16x32_bf16 v[100:103], a[196:199], v[76:79], v[100:103]
  ds_read_b64_tr_b16 a[160:161], v52 offset:0
  buffer_store_dwordx4 v[4:7], v66, s[20:23], s39 offen offset:1024 sc1
  s_add_u32 m0, s26, 118784
  v_mfma_f32_16x16x32_bf16 v[104:107], a[200:203], v[76:79], v[104:107]
  buffer_load_dwordx4 v64, s[12:15], s29 offen lds
  v_accvgpr_read_b32 v68, a112
  v_mfma_f32_16x16x32_bf16 v[108:111], a[204:207], v[76:79], v[108:111]
  ds_read_b64_tr_b16 a[162:163], v52 offset:2048
  v_accvgpr_read_b32 v69, a113
  v_mfma_f32_16x16x32_bf16 v[112:115], a[208:211], v[76:79], v[112:115]
  ds_read_b128 a[228:231], v56 offset:43008
  v_mfma_f32_16x16x32_bf16 v[116:119], a[212:215], v[76:79], v[116:119]
  v_accvgpr_read_b32 v70, a114
  v_mfma_f32_16x16x32_bf16 v[120:123], a[216:219], v[76:79], v[120:123]
  ds_read_b64_tr_b16 a[164:165], v52 offset:8
  v_accvgpr_read_b32 v71, a115
  v_mfma_f32_16x16x32_bf16 v[124:127], a[220:223], v[76:79], v[124:127]
  ds_read_b64_tr_b16 a[166:167], v52 offset:2056
  v_mfma_f32_16x16x32_bf16 v[128:131], a[192:195], v[80:83], v[128:131]
  v_accvgpr_read_b32 v72, a116
  v_mfma_f32_16x16x32_bf16 v[132:135], a[196:199], v[80:83], v[132:135]
  ds_read_b128 a[232:235], v56 offset:45056
  v_accvgpr_read_b32 v73, a117
  v_mfma_f32_16x16x32_bf16 v[136:139], a[200:203], v[80:83], v[136:139]
  ds_read_b64_tr_b16 a[168:169], v53 offset:0
  v_accvgpr_read_b32 v74, a118
  s_add_u32 m0, s26, 122880
  s_add_u32 s33, s29, 40960
  v_mfma_f32_16x16x32_bf16 v[140:143], a[204:207], v[80:83], v[140:143]
  buffer_load_dwordx4 v64, s[12:15], s33 offen lds
  v_mfma_f32_16x16x32_bf16 v[144:147], a[208:211], v[80:83], v[144:147]
  ds_read_b64_tr_b16 a[170:171], v53 offset:2048
  v_accvgpr_read_b32 v75, a119
  v_mfma_f32_16x16x32_bf16 v[148:151], a[212:215], v[80:83], v[148:151]
  ds_read_b128 a[236:239], v56 offset:47104
  v_mul_f32 v68, v11, v68
  s_add_u32 m0, s26, 126976
  s_add_u32 s33, s29, 81920
  v_mfma_f32_16x16x32_bf16 v[152:155], a[216:219], v[80:83], v[152:155]
  buffer_load_dwordx4 v64, s[12:15], s33 offen lds
  v_mfma_f32_16x16x32_bf16 v[156:159], a[220:223], v[80:83], v[156:159]
  ds_read_b64_tr_b16 a[172:173], v53 offset:8
  v_mul_f32 v69, v11, v69
  v_mfma_f32_16x16x32_bf16 v[160:163], a[192:195], v[84:87], v[160:163]
  ds_read_b64_tr_b16 a[174:175], v53 offset:2056
  v_mul_f32 v70, v11, v70
  v_mfma_f32_16x16x32_bf16 v[164:167], a[196:199], v[84:87], v[164:167]
  v_mul_f32 v71, v11, v71
  v_mfma_f32_16x16x32_bf16 v[168:171], a[200:203], v[84:87], v[168:171]
  ds_read_b128 a[240:243], v56 offset:49152
  v_mfma_f32_16x16x32_bf16 v[172:175], a[204:207], v[84:87], v[172:175]
  ds_read_b64_tr_b16 a[176:177], v54 offset:0
  v_mul_f32 v72, v11, v72
  v_mfma_f32_16x16x32_bf16 v[176:179], a[208:211], v[84:87], v[176:179]
  v_mul_f32 v73, v11, v73
  s_add_u32 m0, s26, 131072
  s_add_u32 s33, s29, 122880
  v_mfma_f32_16x16x32_bf16 v[180:183], a[212:215], v[84:87], v[180:183]
  ds_read_b64_tr_b16 a[178:179], v54 offset:2048
  buffer_load_dwordx4 v64, s[12:15], s33 offen lds
  v_mfma_f32_16x16x32_bf16 v[184:187], a[216:219], v[84:87], v[184:187]
  ds_read_b64_tr_b16 a[180:181], v54 offset:8
  v_mul_f32 v74, v11, v74
  v_mfma_f32_16x16x32_bf16 v[188:191], a[220:223], v[84:87], v[188:191]
  v_mul_f32 v75, v11, v75
  v_mfma_f32_16x16x32_bf16 v[192:195], a[192:195], v[88:91], v[192:195]
  ds_read_b64_tr_b16 a[182:183], v54 offset:2056
  v_cvt_pk_bf16_f32 v4, v68, v69
  v_mfma_f32_16x16x32_bf16 v[196:199], a[196:199], v[88:91], v[196:199]
  ds_read_b64_tr_b16 a[184:185], v55 offset:0
  v_mfma_f32_16x16x32_bf16 v[200:203], a[200:203], v[88:91], v[200:203]
  v_cvt_pk_bf16_f32 v5, v70, v71
  v_mfma_f32_16x16x32_bf16 v[204:207], a[204:207], v[88:91], v[204:207]
  ds_read_b64_tr_b16 a[186:187], v55 offset:2048
  v_cvt_pk_bf16_f32 v6, v72, v73
  v_mfma_f32_16x16x32_bf16 v[208:211], a[208:211], v[88:91], v[208:211]
  ds_read_b64_tr_b16 a[188:189], v55 offset:8
  v_mfma_f32_16x16x32_bf16 v[212:215], a[212:215], v[88:91], v[212:215]
  v_cvt_pk_bf16_f32 v7, v74, v75
  v_mfma_f32_16x16x32_bf16 v[216:219], a[216:219], v[88:91], v[216:219]
  ds_read_b64_tr_b16 a[190:191], v55 offset:2056
  buffer_store_dwordx4 v[4:7], v66, s[20:23], s39 offen offset:2048 sc1
  v_mfma_f32_16x16x32_bf16 v[220:223], a[220:223], v[88:91], v[220:223]
  v_accvgpr_read_b32 v68, a120
  s_add_u32 m0, s26, 135168
  s_add_u32 s33, s29, 163840
  v_mfma_f32_16x16x32_bf16 v[224:227], a[192:195], v[92:95], v[224:227]
  buffer_load_dwordx4 v64, s[12:15], s33 offen lds
  v_mfma_f32_16x16x32_bf16 v[228:231], a[196:199], v[92:95], v[228:231]
  v_accvgpr_read_b32 v69, a121
  v_mfma_f32_16x16x32_bf16 v[232:235], a[200:203], v[92:95], v[232:235]
  v_accvgpr_read_b32 v70, a122
  s_add_u32 m0, s26, 32768
  v_mfma_f32_16x16x32_bf16 v[236:239], a[204:207], v[92:95], v[236:239]
  buffer_load_dwordx4 v65, s[16:19], s30 offen lds
  v_mfma_f32_16x16x32_bf16 v[240:243], a[208:211], v[92:95], v[240:243]
  v_accvgpr_read_b32 v71, a123
  v_mfma_f32_16x16x32_bf16 v[244:247], a[212:215], v[92:95], v[244:247]
  v_accvgpr_read_b32 v72, a124
  v_mfma_f32_16x16x32_bf16 v[248:251], a[216:219], v[92:95], v[248:251]
  v_mfma_f32_16x16x32_bf16 v[252:255], a[220:223], v[92:95], v[252:255]
  s_waitcnt lgkmcnt(0)
  v_mfma_f32_16x16x32_bf16 v[96:99], a[160:163], a[224:227], v[96:99]
  ds_read_b128 v[76:79], v57 offset:40960
  v_mfma_f32_16x16x32_bf16 v[100:103], a[164:167], a[224:227], v[100:103]
  ds_read_b64_tr_b16 a[192:193], v52 offset:16384
  v_accvgpr_read_b32 v73, a125
  s_add_u32 m0, s26, 36864
  s_add_u32 s33, s30, 65536
  v_mfma_f32_16x16x32_bf16 v[104:107], a[168:171], a[224:227], v[104:107]
  buffer_load_dwordx4 v65, s[16:19], s33 offen lds
  v_accvgpr_read_b32 v74, a126
  v_mfma_f32_16x16x32_bf16 v[108:111], a[172:175], a[224:227], v[108:111]
  ds_read_b64_tr_b16 a[194:195], v52 offset:18432
  v_accvgpr_read_b32 v75, a127
  v_mfma_f32_16x16x32_bf16 v[112:115], a[176:179], a[224:227], v[112:115]
  ds_read_b128 v[80:83], v57 offset:43008
  v_mfma_f32_16x16x32_bf16 v[116:119], a[180:183], a[224:227], v[116:119]
  v_mul_f32 v68, v11, v68
  v_mfma_f32_16x16x32_bf16 v[120:123], a[184:187], a[224:227], v[120:123]
  ds_read_b64_tr_b16 a[196:197], v52 offset:16392
  v_mul_f32 v69, v11, v69
  v_mfma_f32_16x16x32_bf16 v[124:127], a[188:191], a[224:227], v[124:127]
  ds_read_b64_tr_b16 a[198:199], v52 offset:18440
  v_mfma_f32_16x16x32_bf16 v[128:131], a[160:163], a[228:231], v[128:131]
  v_mul_f32 v70, v11, v70
  v_mfma_f32_16x16x32_bf16 v[132:135], a[164:167], a[228:231], v[132:135]
  ds_read_b128 v[84:87], v57 offset:45056
  v_mul_f32 v71, v11, v71
  v_mfma_f32_16x16x32_bf16 v[136:139], a[168:171], a[228:231], v[136:139]
  ds_read_b64_tr_b16 a[200:201], v53 offset:16384
  v_mul_f32 v72, v11, v72
  s_add_u32 m0, s26, 40960
  s_add_u32 s33, s30, 131072
  v_mfma_f32_16x16x32_bf16 v[140:143], a[172:175], a[228:231], v[140:143]
  buffer_load_dwordx4 v65, s[16:19], s33 offen lds
  v_mfma_f32_16x16x32_bf16 v[144:147], a[176:179], a[228:231], v[144:147]
  ds_read_b64_tr_b16 a[202:203], v53 offset:18432
  v_mul_f32 v73, v11, v73
  v_mfma_f32_16x16x32_bf16 v[148:151], a[180:183], a[228:231], v[148:151]
  ds_read_b128 v[88:91], v57 offset:47104
  v_mul_f32 v74, v11, v74
  s_add_u32 m0, s26, 45056
  s_add_u32 s33, s30, 196608
  v_mfma_f32_16x16x32_bf16 v[152:155], a[184:187], a[228:231], v[152:155]
  buffer_load_dwordx4 v65, s[16:19], s33 offen lds
  v_mfma_f32_16x16x32_bf16 v[156:159], a[188:191], a[228:231], v[156:159]
  ds_read_b64_tr_b16 a[204:205], v53 offset:16392
  v_mul_f32 v75, v11, v75
  v_mfma_f32_16x16x32_bf16 v[160:163], a[160:163], a[232:235], v[160:163]
  ds_read_b64_tr_b16 a[206:207], v53 offset:18440
  v_cvt_pk_bf16_f32 v4, v68, v69
  v_mfma_f32_16x16x32_bf16 v[164:167], a[164:167], a[232:235], v[164:167]
  v_cvt_pk_bf16_f32 v5, v70, v71
  s_add_u32 m0, s26, 49152
  s_add_u32 s33, s30, 262144
  v_mfma_f32_16x16x32_bf16 v[168:171], a[168:171], a[232:235], v[168:171]
  ds_read_b128 v[92:95], v57 offset:49152
  buffer_load_dwordx4 v65, s[16:19], s33 offen lds
  v_mfma_f32_16x16x32_bf16 v[172:175], a[172:175], a[232:235], v[172:175]
  ds_read_b64_tr_b16 a[208:209], v54 offset:16384
  v_cvt_pk_bf16_f32 v6, v72, v73
  v_mfma_f32_16x16x32_bf16 v[176:179], a[176:179], a[232:235], v[176:179]
  v_cvt_pk_bf16_f32 v7, v74, v75
  v_mfma_f32_16x16x32_bf16 v[180:183], a[180:183], a[232:235], v[180:183]
  ds_read_b64_tr_b16 a[210:211], v54 offset:18432
  v_mfma_f32_16x16x32_bf16 v[184:187], a[184:187], a[232:235], v[184:187]
  ds_read_b64_tr_b16 a[212:213], v54 offset:16392
  buffer_store_dwordx4 v[4:7], v66, s[20:23], s39 offen offset:3072 sc1
  s_add_u32 m0, s26, 53248
  s_add_u32 s33, s30, 327680
  v_mfma_f32_16x16x32_bf16 v[188:191], a[188:191], a[232:235], v[188:191]
  buffer_load_dwordx4 v65, s[16:19], s33 offen lds
  s_add_u32 s39, s37, 524288
  v_mfma_f32_16x16x32_bf16 v[192:195], a[160:163], a[236:239], v[192:195]
  ds_read_b64_tr_b16 a[214:215], v54 offset:18440
  v_accvgpr_read_b32 v68, a128
  v_mfma_f32_16x16x32_bf16 v[196:199], a[164:167], a[236:239], v[196:199]
  ds_read_b64_tr_b16 a[216:217], v55 offset:16384
  v_mfma_f32_16x16x32_bf16 v[200:203], a[168:171], a[236:239], v[200:203]
  v_accvgpr_read_b32 v69, a129
  v_mfma_f32_16x16x32_bf16 v[204:207], a[172:175], a[236:239], v[204:207]
  ds_read_b64_tr_b16 a[218:219], v55 offset:18432
  v_accvgpr_read_b32 v70, a130
  v_mfma_f32_16x16x32_bf16 v[208:211], a[176:179], a[236:239], v[208:211]
  ds_read_b64_tr_b16 a[220:221], v55 offset:16392
  v_mfma_f32_16x16x32_bf16 v[212:215], a[180:183], a[236:239], v[212:215]
  v_accvgpr_read_b32 v71, a131
  v_mfma_f32_16x16x32_bf16 v[216:219], a[184:187], a[236:239], v[216:219]
  ds_read_b64_tr_b16 a[222:223], v55 offset:18440
  v_accvgpr_read_b32 v72, a132
  v_mfma_f32_16x16x32_bf16 v[220:223], a[188:191], a[236:239], v[220:223]
  v_accvgpr_read_b32 v73, a133
  s_add_u32 m0, s26, 57344
  s_add_u32 s33, s30, 393216
  v_mfma_f32_16x16x32_bf16 v[224:227], a[160:163], a[240:243], v[224:227]
  buffer_load_dwordx4 v65, s[16:19], s33 offen lds
  v_mfma_f32_16x16x32_bf16 v[228:231], a[164:167], a[240:243], v[228:231]
  v_accvgpr_read_b32 v74, a134
  v_mfma_f32_16x16x32_bf16 v[232:235], a[168:171], a[240:243], v[232:235]
  v_accvgpr_read_b32 v75, a135
  s_add_u32 m0, s26, 61440
  s_add_u32 s33, s30, 458752
  v_mfma_f32_16x16x32_bf16 v[236:239], a[172:175], a[240:243], v[236:239]
  buffer_load_dwordx4 v65, s[16:19], s33 offen lds
  s_add_u32 s29, s29, 128
  s_add_u32 s30, s30, 524288
  s_cmp_eq_u32 s29, 1280
  s_cselect_b32 s29, 0, s29
  s_cselect_b32 s33, 5242880, 0
  s_sub_u32 s30, s30, s33
  v_mfma_f32_16x16x32_bf16 v[240:243], a[176:179], a[240:243], v[240:243]
  v_mul_f32 v68, v12, v68
  v_mfma_f32_16x16x32_bf16 v[244:247], a[180:183], a[240:243], v[244:247]
  v_mul_f32 v69, v12, v69
  v_mfma_f32_16x16x32_bf16 v[248:251], a[184:187], a[240:243], v[248:251]
  v_mfma_f32_16x16x32_bf16 v[252:255], a[188:191], a[240:243], v[252:255]
  s_waitcnt vmcnt(16) lgkmcnt(0)
  s_barrier
  v_mfma_f32_16x16x32_bf16 v[96:99], a[192:195], v[76:79], v[96:99]
  ds_read_b128 a[224:227], v56 offset:0
  v_mfma_f32_16x16x32_bf16 v[100:103], a[196:199], v[76:79], v[100:103]
  ds_read_b64_tr_b16 a[160:161], v48 offset:0
  v_mul_f32 v70, v12, v70
  s_add_u32 m0, s26, 139264
  v_mfma_f32_16x16x32_bf16 v[104:107], a[200:203], v[76:79], v[104:107]
  buffer_load_dwordx4 v64, s[12:15], s29 offen lds
  v_mul_f32 v71, v12, v71
  v_mfma_f32_16x16x32_bf16 v[108:111], a[204:207], v[76:79], v[108:111]
  ds_read_b64_tr_b16 a[162:163], v48 offset:2048
  v_mul_f32 v72, v12, v72
  v_mfma_f32_16x16x32_bf16 v[112:115], a[208:211], v[76:79], v[112:115]
  ds_read_b128 a[228:231], v56 offset:2048
  v_mfma_f32_16x16x32_bf16 v[116:119], a[212:215], v[76:79], v[116:119]
  v_mul_f32 v73, v12, v73
  v_mfma_f32_16x16x32_bf16 v[120:123], a[216:219], v[76:79], v[120:123]
  ds_read_b64_tr_b16 a[164:165], v48 offset:8
  v_mul_f32 v74, v12, v74
  v_mfma_f32_16x16x32_bf16 v[124:127], a[220:223], v[76:79], v[124:127]
  ds_read_b64_tr_b16 a[166:167], v48 offset:2056
  v_mfma_f32_16x16x32_bf16 v[128:131], a[192:195], v[80:83], v[128:131]
  v_mul_f32 v75, v12, v75
  v_mfma_f32_16x16x32_bf16 v[132:135], a[196:199], v[80:83], v[132:135]
  ds_read_b128 a[232:235], v56 offset:4096
  v_cvt_pk_bf16_f32 v4, v68, v69
  v_mfma_f32_16x16x32_bf16 v[136:139], a[200:203], v[80:83], v[136:139]
  ds_read_b64_tr_b16 a[168:169], v49 offset:0
  v_cvt_pk_bf16_f32 v5, v70, v71
  s_add_u32 m0, s26, 143360
  s_add_u32 s33, s29, 40960
  v_mfma_f32_16x16x32_bf16 v[140:143], a[204:207], v[80:83], v[140:143]
  buffer_load_dwordx4 v64, s[12:15], s33 offen lds
  v_mfma_f32_16x16x32_bf16 v[144:147], a[208:211], v[80:83], v[144:147]
  ds_read_b64_tr_b16 a[170:171], v49 offset:2048
  v_cvt_pk_bf16_f32 v6, v72, v73
  v_mfma_f32_16x16x32_bf16 v[148:151], a[212:215], v[80:83], v[148:151]
  ds_read_b128 a[236:239], v56 offset:6144
  v_cvt_pk_bf16_f32 v7, v74, v75
  s_add_u32 m0, s26, 147456
  s_add_u32 s33, s29, 81920
  v_mfma_f32_16x16x32_bf16 v[152:155], a[216:219], v[80:83], v[152:155]
  buffer_load_dwordx4 v64, s[12:15], s33 offen lds
  v_mfma_f32_16x16x32_bf16 v[156:159], a[220:223], v[80:83], v[156:159]
  ds_read_b64_tr_b16 a[172:173], v49 offset:8
  buffer_store_dwordx4 v[4:7], v66, s[20:23], s39 offen offset:0 sc1
  v_mfma_f32_16x16x32_bf16 v[160:163], a[192:195], v[84:87], v[160:163]
  ds_read_b64_tr_b16 a[174:175], v49 offset:2056
  v_accvgpr_read_b32 v68, a136
  v_mfma_f32_16x16x32_bf16 v[164:167], a[196:199], v[84:87], v[164:167]
  v_accvgpr_read_b32 v69, a137
  v_mfma_f32_16x16x32_bf16 v[168:171], a[200:203], v[84:87], v[168:171]
  ds_read_b128 a[240:243], v56 offset:8192
  v_mfma_f32_16x16x32_bf16 v[172:175], a[204:207], v[84:87], v[172:175]
  ds_read_b64_tr_b16 a[176:177], v50 offset:0
  v_accvgpr_read_b32 v70, a138
  v_mfma_f32_16x16x32_bf16 v[176:179], a[208:211], v[84:87], v[176:179]
  v_accvgpr_read_b32 v71, a139
  s_add_u32 m0, s26, 151552
  s_add_u32 s33, s29, 122880
  v_mfma_f32_16x16x32_bf16 v[180:183], a[212:215], v[84:87], v[180:183]
  ds_read_b64_tr_b16 a[178:179], v50 offset:2048
  buffer_load_dwordx4 v64, s[12:15], s33 offen lds
  v_mfma_f32_16x16x32_bf16 v[184:187], a[216:219], v[84:87], v[184:187]
  ds_read_b64_tr_b16 a[180:181], v50 offset:8
  v_accvgpr_read_b32 v72, a140
  v_mfma_f32_16x16x32_bf16 v[188:191], a[220:223], v[84:87], v[188:191]
  v_accvgpr_read_b32 v73, a141
  v_mfma_f32_16x16x32_bf16 v[192:195], a[192:195], v[88:91], v[192:195]
  ds_read_b64_tr_b16 a[182:183], v50 offset:2056
  v_accvgpr_read_b32 v74, a142
  v_mfma_f32_16x16x32_bf16 v[196:199], a[196:199], v[88:91], v[196:199]
  ds_read_b64_tr_b16 a[184:185], v51 offset:0
  v_mfma_f32_16x16x32_bf16 v[200:203], a[200:203], v[88:91], v[200:203]
  v_accvgpr_read_b32 v75, a143
  v_mfma_f32_16x16x32_bf16 v[204:207], a[204:207], v[88:91], v[204:207]
  ds_read_b64_tr_b16 a[186:187], v51 offset:2048
  v_mul_f32 v68, v12, v68
  v_mfma_f32_16x16x32_bf16 v[208:211], a[208:211], v[88:91], v[208:211]
  ds_read_b64_tr_b16 a[188:189], v51 offset:8
  v_mfma_f32_16x16x32_bf16 v[212:215], a[212:215], v[88:91], v[212:215]
  v_mul_f32 v69, v12, v69
  v_mfma_f32_16x16x32_bf16 v[216:219], a[216:219], v[88:91], v[216:219]
  ds_read_b64_tr_b16 a[190:191], v51 offset:2056
  v_mul_f32 v70, v12, v70
  v_mfma_f32_16x16x32_bf16 v[220:223], a[220:223], v[88:91], v[220:223]
  v_mul_f32 v71, v12, v71
  s_add_u32 m0, s26, 155648
  s_add_u32 s33, s29, 163840
  v_mfma_f32_16x16x32_bf16 v[224:227], a[192:195], v[92:95], v[224:227]
  buffer_load_dwordx4 v64, s[12:15], s33 offen lds
  v_mfma_f32_16x16x32_bf16 v[228:231], a[196:199], v[92:95], v[228:231]
  v_mul_f32 v72, v12, v72
  v_mfma_f32_16x16x32_bf16 v[232:235], a[200:203], v[92:95], v[232:235]
  v_mul_f32 v73, v12, v73
  s_add_u32 m0, s26, 65536
  v_mfma_f32_16x16x32_bf16 v[236:239], a[204:207], v[92:95], v[236:239]
  buffer_load_dwordx4 v65, s[16:19], s30 offen lds
  v_mfma_f32_16x16x32_bf16 v[240:243], a[208:211], v[92:95], v[240:243]
  v_mul_f32 v74, v12, v74
  v_mfma_f32_16x16x32_bf16 v[244:247], a[212:215], v[92:95], v[244:247]
  v_mul_f32 v75, v12, v75
  v_mfma_f32_16x16x32_bf16 v[248:251], a[216:219], v[92:95], v[248:251]
  v_mfma_f32_16x16x32_bf16 v[252:255], a[220:223], v[92:95], v[252:255]
  s_waitcnt lgkmcnt(0)
  v_mfma_f32_16x16x32_bf16 v[96:99], a[160:163], a[224:227], v[96:99]
  ds_read_b128 v[76:79], v57 offset:0
  v_mfma_f32_16x16x32_bf16 v[100:103], a[164:167], a[224:227], v[100:103]
  ds_read_b64_tr_b16 a[192:193], v48 offset:16384
  v_cvt_pk_bf16_f32 v4, v68, v69
  s_add_u32 m0, s26, 69632
  s_add_u32 s33, s30, 65536
  v_mfma_f32_16x16x32_bf16 v[104:107], a[168:171], a[224:227], v[104:107]
  buffer_load_dwordx4 v65, s[16:19], s33 offen lds
  v_cvt_pk_bf16_f32 v5, v70, v71
  v_mfma_f32_16x16x32_bf16 v[108:111], a[172:175], a[224:227], v[108:111]
  ds_read_b64_tr_b16 a[194:195], v48 offset:18432
  v_cvt_pk_bf16_f32 v6, v72, v73
  v_mfma_f32_16x16x32_bf16 v[112:115], a[176:179], a[224:227], v[112:115]
  ds_read_b128 v[80:83], v57 offset:2048
  v_mfma_f32_16x16x32_bf16 v[116:119], a[180:183], a[224:227], v[116:119]
  v_cvt_pk_bf16_f32 v7, v74, v75
  v_mfma_f32_16x16x32_bf16 v[120:123], a[184:187], a[224:227], v[120:123]
  ds_read_b64_tr_b16 a[196:197], v48 offset:16392
  buffer_store_dwordx4 v[4:7], v66, s[20:23], s39 offen offset:1024 sc1
  v_mfma_f32_16x16x32_bf16 v[124:127], a[188:191], a[224:227], v[124:127]
  ds_read_b64_tr_b16 a[198:199], v48 offset:18440
  v_mfma_f32_16x16x32_bf16 v[128:131], a[160:163], a[228:231], v[128:131]
  v_accvgpr_read_b32 v68, a144
  v_mfma_f32_16x16x32_bf16 v[132:135], a[164:167], a[228:231], v[132:135]
  ds_read_b128 v[84:87], v57 offset:4096
  v_accvgpr_read_b32 v69, a145
  v_mfma_f32_16x16x32_bf16 v[136:139], a[168:171], a[228:231], v[136:139]
  ds_read_b64_tr_b16 a[200:201], v49 offset:16384
  v_accvgpr_read_b32 v70, a146
  s_add_u32 m0, s26, 73728
  s_add_u32 s33, s30, 131072
  v_mfma_f32_16x16x32_bf16 v[140:143], a[172:175], a[228:231], v[140:143]
  buffer_load_dwordx4 v65, s[16:19], s33 offen lds
  v_mfma_f32_16x16x32_bf16 v[144:147], a[176:179], a[228:231], v[144:147]
  ds_read_b64_tr_b16 a[202:203], v49 offset:18432
  v_accvgpr_read_b32 v71, a147
  v_mfma_f32_16x16x32_bf16 v[148:151], a[180:183], a[228:231], v[148:151]
  ds_read_b128 v[88:91], v57 offset:6144
  v_accvgpr_read_b32 v72, a148
  s_add_u32 m0, s26, 77824
  s_add_u32 s33, s30, 196608
  v_mfma_f32_16x16x32_bf16 v[152:155], a[184:187], a[228:231], v[152:155]
  buffer_load_dwordx4 v65, s[16:19], s33 offen lds
  v_mfma_f32_16x16x32_bf16 v[156:159], a[188:191], a[228:231], v[156:159]
  ds_read_b64_tr_b16 a[204:205], v49 offset:16392
  v_accvgpr_read_b32 v73, a149
  v_mfma_f32_16x16x32_bf16 v[160:163], a[160:163], a[232:235], v[160:163]
  ds_read_b64_tr_b16 a[206:207], v49 offset:18440
  v_accvgpr_read_b32 v74, a150
  v_mfma_f32_16x16x32_bf16 v[164:167], a[164:167], a[232:235], v[164:167]
  v_accvgpr_read_b32 v75, a151
  s_add_u32 m0, s26, 81920
  s_add_u32 s33, s30, 262144
  v_mfma_f32_16x16x32_bf16 v[168:171], a[168:171], a[232:235], v[168:171]
  ds_read_b128 v[92:95], v57 offset:8192
  buffer_load_dwordx4 v65, s[16:19], s33 offen lds
  v_mfma_f32_16x16x32_bf16 v[172:175], a[172:175], a[232:235], v[172:175]
  ds_read_b64_tr_b16 a[208:209], v50 offset:16384
  v_mul_f32 v68, v12, v68
  v_mfma_f32_16x16x32_bf16 v[176:179], a[176:179], a[232:235], v[176:179]
  v_mul_f32 v69, v12, v69
  v_mfma_f32_16x16x32_bf16 v[180:183], a[180:183], a[232:235], v[180:183]
  ds_read_b64_tr_b16 a[210:211], v50 offset:18432
  v_mfma_f32_16x16x32_bf16 v[184:187], a[184:187], a[232:235], v[184:187]
  ds_read_b64_tr_b16 a[212:213], v50 offset:16392
  v_mul_f32 v70, v12, v70
  s_add_u32 m0, s26, 86016
  s_add_u32 s33, s30, 327680
  v_mfma_f32_16x16x32_bf16 v[188:191], a[188:191], a[232:235], v[188:191]
  buffer_load_dwordx4 v65, s[16:19], s33 offen lds
  v_mul_f32 v71, v12, v71
  v_mfma_f32_16x16x32_bf16 v[192:195], a[160:163], a[236:239], v[192:195]
  ds_read_b64_tr_b16 a[214:215], v50 offset:18440
  v_mul_f32 v72, v12, v72
  v_mfma_f32_16x16x32_bf16 v[196:199], a[164:167], a[236:239], v[196:199]
  ds_read_b64_tr_b16 a[216:217], v51 offset:16384
  v_mfma_f32_16x16x32_bf16 v[200:203], a[168:171], a[236:239], v[200:203]
  v_mul_f32 v73, v12, v73
  v_mfma_f32_16x16x32_bf16 v[204:207], a[172:175], a[236:239], v[204:207]
  ds_read_b64_tr_b16 a[218:219], v51 offset:18432
  v_mul_f32 v74, v12, v74
  v_mfma_f32_16x16x32_bf16 v[208:211], a[176:179], a[236:239], v[208:211]
  ds_read_b64_tr_b16 a[220:221], v51 offset:16392
  v_mfma_f32_16x16x32_bf16 v[212:215], a[180:183], a[236:239], v[212:215]
  v_mul_f32 v75, v12, v75
  v_mfma_f32_16x16x32_bf16 v[216:219], a[184:187], a[236:239], v[216:219]
  ds_read_b64_tr_b16 a[222:223], v51 offset:18440
  v_cvt_pk_bf16_f32 v4, v68, v69
  v_mfma_f32_16x16x32_bf16 v[220:223], a[188:191], a[236:239], v[220:223]
  v_cvt_pk_bf16_f32 v5, v70, v71
  s_add_u32 m0, s26, 90112
  s_add_u32 s33, s30, 393216
  v_mfma_f32_16x16x32_bf16 v[224:227], a[160:163], a[240:243], v[224:227]
  buffer_load_dwordx4 v65, s[16:19], s33 offen lds
  v_mfma_f32_16x16x32_bf16 v[228:231], a[164:167], a[240:243], v[228:231]
  v_cvt_pk_bf16_f32 v6, v72, v73
  v_mfma_f32_16x16x32_bf16 v[232:235], a[168:171], a[240:243], v[232:235]
  v_cvt_pk_bf16_f32 v7, v74, v75
  s_add_u32 m0, s26, 94208
  s_add_u32 s33, s30, 458752
  v_mfma_f32_16x16x32_bf16 v[236:239], a[172:175], a[240:243], v[236:239]
  buffer_load_dwordx4 v65, s[16:19], s33 offen lds
  s_add_u32 s29, s29, 128
  s_add_u32 s30, s30, 524288
  s_cmp_eq_u32 s29, 1280
  s_cselect_b32 s29, 0, s29
  s_cselect_b32 s33, 5242880, 0
  s_sub_u32 s30, s30, s33
  v_mfma_f32_16x16x32_bf16 v[240:243], a[176:179], a[240:243], v[240:243]
  buffer_store_dwordx4 v[4:7], v66, s[20:23], s39 offen offset:2048 sc1
  v_mfma_f32_16x16x32_bf16 v[244:247], a[180:183], a[240:243], v[244:247]
  v_accvgpr_read_b32 v68, a152
  v_mfma_f32_16x16x32_bf16 v[248:251], a[184:187], a[240:243], v[248:251]
  v_mfma_f32_16x16x32_bf16 v[252:255], a[188:191], a[240:243], v[252:255]
  s_waitcnt vmcnt(16) lgkmcnt(0)
  s_barrier
  v_mfma_f32_16x16x32_bf16 v[96:99], a[192:195], v[76:79], v[96:99]
  ds_read_b128 a[224:227], v56 offset:20480
  v_mfma_f32_16x16x32_bf16 v[100:103], a[196:199], v[76:79], v[100:103]
  ds_read_b64_tr_b16 a[160:161], v48 offset:32768
  v_accvgpr_read_b32 v69, a153
  v_mfma_f32_16x16x32_bf16 v[104:107], a[200:203], v[76:79], v[104:107]
  v_accvgpr_read_b32 v70, a154
  v_mfma_f32_16x16x32_bf16 v[108:111], a[204:207], v[76:79], v[108:111]
  ds_read_b64_tr_b16 a[162:163], v48 offset:34816
  v_mfma_f32_16x16x32_bf16 v[112:115], a[208:211], v[76:79], v[112:115]
  ds_read_b128 a[228:231], v56 offset:22528
  v_accvgpr_read_b32 v71, a155
  s_add_u32 m0, s25, 0
  v_mfma_f32_16x16x32_bf16 v[116:119], a[212:215], v[76:79], v[116:119]
  buffer_load_dwordx4 v58, s[4:7], s27 offen nt lds
  v_mfma_f32_16x16x32_bf16 v[120:123], a[216:219], v[76:79], v[120:123]
  ds_read_b64_tr_b16 a[164:165], v48 offset:32776
  v_accvgpr_read_b32 v72, a156
  v_mfma_f32_16x16x32_bf16 v[124:127], a[220:223], v[76:79], v[124:127]
  ds_read_b64_tr_b16 a[166:167], v48 offset:34824
  v_mfma_f32_16x16x32_bf16 v[128:131], a[192:195], v[80:83], v[128:131]
  v_accvgpr_read_b32 v73, a157
  v_mfma_f32_16x16x32_bf16 v[132:135], a[196:199], v[80:83], v[132:135]
  ds_read_b128 a[232:235], v56 offset:24576
  v_mfma_f32_16x16x32_bf16 v[136:139], a[200:203], v[80:83], v[136:139]
  ds_read_b64_tr_b16 a[168:169], v49 offset:32768
  v_accvgpr_read_b32 v74, a158
  v_mfma_f32_16x16x32_bf16 v[140:143], a[204:207], v[80:83], v[140:143]
  buffer_load_dwordx4 v59, s[4:7], s27 offen offset:1024 nt lds
  v_mfma_f32_16x16x32_bf16 v[144:147], a[208:211], v[80:83], v[144:147]
  ds_read_b64_tr_b16 a[170:171], v49 offset:34816
  v_accvgpr_read_b32 v75, a159
  v_mfma_f32_16x16x32_bf16 v[148:151], a[212:215], v[80:83], v[148:151]
  ds_read_b128 a[236:239], v56 offset:26624
  v_mfma_f32_16x16x32_bf16 v[152:155], a[216:219], v[80:83], v[152:155]
  v_mul_f32 v68, v12, v68
  v_mfma_f32_16x16x32_bf16 v[156:159], a[220:223], v[80:83], v[156:159]
  ds_read_b64_tr_b16 a[172:173], v49 offset:32776
  v_mfma_f32_16x16x32_bf16 v[160:163], a[192:195], v[84:87], v[160:163]
  ds_read_b64_tr_b16 a[174:175], v49 offset:34824
  v_mul_f32 v69, v12, v69
  v_mfma_f32_16x16x32_bf16 v[164:167], a[196:199], v[84:87], v[164:167]
  v_mfma_f32_16x16x32_bf16 v[168:171], a[200:203], v[84:87], v[168:171]
  ds_read_b128 a[240:243], v56 offset:28672
  v_mul_f32 v70, v12, v70
  v_mfma_f32_16x16x32_bf16 v[172:175], a[204:207], v[84:87], v[172:175]
  ds_read_b64_tr_b16 a[176:177], v50 offset:32768
  v_mfma_f32_16x16x32_bf16 v[176:179], a[208:211], v[84:87], v[176:179]
  v_mul_f32 v71, v12, v71
  v_mfma_f32_16x16x32_bf16 v[180:183], a[212:215], v[84:87], v[180:183]
  ds_read_b64_tr_b16 a[178:179], v50 offset:34816
  v_mul_f32 v72, v12, v72
  v_mfma_f32_16x16x32_bf16 v[184:187], a[216:219], v[84:87], v[184:187]
  ds_read_b64_tr_b16 a[180:181], v50 offset:32776
  v_mfma_f32_16x16x32_bf16 v[188:191], a[220:223], v[84:87], v[188:191]
  v_mul_f32 v73, v12, v73
  v_mfma_f32_16x16x32_bf16 v[192:195], a[192:195], v[88:91], v[192:195]
  ds_read_b64_tr_b16 a[182:183], v50 offset:34824
  v_mfma_f32_16x16x32_bf16 v[196:199], a[196:199], v[88:91], v[196:199]
  ds_read_b64_tr_b16 a[184:185], v51 offset:32768
  v_mul_f32 v74, v12, v74
  v_mfma_f32_16x16x32_bf16 v[200:203], a[200:203], v[88:91], v[200:203]
  buffer_load_dwordx4 v60, s[4:7], s27 offen offset:2048 nt lds
  v_mfma_f32_16x16x32_bf16 v[204:207], a[204:207], v[88:91], v[204:207]
  ds_read_b64_tr_b16 a[186:187], v51 offset:34816
  v_mul_f32 v75, v12, v75
  v_mfma_f32_16x16x32_bf16 v[208:211], a[208:211], v[88:91], v[208:211]
  ds_read_b64_tr_b16 a[188:189], v51 offset:32776
  v_mfma_f32_16x16x32_bf16 v[212:215], a[212:215], v[88:91], v[212:215]
  v_cvt_pk_bf16_f32 v4, v68, v69
  v_mfma_f32_16x16x32_bf16 v[216:219], a[216:219], v[88:91], v[216:219]
  ds_read_b64_tr_b16 a[190:191], v51 offset:34824
  v_mfma_f32_16x16x32_bf16 v[220:223], a[220:223], v[88:91], v[220:223]
  v_cvt_pk_bf16_f32 v5, v70, v71
  v_mfma_f32_16x16x32_bf16 v[224:227], a[192:195], v[92:95], v[224:227]
  buffer_load_dwordx4 v61, s[4:7], s27 offen offset:3072 nt lds
  s_add_u32 s27, s27, 8192
  v_mfma_f32_16x16x32_bf16 v[228:231], a[196:199], v[92:95], v[228:231]
  v_cvt_pk_bf16_f32 v6, v72, v73
  v_mfma_f32_16x16x32_bf16 v[232:235], a[200:203], v[92:95], v[232:235]
  v_mfma_f32_16x16x32_bf16 v[236:239], a[204:207], v[92:95], v[236:239]
  v_cvt_pk_bf16_f32 v7, v74, v75
  v_mfma_f32_16x16x32_bf16 v[240:243], a[208:211], v[92:95], v[240:243]
  v_mfma_f32_16x16x32_bf16 v[244:247], a[212:215], v[92:95], v[244:247]
  buffer_store_dwordx4 v[4:7], v66, s[20:23], s39 offen offset:3072 sc1
  v_mfma_f32_16x16x32_bf16 v[248:251], a[216:219], v[92:95], v[248:251]
  v_mfma_f32_16x16x32_bf16 v[252:255], a[220:223], v[92:95], v[252:255]
  s_waitcnt lgkmcnt(0)
  v_mfma_f32_16x16x32_bf16 v[96:99], a[160:163], a[224:227], v[96:99]
  ds_read_b128 v[76:79], v57 offset:20480
  v_mfma_f32_16x16x32_bf16 v[100:103], a[164:167], a[224:227], v[100:103]
  ds_read_b64_tr_b16 a[192:193], v48 offset:49152
  s_add_u32 m0, s25, 16384
  v_mfma_f32_16x16x32_bf16 v[104:107], a[168:171], a[224:227], v[104:107]
  buffer_load_dwordx4 v62, s[8:11], s28 offen nt lds
  v_mfma_f32_16x16x32_bf16 v[108:111], a[172:175], a[224:227], v[108:111]
  ds_read_b64_tr_b16 a[194:195], v48 offset:51200
  v_mfma_f32_16x16x32_bf16 v[112:115], a[176:179], a[224:227], v[112:115]
  ds_read_b128 v[80:83], v57 offset:22528
  v_mfma_f32_16x16x32_bf16 v[116:119], a[180:183], a[224:227], v[116:119]
  v_mfma_f32_16x16x32_bf16 v[120:123], a[184:187], a[224:227], v[120:123]
  ds_read_b64_tr_b16 a[196:197], v48 offset:49160
  v_mfma_f32_16x16x32_bf16 v[124:127], a[188:191], a[224:227], v[124:127]
  ds_read_b64_tr_b16 a[198:199], v48 offset:51208
  v_mfma_f32_16x16x32_bf16 v[128:131], a[160:163], a[228:231], v[128:131]
  v_mfma_f32_16x16x32_bf16 v[132:135], a[164:167], a[228:231], v[132:135]
  ds_read_b128 v[84:87], v57 offset:24576
  v_mfma_f32_16x16x32_bf16 v[136:139], a[168:171], a[228:231], v[136:139]
  ds_read_b64_tr_b16 a[200:201], v49 offset:49152
  v_mfma_f32_16x16x32_bf16 v[140:143], a[172:175], a[228:231], v[140:143]
  buffer_load_dwordx4 v63, s[8:11], s28 offen offset:1024 nt lds
  v_mfma_f32_16x16x32_bf16 v[144:147], a[176:179], a[228:231], v[144:147]
  ds_read_b64_tr_b16 a[202:203], v49 offset:51200
  v_mfma_f32_16x16x32_bf16 v[148:151], a[180:183], a[228:231], v[148:151]
  ds_read_b128 v[88:91], v57 offset:26624
  v_mfma_f32_16x16x32_bf16 v[152:155], a[184:187], a[228:231], v[152:155]
  v_mfma_f32_16x16x32_bf16 v[156:159], a[188:191], a[228:231], v[156:159]
  ds_read_b64_tr_b16 a[204:205], v49 offset:49160
  v_mfma_f32_16x16x32_bf16 v[160:163], a[160:163], a[232:235], v[160:163]
  ds_read_b64_tr_b16 a[206:207], v49 offset:51208
  v_mfma_f32_16x16x32_bf16 v[164:167], a[164:167], a[232:235], v[164:167]
  v_mfma_f32_16x16x32_bf16 v[168:171], a[168:171], a[232:235], v[168:171]
  ds_read_b128 v[92:95], v57 offset:28672
  v_mfma_f32_16x16x32_bf16 v[172:175], a[172:175], a[232:235], v[172:175]
  ds_read_b64_tr_b16 a[208:209], v50 offset:49152
  v_mfma_f32_16x16x32_bf16 v[176:179], a[176:179], a[232:235], v[176:179]
  v_mfma_f32_16x16x32_bf16 v[180:183], a[180:183], a[232:235], v[180:183]
  ds_read_b64_tr_b16 a[210:211], v50 offset:51200
  v_mfma_f32_16x16x32_bf16 v[184:187], a[184:187], a[232:235], v[184:187]
  ds_read_b64_tr_b16 a[212:213], v50 offset:49160
  v_mfma_f32_16x16x32_bf16 v[188:191], a[188:191], a[232:235], v[188:191]
  buffer_load_dwordx4 v62, s[8:11], s28 offen offset:2048 nt lds
  v_mfma_f32_16x16x32_bf16 v[192:195], a[160:163], a[236:239], v[192:195]
  ds_read_b64_tr_b16 a[214:215], v50 offset:51208
  v_mfma_f32_16x16x32_bf16 v[196:199], a[164:167], a[236:239], v[196:199]
  ds_read_b64_tr_b16 a[216:217], v51 offset:49152
  v_mfma_f32_16x16x32_bf16 v[200:203], a[168:171], a[236:239], v[200:203]
  v_mfma_f32_16x16x32_bf16 v[204:207], a[172:175], a[236:239], v[204:207]
  ds_read_b64_tr_b16 a[218:219], v51 offset:51200
  v_mfma_f32_16x16x32_bf16 v[208:211], a[176:179], a[236:239], v[208:211]
  ds_read_b64_tr_b16 a[220:221], v51 offset:49160
  v_mfma_f32_16x16x32_bf16 v[212:215], a[180:183], a[236:239], v[212:215]
  v_mfma_f32_16x16x32_bf16 v[216:219], a[184:187], a[236:239], v[216:219]
  ds_read_b64_tr_b16 a[222:223], v51 offset:51208
  v_mfma_f32_16x16x32_bf16 v[220:223], a[188:191], a[236:239], v[220:223]
  buffer_load_dwordx4 v63, s[8:11], s28 offen offset:3072 nt lds
  s_add_u32 s28, s28, 8192
  v_mfma_f32_16x16x32_bf16 v[224:227], a[160:163], a[240:243], v[224:227]
  v_mfma_f32_16x16x32_bf16 v[228:231], a[164:167], a[240:243], v[228:231]
  v_mfma_f32_16x16x32_bf16 v[232:235], a[168:171], a[240:243], v[232:235]
  v_mfma_f32_16x16x32_bf16 v[236:239], a[172:175], a[240:243], v[236:239]
  v_mfma_f32_16x16x32_bf16 v[240:243], a[176:179], a[240:243], v[240:243]
  v_mfma_f32_16x16x32_bf16 v[244:247], a[180:183], a[240:243], v[244:247]
  v_mfma_f32_16x16x32_bf16 v[248:251], a[184:187], a[240:243], v[248:251]
  v_mfma_f32_16x16x32_bf16 v[252:255], a[188:191], a[240:243], v[252:255]
  s_waitcnt vmcnt(10) lgkmcnt(0)
  s_barrier
  v_mfma_f32_16x16x32_bf16 v[96:99], a[192:195], v[76:79], v[96:99]
  ds_read_b128 a[224:227], v56 offset:40960
  v_mfma_f32_16x16x32_bf16 v[100:103], a[196:199], v[76:79], v[100:103]
  ds_read_b64_tr_b16 a[160:161], v52 offset:0
  s_add_u32 m0, s25, 32768
  v_mfma_f32_16x16x32_bf16 v[104:107], a[200:203], v[76:79], v[104:107]
  buffer_load_dwordx4 v58, s[4:7], s27 offen nt lds
  v_mfma_f32_16x16x32_bf16 v[108:111], a[204:207], v[76:79], v[108:111]
  ds_read_b64_tr_b16 a[162:163], v52 offset:2048
  v_mfma_f32_16x16x32_bf16 v[112:115], a[208:211], v[76:79], v[112:115]
  ds_read_b128 a[228:231], v56 offset:43008
  v_mfma_f32_16x16x32_bf16 v[116:119], a[212:215], v[76:79], v[116:119]
  v_mfma_f32_16x16x32_bf16 v[120:123], a[216:219], v[76:79], v[120:123]
  ds_read_b64_tr_b16 a[164:165], v52 offset:8
  v_mfma_f32_16x16x32_bf16 v[124:127], a[220:223], v[76:79], v[124:127]
  ds_read_b64_tr_b16 a[166:167], v52 offset:2056
  v_mfma_f32_16x16x32_bf16 v[128:131], a[192:195], v[80:83], v[128:131]
  v_mfma_f32_16x16x32_bf16 v[132:135], a[196:199], v[80:83], v[132:135]
  ds_read_b128 a[232:235], v56 offset:45056
  v_mfma_f32_16x16x32_bf16 v[136:139], a[200:203], v[80:83], v[136:139]
  ds_read_b64_tr_b16 a[168:169], v53 offset:0
  v_mfma_f32_16x16x32_bf16 v[140:143], a[204:207], v[80:83], v[140:143]
  buffer_load_dwordx4 v59, s[4:7], s27 offen offset:1024 nt lds
  v_mfma_f32_16x16x32_bf16 v[144:147], a[208:211], v[80:83], v[144:147]
  ds_read_b64_tr_b16 a[170:171], v53 offset:2048
  v_mfma_f32_16x16x32_bf16 v[148:151], a[212:215], v[80:83], v[148:151]
  ds_read_b128 a[236:239], v56 offset:47104
  v_mfma_f32_16x16x32_bf16 v[152:155], a[216:219], v[80:83], v[152:155]
  v_mfma_f32_16x16x32_bf16 v[156:159], a[220:223], v[80:83], v[156:159]
  ds_read_b64_tr_b16 a[172:173], v53 offset:8
  v_mfma_f32_16x16x32_bf16 v[160:163], a[192:195], v[84:87], v[160:163]
  ds_read_b64_tr_b16 a[174:175], v53 offset:2056
  v_mfma_f32_16x16x32_bf16 v[164:167], a[196:199], v[84:87], v[164:167]
  v_mfma_f32_16x16x32_bf16 v[168:171], a[200:203], v[84:87], v[168:171]
  ds_read_b128 a[240:243], v56 offset:49152
  v_mfma_f32_16x16x32_bf16 v[172:175], a[204:207], v[84:87], v[172:175]
  ds_read_b64_tr_b16 a[176:177], v54 offset:0
  v_mfma_f32_16x16x32_bf16 v[176:179], a[208:211], v[84:87], v[176:179]
  v_mfma_f32_16x16x32_bf16 v[180:183], a[212:215], v[84:87], v[180:183]
  ds_read_b64_tr_b16 a[178:179], v54 offset:2048
  v_mfma_f32_16x16x32_bf16 v[184:187], a[216:219], v[84:87], v[184:187]
  ds_read_b64_tr_b16 a[180:181], v54 offset:8
  v_mfma_f32_16x16x32_bf16 v[188:191], a[220:223], v[84:87], v[188:191]
  buffer_load_dwordx4 v60, s[4:7], s27 offen offset:2048 nt lds
  v_mfma_f32_16x16x32_bf16 v[192:195], a[192:195], v[88:91], v[192:195]
  ds_read_b64_tr_b16 a[182:183], v54 offset:2056
  v_mfma_f32_16x16x32_bf16 v[196:199], a[196:199], v[88:91], v[196:199]
  ds_read_b64_tr_b16 a[184:185], v55 offset:0
  v_mfma_f32_16x16x32_bf16 v[200:203], a[200:203], v[88:91], v[200:203]
  v_mfma_f32_16x16x32_bf16 v[204:207], a[204:207], v[88:91], v[204:207]
  ds_read_b64_tr_b16 a[186:187], v55 offset:2048
  v_mfma_f32_16x16x32_bf16 v[208:211], a[208:211], v[88:91], v[208:211]
  ds_read_b64_tr_b16 a[188:189], v55 offset:8
  v_mfma_f32_16x16x32_bf16 v[212:215], a[212:215], v[88:91], v[212:215]
  v_mfma_f32_16x16x32_bf16 v[216:219], a[216:219], v[88:91], v[216:219]
  ds_read_b64_tr_b16 a[190:191], v55 offset:2056
  v_mfma_f32_16x16x32_bf16 v[220:223], a[220:223], v[88:91], v[220:223]
  buffer_load_dwordx4 v61, s[4:7], s27 offen offset:3072 nt lds
  s_add_u32 s27, s27, 8192
  v_mfma_f32_16x16x32_bf16 v[224:227], a[192:195], v[92:95], v[224:227]
  v_mfma_f32_16x16x32_bf16 v[228:231], a[196:199], v[92:95], v[228:231]
  v_mfma_f32_16x16x32_bf16 v[232:235], a[200:203], v[92:95], v[232:235]
  v_mfma_f32_16x16x32_bf16 v[236:239], a[204:207], v[92:95], v[236:239]
  v_mfma_f32_16x16x32_bf16 v[240:243], a[208:211], v[92:95], v[240:243]
  v_mfma_f32_16x16x32_bf16 v[244:247], a[212:215], v[92:95], v[244:247]
  v_mfma_f32_16x16x32_bf16 v[248:251], a[216:219], v[92:95], v[248:251]
  v_mfma_f32_16x16x32_bf16 v[252:255], a[220:223], v[92:95], v[252:255]
  s_waitcnt lgkmcnt(0)
  v_mfma_f32_16x16x32_bf16 v[96:99], a[160:163], a[224:227], v[96:99]
  ds_read_b128 v[76:79], v57 offset:40960
  v_mfma_f32_16x16x32_bf16 v[100:103], a[164:167], a[224:227], v[100:103]
  ds_read_b64_tr_b16 a[192:193], v52 offset:16384
  s_add_u32 m0, s25, 49152
  v_mfma_f32_16x16x32_bf16 v[104:107], a[168:171], a[224:227], v[104:107]
  buffer_load_dwordx4 v62, s[8:11], s28 offen nt lds
  v_mfma_f32_16x16x32_bf16 v[108:111], a[172:175], a[224:227], v[108:111]
  ds_read_b64_tr_b16 a[194:195], v52 offset:18432
  v_mfma_f32_16x16x32_bf16 v[112:115], a[176:179], a[224:227], v[112:115]
  ds_read_b128 v[80:83], v57 offset:43008
  v_mfma_f32_16x16x32_bf16 v[116:119], a[180:183], a[224:227], v[116:119]
  v_mfma_f32_16x16x32_bf16 v[120:123], a[184:187], a[224:227], v[120:123]
  ds_read_b64_tr_b16 a[196:197], v52 offset:16392
  v_mfma_f32_16x16x32_bf16 v[124:127], a[188:191], a[224:227], v[124:127]
  ds_read_b64_tr_b16 a[198:199], v52 offset:18440
  v_mfma_f32_16x16x32_bf16 v[128:131], a[160:163], a[228:231], v[128:131]
  v_mfma_f32_16x16x32_bf16 v[132:135], a[164:167], a[228:231], v[132:135]
  ds_read_b128 v[84:87], v57 offset:45056
  v_mfma_f32_16x16x32_bf16 v[136:139], a[168:171], a[228:231], v[136:139]
  ds_read_b64_tr_b16 a[200:201], v53 offset:16384
  v_mfma_f32_16x16x32_bf16 v[140:143], a[172:175], a[228:231], v[140:143]
  buffer_load_dwordx4 v63, s[8:11], s28 offen offset:1024 nt lds
  v_mfma_f32_16x16x32_bf16 v[144:147], a[176:179], a[228:231], v[144:147]
  ds_read_b64_tr_b16 a[202:203], v53 offset:18432
  v_mfma_f32_16x16x32_bf16 v[148:151], a[180:183], a[228:231], v[148:151]
  ds_read_b128 v[88:91], v57 offset:47104
  v_mfma_f32_16x16x32_bf16 v[152:155], a[184:187], a[228:231], v[152:155]
  v_mfma_f32_16x16x32_bf16 v[156:159], a[188:191], a[228:231], v[156:159]
  ds_read_b64_tr_b16 a[204:205], v53 offset:16392
  v_mfma_f32_16x16x32_bf16 v[160:163], a[160:163], a[232:235], v[160:163]
  ds_read_b64_tr_b16 a[206:207], v53 offset:18440
  v_mfma_f32_16x16x32_bf16 v[164:167], a[164:167], a[232:235], v[164:167]
  v_mfma_f32_16x16x32_bf16 v[168:171], a[168:171], a[232:235], v[168:171]
  ds_read_b128 v[92:95], v57 offset:49152
  v_mfma_f32_16x16x32_bf16 v[172:175], a[172:175], a[232:235], v[172:175]
  ds_read_b64_tr_b16 a[208:209], v54 offset:16384
  v_mfma_f32_16x16x32_bf16 v[176:179], a[176:179], a[232:235], v[176:179]
  v_mfma_f32_16x16x32_bf16 v[180:183], a[180:183], a[232:235], v[180:183]
  ds_read_b64_tr_b16 a[210:211], v54 offset:18432
  v_mfma_f32_16x16x32_bf16 v[184:187], a[184:187], a[232:235], v[184:187]
  ds_read_b64_tr_b16 a[212:213], v54 offset:16392
  v_mfma_f32_16x16x32_bf16 v[188:191], a[188:191], a[232:235], v[188:191]
  buffer_load_dwordx4 v62, s[8:11], s28 offen offset:2048 nt lds
  v_mfma_f32_16x16x32_bf16 v[192:195], a[160:163], a[236:239], v[192:195]
  ds_read_b64_tr_b16 a[214:215], v54 offset:18440
  v_mfma_f32_16x16x32_bf16 v[196:199], a[164:167], a[236:239], v[196:199]
  ds_read_b64_tr_b16 a[216:217], v55 offset:16384
  v_mfma_f32_16x16x32_bf16 v[200:203], a[168:171], a[236:239], v[200:203]
  v_mfma_f32_16x16x32_bf16 v[204:207], a[172:175], a[236:239], v[204:207]
  ds_read_b64_tr_b16 a[218:219], v55 offset:18432
  v_mfma_f32_16x16x32_bf16 v[208:211], a[176:179], a[236:239], v[208:211]
  ds_read_b64_tr_b16 a[220:221], v55 offset:16392
  v_mfma_f32_16x16x32_bf16 v[212:215], a[180:183], a[236:239], v[212:215]
  v_mfma_f32_16x16x32_bf16 v[216:219], a[184:187], a[236:239], v[216:219]
  ds_read_b64_tr_b16 a[222:223], v55 offset:18440
  v_mfma_f32_16x16x32_bf16 v[220:223], a[188:191], a[236:239], v[220:223]
  buffer_load_dwordx4 v63, s[8:11], s28 offen offset:3072 nt lds
  s_add_u32 s28, s28, 8192
  v_mfma_f32_16x16x32_bf16 v[224:227], a[160:163], a[240:243], v[224:227]
  v_mfma_f32_16x16x32_bf16 v[228:231], a[164:167], a[240:243], v[228:231]
  v_mfma_f32_16x16x32_bf16 v[232:235], a[168:171], a[240:243], v[232:235]
  v_mfma_f32_16x16x32_bf16 v[236:239], a[172:175], a[240:243], v[236:239]
  v_mfma_f32_16x16x32_bf16 v[240:243], a[176:179], a[240:243], v[240:243]
  v_mfma_f32_16x16x32_bf16 v[244:247], a[180:183], a[240:243], v[244:247]
  v_mfma_f32_16x16x32_bf16 v[248:251], a[184:187], a[240:243], v[248:251]
  v_mfma_f32_16x16x32_bf16 v[252:255], a[188:191], a[240:243], v[252:255]
  s_waitcnt lgkmcnt(0)
  s_barrier
  v_mfma_f32_16x16x32_bf16 v[96:99], a[192:195], v[76:79], v[96:99]
  v_mfma_f32_16x16x32_bf16 v[100:103], a[196:199], v[76:79], v[100:103]
  v_mfma_f32_16x16x32_bf16 v[104:107], a[200:203], v[76:79], v[104:107]
  v_mfma_f32_16x16x32_bf16 v[108:111], a[204:207], v[76:79], v[108:111]
  v_mfma_f32_16x16x32_bf16 v[112:115], a[208:211], v[76:79], v[112:115]
  v_mfma_f32_16x16x32_bf16 v[116:119], a[212:215], v[76:79], v[116:119]
  v_mfma_f32_16x16x32_bf16 v[120:123], a[216:219], v[76:79], v[120:123]
  v_mfma_f32_16x16x32_bf16 v[124:127], a[220:223], v[76:79], v[124:127]
  v_mfma_f32_16x16x32_bf16 v[128:131], a[192:195], v[80:83], v[128:131]
  v_mfma_f32_16x16x32_bf16 v[132:135], a[196:199], v[80:83], v[132:135]
  v_mfma_f32_16x16x32_bf16 v[136:139], a[200:203], v[80:83], v[136:139]
  v_mfma_f32_16x16x32_bf16 v[140:143], a[204:207], v[80:83], v[140:143]
  v_mfma_f32_16x16x32_bf16 v[144:147], a[208:211], v[80:83], v[144:147]
  v_mfma_f32_16x16x32_bf16 v[148:151], a[212:215], v[80:83], v[148:151]
  v_mfma_f32_16x16x32_bf16 v[152:155], a[216:219], v[80:83], v[152:155]
  v_mfma_f32_16x16x32_bf16 v[156:159], a[220:223], v[80:83], v[156:159]
  v_mfma_f32_16x16x32_bf16 v[160:163], a[192:195], v[84:87], v[160:163]
  v_mfma_f32_16x16x32_bf16 v[164:167], a[196:199], v[84:87], v[164:167]
  v_mfma_f32_16x16x32_bf16 v[168:171], a[200:203], v[84:87], v[168:171]
  v_mfma_f32_16x16x32_bf16 v[172:175], a[204:207], v[84:87], v[172:175]
  v_mfma_f32_16x16x32_bf16 v[176:179], a[208:211], v[84:87], v[176:179]
  v_mfma_f32_16x16x32_bf16 v[180:183], a[212:215], v[84:87], v[180:183]
  v_mfma_f32_16x16x32_bf16 v[184:187], a[216:219], v[84:87], v[184:187]
  v_mfma_f32_16x16x32_bf16 v[188:191], a[220:223], v[84:87], v[188:191]
  v_mfma_f32_16x16x32_bf16 v[192:195], a[192:195], v[88:91], v[192:195]
  v_mfma_f32_16x16x32_bf16 v[196:199], a[196:199], v[88:91], v[196:199]
  v_mfma_f32_16x16x32_bf16 v[200:203], a[200:203], v[88:91], v[200:203]
  v_mfma_f32_16x16x32_bf16 v[204:207], a[204:207], v[88:91], v[204:207]
  v_mfma_f32_16x16x32_bf16 v[208:211], a[208:211], v[88:91], v[208:211]
  v_mfma_f32_16x16x32_bf16 v[212:215], a[212:215], v[88:91], v[212:215]
  v_mfma_f32_16x16x32_bf16 v[216:219], a[216:219], v[88:91], v[216:219]
  v_mfma_f32_16x16x32_bf16 v[220:223], a[220:223], v[88:91], v[220:223]
  v_mfma_f32_16x16x32_bf16 v[224:227], a[192:195], v[92:95], v[224:227]
  v_mfma_f32_16x16x32_bf16 v[228:231], a[196:199], v[92:95], v[228:231]
  v_mfma_f32_16x16x32_bf16 v[232:235], a[200:203], v[92:95], v[232:235]
  v_mfma_f32_16x16x32_bf16 v[236:239], a[204:207], v[92:95], v[236:239]
  v_mfma_f32_16x16x32_bf16 v[240:243], a[208:211], v[92:95], v[240:243]
  v_mfma_f32_16x16x32_bf16 v[244:247], a[212:215], v[92:95], v[244:247]
  v_mfma_f32_16x16x32_bf16 v[248:251], a[216:219], v[92:95], v[248:251]
  v_mfma_f32_16x16x32_bf16 v[252:255], a[220:223], v[92:95], v[252:255]
  s_add_u32 s37, s37, 65536
  s_branch concat_heads__mha_block_cached__mha_block_cached__near_ridge_kernel_conv
concat_heads__mha_block_cached__mha_block_cached__near_ridge_kernel_final:
  s_cmp_eq_u32 s71, 0
  s_cbranch_scc0 concat_heads__mha_block_cached__mha_block_cached__near_ridge_kernel_t2
  s_add_u32 s39, s37, 0
  v_accvgpr_read_b32 v68, a0
  v_accvgpr_read_b32 v69, a1
  v_accvgpr_read_b32 v70, a2
  v_accvgpr_read_b32 v71, a3
  v_accvgpr_read_b32 v72, a4
  v_accvgpr_read_b32 v73, a5
  v_accvgpr_read_b32 v74, a6
  v_accvgpr_read_b32 v75, a7
  v_mul_f32 v68, v8, v68
  v_mul_f32 v69, v8, v69
  v_mul_f32 v70, v8, v70
  v_mul_f32 v71, v8, v71
  v_mul_f32 v72, v8, v72
  v_mul_f32 v73, v8, v73
  v_mul_f32 v74, v8, v74
  v_mul_f32 v75, v8, v75
  v_cvt_pk_bf16_f32 v76, v68, v69
  v_cvt_pk_bf16_f32 v77, v70, v71
  v_cvt_pk_bf16_f32 v78, v72, v73
  v_cvt_pk_bf16_f32 v79, v74, v75
  buffer_store_dwordx4 v[76:79], v66, s[20:23], s39 offen offset:0 sc1
  v_accvgpr_read_b32 v68, a8
  v_accvgpr_read_b32 v69, a9
  v_accvgpr_read_b32 v70, a10
  v_accvgpr_read_b32 v71, a11
  v_accvgpr_read_b32 v72, a12
  v_accvgpr_read_b32 v73, a13
  v_accvgpr_read_b32 v74, a14
  v_accvgpr_read_b32 v75, a15
  v_mul_f32 v68, v8, v68
  v_mul_f32 v69, v8, v69
  v_mul_f32 v70, v8, v70
  v_mul_f32 v71, v8, v71
  v_mul_f32 v72, v8, v72
  v_mul_f32 v73, v8, v73
  v_mul_f32 v74, v8, v74
  v_mul_f32 v75, v8, v75
  v_cvt_pk_bf16_f32 v80, v68, v69
  v_cvt_pk_bf16_f32 v81, v70, v71
  v_cvt_pk_bf16_f32 v82, v72, v73
  v_cvt_pk_bf16_f32 v83, v74, v75
  buffer_store_dwordx4 v[80:83], v66, s[20:23], s39 offen offset:1024 sc1
  v_accvgpr_read_b32 v68, a16
  v_accvgpr_read_b32 v69, a17
  v_accvgpr_read_b32 v70, a18
  v_accvgpr_read_b32 v71, a19
  v_accvgpr_read_b32 v72, a20
  v_accvgpr_read_b32 v73, a21
  v_accvgpr_read_b32 v74, a22
  v_accvgpr_read_b32 v75, a23
  v_mul_f32 v68, v8, v68
  v_mul_f32 v69, v8, v69
  v_mul_f32 v70, v8, v70
  v_mul_f32 v71, v8, v71
  v_mul_f32 v72, v8, v72
  v_mul_f32 v73, v8, v73
  v_mul_f32 v74, v8, v74
  v_mul_f32 v75, v8, v75
  v_cvt_pk_bf16_f32 v76, v68, v69
  v_cvt_pk_bf16_f32 v77, v70, v71
  v_cvt_pk_bf16_f32 v78, v72, v73
  v_cvt_pk_bf16_f32 v79, v74, v75
  buffer_store_dwordx4 v[76:79], v66, s[20:23], s39 offen offset:2048 sc1
  v_accvgpr_read_b32 v68, a24
  v_accvgpr_read_b32 v69, a25
  v_accvgpr_read_b32 v70, a26
  v_accvgpr_read_b32 v71, a27
  v_accvgpr_read_b32 v72, a28
  v_accvgpr_read_b32 v73, a29
  v_accvgpr_read_b32 v74, a30
  v_accvgpr_read_b32 v75, a31
  v_mul_f32 v68, v8, v68
  v_mul_f32 v69, v8, v69
  v_mul_f32 v70, v8, v70
  v_mul_f32 v71, v8, v71
  v_mul_f32 v72, v8, v72
  v_mul_f32 v73, v8, v73
  v_mul_f32 v74, v8, v74
  v_mul_f32 v75, v8, v75
  v_cvt_pk_bf16_f32 v80, v68, v69
  v_cvt_pk_bf16_f32 v81, v70, v71
  v_cvt_pk_bf16_f32 v82, v72, v73
  v_cvt_pk_bf16_f32 v83, v74, v75
  buffer_store_dwordx4 v[80:83], v66, s[20:23], s39 offen offset:3072 sc1
  s_add_u32 s39, s37, 131072
  v_accvgpr_read_b32 v68, a32
  v_accvgpr_read_b32 v69, a33
  v_accvgpr_read_b32 v70, a34
  v_accvgpr_read_b32 v71, a35
  v_accvgpr_read_b32 v72, a36
  v_accvgpr_read_b32 v73, a37
  v_accvgpr_read_b32 v74, a38
  v_accvgpr_read_b32 v75, a39
  v_mul_f32 v68, v9, v68
  v_mul_f32 v69, v9, v69
  v_mul_f32 v70, v9, v70
  v_mul_f32 v71, v9, v71
  v_mul_f32 v72, v9, v72
  v_mul_f32 v73, v9, v73
  v_mul_f32 v74, v9, v74
  v_mul_f32 v75, v9, v75
  v_cvt_pk_bf16_f32 v76, v68, v69
  v_cvt_pk_bf16_f32 v77, v70, v71
  v_cvt_pk_bf16_f32 v78, v72, v73
  v_cvt_pk_bf16_f32 v79, v74, v75
  buffer_store_dwordx4 v[76:79], v66, s[20:23], s39 offen offset:0 sc1
  v_accvgpr_read_b32 v68, a40
  v_accvgpr_read_b32 v69, a41
  v_accvgpr_read_b32 v70, a42
  v_accvgpr_read_b32 v71, a43
  v_accvgpr_read_b32 v72, a44
  v_accvgpr_read_b32 v73, a45
  v_accvgpr_read_b32 v74, a46
  v_accvgpr_read_b32 v75, a47
  v_mul_f32 v68, v9, v68
  v_mul_f32 v69, v9, v69
  v_mul_f32 v70, v9, v70
  v_mul_f32 v71, v9, v71
  v_mul_f32 v72, v9, v72
  v_mul_f32 v73, v9, v73
  v_mul_f32 v74, v9, v74
  v_mul_f32 v75, v9, v75
  v_cvt_pk_bf16_f32 v80, v68, v69
  v_cvt_pk_bf16_f32 v81, v70, v71
  v_cvt_pk_bf16_f32 v82, v72, v73
  v_cvt_pk_bf16_f32 v83, v74, v75
  buffer_store_dwordx4 v[80:83], v66, s[20:23], s39 offen offset:1024 sc1
  v_accvgpr_read_b32 v68, a48
  v_accvgpr_read_b32 v69, a49
  v_accvgpr_read_b32 v70, a50
  v_accvgpr_read_b32 v71, a51
  v_accvgpr_read_b32 v72, a52
  v_accvgpr_read_b32 v73, a53
  v_accvgpr_read_b32 v74, a54
  v_accvgpr_read_b32 v75, a55
  v_mul_f32 v68, v9, v68
  v_mul_f32 v69, v9, v69
  v_mul_f32 v70, v9, v70
  v_mul_f32 v71, v9, v71
  v_mul_f32 v72, v9, v72
  v_mul_f32 v73, v9, v73
  v_mul_f32 v74, v9, v74
  v_mul_f32 v75, v9, v75
  v_cvt_pk_bf16_f32 v76, v68, v69
  v_cvt_pk_bf16_f32 v77, v70, v71
  v_cvt_pk_bf16_f32 v78, v72, v73
  v_cvt_pk_bf16_f32 v79, v74, v75
  buffer_store_dwordx4 v[76:79], v66, s[20:23], s39 offen offset:2048 sc1
  v_accvgpr_read_b32 v68, a56
  v_accvgpr_read_b32 v69, a57
  v_accvgpr_read_b32 v70, a58
  v_accvgpr_read_b32 v71, a59
  v_accvgpr_read_b32 v72, a60
  v_accvgpr_read_b32 v73, a61
  v_accvgpr_read_b32 v74, a62
  v_accvgpr_read_b32 v75, a63
  v_mul_f32 v68, v9, v68
  v_mul_f32 v69, v9, v69
  v_mul_f32 v70, v9, v70
  v_mul_f32 v71, v9, v71
  v_mul_f32 v72, v9, v72
  v_mul_f32 v73, v9, v73
  v_mul_f32 v74, v9, v74
  v_mul_f32 v75, v9, v75
  v_cvt_pk_bf16_f32 v80, v68, v69
  v_cvt_pk_bf16_f32 v81, v70, v71
  v_cvt_pk_bf16_f32 v82, v72, v73
  v_cvt_pk_bf16_f32 v83, v74, v75
  buffer_store_dwordx4 v[80:83], v66, s[20:23], s39 offen offset:3072 sc1
  s_add_u32 s39, s37, 262144
  v_accvgpr_read_b32 v68, a64
  v_accvgpr_read_b32 v69, a65
  v_accvgpr_read_b32 v70, a66
  v_accvgpr_read_b32 v71, a67
  v_accvgpr_read_b32 v72, a68
  v_accvgpr_read_b32 v73, a69
  v_accvgpr_read_b32 v74, a70
  v_accvgpr_read_b32 v75, a71
  v_mul_f32 v68, v10, v68
  v_mul_f32 v69, v10, v69
  v_mul_f32 v70, v10, v70
  v_mul_f32 v71, v10, v71
  v_mul_f32 v72, v10, v72
  v_mul_f32 v73, v10, v73
  v_mul_f32 v74, v10, v74
  v_mul_f32 v75, v10, v75
  v_cvt_pk_bf16_f32 v76, v68, v69
  v_cvt_pk_bf16_f32 v77, v70, v71
  v_cvt_pk_bf16_f32 v78, v72, v73
  v_cvt_pk_bf16_f32 v79, v74, v75
  buffer_store_dwordx4 v[76:79], v66, s[20:23], s39 offen offset:0 sc1
  v_accvgpr_read_b32 v68, a72
  v_accvgpr_read_b32 v69, a73
  v_accvgpr_read_b32 v70, a74
  v_accvgpr_read_b32 v71, a75
  v_accvgpr_read_b32 v72, a76
  v_accvgpr_read_b32 v73, a77
  v_accvgpr_read_b32 v74, a78
  v_accvgpr_read_b32 v75, a79
  v_mul_f32 v68, v10, v68
  v_mul_f32 v69, v10, v69
  v_mul_f32 v70, v10, v70
  v_mul_f32 v71, v10, v71
  v_mul_f32 v72, v10, v72
  v_mul_f32 v73, v10, v73
  v_mul_f32 v74, v10, v74
  v_mul_f32 v75, v10, v75
  v_cvt_pk_bf16_f32 v80, v68, v69
  v_cvt_pk_bf16_f32 v81, v70, v71
  v_cvt_pk_bf16_f32 v82, v72, v73
  v_cvt_pk_bf16_f32 v83, v74, v75
  buffer_store_dwordx4 v[80:83], v66, s[20:23], s39 offen offset:1024 sc1
  v_accvgpr_read_b32 v68, a80
  v_accvgpr_read_b32 v69, a81
  v_accvgpr_read_b32 v70, a82
  v_accvgpr_read_b32 v71, a83
  v_accvgpr_read_b32 v72, a84
  v_accvgpr_read_b32 v73, a85
  v_accvgpr_read_b32 v74, a86
  v_accvgpr_read_b32 v75, a87
  v_mul_f32 v68, v10, v68
  v_mul_f32 v69, v10, v69
  v_mul_f32 v70, v10, v70
  v_mul_f32 v71, v10, v71
  v_mul_f32 v72, v10, v72
  v_mul_f32 v73, v10, v73
  v_mul_f32 v74, v10, v74
  v_mul_f32 v75, v10, v75
  v_cvt_pk_bf16_f32 v76, v68, v69
  v_cvt_pk_bf16_f32 v77, v70, v71
  v_cvt_pk_bf16_f32 v78, v72, v73
  v_cvt_pk_bf16_f32 v79, v74, v75
  buffer_store_dwordx4 v[76:79], v66, s[20:23], s39 offen offset:2048 sc1
  v_accvgpr_read_b32 v68, a88
  v_accvgpr_read_b32 v69, a89
  v_accvgpr_read_b32 v70, a90
  v_accvgpr_read_b32 v71, a91
  v_accvgpr_read_b32 v72, a92
  v_accvgpr_read_b32 v73, a93
  v_accvgpr_read_b32 v74, a94
  v_accvgpr_read_b32 v75, a95
  v_mul_f32 v68, v10, v68
  v_mul_f32 v69, v10, v69
  v_mul_f32 v70, v10, v70
  v_mul_f32 v71, v10, v71
  v_mul_f32 v72, v10, v72
  v_mul_f32 v73, v10, v73
  v_mul_f32 v74, v10, v74
  v_mul_f32 v75, v10, v75
  v_cvt_pk_bf16_f32 v80, v68, v69
  v_cvt_pk_bf16_f32 v81, v70, v71
  v_cvt_pk_bf16_f32 v82, v72, v73
  v_cvt_pk_bf16_f32 v83, v74, v75
  buffer_store_dwordx4 v[80:83], v66, s[20:23], s39 offen offset:3072 sc1
  s_add_u32 s39, s37, 393216
  v_accvgpr_read_b32 v68, a96
  v_accvgpr_read_b32 v69, a97
  v_accvgpr_read_b32 v70, a98
  v_accvgpr_read_b32 v71, a99
  v_accvgpr_read_b32 v72, a100
  v_accvgpr_read_b32 v73, a101
  v_accvgpr_read_b32 v74, a102
  v_accvgpr_read_b32 v75, a103
  v_mul_f32 v68, v11, v68
  v_mul_f32 v69, v11, v69
  v_mul_f32 v70, v11, v70
  v_mul_f32 v71, v11, v71
  v_mul_f32 v72, v11, v72
  v_mul_f32 v73, v11, v73
  v_mul_f32 v74, v11, v74
  v_mul_f32 v75, v11, v75
  v_cvt_pk_bf16_f32 v76, v68, v69
  v_cvt_pk_bf16_f32 v77, v70, v71
  v_cvt_pk_bf16_f32 v78, v72, v73
  v_cvt_pk_bf16_f32 v79, v74, v75
  buffer_store_dwordx4 v[76:79], v66, s[20:23], s39 offen offset:0 sc1
  v_accvgpr_read_b32 v68, a104
  v_accvgpr_read_b32 v69, a105
  v_accvgpr_read_b32 v70, a106
  v_accvgpr_read_b32 v71, a107
  v_accvgpr_read_b32 v72, a108
  v_accvgpr_read_b32 v73, a109
  v_accvgpr_read_b32 v74, a110
  v_accvgpr_read_b32 v75, a111
  v_mul_f32 v68, v11, v68
  v_mul_f32 v69, v11, v69
  v_mul_f32 v70, v11, v70
  v_mul_f32 v71, v11, v71
  v_mul_f32 v72, v11, v72
  v_mul_f32 v73, v11, v73
  v_mul_f32 v74, v11, v74
  v_mul_f32 v75, v11, v75
  v_cvt_pk_bf16_f32 v80, v68, v69
  v_cvt_pk_bf16_f32 v81, v70, v71
  v_cvt_pk_bf16_f32 v82, v72, v73
  v_cvt_pk_bf16_f32 v83, v74, v75
  buffer_store_dwordx4 v[80:83], v66, s[20:23], s39 offen offset:1024 sc1
  v_accvgpr_read_b32 v68, a112
  v_accvgpr_read_b32 v69, a113
  v_accvgpr_read_b32 v70, a114
  v_accvgpr_read_b32 v71, a115
  v_accvgpr_read_b32 v72, a116
  v_accvgpr_read_b32 v73, a117
  v_accvgpr_read_b32 v74, a118
  v_accvgpr_read_b32 v75, a119
  v_mul_f32 v68, v11, v68
  v_mul_f32 v69, v11, v69
  v_mul_f32 v70, v11, v70
  v_mul_f32 v71, v11, v71
  v_mul_f32 v72, v11, v72
  v_mul_f32 v73, v11, v73
  v_mul_f32 v74, v11, v74
  v_mul_f32 v75, v11, v75
  v_cvt_pk_bf16_f32 v76, v68, v69
  v_cvt_pk_bf16_f32 v77, v70, v71
  v_cvt_pk_bf16_f32 v78, v72, v73
  v_cvt_pk_bf16_f32 v79, v74, v75
  buffer_store_dwordx4 v[76:79], v66, s[20:23], s39 offen offset:2048 sc1
  v_accvgpr_read_b32 v68, a120
  v_accvgpr_read_b32 v69, a121
  v_accvgpr_read_b32 v70, a122
  v_accvgpr_read_b32 v71, a123
  v_accvgpr_read_b32 v72, a124
  v_accvgpr_read_b32 v73, a125
  v_accvgpr_read_b32 v74, a126
  v_accvgpr_read_b32 v75, a127
  v_mul_f32 v68, v11, v68
  v_mul_f32 v69, v11, v69
  v_mul_f32 v70, v11, v70
  v_mul_f32 v71, v11, v71
  v_mul_f32 v72, v11, v72
  v_mul_f32 v73, v11, v73
  v_mul_f32 v74, v11, v74
  v_mul_f32 v75, v11, v75
  v_cvt_pk_bf16_f32 v80, v68, v69
  v_cvt_pk_bf16_f32 v81, v70, v71
  v_cvt_pk_bf16_f32 v82, v72, v73
  v_cvt_pk_bf16_f32 v83, v74, v75
  buffer_store_dwordx4 v[80:83], v66, s[20:23], s39 offen offset:3072 sc1
  s_add_u32 s39, s37, 524288
  v_accvgpr_read_b32 v68, a128
  v_accvgpr_read_b32 v69, a129
  v_accvgpr_read_b32 v70, a130
  v_accvgpr_read_b32 v71, a131
  v_accvgpr_read_b32 v72, a132
  v_accvgpr_read_b32 v73, a133
  v_accvgpr_read_b32 v74, a134
  v_accvgpr_read_b32 v75, a135
  v_mul_f32 v68, v12, v68
  v_mul_f32 v69, v12, v69
  v_mul_f32 v70, v12, v70
  v_mul_f32 v71, v12, v71
  v_mul_f32 v72, v12, v72
  v_mul_f32 v73, v12, v73
  v_mul_f32 v74, v12, v74
  v_mul_f32 v75, v12, v75
  v_cvt_pk_bf16_f32 v76, v68, v69
  v_cvt_pk_bf16_f32 v77, v70, v71
  v_cvt_pk_bf16_f32 v78, v72, v73
  v_cvt_pk_bf16_f32 v79, v74, v75
  buffer_store_dwordx4 v[76:79], v66, s[20:23], s39 offen offset:0 sc1
  v_accvgpr_read_b32 v68, a136
  v_accvgpr_read_b32 v69, a137
  v_accvgpr_read_b32 v70, a138
  v_accvgpr_read_b32 v71, a139
  v_accvgpr_read_b32 v72, a140
  v_accvgpr_read_b32 v73, a141
  v_accvgpr_read_b32 v74, a142
  v_accvgpr_read_b32 v75, a143
  v_mul_f32 v68, v12, v68
  v_mul_f32 v69, v12, v69
  v_mul_f32 v70, v12, v70
  v_mul_f32 v71, v12, v71
  v_mul_f32 v72, v12, v72
  v_mul_f32 v73, v12, v73
  v_mul_f32 v74, v12, v74
  v_mul_f32 v75, v12, v75
  v_cvt_pk_bf16_f32 v80, v68, v69
  v_cvt_pk_bf16_f32 v81, v70, v71
  v_cvt_pk_bf16_f32 v82, v72, v73
  v_cvt_pk_bf16_f32 v83, v74, v75
  buffer_store_dwordx4 v[80:83], v66, s[20:23], s39 offen offset:1024 sc1
  v_accvgpr_read_b32 v68, a144
  v_accvgpr_read_b32 v69, a145
  v_accvgpr_read_b32 v70, a146
  v_accvgpr_read_b32 v71, a147
  v_accvgpr_read_b32 v72, a148
  v_accvgpr_read_b32 v73, a149
  v_accvgpr_read_b32 v74, a150
  v_accvgpr_read_b32 v75, a151
  v_mul_f32 v68, v12, v68
  v_mul_f32 v69, v12, v69
  v_mul_f32 v70, v12, v70
  v_mul_f32 v71, v12, v71
  v_mul_f32 v72, v12, v72
  v_mul_f32 v73, v12, v73
  v_mul_f32 v74, v12, v74
  v_mul_f32 v75, v12, v75
  v_cvt_pk_bf16_f32 v76, v68, v69
  v_cvt_pk_bf16_f32 v77, v70, v71
  v_cvt_pk_bf16_f32 v78, v72, v73
  v_cvt_pk_bf16_f32 v79, v74, v75
  buffer_store_dwordx4 v[76:79], v66, s[20:23], s39 offen offset:2048 sc1
  v_accvgpr_read_b32 v68, a152
  v_accvgpr_read_b32 v69, a153
  v_accvgpr_read_b32 v70, a154
  v_accvgpr_read_b32 v71, a155
  v_accvgpr_read_b32 v72, a156
  v_accvgpr_read_b32 v73, a157
  v_accvgpr_read_b32 v74, a158
  v_accvgpr_read_b32 v75, a159
  v_mul_f32 v68, v12, v68
  v_mul_f32 v69, v12, v69
  v_mul_f32 v70, v12, v70
  v_mul_f32 v71, v12, v71
  v_mul_f32 v72, v12, v72
  v_mul_f32 v73, v12, v73
  v_mul_f32 v74, v12, v74
  v_mul_f32 v75, v12, v75
  v_cvt_pk_bf16_f32 v80, v68, v69
  v_cvt_pk_bf16_f32 v81, v70, v71
  v_cvt_pk_bf16_f32 v82, v72, v73
  v_cvt_pk_bf16_f32 v83, v74, v75
  buffer_store_dwordx4 v[80:83], v66, s[20:23], s39 offen offset:3072 sc1
  s_waitcnt vmcnt(0)
  s_barrier
  s_cmp_eq_u32 s24, 0
  s_cbranch_scc0 concat_heads__mha_block_cached__mha_block_cached__near_ridge_kernel_sg2
  s_lshl_b32 s87, s66, 1
  s_add_u32 s87, s87, 1
  s_lshl_b32 s87, s87, 4
  v_mov_b32 v1, 1
  v_mov_b32 v2, s87
  s_mov_b64 exec, 1
  buffer_atomic_add v1, v2, s[76:79], 0 offen sc1
  s_mov_b64 exec, -1
concat_heads__mha_block_cached__mha_block_cached__near_ridge_kernel_sg2:
  s_branch concat_heads__mha_block_cached__mha_block_cached__near_ridge_kernel_exit
concat_heads__mha_block_cached__mha_block_cached__near_ridge_kernel_t2:
  s_lshl_b32 s87, s66, 5
  v_mov_b32 v2, s87
  buffer_load_dword v1, v2, s[76:79], 0 offen sc1
  s_waitcnt vmcnt(0)
  v_readfirstlane_b32 s87, v1
  s_nop 3
  s_cmp_ge_u32 s87, 32
  s_cbranch_scc0 concat_heads__mha_block_cached__mha_block_cached__near_ridge_kernel_t2poll
  s_barrier
  s_branch concat_heads__mha_block_cached__mha_block_cached__near_ridge_kernel_t2go
concat_heads__mha_block_cached__mha_block_cached__near_ridge_kernel_t2poll:
  s_cmp_eq_u32 s24, 0
  s_cbranch_scc0 concat_heads__mha_block_cached__mha_block_cached__near_ridge_kernel_wi3_x
  s_lshl_b32 s87, s66, 1
  s_add_u32 s87, s87, 0
  s_lshl_b32 s87, s87, 4
  v_mov_b32 v2, s87
  s_mov_b32 s86, 400000
concat_heads__mha_block_cached__mha_block_cached__near_ridge_kernel_wi3:
  buffer_load_dword v1, v2, s[76:79], 0 offen sc1
  s_waitcnt vmcnt(0)
  v_readfirstlane_b32 s87, v1
  s_nop 3
  s_cmp_ge_u32 s87, 32
  s_cbranch_scc1 concat_heads__mha_block_cached__mha_block_cached__near_ridge_kernel_wi3_x
  s_sleep 2
  s_sub_u32 s86, s86, 1
  s_cmp_lg_u32 s86, 0
  s_cbranch_scc1 concat_heads__mha_block_cached__mha_block_cached__near_ridge_kernel_wi3
concat_heads__mha_block_cached__mha_block_cached__near_ridge_kernel_wi3_x:
  s_barrier
concat_heads__mha_block_cached__mha_block_cached__near_ridge_kernel_t2go:
  s_mul_i32 s90, s67, 52
  s_lshr_b32 s90, s90, 8
  s_mul_i32 s91, s90, 5
  s_sub_u32 s91, s67, s91
  s_and_b32 s92, s66, 3
  s_mul_i32 s92, s92, 5
  s_add_u32 s92, s92, s90
  s_lshl_b32 s92, s92, 2
  s_add_u32 s92, s92, s24
  s_mul_i32 s93, s68, 160
  s_lshl_b32 s94, s92, 1
  s_add_u32 s93, s93, s94
  s_lshl_b32 s93, s93, 17
  s_add_u32 s12, s60, s93
  s_addc_u32 s13, s61, 0
  s_and_b32 s13, s13, 0xffff
  s_mov_b32 s14, 65536
  s_mov_b32 s15, 0x20000
  s_add_u32 s93, s93, 131072
  s_add_u32 s4, s60, s93
  s_addc_u32 s5, s61, 0
  s_and_b32 s5, s5, 0xffff
  s_mov_b32 s6, 65536
  s_mov_b32 s7, 0x20000
  s_lshl_b32 s93, s91, 8
  s_add_u32 s16, s62, s93
  s_addc_u32 s17, s63, 0
  s_and_b32 s17, s17, 0xffff
  s_sub_u32 s18, 5242880, s93
  s_mov_b32 s19, 0x20000
  s_mul_i32 s85, s92, 81920
  s_mul_i32 s90, s68, 1280
  s_add_u32 s85, s85, s90
  s_add_u32 s85, s85, s93
  s_lshl_b32 s80, s24, 13
  v_lshrrev_b32 v2, 4, v66
  v_lshrrev_b32 v3, 4, v2
  v_and_b32 v4, 15, v2
  v_add_u32 v5, 0, v3
  v_lshlrev_b32 v5, 1, v5
  v_xor_b32 v5, v5, v4
  v_lshlrev_b32 v5, 4, v5
  v_mul_u32_u24 v6, 1280, v3
  v_add_u32 v164, v6, v5
  v_add_u32 v5, 4, v3
  v_lshlrev_b32 v5, 1, v5
  v_xor_b32 v5, v5, v4
  v_lshlrev_b32 v5, 4, v5
  v_mul_u32_u24 v6, 1280, v3
  v_add_u32 v165, v6, v5
  v_lshrrev_b32 v3, 2, v2
  v_lshlrev_b32 v4, 8, v3
  v_and_b32 v5, 2, v2
  v_lshlrev_b32 v5, 3, v5
  v_add_u32 v4, v4, v5
  v_and_b32 v5, 1, v2
  v_lshlrev_b32 v5, 3, v5
  v_add_u32 v4, v4, v5
  v_and_b32 v3, 7, v3
  v_xor_b32 v5, 0, v3
  v_lshlrev_b32 v5, 5, v5
  v_add_u32 v148, v4, v5
  v_add_u32 v156, 0x10000, v148
  v_xor_b32 v5, 1, v3
  v_lshlrev_b32 v5, 5, v5
  v_add_u32 v149, v4, v5
  v_add_u32 v157, 0x10000, v149
  v_xor_b32 v5, 2, v3
  v_lshlrev_b32 v5, 5, v5
  v_add_u32 v150, v4, v5
  v_add_u32 v158, 0x10000, v150
  v_xor_b32 v5, 3, v3
  v_lshlrev_b32 v5, 5, v5
  v_add_u32 v151, v4, v5
  v_add_u32 v159, 0x10000, v151
  v_xor_b32 v5, 4, v3
  v_lshlrev_b32 v5, 5, v5
  v_add_u32 v152, v4, v5
  v_add_u32 v160, 0x10000, v152
  v_xor_b32 v5, 5, v3
  v_lshlrev_b32 v5, 5, v5
  v_add_u32 v153, v4, v5
  v_add_u32 v161, 0x10000, v153
  v_xor_b32 v5, 6, v3
  v_lshlrev_b32 v5, 5, v5
  v_add_u32 v154, v4, v5
  v_add_u32 v162, 0x10000, v154
  v_xor_b32 v5, 7, v3
  v_lshlrev_b32 v5, 5, v5
  v_add_u32 v155, v4, v5
  v_add_u32 v163, 0x10000, v155
  v_and_b32 v3, 15, v2
  v_mul_u32_u24 v3, 2560, v3
  v_lshrrev_b32 v4, 4, v2
  v_and_b32 v4, 1, v4
  v_lshlrev_b32 v4, 5, v4
  v_add_u32 v3, v3, v4
  v_lshrrev_b32 v4, 5, v2
  v_lshlrev_b32 v4, 4, v4
  v_add_u32 v166, v3, v4
  s_mul_i32 s81, s24, 40960
  s_mov_b32 s82, 0
  s_add_u32 m0, s80, 0
  s_nop 0
  buffer_load_dwordx4 v164, s[16:19], s81 offen lds
  s_add_u32 m0, s80, 1024
  s_add_u32 s84, s81, 5120
  buffer_load_dwordx4 v165, s[16:19], s84 offen lds
  s_add_u32 m0, s80, 2048
  s_add_u32 s84, s81, 10240
  buffer_load_dwordx4 v164, s[16:19], s84 offen lds
  s_add_u32 m0, s80, 3072
  s_add_u32 s84, s81, 15360
  buffer_load_dwordx4 v165, s[16:19], s84 offen lds
  s_add_u32 m0, s80, 4096
  s_add_u32 s84, s81, 20480
  buffer_load_dwordx4 v164, s[16:19], s84 offen lds
  s_add_u32 m0, s80, 5120
  s_add_u32 s84, s81, 25600
  buffer_load_dwordx4 v165, s[16:19], s84 offen lds
  s_add_u32 m0, s80, 6144
  s_add_u32 s84, s81, 30720
  buffer_load_dwordx4 v164, s[16:19], s84 offen lds
  s_add_u32 m0, s80, 7168
  s_add_u32 s84, s81, 35840
  buffer_load_dwordx4 v165, s[16:19], s84 offen lds
  s_add_u32 s81, s81, 163840
  s_add_u32 m0, s80, 32768
  s_nop 0
  buffer_load_dwordx4 v164, s[16:19], s81 offen lds
  s_add_u32 m0, s80, 33792
  s_add_u32 s84, s81, 5120
  buffer_load_dwordx4 v165, s[16:19], s84 offen lds
  s_add_u32 m0, s80, 34816
  s_add_u32 s84, s81, 10240
  buffer_load_dwordx4 v164, s[16:19], s84 offen lds
  s_add_u32 m0, s80, 35840
  s_add_u32 s84, s81, 15360
  buffer_load_dwordx4 v165, s[16:19], s84 offen lds
  s_add_u32 m0, s80, 36864
  s_add_u32 s84, s81, 20480
  buffer_load_dwordx4 v164, s[16:19], s84 offen lds
  s_add_u32 m0, s80, 37888
  s_add_u32 s84, s81, 25600
  buffer_load_dwordx4 v165, s[16:19], s84 offen lds
  s_add_u32 m0, s80, 38912
  s_add_u32 s84, s81, 30720
  buffer_load_dwordx4 v164, s[16:19], s84 offen lds
  s_add_u32 m0, s80, 39936
  s_add_u32 s84, s81, 35840
  buffer_load_dwordx4 v165, s[16:19], s84 offen lds
  s_add_u32 s81, s81, 163840
  s_add_u32 s39, s37, 262144
  v_accvgpr_read_b32 v68, a64
  v_accvgpr_read_b32 v69, a65
  v_accvgpr_read_b32 v70, a66
  v_accvgpr_read_b32 v71, a67
  v_accvgpr_read_b32 v72, a68
  v_accvgpr_read_b32 v73, a69
  v_accvgpr_read_b32 v74, a70
  v_accvgpr_read_b32 v75, a71
  v_mul_f32 v68, v10, v68
  v_mul_f32 v69, v10, v69
  v_mul_f32 v70, v10, v70
  v_mul_f32 v71, v10, v71
  v_mul_f32 v72, v10, v72
  v_mul_f32 v73, v10, v73
  v_mul_f32 v74, v10, v74
  v_mul_f32 v75, v10, v75
  v_cvt_pk_bf16_f32 v76, v68, v69
  v_cvt_pk_bf16_f32 v77, v70, v71
  v_cvt_pk_bf16_f32 v78, v72, v73
  v_cvt_pk_bf16_f32 v79, v74, v75
  buffer_store_dwordx4 v[76:79], v66, s[20:23], s39 offen offset:0 sc1
  v_accvgpr_read_b32 v68, a72
  v_accvgpr_read_b32 v69, a73
  v_accvgpr_read_b32 v70, a74
  v_accvgpr_read_b32 v71, a75
  v_accvgpr_read_b32 v72, a76
  v_accvgpr_read_b32 v73, a77
  v_accvgpr_read_b32 v74, a78
  v_accvgpr_read_b32 v75, a79
  v_mul_f32 v68, v10, v68
  v_mul_f32 v69, v10, v69
  v_mul_f32 v70, v10, v70
  v_mul_f32 v71, v10, v71
  v_mul_f32 v72, v10, v72
  v_mul_f32 v73, v10, v73
  v_mul_f32 v74, v10, v74
  v_mul_f32 v75, v10, v75
  v_cvt_pk_bf16_f32 v80, v68, v69
  v_cvt_pk_bf16_f32 v81, v70, v71
  v_cvt_pk_bf16_f32 v82, v72, v73
  v_cvt_pk_bf16_f32 v83, v74, v75
  buffer_store_dwordx4 v[80:83], v66, s[20:23], s39 offen offset:1024 sc1
  v_accvgpr_read_b32 v68, a80
  v_accvgpr_read_b32 v69, a81
  v_accvgpr_read_b32 v70, a82
  v_accvgpr_read_b32 v71, a83
  v_accvgpr_read_b32 v72, a84
  v_accvgpr_read_b32 v73, a85
  v_accvgpr_read_b32 v74, a86
  v_accvgpr_read_b32 v75, a87
  v_mul_f32 v68, v10, v68
  v_mul_f32 v69, v10, v69
  v_mul_f32 v70, v10, v70
  v_mul_f32 v71, v10, v71
  v_mul_f32 v72, v10, v72
  v_mul_f32 v73, v10, v73
  v_mul_f32 v74, v10, v74
  v_mul_f32 v75, v10, v75
  v_cvt_pk_bf16_f32 v76, v68, v69
  v_cvt_pk_bf16_f32 v77, v70, v71
  v_cvt_pk_bf16_f32 v78, v72, v73
  v_cvt_pk_bf16_f32 v79, v74, v75
  buffer_store_dwordx4 v[76:79], v66, s[20:23], s39 offen offset:2048 sc1
  v_accvgpr_read_b32 v68, a88
  v_accvgpr_read_b32 v69, a89
  v_accvgpr_read_b32 v70, a90
  v_accvgpr_read_b32 v71, a91
  v_accvgpr_read_b32 v72, a92
  v_accvgpr_read_b32 v73, a93
  v_accvgpr_read_b32 v74, a94
  v_accvgpr_read_b32 v75, a95
  v_mul_f32 v68, v10, v68
  v_mul_f32 v69, v10, v69
  v_mul_f32 v70, v10, v70
  v_mul_f32 v71, v10, v71
  v_mul_f32 v72, v10, v72
  v_mul_f32 v73, v10, v73
  v_mul_f32 v74, v10, v74
  v_mul_f32 v75, v10, v75
  v_cvt_pk_bf16_f32 v80, v68, v69
  v_cvt_pk_bf16_f32 v81, v70, v71
  v_cvt_pk_bf16_f32 v82, v72, v73
  v_cvt_pk_bf16_f32 v83, v74, v75
  buffer_store_dwordx4 v[80:83], v66, s[20:23], s39 offen offset:3072 sc1
  s_add_u32 s39, s37, 393216
  v_accvgpr_read_b32 v68, a96
  v_accvgpr_read_b32 v69, a97
  v_accvgpr_read_b32 v70, a98
  v_accvgpr_read_b32 v71, a99
  v_accvgpr_read_b32 v72, a100
  v_accvgpr_read_b32 v73, a101
  v_accvgpr_read_b32 v74, a102
  v_accvgpr_read_b32 v75, a103
  v_mul_f32 v68, v11, v68
  v_mul_f32 v69, v11, v69
  v_mul_f32 v70, v11, v70
  v_mul_f32 v71, v11, v71
  v_mul_f32 v72, v11, v72
  v_mul_f32 v73, v11, v73
  v_mul_f32 v74, v11, v74
  v_mul_f32 v75, v11, v75
  v_cvt_pk_bf16_f32 v76, v68, v69
  v_cvt_pk_bf16_f32 v77, v70, v71
  v_cvt_pk_bf16_f32 v78, v72, v73
  v_cvt_pk_bf16_f32 v79, v74, v75
  buffer_store_dwordx4 v[76:79], v66, s[20:23], s39 offen offset:0 sc1
  v_accvgpr_read_b32 v68, a104
  v_accvgpr_read_b32 v69, a105
  v_accvgpr_read_b32 v70, a106
  v_accvgpr_read_b32 v71, a107
  v_accvgpr_read_b32 v72, a108
  v_accvgpr_read_b32 v73, a109
  v_accvgpr_read_b32 v74, a110
  v_accvgpr_read_b32 v75, a111
  v_mul_f32 v68, v11, v68
  v_mul_f32 v69, v11, v69
  v_mul_f32 v70, v11, v70
  v_mul_f32 v71, v11, v71
  v_mul_f32 v72, v11, v72
  v_mul_f32 v73, v11, v73
  v_mul_f32 v74, v11, v74
  v_mul_f32 v75, v11, v75
  v_cvt_pk_bf16_f32 v80, v68, v69
  v_cvt_pk_bf16_f32 v81, v70, v71
  v_cvt_pk_bf16_f32 v82, v72, v73
  v_cvt_pk_bf16_f32 v83, v74, v75
  buffer_store_dwordx4 v[80:83], v66, s[20:23], s39 offen offset:1024 sc1
  v_accvgpr_read_b32 v68, a112
  v_accvgpr_read_b32 v69, a113
  v_accvgpr_read_b32 v70, a114
  v_accvgpr_read_b32 v71, a115
  v_accvgpr_read_b32 v72, a116
  v_accvgpr_read_b32 v73, a117
  v_accvgpr_read_b32 v74, a118
  v_accvgpr_read_b32 v75, a119
  v_mul_f32 v68, v11, v68
  v_mul_f32 v69, v11, v69
  v_mul_f32 v70, v11, v70
  v_mul_f32 v71, v11, v71
  v_mul_f32 v72, v11, v72
  v_mul_f32 v73, v11, v73
  v_mul_f32 v74, v11, v74
  v_mul_f32 v75, v11, v75
  v_cvt_pk_bf16_f32 v76, v68, v69
  v_cvt_pk_bf16_f32 v77, v70, v71
  v_cvt_pk_bf16_f32 v78, v72, v73
  v_cvt_pk_bf16_f32 v79, v74, v75
  buffer_store_dwordx4 v[76:79], v66, s[20:23], s39 offen offset:2048 sc1
  v_accvgpr_read_b32 v68, a120
  v_accvgpr_read_b32 v69, a121
  v_accvgpr_read_b32 v70, a122
  v_accvgpr_read_b32 v71, a123
  v_accvgpr_read_b32 v72, a124
  v_accvgpr_read_b32 v73, a125
  v_accvgpr_read_b32 v74, a126
  v_accvgpr_read_b32 v75, a127
  v_mul_f32 v68, v11, v68
  v_mul_f32 v69, v11, v69
  v_mul_f32 v70, v11, v70
  v_mul_f32 v71, v11, v71
  v_mul_f32 v72, v11, v72
  v_mul_f32 v73, v11, v73
  v_mul_f32 v74, v11, v74
  v_mul_f32 v75, v11, v75
  v_cvt_pk_bf16_f32 v80, v68, v69
  v_cvt_pk_bf16_f32 v81, v70, v71
  v_cvt_pk_bf16_f32 v82, v72, v73
  v_cvt_pk_bf16_f32 v83, v74, v75
  buffer_store_dwordx4 v[80:83], v66, s[20:23], s39 offen offset:3072 sc1
  s_nop 1
  buffer_load_dwordx4 a[64:67], v66, s[12:15], s82 offen offset:0 sc1
  buffer_load_dwordx4 a[68:71], v66, s[4:7], s82 offen offset:0 sc1
  buffer_load_dwordx4 a[72:75], v66, s[12:15], s82 offen offset:1024 sc1
  buffer_load_dwordx4 a[76:79], v66, s[4:7], s82 offen offset:1024 sc1
  buffer_load_dwordx4 a[80:83], v66, s[12:15], s82 offen offset:2048 sc1
  buffer_load_dwordx4 a[84:87], v66, s[4:7], s82 offen offset:2048 sc1
  buffer_load_dwordx4 a[88:91], v66, s[12:15], s82 offen offset:3072 sc1
  buffer_load_dwordx4 a[92:95], v66, s[4:7], s82 offen offset:3072 sc1
  s_add_u32 s82, s82, 4096
  buffer_load_dwordx4 a[96:99], v66, s[12:15], s82 offen offset:0 sc1
  buffer_load_dwordx4 a[100:103], v66, s[4:7], s82 offen offset:0 sc1
  buffer_load_dwordx4 a[104:107], v66, s[12:15], s82 offen offset:1024 sc1
  buffer_load_dwordx4 a[108:111], v66, s[4:7], s82 offen offset:1024 sc1
  buffer_load_dwordx4 a[112:115], v66, s[12:15], s82 offen offset:2048 sc1
  buffer_load_dwordx4 a[116:119], v66, s[4:7], s82 offen offset:2048 sc1
  buffer_load_dwordx4 a[120:123], v66, s[12:15], s82 offen offset:3072 sc1
  buffer_load_dwordx4 a[124:127], v66, s[4:7], s82 offen offset:3072 sc1
  s_add_u32 s82, s82, 4096
  s_add_u32 s39, s37, 524288
  v_accvgpr_read_b32 v68, a128
  v_accvgpr_read_b32 v69, a129
  v_accvgpr_read_b32 v70, a130
  v_accvgpr_read_b32 v71, a131
  v_accvgpr_read_b32 v72, a132
  v_accvgpr_read_b32 v73, a133
  v_accvgpr_read_b32 v74, a134
  v_accvgpr_read_b32 v75, a135
  v_mul_f32 v68, v12, v68
  v_mul_f32 v69, v12, v69
  v_mul_f32 v70, v12, v70
  v_mul_f32 v71, v12, v71
  v_mul_f32 v72, v12, v72
  v_mul_f32 v73, v12, v73
  v_mul_f32 v74, v12, v74
  v_mul_f32 v75, v12, v75
  v_cvt_pk_bf16_f32 v76, v68, v69
  v_cvt_pk_bf16_f32 v77, v70, v71
  v_cvt_pk_bf16_f32 v78, v72, v73
  v_cvt_pk_bf16_f32 v79, v74, v75
  buffer_store_dwordx4 v[76:79], v66, s[20:23], s39 offen offset:0 sc1
  v_accvgpr_read_b32 v68, a136
  v_accvgpr_read_b32 v69, a137
  v_accvgpr_read_b32 v70, a138
  v_accvgpr_read_b32 v71, a139
  v_accvgpr_read_b32 v72, a140
  v_accvgpr_read_b32 v73, a141
  v_accvgpr_read_b32 v74, a142
  v_accvgpr_read_b32 v75, a143
  v_mul_f32 v68, v12, v68
  v_mul_f32 v69, v12, v69
  v_mul_f32 v70, v12, v70
  v_mul_f32 v71, v12, v71
  v_mul_f32 v72, v12, v72
  v_mul_f32 v73, v12, v73
  v_mul_f32 v74, v12, v74
  v_mul_f32 v75, v12, v75
  v_cvt_pk_bf16_f32 v80, v68, v69
  v_cvt_pk_bf16_f32 v81, v70, v71
  v_cvt_pk_bf16_f32 v82, v72, v73
  v_cvt_pk_bf16_f32 v83, v74, v75
  buffer_store_dwordx4 v[80:83], v66, s[20:23], s39 offen offset:1024 sc1
  v_accvgpr_read_b32 v68, a144
  v_accvgpr_read_b32 v69, a145
  v_accvgpr_read_b32 v70, a146
  v_accvgpr_read_b32 v71, a147
  v_accvgpr_read_b32 v72, a148
  v_accvgpr_read_b32 v73, a149
  v_accvgpr_read_b32 v74, a150
  v_accvgpr_read_b32 v75, a151
  v_mul_f32 v68, v12, v68
  v_mul_f32 v69, v12, v69
  v_mul_f32 v70, v12, v70
  v_mul_f32 v71, v12, v71
  v_mul_f32 v72, v12, v72
  v_mul_f32 v73, v12, v73
  v_mul_f32 v74, v12, v74
  v_mul_f32 v75, v12, v75
  v_cvt_pk_bf16_f32 v76, v68, v69
  v_cvt_pk_bf16_f32 v77, v70, v71
  v_cvt_pk_bf16_f32 v78, v72, v73
  v_cvt_pk_bf16_f32 v79, v74, v75
  buffer_store_dwordx4 v[76:79], v66, s[20:23], s39 offen offset:2048 sc1
  v_accvgpr_read_b32 v68, a152
  v_accvgpr_read_b32 v69, a153
  v_accvgpr_read_b32 v70, a154
  v_accvgpr_read_b32 v71, a155
  v_accvgpr_read_b32 v72, a156
  v_accvgpr_read_b32 v73, a157
  v_accvgpr_read_b32 v74, a158
  v_accvgpr_read_b32 v75, a159
  v_mul_f32 v68, v12, v68
  v_mul_f32 v69, v12, v69
  v_mul_f32 v70, v12, v70
  v_mul_f32 v71, v12, v71
  v_mul_f32 v72, v12, v72
  v_mul_f32 v73, v12, v73
  v_mul_f32 v74, v12, v74
  v_mul_f32 v75, v12, v75
  v_cvt_pk_bf16_f32 v80, v68, v69
  v_cvt_pk_bf16_f32 v81, v70, v71
  v_cvt_pk_bf16_f32 v82, v72, v73
  v_cvt_pk_bf16_f32 v83, v74, v75
  buffer_store_dwordx4 v[80:83], v66, s[20:23], s39 offen offset:3072 sc1
  s_add_u32 s39, s37, 0
  v_accvgpr_read_b32 v68, a0
  v_accvgpr_read_b32 v69, a1
  v_accvgpr_read_b32 v70, a2
  v_accvgpr_read_b32 v71, a3
  v_accvgpr_read_b32 v72, a4
  v_accvgpr_read_b32 v73, a5
  v_accvgpr_read_b32 v74, a6
  v_accvgpr_read_b32 v75, a7
  v_mul_f32 v68, v8, v68
  v_mul_f32 v69, v8, v69
  v_mul_f32 v70, v8, v70
  v_mul_f32 v71, v8, v71
  v_mul_f32 v72, v8, v72
  v_mul_f32 v73, v8, v73
  v_mul_f32 v74, v8, v74
  v_mul_f32 v75, v8, v75
  v_cvt_pk_bf16_f32 v76, v68, v69
  v_cvt_pk_bf16_f32 v77, v70, v71
  v_cvt_pk_bf16_f32 v78, v72, v73
  v_cvt_pk_bf16_f32 v79, v74, v75
  buffer_store_dwordx4 v[76:79], v66, s[20:23], s39 offen offset:0 sc1
  v_accvgpr_read_b32 v68, a8
  v_accvgpr_read_b32 v69, a9
  v_accvgpr_read_b32 v70, a10
  v_accvgpr_read_b32 v71, a11
  v_accvgpr_read_b32 v72, a12
  v_accvgpr_read_b32 v73, a13
  v_accvgpr_read_b32 v74, a14
  v_accvgpr_read_b32 v75, a15
  v_mul_f32 v68, v8, v68
  v_mul_f32 v69, v8, v69
  v_mul_f32 v70, v8, v70
  v_mul_f32 v71, v8, v71
  v_mul_f32 v72, v8, v72
  v_mul_f32 v73, v8, v73
  v_mul_f32 v74, v8, v74
  v_mul_f32 v75, v8, v75
  v_cvt_pk_bf16_f32 v80, v68, v69
  v_cvt_pk_bf16_f32 v81, v70, v71
  v_cvt_pk_bf16_f32 v82, v72, v73
  v_cvt_pk_bf16_f32 v83, v74, v75
  buffer_store_dwordx4 v[80:83], v66, s[20:23], s39 offen offset:1024 sc1
  v_accvgpr_read_b32 v68, a16
  v_accvgpr_read_b32 v69, a17
  v_accvgpr_read_b32 v70, a18
  v_accvgpr_read_b32 v71, a19
  v_accvgpr_read_b32 v72, a20
  v_accvgpr_read_b32 v73, a21
  v_accvgpr_read_b32 v74, a22
  v_accvgpr_read_b32 v75, a23
  v_mul_f32 v68, v8, v68
  v_mul_f32 v69, v8, v69
  v_mul_f32 v70, v8, v70
  v_mul_f32 v71, v8, v71
  v_mul_f32 v72, v8, v72
  v_mul_f32 v73, v8, v73
  v_mul_f32 v74, v8, v74
  v_mul_f32 v75, v8, v75
  v_cvt_pk_bf16_f32 v76, v68, v69
  v_cvt_pk_bf16_f32 v77, v70, v71
  v_cvt_pk_bf16_f32 v78, v72, v73
  v_cvt_pk_bf16_f32 v79, v74, v75
  buffer_store_dwordx4 v[76:79], v66, s[20:23], s39 offen offset:2048 sc1
  v_accvgpr_read_b32 v68, a24
  v_accvgpr_read_b32 v69, a25
  v_accvgpr_read_b32 v70, a26
  v_accvgpr_read_b32 v71, a27
  v_accvgpr_read_b32 v72, a28
  v_accvgpr_read_b32 v73, a29
  v_accvgpr_read_b32 v74, a30
  v_accvgpr_read_b32 v75, a31
  v_mul_f32 v68, v8, v68
  v_mul_f32 v69, v8, v69
  v_mul_f32 v70, v8, v70
  v_mul_f32 v71, v8, v71
  v_mul_f32 v72, v8, v72
  v_mul_f32 v73, v8, v73
  v_mul_f32 v74, v8, v74
  v_mul_f32 v75, v8, v75
  v_cvt_pk_bf16_f32 v80, v68, v69
  v_cvt_pk_bf16_f32 v81, v70, v71
  v_cvt_pk_bf16_f32 v82, v72, v73
  v_cvt_pk_bf16_f32 v83, v74, v75
  buffer_store_dwordx4 v[80:83], v66, s[20:23], s39 offen offset:3072 sc1
  s_add_u32 s39, s37, 131072
  v_accvgpr_read_b32 v68, a32
  v_accvgpr_read_b32 v69, a33
  v_accvgpr_read_b32 v70, a34
  v_accvgpr_read_b32 v71, a35
  v_accvgpr_read_b32 v72, a36
  v_accvgpr_read_b32 v73, a37
  v_accvgpr_read_b32 v74, a38
  v_accvgpr_read_b32 v75, a39
  v_mul_f32 v68, v9, v68
  v_mul_f32 v69, v9, v69
  v_mul_f32 v70, v9, v70
  v_mul_f32 v71, v9, v71
  v_mul_f32 v72, v9, v72
  v_mul_f32 v73, v9, v73
  v_mul_f32 v74, v9, v74
  v_mul_f32 v75, v9, v75
  v_cvt_pk_bf16_f32 v76, v68, v69
  v_cvt_pk_bf16_f32 v77, v70, v71
  v_cvt_pk_bf16_f32 v78, v72, v73
  v_cvt_pk_bf16_f32 v79, v74, v75
  buffer_store_dwordx4 v[76:79], v66, s[20:23], s39 offen offset:0 sc1
  v_accvgpr_read_b32 v68, a40
  v_accvgpr_read_b32 v69, a41
  v_accvgpr_read_b32 v70, a42
  v_accvgpr_read_b32 v71, a43
  v_accvgpr_read_b32 v72, a44
  v_accvgpr_read_b32 v73, a45
  v_accvgpr_read_b32 v74, a46
  v_accvgpr_read_b32 v75, a47
  v_mul_f32 v68, v9, v68
  v_mul_f32 v69, v9, v69
  v_mul_f32 v70, v9, v70
  v_mul_f32 v71, v9, v71
  v_mul_f32 v72, v9, v72
  v_mul_f32 v73, v9, v73
  v_mul_f32 v74, v9, v74
  v_mul_f32 v75, v9, v75
  v_cvt_pk_bf16_f32 v80, v68, v69
  v_cvt_pk_bf16_f32 v81, v70, v71
  v_cvt_pk_bf16_f32 v82, v72, v73
  v_cvt_pk_bf16_f32 v83, v74, v75
  buffer_store_dwordx4 v[80:83], v66, s[20:23], s39 offen offset:1024 sc1
  v_accvgpr_read_b32 v68, a48
  v_accvgpr_read_b32 v69, a49
  v_accvgpr_read_b32 v70, a50
  v_accvgpr_read_b32 v71, a51
  v_accvgpr_read_b32 v72, a52
  v_accvgpr_read_b32 v73, a53
  v_accvgpr_read_b32 v74, a54
  v_accvgpr_read_b32 v75, a55
  v_mul_f32 v68, v9, v68
  v_mul_f32 v69, v9, v69
  v_mul_f32 v70, v9, v70
  v_mul_f32 v71, v9, v71
  v_mul_f32 v72, v9, v72
  v_mul_f32 v73, v9, v73
  v_mul_f32 v74, v9, v74
  v_mul_f32 v75, v9, v75
  v_cvt_pk_bf16_f32 v76, v68, v69
  v_cvt_pk_bf16_f32 v77, v70, v71
  v_cvt_pk_bf16_f32 v78, v72, v73
  v_cvt_pk_bf16_f32 v79, v74, v75
  buffer_store_dwordx4 v[76:79], v66, s[20:23], s39 offen offset:2048 sc1
  v_accvgpr_read_b32 v68, a56
  v_accvgpr_read_b32 v69, a57
  v_accvgpr_read_b32 v70, a58
  v_accvgpr_read_b32 v71, a59
  v_accvgpr_read_b32 v72, a60
  v_accvgpr_read_b32 v73, a61
  v_accvgpr_read_b32 v74, a62
  v_accvgpr_read_b32 v75, a63
  v_mul_f32 v68, v9, v68
  v_mul_f32 v69, v9, v69
  v_mul_f32 v70, v9, v70
  v_mul_f32 v71, v9, v71
  v_mul_f32 v72, v9, v72
  v_mul_f32 v73, v9, v73
  v_mul_f32 v74, v9, v74
  v_mul_f32 v75, v9, v75
  v_cvt_pk_bf16_f32 v80, v68, v69
  v_cvt_pk_bf16_f32 v81, v70, v71
  v_cvt_pk_bf16_f32 v82, v72, v73
  v_cvt_pk_bf16_f32 v83, v74, v75
  buffer_store_dwordx4 v[80:83], v66, s[20:23], s39 offen offset:3072 sc1
  v_accvgpr_write_b32 a0, 0
  v_accvgpr_write_b32 a1, 0
  v_accvgpr_write_b32 a2, 0
  v_accvgpr_write_b32 a3, 0
  v_accvgpr_write_b32 a4, 0
  v_accvgpr_write_b32 a5, 0
  v_accvgpr_write_b32 a6, 0
  v_accvgpr_write_b32 a7, 0
  v_accvgpr_write_b32 a8, 0
  v_accvgpr_write_b32 a9, 0
  v_accvgpr_write_b32 a10, 0
  v_accvgpr_write_b32 a11, 0
  v_accvgpr_write_b32 a12, 0
  v_accvgpr_write_b32 a13, 0
  v_accvgpr_write_b32 a14, 0
  v_accvgpr_write_b32 a15, 0
  v_accvgpr_write_b32 a16, 0
  v_accvgpr_write_b32 a17, 0
  v_accvgpr_write_b32 a18, 0
  v_accvgpr_write_b32 a19, 0
  v_accvgpr_write_b32 a20, 0
  v_accvgpr_write_b32 a21, 0
  v_accvgpr_write_b32 a22, 0
  v_accvgpr_write_b32 a23, 0
  v_accvgpr_write_b32 a24, 0
  v_accvgpr_write_b32 a25, 0
  v_accvgpr_write_b32 a26, 0
  v_accvgpr_write_b32 a27, 0
  v_accvgpr_write_b32 a28, 0
  v_accvgpr_write_b32 a29, 0
  v_accvgpr_write_b32 a30, 0
  v_accvgpr_write_b32 a31, 0
  v_accvgpr_write_b32 a32, 0
  v_accvgpr_write_b32 a33, 0
  v_accvgpr_write_b32 a34, 0
  v_accvgpr_write_b32 a35, 0
  v_accvgpr_write_b32 a36, 0
  v_accvgpr_write_b32 a37, 0
  v_accvgpr_write_b32 a38, 0
  v_accvgpr_write_b32 a39, 0
  v_accvgpr_write_b32 a40, 0
  v_accvgpr_write_b32 a41, 0
  v_accvgpr_write_b32 a42, 0
  v_accvgpr_write_b32 a43, 0
  v_accvgpr_write_b32 a44, 0
  v_accvgpr_write_b32 a45, 0
  v_accvgpr_write_b32 a46, 0
  v_accvgpr_write_b32 a47, 0
  v_accvgpr_write_b32 a48, 0
  v_accvgpr_write_b32 a49, 0
  v_accvgpr_write_b32 a50, 0
  v_accvgpr_write_b32 a51, 0
  v_accvgpr_write_b32 a52, 0
  v_accvgpr_write_b32 a53, 0
  v_accvgpr_write_b32 a54, 0
  v_accvgpr_write_b32 a55, 0
  v_accvgpr_write_b32 a56, 0
  v_accvgpr_write_b32 a57, 0
  v_accvgpr_write_b32 a58, 0
  v_accvgpr_write_b32 a59, 0
  v_accvgpr_write_b32 a60, 0
  v_accvgpr_write_b32 a61, 0
  v_accvgpr_write_b32 a62, 0
  v_accvgpr_write_b32 a63, 0
  s_waitcnt vmcnt(20)
  s_barrier
  ds_read_b64_tr_b16 a[192:193], v148 offset:0
  ds_read_b64_tr_b16 a[194:195], v148 offset:4096
  ds_read_b64_tr_b16 a[196:197], v149 offset:0
  ds_read_b64_tr_b16 a[198:199], v149 offset:4096
  ds_read_b64_tr_b16 a[200:201], v150 offset:0
  ds_read_b64_tr_b16 a[202:203], v150 offset:4096
  ds_read_b64_tr_b16 a[204:205], v151 offset:0
  ds_read_b64_tr_b16 a[206:207], v151 offset:4096
  ds_read_b64_tr_b16 a[208:209], v152 offset:0
  ds_read_b64_tr_b16 a[210:211], v152 offset:4096
  ds_read_b64_tr_b16 a[212:213], v153 offset:0
  ds_read_b64_tr_b16 a[214:215], v153 offset:4096
  ds_read_b64_tr_b16 a[216:217], v154 offset:0
  ds_read_b64_tr_b16 a[218:219], v154 offset:4096
  ds_read_b64_tr_b16 a[220:221], v155 offset:0
  ds_read_b64_tr_b16 a[222:223], v155 offset:4096
  buffer_load_dwordx4 a[128:131], v66, s[12:15], s82 offen offset:0 sc1
  s_add_u32 m0, s80, 65536
  s_nop 0
  buffer_load_dwordx4 v164, s[16:19], s81 offen lds
  buffer_load_dwordx4 a[132:135], v66, s[4:7], s82 offen offset:0 sc1
  s_add_u32 m0, s80, 66560
  s_add_u32 s84, s81, 5120
  buffer_load_dwordx4 v165, s[16:19], s84 offen lds
  s_waitcnt lgkmcnt(0)
  v_mfma_f32_16x16x32_bf16 a[0:3], a[192:195], a[64:67], a[0:3]
  ds_read_b64_tr_b16 a[224:225], v148 offset:8192
  ds_read_b64_tr_b16 a[226:227], v148 offset:12288
  v_mfma_f32_16x16x32_bf16 a[32:35], a[192:195], a[68:71], a[32:35]
  ds_read_b64_tr_b16 a[228:229], v149 offset:8192
  ds_read_b64_tr_b16 a[230:231], v149 offset:12288
  v_mfma_f32_16x16x32_bf16 a[4:7], a[196:199], a[64:67], a[4:7]
  ds_read_b64_tr_b16 a[232:233], v150 offset:8192
  ds_read_b64_tr_b16 a[234:235], v150 offset:12288
  v_mfma_f32_16x16x32_bf16 a[36:39], a[196:199], a[68:71], a[36:39]
  ds_read_b64_tr_b16 a[236:237], v151 offset:8192
  ds_read_b64_tr_b16 a[238:239], v151 offset:12288
  v_mfma_f32_16x16x32_bf16 a[8:11], a[200:203], a[64:67], a[8:11]
  ds_read_b64_tr_b16 a[240:241], v152 offset:8192
  ds_read_b64_tr_b16 a[242:243], v152 offset:12288
  v_mfma_f32_16x16x32_bf16 a[40:43], a[200:203], a[68:71], a[40:43]
  ds_read_b64_tr_b16 a[244:245], v153 offset:8192
  ds_read_b64_tr_b16 a[246:247], v153 offset:12288
  v_mfma_f32_16x16x32_bf16 a[12:15], a[204:207], a[64:67], a[12:15]
  ds_read_b64_tr_b16 a[248:249], v154 offset:8192
  ds_read_b64_tr_b16 a[250:251], v154 offset:12288
  v_mfma_f32_16x16x32_bf16 a[44:47], a[204:207], a[68:71], a[44:47]
  ds_read_b64_tr_b16 a[252:253], v155 offset:8192
  ds_read_b64_tr_b16 a[254:255], v155 offset:12288
  v_mfma_f32_16x16x32_bf16 a[16:19], a[208:211], a[64:67], a[16:19]
  v_mfma_f32_16x16x32_bf16 a[48:51], a[208:211], a[68:71], a[48:51]
  buffer_load_dwordx4 a[136:139], v66, s[12:15], s82 offen offset:1024 sc1
  v_mfma_f32_16x16x32_bf16 a[20:23], a[212:215], a[64:67], a[20:23]
  v_mfma_f32_16x16x32_bf16 a[52:55], a[212:215], a[68:71], a[52:55]
  s_add_u32 m0, s80, 67584
  s_add_u32 s84, s81, 10240
  buffer_load_dwordx4 v164, s[16:19], s84 offen lds
  v_mfma_f32_16x16x32_bf16 a[24:27], a[216:219], a[64:67], a[24:27]
  v_mfma_f32_16x16x32_bf16 a[56:59], a[216:219], a[68:71], a[56:59]
  buffer_load_dwordx4 a[140:143], v66, s[4:7], s82 offen offset:1024 sc1
  v_mfma_f32_16x16x32_bf16 a[28:31], a[220:223], a[64:67], a[28:31]
  v_mfma_f32_16x16x32_bf16 a[60:63], a[220:223], a[68:71], a[60:63]
  s_add_u32 m0, s80, 68608
  s_add_u32 s84, s81, 15360
  buffer_load_dwordx4 v165, s[16:19], s84 offen lds
  s_waitcnt lgkmcnt(0)
  v_mfma_f32_16x16x32_bf16 a[0:3], a[224:227], a[72:75], a[0:3]
  ds_read_b64_tr_b16 a[192:193], v148 offset:16384
  ds_read_b64_tr_b16 a[194:195], v148 offset:20480
  v_mfma_f32_16x16x32_bf16 a[32:35], a[224:227], a[76:79], a[32:35]
  ds_read_b64_tr_b16 a[196:197], v149 offset:16384
  ds_read_b64_tr_b16 a[198:199], v149 offset:20480
  v_mfma_f32_16x16x32_bf16 a[4:7], a[228:231], a[72:75], a[4:7]
  ds_read_b64_tr_b16 a[200:201], v150 offset:16384
  ds_read_b64_tr_b16 a[202:203], v150 offset:20480
  v_mfma_f32_16x16x32_bf16 a[36:39], a[228:231], a[76:79], a[36:39]
  ds_read_b64_tr_b16 a[204:205], v151 offset:16384
  ds_read_b64_tr_b16 a[206:207], v151 offset:20480
  v_mfma_f32_16x16x32_bf16 a[8:11], a[232:235], a[72:75], a[8:11]
  ds_read_b64_tr_b16 a[208:209], v152 offset:16384
  ds_read_b64_tr_b16 a[210:211], v152 offset:20480
  v_mfma_f32_16x16x32_bf16 a[40:43], a[232:235], a[76:79], a[40:43]
  ds_read_b64_tr_b16 a[212:213], v153 offset:16384
  ds_read_b64_tr_b16 a[214:215], v153 offset:20480
  v_mfma_f32_16x16x32_bf16 a[12:15], a[236:239], a[72:75], a[12:15]
  ds_read_b64_tr_b16 a[216:217], v154 offset:16384
  ds_read_b64_tr_b16 a[218:219], v154 offset:20480
  v_mfma_f32_16x16x32_bf16 a[44:47], a[236:239], a[76:79], a[44:47]
  ds_read_b64_tr_b16 a[220:221], v155 offset:16384
  ds_read_b64_tr_b16 a[222:223], v155 offset:20480
  v_mfma_f32_16x16x32_bf16 a[16:19], a[240:243], a[72:75], a[16:19]
  v_mfma_f32_16x16x32_bf16 a[48:51], a[240:243], a[76:79], a[48:51]
  buffer_load_dwordx4 a[144:147], v66, s[12:15], s82 offen offset:2048 sc1
  v_mfma_f32_16x16x32_bf16 a[20:23], a[244:247], a[72:75], a[20:23]
  v_mfma_f32_16x16x32_bf16 a[52:55], a[244:247], a[76:79], a[52:55]
  s_add_u32 m0, s80, 69632
  s_add_u32 s84, s81, 20480
  buffer_load_dwordx4 v164, s[16:19], s84 offen lds
  v_mfma_f32_16x16x32_bf16 a[24:27], a[248:251], a[72:75], a[24:27]
  v_mfma_f32_16x16x32_bf16 a[56:59], a[248:251], a[76:79], a[56:59]
  buffer_load_dwordx4 a[148:151], v66, s[4:7], s82 offen offset:2048 sc1
  v_mfma_f32_16x16x32_bf16 a[28:31], a[252:255], a[72:75], a[28:31]
  v_mfma_f32_16x16x32_bf16 a[60:63], a[252:255], a[76:79], a[60:63]
  s_add_u32 m0, s80, 70656
  s_add_u32 s84, s81, 25600
  buffer_load_dwordx4 v165, s[16:19], s84 offen lds
  s_waitcnt lgkmcnt(0)
  v_mfma_f32_16x16x32_bf16 a[0:3], a[192:195], a[80:83], a[0:3]
  ds_read_b64_tr_b16 a[224:225], v148 offset:24576
  ds_read_b64_tr_b16 a[226:227], v148 offset:28672
  v_mfma_f32_16x16x32_bf16 a[32:35], a[192:195], a[84:87], a[32:35]
  ds_read_b64_tr_b16 a[228:229], v149 offset:24576
  ds_read_b64_tr_b16 a[230:231], v149 offset:28672
  v_mfma_f32_16x16x32_bf16 a[4:7], a[196:199], a[80:83], a[4:7]
  ds_read_b64_tr_b16 a[232:233], v150 offset:24576
  ds_read_b64_tr_b16 a[234:235], v150 offset:28672
  v_mfma_f32_16x16x32_bf16 a[36:39], a[196:199], a[84:87], a[36:39]
  ds_read_b64_tr_b16 a[236:237], v151 offset:24576
  ds_read_b64_tr_b16 a[238:239], v151 offset:28672
  v_mfma_f32_16x16x32_bf16 a[8:11], a[200:203], a[80:83], a[8:11]
  ds_read_b64_tr_b16 a[240:241], v152 offset:24576
  ds_read_b64_tr_b16 a[242:243], v152 offset:28672
  v_mfma_f32_16x16x32_bf16 a[40:43], a[200:203], a[84:87], a[40:43]
  ds_read_b64_tr_b16 a[244:245], v153 offset:24576
  ds_read_b64_tr_b16 a[246:247], v153 offset:28672
  v_mfma_f32_16x16x32_bf16 a[12:15], a[204:207], a[80:83], a[12:15]
  ds_read_b64_tr_b16 a[248:249], v154 offset:24576
  ds_read_b64_tr_b16 a[250:251], v154 offset:28672
  v_mfma_f32_16x16x32_bf16 a[44:47], a[204:207], a[84:87], a[44:47]
  ds_read_b64_tr_b16 a[252:253], v155 offset:24576
  ds_read_b64_tr_b16 a[254:255], v155 offset:28672
  v_mfma_f32_16x16x32_bf16 a[16:19], a[208:211], a[80:83], a[16:19]
  v_mfma_f32_16x16x32_bf16 a[48:51], a[208:211], a[84:87], a[48:51]
  buffer_load_dwordx4 a[152:155], v66, s[12:15], s82 offen offset:3072 sc1
  v_mfma_f32_16x16x32_bf16 a[20:23], a[212:215], a[80:83], a[20:23]
  v_mfma_f32_16x16x32_bf16 a[52:55], a[212:215], a[84:87], a[52:55]
  s_add_u32 m0, s80, 71680
  s_add_u32 s84, s81, 30720
  buffer_load_dwordx4 v164, s[16:19], s84 offen lds
  v_mfma_f32_16x16x32_bf16 a[24:27], a[216:219], a[80:83], a[24:27]
  v_mfma_f32_16x16x32_bf16 a[56:59], a[216:219], a[84:87], a[56:59]
  buffer_load_dwordx4 a[156:159], v66, s[4:7], s82 offen offset:3072 sc1
  s_add_u32 s82, s82, 4096
  v_mfma_f32_16x16x32_bf16 a[28:31], a[220:223], a[80:83], a[28:31]
  v_mfma_f32_16x16x32_bf16 a[60:63], a[220:223], a[84:87], a[60:63]
  s_add_u32 m0, s80, 72704
  s_add_u32 s84, s81, 35840
  buffer_load_dwordx4 v165, s[16:19], s84 offen lds
  s_add_u32 s81, s81, 163840
  s_waitcnt vmcnt(28)
  s_barrier
  s_waitcnt lgkmcnt(0)
  v_mfma_f32_16x16x32_bf16 a[0:3], a[224:227], a[88:91], a[0:3]
  ds_read_b64_tr_b16 a[192:193], v148 offset:32768
  ds_read_b64_tr_b16 a[194:195], v148 offset:36864
  v_mfma_f32_16x16x32_bf16 a[32:35], a[224:227], a[92:95], a[32:35]
  ds_read_b64_tr_b16 a[196:197], v149 offset:32768
  ds_read_b64_tr_b16 a[198:199], v149 offset:36864
  v_mfma_f32_16x16x32_bf16 a[4:7], a[228:231], a[88:91], a[4:7]
  ds_read_b64_tr_b16 a[200:201], v150 offset:32768
  ds_read_b64_tr_b16 a[202:203], v150 offset:36864
  v_mfma_f32_16x16x32_bf16 a[36:39], a[228:231], a[92:95], a[36:39]
  ds_read_b64_tr_b16 a[204:205], v151 offset:32768
  ds_read_b64_tr_b16 a[206:207], v151 offset:36864
  v_mfma_f32_16x16x32_bf16 a[8:11], a[232:235], a[88:91], a[8:11]
  ds_read_b64_tr_b16 a[208:209], v152 offset:32768
  ds_read_b64_tr_b16 a[210:211], v152 offset:36864
  v_mfma_f32_16x16x32_bf16 a[40:43], a[232:235], a[92:95], a[40:43]
  ds_read_b64_tr_b16 a[212:213], v153 offset:32768
  ds_read_b64_tr_b16 a[214:215], v153 offset:36864
  v_mfma_f32_16x16x32_bf16 a[12:15], a[236:239], a[88:91], a[12:15]
  ds_read_b64_tr_b16 a[216:217], v154 offset:32768
  ds_read_b64_tr_b16 a[218:219], v154 offset:36864
  v_mfma_f32_16x16x32_bf16 a[44:47], a[236:239], a[92:95], a[44:47]
  ds_read_b64_tr_b16 a[220:221], v155 offset:32768
  ds_read_b64_tr_b16 a[222:223], v155 offset:36864
  v_mfma_f32_16x16x32_bf16 a[16:19], a[240:243], a[88:91], a[16:19]
  v_mfma_f32_16x16x32_bf16 a[48:51], a[240:243], a[92:95], a[48:51]
  buffer_load_dwordx4 a[160:163], v66, s[12:15], s82 offen offset:0 sc1
  v_mfma_f32_16x16x32_bf16 a[20:23], a[244:247], a[88:91], a[20:23]
  v_mfma_f32_16x16x32_bf16 a[52:55], a[244:247], a[92:95], a[52:55]
  s_add_u32 m0, s80, 98304
  s_nop 0
  buffer_load_dwordx4 v164, s[16:19], s81 offen lds
  v_mfma_f32_16x16x32_bf16 a[24:27], a[248:251], a[88:91], a[24:27]
  v_mfma_f32_16x16x32_bf16 a[56:59], a[248:251], a[92:95], a[56:59]
  buffer_load_dwordx4 a[164:167], v66, s[4:7], s82 offen offset:0 sc1
  v_mfma_f32_16x16x32_bf16 a[28:31], a[252:255], a[88:91], a[28:31]
  v_mfma_f32_16x16x32_bf16 a[60:63], a[252:255], a[92:95], a[60:63]
  s_add_u32 m0, s80, 99328
  s_add_u32 s84, s81, 5120
  buffer_load_dwordx4 v165, s[16:19], s84 offen lds
  s_waitcnt lgkmcnt(0)
  v_mfma_f32_16x16x32_bf16 a[0:3], a[192:195], a[96:99], a[0:3]
  ds_read_b64_tr_b16 a[224:225], v148 offset:40960
  ds_read_b64_tr_b16 a[226:227], v148 offset:45056
  v_mfma_f32_16x16x32_bf16 a[32:35], a[192:195], a[100:103], a[32:35]
  ds_read_b64_tr_b16 a[228:229], v149 offset:40960
  ds_read_b64_tr_b16 a[230:231], v149 offset:45056
  v_mfma_f32_16x16x32_bf16 a[4:7], a[196:199], a[96:99], a[4:7]
  ds_read_b64_tr_b16 a[232:233], v150 offset:40960
  ds_read_b64_tr_b16 a[234:235], v150 offset:45056
  v_mfma_f32_16x16x32_bf16 a[36:39], a[196:199], a[100:103], a[36:39]
  ds_read_b64_tr_b16 a[236:237], v151 offset:40960
  ds_read_b64_tr_b16 a[238:239], v151 offset:45056
  v_mfma_f32_16x16x32_bf16 a[8:11], a[200:203], a[96:99], a[8:11]
  ds_read_b64_tr_b16 a[240:241], v152 offset:40960
  ds_read_b64_tr_b16 a[242:243], v152 offset:45056
  v_mfma_f32_16x16x32_bf16 a[40:43], a[200:203], a[100:103], a[40:43]
  ds_read_b64_tr_b16 a[244:245], v153 offset:40960
  ds_read_b64_tr_b16 a[246:247], v153 offset:45056
  v_mfma_f32_16x16x32_bf16 a[12:15], a[204:207], a[96:99], a[12:15]
  ds_read_b64_tr_b16 a[248:249], v154 offset:40960
  ds_read_b64_tr_b16 a[250:251], v154 offset:45056
  v_mfma_f32_16x16x32_bf16 a[44:47], a[204:207], a[100:103], a[44:47]
  ds_read_b64_tr_b16 a[252:253], v155 offset:40960
  ds_read_b64_tr_b16 a[254:255], v155 offset:45056
  v_mfma_f32_16x16x32_bf16 a[16:19], a[208:211], a[96:99], a[16:19]
  v_mfma_f32_16x16x32_bf16 a[48:51], a[208:211], a[100:103], a[48:51]
  buffer_load_dwordx4 a[168:171], v66, s[12:15], s82 offen offset:1024 sc1
  v_mfma_f32_16x16x32_bf16 a[20:23], a[212:215], a[96:99], a[20:23]
  v_mfma_f32_16x16x32_bf16 a[52:55], a[212:215], a[100:103], a[52:55]
  s_add_u32 m0, s80, 100352
  s_add_u32 s84, s81, 10240
  buffer_load_dwordx4 v164, s[16:19], s84 offen lds
  v_mfma_f32_16x16x32_bf16 a[24:27], a[216:219], a[96:99], a[24:27]
  v_mfma_f32_16x16x32_bf16 a[56:59], a[216:219], a[100:103], a[56:59]
  buffer_load_dwordx4 a[172:175], v66, s[4:7], s82 offen offset:1024 sc1
  v_mfma_f32_16x16x32_bf16 a[28:31], a[220:223], a[96:99], a[28:31]
  v_mfma_f32_16x16x32_bf16 a[60:63], a[220:223], a[100:103], a[60:63]
  s_add_u32 m0, s80, 101376
  s_add_u32 s84, s81, 15360
  buffer_load_dwordx4 v165, s[16:19], s84 offen lds
  s_waitcnt lgkmcnt(0)
  v_mfma_f32_16x16x32_bf16 a[0:3], a[224:227], a[104:107], a[0:3]
  ds_read_b64_tr_b16 a[192:193], v148 offset:49152
  ds_read_b64_tr_b16 a[194:195], v148 offset:53248
  v_mfma_f32_16x16x32_bf16 a[32:35], a[224:227], a[108:111], a[32:35]
  ds_read_b64_tr_b16 a[196:197], v149 offset:49152
  ds_read_b64_tr_b16 a[198:199], v149 offset:53248
  v_mfma_f32_16x16x32_bf16 a[4:7], a[228:231], a[104:107], a[4:7]
  ds_read_b64_tr_b16 a[200:201], v150 offset:49152
  ds_read_b64_tr_b16 a[202:203], v150 offset:53248
  v_mfma_f32_16x16x32_bf16 a[36:39], a[228:231], a[108:111], a[36:39]
  ds_read_b64_tr_b16 a[204:205], v151 offset:49152
  ds_read_b64_tr_b16 a[206:207], v151 offset:53248
  v_mfma_f32_16x16x32_bf16 a[8:11], a[232:235], a[104:107], a[8:11]
  ds_read_b64_tr_b16 a[208:209], v152 offset:49152
  ds_read_b64_tr_b16 a[210:211], v152 offset:53248
  v_mfma_f32_16x16x32_bf16 a[40:43], a[232:235], a[108:111], a[40:43]
  ds_read_b64_tr_b16 a[212:213], v153 offset:49152
  ds_read_b64_tr_b16 a[214:215], v153 offset:53248
  v_mfma_f32_16x16x32_bf16 a[12:15], a[236:239], a[104:107], a[12:15]
  ds_read_b64_tr_b16 a[216:217], v154 offset:49152
  ds_read_b64_tr_b16 a[218:219], v154 offset:53248
  v_mfma_f32_16x16x32_bf16 a[44:47], a[236:239], a[108:111], a[44:47]
  ds_read_b64_tr_b16 a[220:221], v155 offset:49152
  ds_read_b64_tr_b16 a[222:223], v155 offset:53248
  v_mfma_f32_16x16x32_bf16 a[16:19], a[240:243], a[104:107], a[16:19]
  v_mfma_f32_16x16x32_bf16 a[48:51], a[240:243], a[108:111], a[48:51]
  buffer_load_dwordx4 a[176:179], v66, s[12:15], s82 offen offset:2048 sc1
  v_mfma_f32_16x16x32_bf16 a[20:23], a[244:247], a[104:107], a[20:23]
  v_mfma_f32_16x16x32_bf16 a[52:55], a[244:247], a[108:111], a[52:55]
  s_add_u32 m0, s80, 102400
  s_add_u32 s84, s81, 20480
  buffer_load_dwordx4 v164, s[16:19], s84 offen lds
  v_mfma_f32_16x16x32_bf16 a[24:27], a[248:251], a[104:107], a[24:27]
  v_mfma_f32_16x16x32_bf16 a[56:59], a[248:251], a[108:111], a[56:59]
  buffer_load_dwordx4 a[180:183], v66, s[4:7], s82 offen offset:2048 sc1
  v_mfma_f32_16x16x32_bf16 a[28:31], a[252:255], a[104:107], a[28:31]
  v_mfma_f32_16x16x32_bf16 a[60:63], a[252:255], a[108:111], a[60:63]
  s_add_u32 m0, s80, 103424
  s_add_u32 s84, s81, 25600
  buffer_load_dwordx4 v165, s[16:19], s84 offen lds
  s_waitcnt lgkmcnt(0)
  v_mfma_f32_16x16x32_bf16 a[0:3], a[192:195], a[112:115], a[0:3]
  ds_read_b64_tr_b16 a[224:225], v148 offset:57344
  ds_read_b64_tr_b16 a[226:227], v148 offset:61440
  v_mfma_f32_16x16x32_bf16 a[32:35], a[192:195], a[116:119], a[32:35]
  ds_read_b64_tr_b16 a[228:229], v149 offset:57344
  ds_read_b64_tr_b16 a[230:231], v149 offset:61440
  v_mfma_f32_16x16x32_bf16 a[4:7], a[196:199], a[112:115], a[4:7]
  ds_read_b64_tr_b16 a[232:233], v150 offset:57344
  ds_read_b64_tr_b16 a[234:235], v150 offset:61440
  v_mfma_f32_16x16x32_bf16 a[36:39], a[196:199], a[116:119], a[36:39]
  ds_read_b64_tr_b16 a[236:237], v151 offset:57344
  ds_read_b64_tr_b16 a[238:239], v151 offset:61440
  v_mfma_f32_16x16x32_bf16 a[8:11], a[200:203], a[112:115], a[8:11]
  ds_read_b64_tr_b16 a[240:241], v152 offset:57344
  ds_read_b64_tr_b16 a[242:243], v152 offset:61440
  v_mfma_f32_16x16x32_bf16 a[40:43], a[200:203], a[116:119], a[40:43]
  ds_read_b64_tr_b16 a[244:245], v153 offset:57344
  ds_read_b64_tr_b16 a[246:247], v153 offset:61440
  v_mfma_f32_16x16x32_bf16 a[12:15], a[204:207], a[112:115], a[12:15]
  ds_read_b64_tr_b16 a[248:249], v154 offset:57344
  ds_read_b64_tr_b16 a[250:251], v154 offset:61440
  v_mfma_f32_16x16x32_bf16 a[44:47], a[204:207], a[116:119], a[44:47]
  ds_read_b64_tr_b16 a[252:253], v155 offset:57344
  ds_read_b64_tr_b16 a[254:255], v155 offset:61440
  v_mfma_f32_16x16x32_bf16 a[16:19], a[208:211], a[112:115], a[16:19]
  v_mfma_f32_16x16x32_bf16 a[48:51], a[208:211], a[116:119], a[48:51]
  buffer_load_dwordx4 a[184:187], v66, s[12:15], s82 offen offset:3072 sc1
  v_mfma_f32_16x16x32_bf16 a[20:23], a[212:215], a[112:115], a[20:23]
  v_mfma_f32_16x16x32_bf16 a[52:55], a[212:215], a[116:119], a[52:55]
  s_add_u32 m0, s80, 104448
  s_add_u32 s84, s81, 30720
  buffer_load_dwordx4 v164, s[16:19], s84 offen lds
  v_mfma_f32_16x16x32_bf16 a[24:27], a[216:219], a[112:115], a[24:27]
  v_mfma_f32_16x16x32_bf16 a[56:59], a[216:219], a[116:119], a[56:59]
  buffer_load_dwordx4 a[188:191], v66, s[4:7], s82 offen offset:3072 sc1
  s_add_u32 s82, s82, 4096
  v_mfma_f32_16x16x32_bf16 a[28:31], a[220:223], a[112:115], a[28:31]
  v_mfma_f32_16x16x32_bf16 a[60:63], a[220:223], a[116:119], a[60:63]
  s_add_u32 m0, s80, 105472
  s_add_u32 s84, s81, 35840
  buffer_load_dwordx4 v165, s[16:19], s84 offen lds
  s_add_u32 s81, s81, 163840
  s_waitcnt vmcnt(16)
  s_barrier
  s_waitcnt lgkmcnt(0)
  v_mfma_f32_16x16x32_bf16 a[0:3], a[224:227], a[120:123], a[0:3]
  ds_read_b64_tr_b16 a[192:193], v156 offset:0
  ds_read_b64_tr_b16 a[194:195], v156 offset:4096
  v_mfma_f32_16x16x32_bf16 a[32:35], a[224:227], a[124:127], a[32:35]
  ds_read_b64_tr_b16 a[196:197], v157 offset:0
  ds_read_b64_tr_b16 a[198:199], v157 offset:4096
  v_mfma_f32_16x16x32_bf16 a[4:7], a[228:231], a[120:123], a[4:7]
  ds_read_b64_tr_b16 a[200:201], v158 offset:0
  ds_read_b64_tr_b16 a[202:203], v158 offset:4096
  v_mfma_f32_16x16x32_bf16 a[36:39], a[228:231], a[124:127], a[36:39]
  ds_read_b64_tr_b16 a[204:205], v159 offset:0
  ds_read_b64_tr_b16 a[206:207], v159 offset:4096
  v_mfma_f32_16x16x32_bf16 a[8:11], a[232:235], a[120:123], a[8:11]
  ds_read_b64_tr_b16 a[208:209], v160 offset:0
  ds_read_b64_tr_b16 a[210:211], v160 offset:4096
  v_mfma_f32_16x16x32_bf16 a[40:43], a[232:235], a[124:127], a[40:43]
  ds_read_b64_tr_b16 a[212:213], v161 offset:0
  ds_read_b64_tr_b16 a[214:215], v161 offset:4096
  v_mfma_f32_16x16x32_bf16 a[12:15], a[236:239], a[120:123], a[12:15]
  ds_read_b64_tr_b16 a[216:217], v162 offset:0
  ds_read_b64_tr_b16 a[218:219], v162 offset:4096
  v_mfma_f32_16x16x32_bf16 a[44:47], a[236:239], a[124:127], a[44:47]
  ds_read_b64_tr_b16 a[220:221], v163 offset:0
  ds_read_b64_tr_b16 a[222:223], v163 offset:4096
  v_mfma_f32_16x16x32_bf16 a[16:19], a[240:243], a[120:123], a[16:19]
  v_mfma_f32_16x16x32_bf16 a[48:51], a[240:243], a[124:127], a[48:51]
  buffer_load_dwordx4 a[64:67], v66, s[12:15], s82 offen offset:0 sc1
  v_mfma_f32_16x16x32_bf16 a[20:23], a[244:247], a[120:123], a[20:23]
  v_mfma_f32_16x16x32_bf16 a[52:55], a[244:247], a[124:127], a[52:55]
  s_add_u32 m0, s80, 0
  s_nop 0
  buffer_load_dwordx4 v164, s[16:19], s81 offen lds
  v_mfma_f32_16x16x32_bf16 a[24:27], a[248:251], a[120:123], a[24:27]
  v_mfma_f32_16x16x32_bf16 a[56:59], a[248:251], a[124:127], a[56:59]
  buffer_load_dwordx4 a[68:71], v66, s[4:7], s82 offen offset:0 sc1
  v_mfma_f32_16x16x32_bf16 a[28:31], a[252:255], a[120:123], a[28:31]
  v_mfma_f32_16x16x32_bf16 a[60:63], a[252:255], a[124:127], a[60:63]
  s_add_u32 m0, s80, 1024
  s_add_u32 s84, s81, 5120
  buffer_load_dwordx4 v165, s[16:19], s84 offen lds
  s_waitcnt lgkmcnt(0)
  v_mfma_f32_16x16x32_bf16 a[0:3], a[192:195], a[128:131], a[0:3]
  ds_read_b64_tr_b16 a[224:225], v156 offset:8192
  ds_read_b64_tr_b16 a[226:227], v156 offset:12288
  v_mfma_f32_16x16x32_bf16 a[32:35], a[192:195], a[132:135], a[32:35]
  ds_read_b64_tr_b16 a[228:229], v157 offset:8192
  ds_read_b64_tr_b16 a[230:231], v157 offset:12288
  v_mfma_f32_16x16x32_bf16 a[4:7], a[196:199], a[128:131], a[4:7]
  ds_read_b64_tr_b16 a[232:233], v158 offset:8192
  ds_read_b64_tr_b16 a[234:235], v158 offset:12288
  v_mfma_f32_16x16x32_bf16 a[36:39], a[196:199], a[132:135], a[36:39]
  ds_read_b64_tr_b16 a[236:237], v159 offset:8192
  ds_read_b64_tr_b16 a[238:239], v159 offset:12288
  v_mfma_f32_16x16x32_bf16 a[8:11], a[200:203], a[128:131], a[8:11]
  ds_read_b64_tr_b16 a[240:241], v160 offset:8192
  ds_read_b64_tr_b16 a[242:243], v160 offset:12288
  v_mfma_f32_16x16x32_bf16 a[40:43], a[200:203], a[132:135], a[40:43]
  ds_read_b64_tr_b16 a[244:245], v161 offset:8192
  ds_read_b64_tr_b16 a[246:247], v161 offset:12288
  v_mfma_f32_16x16x32_bf16 a[12:15], a[204:207], a[128:131], a[12:15]
  ds_read_b64_tr_b16 a[248:249], v162 offset:8192
  ds_read_b64_tr_b16 a[250:251], v162 offset:12288
  v_mfma_f32_16x16x32_bf16 a[44:47], a[204:207], a[132:135], a[44:47]
  ds_read_b64_tr_b16 a[252:253], v163 offset:8192
  ds_read_b64_tr_b16 a[254:255], v163 offset:12288
  v_mfma_f32_16x16x32_bf16 a[16:19], a[208:211], a[128:131], a[16:19]
  v_mfma_f32_16x16x32_bf16 a[48:51], a[208:211], a[132:135], a[48:51]
  buffer_load_dwordx4 a[72:75], v66, s[12:15], s82 offen offset:1024 sc1
  v_mfma_f32_16x16x32_bf16 a[20:23], a[212:215], a[128:131], a[20:23]
  v_mfma_f32_16x16x32_bf16 a[52:55], a[212:215], a[132:135], a[52:55]
  s_add_u32 m0, s80, 2048
  s_add_u32 s84, s81, 10240
  buffer_load_dwordx4 v164, s[16:19], s84 offen lds
  v_mfma_f32_16x16x32_bf16 a[24:27], a[216:219], a[128:131], a[24:27]
  v_mfma_f32_16x16x32_bf16 a[56:59], a[216:219], a[132:135], a[56:59]
  buffer_load_dwordx4 a[76:79], v66, s[4:7], s82 offen offset:1024 sc1
  v_mfma_f32_16x16x32_bf16 a[28:31], a[220:223], a[128:131], a[28:31]
  v_mfma_f32_16x16x32_bf16 a[60:63], a[220:223], a[132:135], a[60:63]
  s_add_u32 m0, s80, 3072
  s_add_u32 s84, s81, 15360
  buffer_load_dwordx4 v165, s[16:19], s84 offen lds
  s_waitcnt lgkmcnt(0)
  v_mfma_f32_16x16x32_bf16 a[0:3], a[224:227], a[136:139], a[0:3]
  ds_read_b64_tr_b16 a[192:193], v156 offset:16384
  ds_read_b64_tr_b16 a[194:195], v156 offset:20480
  v_mfma_f32_16x16x32_bf16 a[32:35], a[224:227], a[140:143], a[32:35]
  ds_read_b64_tr_b16 a[196:197], v157 offset:16384
  ds_read_b64_tr_b16 a[198:199], v157 offset:20480
  v_mfma_f32_16x16x32_bf16 a[4:7], a[228:231], a[136:139], a[4:7]
  ds_read_b64_tr_b16 a[200:201], v158 offset:16384
  ds_read_b64_tr_b16 a[202:203], v158 offset:20480
  v_mfma_f32_16x16x32_bf16 a[36:39], a[228:231], a[140:143], a[36:39]
  ds_read_b64_tr_b16 a[204:205], v159 offset:16384
  ds_read_b64_tr_b16 a[206:207], v159 offset:20480
  v_mfma_f32_16x16x32_bf16 a[8:11], a[232:235], a[136:139], a[8:11]
  ds_read_b64_tr_b16 a[208:209], v160 offset:16384
  ds_read_b64_tr_b16 a[210:211], v160 offset:20480
  v_mfma_f32_16x16x32_bf16 a[40:43], a[232:235], a[140:143], a[40:43]
  ds_read_b64_tr_b16 a[212:213], v161 offset:16384
  ds_read_b64_tr_b16 a[214:215], v161 offset:20480
  v_mfma_f32_16x16x32_bf16 a[12:15], a[236:239], a[136:139], a[12:15]
  ds_read_b64_tr_b16 a[216:217], v162 offset:16384
  ds_read_b64_tr_b16 a[218:219], v162 offset:20480
  v_mfma_f32_16x16x32_bf16 a[44:47], a[236:239], a[140:143], a[44:47]
  ds_read_b64_tr_b16 a[220:221], v163 offset:16384
  ds_read_b64_tr_b16 a[222:223], v163 offset:20480
  v_mfma_f32_16x16x32_bf16 a[16:19], a[240:243], a[136:139], a[16:19]
  v_mfma_f32_16x16x32_bf16 a[48:51], a[240:243], a[140:143], a[48:51]
  buffer_load_dwordx4 a[80:83], v66, s[12:15], s82 offen offset:2048 sc1
  v_mfma_f32_16x16x32_bf16 a[20:23], a[244:247], a[136:139], a[20:23]
  v_mfma_f32_16x16x32_bf16 a[52:55], a[244:247], a[140:143], a[52:55]
  s_add_u32 m0, s80, 4096
  s_add_u32 s84, s81, 20480
  buffer_load_dwordx4 v164, s[16:19], s84 offen lds
  v_mfma_f32_16x16x32_bf16 a[24:27], a[248:251], a[136:139], a[24:27]
  v_mfma_f32_16x16x32_bf16 a[56:59], a[248:251], a[140:143], a[56:59]
  buffer_load_dwordx4 a[84:87], v66, s[4:7], s82 offen offset:2048 sc1
  v_mfma_f32_16x16x32_bf16 a[28:31], a[252:255], a[136:139], a[28:31]
  v_mfma_f32_16x16x32_bf16 a[60:63], a[252:255], a[140:143], a[60:63]
  s_add_u32 m0, s80, 5120
  s_add_u32 s84, s81, 25600
  buffer_load_dwordx4 v165, s[16:19], s84 offen lds
  s_waitcnt lgkmcnt(0)
  v_mfma_f32_16x16x32_bf16 a[0:3], a[192:195], a[144:147], a[0:3]
  ds_read_b64_tr_b16 a[224:225], v156 offset:24576
  ds_read_b64_tr_b16 a[226:227], v156 offset:28672
  v_mfma_f32_16x16x32_bf16 a[32:35], a[192:195], a[148:151], a[32:35]
  ds_read_b64_tr_b16 a[228:229], v157 offset:24576
  ds_read_b64_tr_b16 a[230:231], v157 offset:28672
  v_mfma_f32_16x16x32_bf16 a[4:7], a[196:199], a[144:147], a[4:7]
  ds_read_b64_tr_b16 a[232:233], v158 offset:24576
  ds_read_b64_tr_b16 a[234:235], v158 offset:28672
  v_mfma_f32_16x16x32_bf16 a[36:39], a[196:199], a[148:151], a[36:39]
  ds_read_b64_tr_b16 a[236:237], v159 offset:24576
  ds_read_b64_tr_b16 a[238:239], v159 offset:28672
  v_mfma_f32_16x16x32_bf16 a[8:11], a[200:203], a[144:147], a[8:11]
  ds_read_b64_tr_b16 a[240:241], v160 offset:24576
  ds_read_b64_tr_b16 a[242:243], v160 offset:28672
  v_mfma_f32_16x16x32_bf16 a[40:43], a[200:203], a[148:151], a[40:43]
  ds_read_b64_tr_b16 a[244:245], v161 offset:24576
  ds_read_b64_tr_b16 a[246:247], v161 offset:28672
  v_mfma_f32_16x16x32_bf16 a[12:15], a[204:207], a[144:147], a[12:15]
  ds_read_b64_tr_b16 a[248:249], v162 offset:24576
  ds_read_b64_tr_b16 a[250:251], v162 offset:28672
  v_mfma_f32_16x16x32_bf16 a[44:47], a[204:207], a[148:151], a[44:47]
  ds_read_b64_tr_b16 a[252:253], v163 offset:24576
  ds_read_b64_tr_b16 a[254:255], v163 offset:28672
  v_mfma_f32_16x16x32_bf16 a[16:19], a[208:211], a[144:147], a[16:19]
  v_mfma_f32_16x16x32_bf16 a[48:51], a[208:211], a[148:151], a[48:51]
  buffer_load_dwordx4 a[88:91], v66, s[12:15], s82 offen offset:3072 sc1
  v_mfma_f32_16x16x32_bf16 a[20:23], a[212:215], a[144:147], a[20:23]
  v_mfma_f32_16x16x32_bf16 a[52:55], a[212:215], a[148:151], a[52:55]
  s_add_u32 m0, s80, 6144
  s_add_u32 s84, s81, 30720
  buffer_load_dwordx4 v164, s[16:19], s84 offen lds
  v_mfma_f32_16x16x32_bf16 a[24:27], a[216:219], a[144:147], a[24:27]
  v_mfma_f32_16x16x32_bf16 a[56:59], a[216:219], a[148:151], a[56:59]
  buffer_load_dwordx4 a[92:95], v66, s[4:7], s82 offen offset:3072 sc1
  s_add_u32 s82, s82, 4096
  v_mfma_f32_16x16x32_bf16 a[28:31], a[220:223], a[144:147], a[28:31]
  v_mfma_f32_16x16x32_bf16 a[60:63], a[220:223], a[148:151], a[60:63]
  s_add_u32 m0, s80, 7168
  s_add_u32 s84, s81, 35840
  buffer_load_dwordx4 v165, s[16:19], s84 offen lds
  s_add_u32 s81, s81, 163840
  s_waitcnt vmcnt(16)
  s_barrier
  s_waitcnt lgkmcnt(0)
  v_mfma_f32_16x16x32_bf16 a[0:3], a[224:227], a[152:155], a[0:3]
  ds_read_b64_tr_b16 a[192:193], v156 offset:32768
  ds_read_b64_tr_b16 a[194:195], v156 offset:36864
  v_mfma_f32_16x16x32_bf16 a[32:35], a[224:227], a[156:159], a[32:35]
  ds_read_b64_tr_b16 a[196:197], v157 offset:32768
  ds_read_b64_tr_b16 a[198:199], v157 offset:36864
  v_mfma_f32_16x16x32_bf16 a[4:7], a[228:231], a[152:155], a[4:7]
  ds_read_b64_tr_b16 a[200:201], v158 offset:32768
  ds_read_b64_tr_b16 a[202:203], v158 offset:36864
  v_mfma_f32_16x16x32_bf16 a[36:39], a[228:231], a[156:159], a[36:39]
  ds_read_b64_tr_b16 a[204:205], v159 offset:32768
  ds_read_b64_tr_b16 a[206:207], v159 offset:36864
  v_mfma_f32_16x16x32_bf16 a[8:11], a[232:235], a[152:155], a[8:11]
  ds_read_b64_tr_b16 a[208:209], v160 offset:32768
  ds_read_b64_tr_b16 a[210:211], v160 offset:36864
  v_mfma_f32_16x16x32_bf16 a[40:43], a[232:235], a[156:159], a[40:43]
  ds_read_b64_tr_b16 a[212:213], v161 offset:32768
  ds_read_b64_tr_b16 a[214:215], v161 offset:36864
  v_mfma_f32_16x16x32_bf16 a[12:15], a[236:239], a[152:155], a[12:15]
  ds_read_b64_tr_b16 a[216:217], v162 offset:32768
  ds_read_b64_tr_b16 a[218:219], v162 offset:36864
  v_mfma_f32_16x16x32_bf16 a[44:47], a[236:239], a[156:159], a[44:47]
  ds_read_b64_tr_b16 a[220:221], v163 offset:32768
  ds_read_b64_tr_b16 a[222:223], v163 offset:36864
  v_mfma_f32_16x16x32_bf16 a[16:19], a[240:243], a[152:155], a[16:19]
  v_mfma_f32_16x16x32_bf16 a[48:51], a[240:243], a[156:159], a[48:51]
  buffer_load_dwordx4 a[96:99], v66, s[12:15], s82 offen offset:0 sc1
  v_mfma_f32_16x16x32_bf16 a[20:23], a[244:247], a[152:155], a[20:23]
  v_mfma_f32_16x16x32_bf16 a[52:55], a[244:247], a[156:159], a[52:55]
  s_add_u32 m0, s80, 32768
  s_nop 0
  buffer_load_dwordx4 v164, s[16:19], s81 offen lds
  v_mfma_f32_16x16x32_bf16 a[24:27], a[248:251], a[152:155], a[24:27]
  v_mfma_f32_16x16x32_bf16 a[56:59], a[248:251], a[156:159], a[56:59]
  buffer_load_dwordx4 a[100:103], v66, s[4:7], s82 offen offset:0 sc1
  v_mfma_f32_16x16x32_bf16 a[28:31], a[252:255], a[152:155], a[28:31]
  v_mfma_f32_16x16x32_bf16 a[60:63], a[252:255], a[156:159], a[60:63]
  s_add_u32 m0, s80, 33792
  s_add_u32 s84, s81, 5120
  buffer_load_dwordx4 v165, s[16:19], s84 offen lds
  s_waitcnt lgkmcnt(0)
  v_mfma_f32_16x16x32_bf16 a[0:3], a[192:195], a[160:163], a[0:3]
  ds_read_b64_tr_b16 a[224:225], v156 offset:40960
  ds_read_b64_tr_b16 a[226:227], v156 offset:45056
  v_mfma_f32_16x16x32_bf16 a[32:35], a[192:195], a[164:167], a[32:35]
  ds_read_b64_tr_b16 a[228:229], v157 offset:40960
  ds_read_b64_tr_b16 a[230:231], v157 offset:45056
  v_mfma_f32_16x16x32_bf16 a[4:7], a[196:199], a[160:163], a[4:7]
  ds_read_b64_tr_b16 a[232:233], v158 offset:40960
  ds_read_b64_tr_b16 a[234:235], v158 offset:45056
  v_mfma_f32_16x16x32_bf16 a[36:39], a[196:199], a[164:167], a[36:39]
  ds_read_b64_tr_b16 a[236:237], v159 offset:40960
  ds_read_b64_tr_b16 a[238:239], v159 offset:45056
  v_mfma_f32_16x16x32_bf16 a[8:11], a[200:203], a[160:163], a[8:11]
  ds_read_b64_tr_b16 a[240:241], v160 offset:40960
  ds_read_b64_tr_b16 a[242:243], v160 offset:45056
  v_mfma_f32_16x16x32_bf16 a[40:43], a[200:203], a[164:167], a[40:43]
  ds_read_b64_tr_b16 a[244:245], v161 offset:40960
  ds_read_b64_tr_b16 a[246:247], v161 offset:45056
  v_mfma_f32_16x16x32_bf16 a[12:15], a[204:207], a[160:163], a[12:15]
  ds_read_b64_tr_b16 a[248:249], v162 offset:40960
  ds_read_b64_tr_b16 a[250:251], v162 offset:45056
  v_mfma_f32_16x16x32_bf16 a[44:47], a[204:207], a[164:167], a[44:47]
  ds_read_b64_tr_b16 a[252:253], v163 offset:40960
  ds_read_b64_tr_b16 a[254:255], v163 offset:45056
  v_mfma_f32_16x16x32_bf16 a[16:19], a[208:211], a[160:163], a[16:19]
  v_mfma_f32_16x16x32_bf16 a[48:51], a[208:211], a[164:167], a[48:51]
  buffer_load_dwordx4 a[104:107], v66, s[12:15], s82 offen offset:1024 sc1
  v_mfma_f32_16x16x32_bf16 a[20:23], a[212:215], a[160:163], a[20:23]
  v_mfma_f32_16x16x32_bf16 a[52:55], a[212:215], a[164:167], a[52:55]
  s_add_u32 m0, s80, 34816
  s_add_u32 s84, s81, 10240
  buffer_load_dwordx4 v164, s[16:19], s84 offen lds
  v_mfma_f32_16x16x32_bf16 a[24:27], a[216:219], a[160:163], a[24:27]
  v_mfma_f32_16x16x32_bf16 a[56:59], a[216:219], a[164:167], a[56:59]
  buffer_load_dwordx4 a[108:111], v66, s[4:7], s82 offen offset:1024 sc1
  v_mfma_f32_16x16x32_bf16 a[28:31], a[220:223], a[160:163], a[28:31]
  v_mfma_f32_16x16x32_bf16 a[60:63], a[220:223], a[164:167], a[60:63]
  s_add_u32 m0, s80, 35840
  s_add_u32 s84, s81, 15360
  buffer_load_dwordx4 v165, s[16:19], s84 offen lds
  s_waitcnt lgkmcnt(0)
  v_mfma_f32_16x16x32_bf16 a[0:3], a[224:227], a[168:171], a[0:3]
  ds_read_b64_tr_b16 a[192:193], v156 offset:49152
  ds_read_b64_tr_b16 a[194:195], v156 offset:53248
  v_mfma_f32_16x16x32_bf16 a[32:35], a[224:227], a[172:175], a[32:35]
  ds_read_b64_tr_b16 a[196:197], v157 offset:49152
  ds_read_b64_tr_b16 a[198:199], v157 offset:53248
  v_mfma_f32_16x16x32_bf16 a[4:7], a[228:231], a[168:171], a[4:7]
  ds_read_b64_tr_b16 a[200:201], v158 offset:49152
  ds_read_b64_tr_b16 a[202:203], v158 offset:53248
  v_mfma_f32_16x16x32_bf16 a[36:39], a[228:231], a[172:175], a[36:39]
  ds_read_b64_tr_b16 a[204:205], v159 offset:49152
  ds_read_b64_tr_b16 a[206:207], v159 offset:53248
  v_mfma_f32_16x16x32_bf16 a[8:11], a[232:235], a[168:171], a[8:11]
  ds_read_b64_tr_b16 a[208:209], v160 offset:49152
  ds_read_b64_tr_b16 a[210:211], v160 offset:53248
  v_mfma_f32_16x16x32_bf16 a[40:43], a[232:235], a[172:175], a[40:43]
  ds_read_b64_tr_b16 a[212:213], v161 offset:49152
  ds_read_b64_tr_b16 a[214:215], v161 offset:53248
  v_mfma_f32_16x16x32_bf16 a[12:15], a[236:239], a[168:171], a[12:15]
  ds_read_b64_tr_b16 a[216:217], v162 offset:49152
  ds_read_b64_tr_b16 a[218:219], v162 offset:53248
  v_mfma_f32_16x16x32_bf16 a[44:47], a[236:239], a[172:175], a[44:47]
  ds_read_b64_tr_b16 a[220:221], v163 offset:49152
  ds_read_b64_tr_b16 a[222:223], v163 offset:53248
  v_mfma_f32_16x16x32_bf16 a[16:19], a[240:243], a[168:171], a[16:19]
  v_mfma_f32_16x16x32_bf16 a[48:51], a[240:243], a[172:175], a[48:51]
  buffer_load_dwordx4 a[112:115], v66, s[12:15], s82 offen offset:2048 sc1
  v_mfma_f32_16x16x32_bf16 a[20:23], a[244:247], a[168:171], a[20:23]
  v_mfma_f32_16x16x32_bf16 a[52:55], a[244:247], a[172:175], a[52:55]
  s_add_u32 m0, s80, 36864
  s_add_u32 s84, s81, 20480
  buffer_load_dwordx4 v164, s[16:19], s84 offen lds
  v_mfma_f32_16x16x32_bf16 a[24:27], a[248:251], a[168:171], a[24:27]
  v_mfma_f32_16x16x32_bf16 a[56:59], a[248:251], a[172:175], a[56:59]
  buffer_load_dwordx4 a[116:119], v66, s[4:7], s82 offen offset:2048 sc1
  v_mfma_f32_16x16x32_bf16 a[28:31], a[252:255], a[168:171], a[28:31]
  v_mfma_f32_16x16x32_bf16 a[60:63], a[252:255], a[172:175], a[60:63]
  s_add_u32 m0, s80, 37888
  s_add_u32 s84, s81, 25600
  buffer_load_dwordx4 v165, s[16:19], s84 offen lds
  s_waitcnt lgkmcnt(0)
  v_mfma_f32_16x16x32_bf16 a[0:3], a[192:195], a[176:179], a[0:3]
  ds_read_b64_tr_b16 a[224:225], v156 offset:57344
  ds_read_b64_tr_b16 a[226:227], v156 offset:61440
  v_mfma_f32_16x16x32_bf16 a[32:35], a[192:195], a[180:183], a[32:35]
  ds_read_b64_tr_b16 a[228:229], v157 offset:57344
  ds_read_b64_tr_b16 a[230:231], v157 offset:61440
  v_mfma_f32_16x16x32_bf16 a[4:7], a[196:199], a[176:179], a[4:7]
  ds_read_b64_tr_b16 a[232:233], v158 offset:57344
  ds_read_b64_tr_b16 a[234:235], v158 offset:61440
  v_mfma_f32_16x16x32_bf16 a[36:39], a[196:199], a[180:183], a[36:39]
  ds_read_b64_tr_b16 a[236:237], v159 offset:57344
  ds_read_b64_tr_b16 a[238:239], v159 offset:61440
  v_mfma_f32_16x16x32_bf16 a[8:11], a[200:203], a[176:179], a[8:11]
  ds_read_b64_tr_b16 a[240:241], v160 offset:57344
  ds_read_b64_tr_b16 a[242:243], v160 offset:61440
  v_mfma_f32_16x16x32_bf16 a[40:43], a[200:203], a[180:183], a[40:43]
  ds_read_b64_tr_b16 a[244:245], v161 offset:57344
  ds_read_b64_tr_b16 a[246:247], v161 offset:61440
  v_mfma_f32_16x16x32_bf16 a[12:15], a[204:207], a[176:179], a[12:15]
  ds_read_b64_tr_b16 a[248:249], v162 offset:57344
  ds_read_b64_tr_b16 a[250:251], v162 offset:61440
  v_mfma_f32_16x16x32_bf16 a[44:47], a[204:207], a[180:183], a[44:47]
  ds_read_b64_tr_b16 a[252:253], v163 offset:57344
  ds_read_b64_tr_b16 a[254:255], v163 offset:61440
  v_mfma_f32_16x16x32_bf16 a[16:19], a[208:211], a[176:179], a[16:19]
  v_mfma_f32_16x16x32_bf16 a[48:51], a[208:211], a[180:183], a[48:51]
  buffer_load_dwordx4 a[120:123], v66, s[12:15], s82 offen offset:3072 sc1
  v_mfma_f32_16x16x32_bf16 a[20:23], a[212:215], a[176:179], a[20:23]
  v_mfma_f32_16x16x32_bf16 a[52:55], a[212:215], a[180:183], a[52:55]
  s_add_u32 m0, s80, 38912
  s_add_u32 s84, s81, 30720
  buffer_load_dwordx4 v164, s[16:19], s84 offen lds
  v_mfma_f32_16x16x32_bf16 a[24:27], a[216:219], a[176:179], a[24:27]
  v_mfma_f32_16x16x32_bf16 a[56:59], a[216:219], a[180:183], a[56:59]
  buffer_load_dwordx4 a[124:127], v66, s[4:7], s82 offen offset:3072 sc1
  s_add_u32 s82, s82, 4096
  v_mfma_f32_16x16x32_bf16 a[28:31], a[220:223], a[176:179], a[28:31]
  v_mfma_f32_16x16x32_bf16 a[60:63], a[220:223], a[180:183], a[60:63]
  s_add_u32 m0, s80, 39936
  s_add_u32 s84, s81, 35840
  buffer_load_dwordx4 v165, s[16:19], s84 offen lds
  s_add_u32 s81, s81, 163840
  s_cmp_eq_u32 s24, 0
  s_cbranch_scc0 concat_heads__mha_block_cached__mha_block_cached__near_ridge_kernel_sg4
  s_lshl_b32 s87, s66, 1
  s_add_u32 s87, s87, 1
  s_lshl_b32 s87, s87, 4
  v_mov_b32 v1, 1
  v_mov_b32 v2, s87
  s_mov_b64 exec, 1
  buffer_atomic_add v1, v2, s[76:79], 0 offen sc1
  s_mov_b64 exec, -1
concat_heads__mha_block_cached__mha_block_cached__near_ridge_kernel_sg4:
  s_mov_b32 s83, 7
concat_heads__mha_block_cached__mha_block_cached__near_ridge_kernel_t2loop:
  s_waitcnt vmcnt(16)
  s_barrier
  s_waitcnt lgkmcnt(0)
  v_mfma_f32_16x16x32_bf16 a[0:3], a[224:227], a[184:187], a[0:3]
  ds_read_b64_tr_b16 a[192:193], v148 offset:0
  ds_read_b64_tr_b16 a[194:195], v148 offset:4096
  v_mfma_f32_16x16x32_bf16 a[32:35], a[224:227], a[188:191], a[32:35]
  ds_read_b64_tr_b16 a[196:197], v149 offset:0
  ds_read_b64_tr_b16 a[198:199], v149 offset:4096
  v_mfma_f32_16x16x32_bf16 a[4:7], a[228:231], a[184:187], a[4:7]
  ds_read_b64_tr_b16 a[200:201], v150 offset:0
  ds_read_b64_tr_b16 a[202:203], v150 offset:4096
  v_mfma_f32_16x16x32_bf16 a[36:39], a[228:231], a[188:191], a[36:39]
  ds_read_b64_tr_b16 a[204:205], v151 offset:0
  ds_read_b64_tr_b16 a[206:207], v151 offset:4096
  v_mfma_f32_16x16x32_bf16 a[8:11], a[232:235], a[184:187], a[8:11]
  ds_read_b64_tr_b16 a[208:209], v152 offset:0
  ds_read_b64_tr_b16 a[210:211], v152 offset:4096
  v_mfma_f32_16x16x32_bf16 a[40:43], a[232:235], a[188:191], a[40:43]
  ds_read_b64_tr_b16 a[212:213], v153 offset:0
  ds_read_b64_tr_b16 a[214:215], v153 offset:4096
  v_mfma_f32_16x16x32_bf16 a[12:15], a[236:239], a[184:187], a[12:15]
  ds_read_b64_tr_b16 a[216:217], v154 offset:0
  ds_read_b64_tr_b16 a[218:219], v154 offset:4096
  v_mfma_f32_16x16x32_bf16 a[44:47], a[236:239], a[188:191], a[44:47]
  ds_read_b64_tr_b16 a[220:221], v155 offset:0
  ds_read_b64_tr_b16 a[222:223], v155 offset:4096
  v_mfma_f32_16x16x32_bf16 a[16:19], a[240:243], a[184:187], a[16:19]
  v_mfma_f32_16x16x32_bf16 a[48:51], a[240:243], a[188:191], a[48:51]
  buffer_load_dwordx4 a[128:131], v66, s[12:15], s82 offen offset:0 sc1
  v_mfma_f32_16x16x32_bf16 a[20:23], a[244:247], a[184:187], a[20:23]
  v_mfma_f32_16x16x32_bf16 a[52:55], a[244:247], a[188:191], a[52:55]
  s_add_u32 m0, s80, 65536
  s_nop 0
  buffer_load_dwordx4 v164, s[16:19], s81 offen lds
  v_mfma_f32_16x16x32_bf16 a[24:27], a[248:251], a[184:187], a[24:27]
  v_mfma_f32_16x16x32_bf16 a[56:59], a[248:251], a[188:191], a[56:59]
  buffer_load_dwordx4 a[132:135], v66, s[4:7], s82 offen offset:0 sc1
  v_mfma_f32_16x16x32_bf16 a[28:31], a[252:255], a[184:187], a[28:31]
  v_mfma_f32_16x16x32_bf16 a[60:63], a[252:255], a[188:191], a[60:63]
  s_add_u32 m0, s80, 66560
  s_add_u32 s84, s81, 5120
  buffer_load_dwordx4 v165, s[16:19], s84 offen lds
  s_waitcnt lgkmcnt(0)
  v_mfma_f32_16x16x32_bf16 a[0:3], a[192:195], a[64:67], a[0:3]
  ds_read_b64_tr_b16 a[224:225], v148 offset:8192
  ds_read_b64_tr_b16 a[226:227], v148 offset:12288
  v_mfma_f32_16x16x32_bf16 a[32:35], a[192:195], a[68:71], a[32:35]
  ds_read_b64_tr_b16 a[228:229], v149 offset:8192
  ds_read_b64_tr_b16 a[230:231], v149 offset:12288
  v_mfma_f32_16x16x32_bf16 a[4:7], a[196:199], a[64:67], a[4:7]
  ds_read_b64_tr_b16 a[232:233], v150 offset:8192
  ds_read_b64_tr_b16 a[234:235], v150 offset:12288
  v_mfma_f32_16x16x32_bf16 a[36:39], a[196:199], a[68:71], a[36:39]
  ds_read_b64_tr_b16 a[236:237], v151 offset:8192
  ds_read_b64_tr_b16 a[238:239], v151 offset:12288
  v_mfma_f32_16x16x32_bf16 a[8:11], a[200:203], a[64:67], a[8:11]
  ds_read_b64_tr_b16 a[240:241], v152 offset:8192
  ds_read_b64_tr_b16 a[242:243], v152 offset:12288
  v_mfma_f32_16x16x32_bf16 a[40:43], a[200:203], a[68:71], a[40:43]
  ds_read_b64_tr_b16 a[244:245], v153 offset:8192
  ds_read_b64_tr_b16 a[246:247], v153 offset:12288
  v_mfma_f32_16x16x32_bf16 a[12:15], a[204:207], a[64:67], a[12:15]
  ds_read_b64_tr_b16 a[248:249], v154 offset:8192
  ds_read_b64_tr_b16 a[250:251], v154 offset:12288
  v_mfma_f32_16x16x32_bf16 a[44:47], a[204:207], a[68:71], a[44:47]
  ds_read_b64_tr_b16 a[252:253], v155 offset:8192
  ds_read_b64_tr_b16 a[254:255], v155 offset:12288
  v_mfma_f32_16x16x32_bf16 a[16:19], a[208:211], a[64:67], a[16:19]
  v_mfma_f32_16x16x32_bf16 a[48:51], a[208:211], a[68:71], a[48:51]
  buffer_load_dwordx4 a[136:139], v66, s[12:15], s82 offen offset:1024 sc1
  v_mfma_f32_16x16x32_bf16 a[20:23], a[212:215], a[64:67], a[20:23]
  v_mfma_f32_16x16x32_bf16 a[52:55], a[212:215], a[68:71], a[52:55]
  s_add_u32 m0, s80, 67584
  s_add_u32 s84, s81, 10240
  buffer_load_dwordx4 v164, s[16:19], s84 offen lds
  v_mfma_f32_16x16x32_bf16 a[24:27], a[216:219], a[64:67], a[24:27]
  v_mfma_f32_16x16x32_bf16 a[56:59], a[216:219], a[68:71], a[56:59]
  buffer_load_dwordx4 a[140:143], v66, s[4:7], s82 offen offset:1024 sc1
  v_mfma_f32_16x16x32_bf16 a[28:31], a[220:223], a[64:67], a[28:31]
  v_mfma_f32_16x16x32_bf16 a[60:63], a[220:223], a[68:71], a[60:63]
  s_add_u32 m0, s80, 68608
  s_add_u32 s84, s81, 15360
  buffer_load_dwordx4 v165, s[16:19], s84 offen lds
  s_waitcnt lgkmcnt(0)
  v_mfma_f32_16x16x32_bf16 a[0:3], a[224:227], a[72:75], a[0:3]
  ds_read_b64_tr_b16 a[192:193], v148 offset:16384
  ds_read_b64_tr_b16 a[194:195], v148 offset:20480
  v_mfma_f32_16x16x32_bf16 a[32:35], a[224:227], a[76:79], a[32:35]
  ds_read_b64_tr_b16 a[196:197], v149 offset:16384
  ds_read_b64_tr_b16 a[198:199], v149 offset:20480
  v_mfma_f32_16x16x32_bf16 a[4:7], a[228:231], a[72:75], a[4:7]
  ds_read_b64_tr_b16 a[200:201], v150 offset:16384
  ds_read_b64_tr_b16 a[202:203], v150 offset:20480
  v_mfma_f32_16x16x32_bf16 a[36:39], a[228:231], a[76:79], a[36:39]
  ds_read_b64_tr_b16 a[204:205], v151 offset:16384
  ds_read_b64_tr_b16 a[206:207], v151 offset:20480
  v_mfma_f32_16x16x32_bf16 a[8:11], a[232:235], a[72:75], a[8:11]
  ds_read_b64_tr_b16 a[208:209], v152 offset:16384
  ds_read_b64_tr_b16 a[210:211], v152 offset:20480
  v_mfma_f32_16x16x32_bf16 a[40:43], a[232:235], a[76:79], a[40:43]
  ds_read_b64_tr_b16 a[212:213], v153 offset:16384
  ds_read_b64_tr_b16 a[214:215], v153 offset:20480
  v_mfma_f32_16x16x32_bf16 a[12:15], a[236:239], a[72:75], a[12:15]
  ds_read_b64_tr_b16 a[216:217], v154 offset:16384
  ds_read_b64_tr_b16 a[218:219], v154 offset:20480
  v_mfma_f32_16x16x32_bf16 a[44:47], a[236:239], a[76:79], a[44:47]
  ds_read_b64_tr_b16 a[220:221], v155 offset:16384
  ds_read_b64_tr_b16 a[222:223], v155 offset:20480
  v_mfma_f32_16x16x32_bf16 a[16:19], a[240:243], a[72:75], a[16:19]
  v_mfma_f32_16x16x32_bf16 a[48:51], a[240:243], a[76:79], a[48:51]
  buffer_load_dwordx4 a[144:147], v66, s[12:15], s82 offen offset:2048 sc1
  v_mfma_f32_16x16x32_bf16 a[20:23], a[244:247], a[72:75], a[20:23]
  v_mfma_f32_16x16x32_bf16 a[52:55], a[244:247], a[76:79], a[52:55]
  s_add_u32 m0, s80, 69632
  s_add_u32 s84, s81, 20480
  buffer_load_dwordx4 v164, s[16:19], s84 offen lds
  v_mfma_f32_16x16x32_bf16 a[24:27], a[248:251], a[72:75], a[24:27]
  v_mfma_f32_16x16x32_bf16 a[56:59], a[248:251], a[76:79], a[56:59]
  buffer_load_dwordx4 a[148:151], v66, s[4:7], s82 offen offset:2048 sc1
  v_mfma_f32_16x16x32_bf16 a[28:31], a[252:255], a[72:75], a[28:31]
  v_mfma_f32_16x16x32_bf16 a[60:63], a[252:255], a[76:79], a[60:63]
  s_add_u32 m0, s80, 70656
  s_add_u32 s84, s81, 25600
  buffer_load_dwordx4 v165, s[16:19], s84 offen lds
  s_waitcnt lgkmcnt(0)
  v_mfma_f32_16x16x32_bf16 a[0:3], a[192:195], a[80:83], a[0:3]
  ds_read_b64_tr_b16 a[224:225], v148 offset:24576
  ds_read_b64_tr_b16 a[226:227], v148 offset:28672
  v_mfma_f32_16x16x32_bf16 a[32:35], a[192:195], a[84:87], a[32:35]
  ds_read_b64_tr_b16 a[228:229], v149 offset:24576
  ds_read_b64_tr_b16 a[230:231], v149 offset:28672
  v_mfma_f32_16x16x32_bf16 a[4:7], a[196:199], a[80:83], a[4:7]
  ds_read_b64_tr_b16 a[232:233], v150 offset:24576
  ds_read_b64_tr_b16 a[234:235], v150 offset:28672
  v_mfma_f32_16x16x32_bf16 a[36:39], a[196:199], a[84:87], a[36:39]
  ds_read_b64_tr_b16 a[236:237], v151 offset:24576
  ds_read_b64_tr_b16 a[238:239], v151 offset:28672
  v_mfma_f32_16x16x32_bf16 a[8:11], a[200:203], a[80:83], a[8:11]
  ds_read_b64_tr_b16 a[240:241], v152 offset:24576
  ds_read_b64_tr_b16 a[242:243], v152 offset:28672
  v_mfma_f32_16x16x32_bf16 a[40:43], a[200:203], a[84:87], a[40:43]
  ds_read_b64_tr_b16 a[244:245], v153 offset:24576
  ds_read_b64_tr_b16 a[246:247], v153 offset:28672
  v_mfma_f32_16x16x32_bf16 a[12:15], a[204:207], a[80:83], a[12:15]
  ds_read_b64_tr_b16 a[248:249], v154 offset:24576
  ds_read_b64_tr_b16 a[250:251], v154 offset:28672
  v_mfma_f32_16x16x32_bf16 a[44:47], a[204:207], a[84:87], a[44:47]
  ds_read_b64_tr_b16 a[252:253], v155 offset:24576
  ds_read_b64_tr_b16 a[254:255], v155 offset:28672
  v_mfma_f32_16x16x32_bf16 a[16:19], a[208:211], a[80:83], a[16:19]
  v_mfma_f32_16x16x32_bf16 a[48:51], a[208:211], a[84:87], a[48:51]
  buffer_load_dwordx4 a[152:155], v66, s[12:15], s82 offen offset:3072 sc1
  v_mfma_f32_16x16x32_bf16 a[20:23], a[212:215], a[80:83], a[20:23]
  v_mfma_f32_16x16x32_bf16 a[52:55], a[212:215], a[84:87], a[52:55]
  s_add_u32 m0, s80, 71680
  s_add_u32 s84, s81, 30720
  buffer_load_dwordx4 v164, s[16:19], s84 offen lds
  v_mfma_f32_16x16x32_bf16 a[24:27], a[216:219], a[80:83], a[24:27]
  v_mfma_f32_16x16x32_bf16 a[56:59], a[216:219], a[84:87], a[56:59]
  buffer_load_dwordx4 a[156:159], v66, s[4:7], s82 offen offset:3072 sc1
  s_add_u32 s82, s82, 4096
  v_mfma_f32_16x16x32_bf16 a[28:31], a[220:223], a[80:83], a[28:31]
  v_mfma_f32_16x16x32_bf16 a[60:63], a[220:223], a[84:87], a[60:63]
  s_add_u32 m0, s80, 72704
  s_add_u32 s84, s81, 35840
  buffer_load_dwordx4 v165, s[16:19], s84 offen lds
  s_add_u32 s81, s81, 163840
  s_waitcnt vmcnt(16)
  s_barrier
  s_waitcnt lgkmcnt(0)
  v_mfma_f32_16x16x32_bf16 a[0:3], a[224:227], a[88:91], a[0:3]
  ds_read_b64_tr_b16 a[192:193], v148 offset:32768
  ds_read_b64_tr_b16 a[194:195], v148 offset:36864
  v_mfma_f32_16x16x32_bf16 a[32:35], a[224:227], a[92:95], a[32:35]
  ds_read_b64_tr_b16 a[196:197], v149 offset:32768
  ds_read_b64_tr_b16 a[198:199], v149 offset:36864
  v_mfma_f32_16x16x32_bf16 a[4:7], a[228:231], a[88:91], a[4:7]
  ds_read_b64_tr_b16 a[200:201], v150 offset:32768
  ds_read_b64_tr_b16 a[202:203], v150 offset:36864
  v_mfma_f32_16x16x32_bf16 a[36:39], a[228:231], a[92:95], a[36:39]
  ds_read_b64_tr_b16 a[204:205], v151 offset:32768
  ds_read_b64_tr_b16 a[206:207], v151 offset:36864
  v_mfma_f32_16x16x32_bf16 a[8:11], a[232:235], a[88:91], a[8:11]
  ds_read_b64_tr_b16 a[208:209], v152 offset:32768
  ds_read_b64_tr_b16 a[210:211], v152 offset:36864
  v_mfma_f32_16x16x32_bf16 a[40:43], a[232:235], a[92:95], a[40:43]
  ds_read_b64_tr_b16 a[212:213], v153 offset:32768
  ds_read_b64_tr_b16 a[214:215], v153 offset:36864
  v_mfma_f32_16x16x32_bf16 a[12:15], a[236:239], a[88:91], a[12:15]
  ds_read_b64_tr_b16 a[216:217], v154 offset:32768
  ds_read_b64_tr_b16 a[218:219], v154 offset:36864
  v_mfma_f32_16x16x32_bf16 a[44:47], a[236:239], a[92:95], a[44:47]
  ds_read_b64_tr_b16 a[220:221], v155 offset:32768
  ds_read_b64_tr_b16 a[222:223], v155 offset:36864
  v_mfma_f32_16x16x32_bf16 a[16:19], a[240:243], a[88:91], a[16:19]
  v_mfma_f32_16x16x32_bf16 a[48:51], a[240:243], a[92:95], a[48:51]
  buffer_load_dwordx4 a[160:163], v66, s[12:15], s82 offen offset:0 sc1
  v_mfma_f32_16x16x32_bf16 a[20:23], a[244:247], a[88:91], a[20:23]
  v_mfma_f32_16x16x32_bf16 a[52:55], a[244:247], a[92:95], a[52:55]
  s_add_u32 m0, s80, 98304
  s_nop 0
  buffer_load_dwordx4 v164, s[16:19], s81 offen lds
  v_mfma_f32_16x16x32_bf16 a[24:27], a[248:251], a[88:91], a[24:27]
  v_mfma_f32_16x16x32_bf16 a[56:59], a[248:251], a[92:95], a[56:59]
  buffer_load_dwordx4 a[164:167], v66, s[4:7], s82 offen offset:0 sc1
  v_mfma_f32_16x16x32_bf16 a[28:31], a[252:255], a[88:91], a[28:31]
  v_mfma_f32_16x16x32_bf16 a[60:63], a[252:255], a[92:95], a[60:63]
  s_add_u32 m0, s80, 99328
  s_add_u32 s84, s81, 5120
  buffer_load_dwordx4 v165, s[16:19], s84 offen lds
  s_waitcnt lgkmcnt(0)
  v_mfma_f32_16x16x32_bf16 a[0:3], a[192:195], a[96:99], a[0:3]
  ds_read_b64_tr_b16 a[224:225], v148 offset:40960
  ds_read_b64_tr_b16 a[226:227], v148 offset:45056
  v_mfma_f32_16x16x32_bf16 a[32:35], a[192:195], a[100:103], a[32:35]
  ds_read_b64_tr_b16 a[228:229], v149 offset:40960
  ds_read_b64_tr_b16 a[230:231], v149 offset:45056
  v_mfma_f32_16x16x32_bf16 a[4:7], a[196:199], a[96:99], a[4:7]
  ds_read_b64_tr_b16 a[232:233], v150 offset:40960
  ds_read_b64_tr_b16 a[234:235], v150 offset:45056
  v_mfma_f32_16x16x32_bf16 a[36:39], a[196:199], a[100:103], a[36:39]
  ds_read_b64_tr_b16 a[236:237], v151 offset:40960
  ds_read_b64_tr_b16 a[238:239], v151 offset:45056
  v_mfma_f32_16x16x32_bf16 a[8:11], a[200:203], a[96:99], a[8:11]
  ds_read_b64_tr_b16 a[240:241], v152 offset:40960
  ds_read_b64_tr_b16 a[242:243], v152 offset:45056
  v_mfma_f32_16x16x32_bf16 a[40:43], a[200:203], a[100:103], a[40:43]
  ds_read_b64_tr_b16 a[244:245], v153 offset:40960
  ds_read_b64_tr_b16 a[246:247], v153 offset:45056
  v_mfma_f32_16x16x32_bf16 a[12:15], a[204:207], a[96:99], a[12:15]
  ds_read_b64_tr_b16 a[248:249], v154 offset:40960
  ds_read_b64_tr_b16 a[250:251], v154 offset:45056
  v_mfma_f32_16x16x32_bf16 a[44:47], a[204:207], a[100:103], a[44:47]
  ds_read_b64_tr_b16 a[252:253], v155 offset:40960
  ds_read_b64_tr_b16 a[254:255], v155 offset:45056
  v_mfma_f32_16x16x32_bf16 a[16:19], a[208:211], a[96:99], a[16:19]
  v_mfma_f32_16x16x32_bf16 a[48:51], a[208:211], a[100:103], a[48:51]
  buffer_load_dwordx4 a[168:171], v66, s[12:15], s82 offen offset:1024 sc1
  v_mfma_f32_16x16x32_bf16 a[20:23], a[212:215], a[96:99], a[20:23]
  v_mfma_f32_16x16x32_bf16 a[52:55], a[212:215], a[100:103], a[52:55]
  s_add_u32 m0, s80, 100352
  s_add_u32 s84, s81, 10240
  buffer_load_dwordx4 v164, s[16:19], s84 offen lds
  v_mfma_f32_16x16x32_bf16 a[24:27], a[216:219], a[96:99], a[24:27]
  v_mfma_f32_16x16x32_bf16 a[56:59], a[216:219], a[100:103], a[56:59]
  buffer_load_dwordx4 a[172:175], v66, s[4:7], s82 offen offset:1024 sc1
  v_mfma_f32_16x16x32_bf16 a[28:31], a[220:223], a[96:99], a[28:31]
  v_mfma_f32_16x16x32_bf16 a[60:63], a[220:223], a[100:103], a[60:63]
  s_add_u32 m0, s80, 101376
  s_add_u32 s84, s81, 15360
  buffer_load_dwordx4 v165, s[16:19], s84 offen lds
  s_waitcnt lgkmcnt(0)
  v_mfma_f32_16x16x32_bf16 a[0:3], a[224:227], a[104:107], a[0:3]
  ds_read_b64_tr_b16 a[192:193], v148 offset:49152
  ds_read_b64_tr_b16 a[194:195], v148 offset:53248
  v_mfma_f32_16x16x32_bf16 a[32:35], a[224:227], a[108:111], a[32:35]
  ds_read_b64_tr_b16 a[196:197], v149 offset:49152
  ds_read_b64_tr_b16 a[198:199], v149 offset:53248
  v_mfma_f32_16x16x32_bf16 a[4:7], a[228:231], a[104:107], a[4:7]
  ds_read_b64_tr_b16 a[200:201], v150 offset:49152
  ds_read_b64_tr_b16 a[202:203], v150 offset:53248
  v_mfma_f32_16x16x32_bf16 a[36:39], a[228:231], a[108:111], a[36:39]
  ds_read_b64_tr_b16 a[204:205], v151 offset:49152
  ds_read_b64_tr_b16 a[206:207], v151 offset:53248
  v_mfma_f32_16x16x32_bf16 a[8:11], a[232:235], a[104:107], a[8:11]
  ds_read_b64_tr_b16 a[208:209], v152 offset:49152
  ds_read_b64_tr_b16 a[210:211], v152 offset:53248
  v_mfma_f32_16x16x32_bf16 a[40:43], a[232:235], a[108:111], a[40:43]
  ds_read_b64_tr_b16 a[212:213], v153 offset:49152
  ds_read_b64_tr_b16 a[214:215], v153 offset:53248
  v_mfma_f32_16x16x32_bf16 a[12:15], a[236:239], a[104:107], a[12:15]
  ds_read_b64_tr_b16 a[216:217], v154 offset:49152
  ds_read_b64_tr_b16 a[218:219], v154 offset:53248
  v_mfma_f32_16x16x32_bf16 a[44:47], a[236:239], a[108:111], a[44:47]
  ds_read_b64_tr_b16 a[220:221], v155 offset:49152
  ds_read_b64_tr_b16 a[222:223], v155 offset:53248
  v_mfma_f32_16x16x32_bf16 a[16:19], a[240:243], a[104:107], a[16:19]
  v_mfma_f32_16x16x32_bf16 a[48:51], a[240:243], a[108:111], a[48:51]
  buffer_load_dwordx4 a[176:179], v66, s[12:15], s82 offen offset:2048 sc1
  v_mfma_f32_16x16x32_bf16 a[20:23], a[244:247], a[104:107], a[20:23]
  v_mfma_f32_16x16x32_bf16 a[52:55], a[244:247], a[108:111], a[52:55]
  s_add_u32 m0, s80, 102400
  s_add_u32 s84, s81, 20480
  buffer_load_dwordx4 v164, s[16:19], s84 offen lds
  v_mfma_f32_16x16x32_bf16 a[24:27], a[248:251], a[104:107], a[24:27]
  v_mfma_f32_16x16x32_bf16 a[56:59], a[248:251], a[108:111], a[56:59]
  buffer_load_dwordx4 a[180:183], v66, s[4:7], s82 offen offset:2048 sc1
  v_mfma_f32_16x16x32_bf16 a[28:31], a[252:255], a[104:107], a[28:31]
  v_mfma_f32_16x16x32_bf16 a[60:63], a[252:255], a[108:111], a[60:63]
  s_add_u32 m0, s80, 103424
  s_add_u32 s84, s81, 25600
  buffer_load_dwordx4 v165, s[16:19], s84 offen lds
  s_waitcnt lgkmcnt(0)
  v_mfma_f32_16x16x32_bf16 a[0:3], a[192:195], a[112:115], a[0:3]
  ds_read_b64_tr_b16 a[224:225], v148 offset:57344
  ds_read_b64_tr_b16 a[226:227], v148 offset:61440
  v_mfma_f32_16x16x32_bf16 a[32:35], a[192:195], a[116:119], a[32:35]
  ds_read_b64_tr_b16 a[228:229], v149 offset:57344
  ds_read_b64_tr_b16 a[230:231], v149 offset:61440
  v_mfma_f32_16x16x32_bf16 a[4:7], a[196:199], a[112:115], a[4:7]
  ds_read_b64_tr_b16 a[232:233], v150 offset:57344
  ds_read_b64_tr_b16 a[234:235], v150 offset:61440
  v_mfma_f32_16x16x32_bf16 a[36:39], a[196:199], a[116:119], a[36:39]
  ds_read_b64_tr_b16 a[236:237], v151 offset:57344
  ds_read_b64_tr_b16 a[238:239], v151 offset:61440
  v_mfma_f32_16x16x32_bf16 a[8:11], a[200:203], a[112:115], a[8:11]
  ds_read_b64_tr_b16 a[240:241], v152 offset:57344
  ds_read_b64_tr_b16 a[242:243], v152 offset:61440
  v_mfma_f32_16x16x32_bf16 a[40:43], a[200:203], a[116:119], a[40:43]
  ds_read_b64_tr_b16 a[244:245], v153 offset:57344
  ds_read_b64_tr_b16 a[246:247], v153 offset:61440
  v_mfma_f32_16x16x32_bf16 a[12:15], a[204:207], a[112:115], a[12:15]
  ds_read_b64_tr_b16 a[248:249], v154 offset:57344
  ds_read_b64_tr_b16 a[250:251], v154 offset:61440
  v_mfma_f32_16x16x32_bf16 a[44:47], a[204:207], a[116:119], a[44:47]
  ds_read_b64_tr_b16 a[252:253], v155 offset:57344
  ds_read_b64_tr_b16 a[254:255], v155 offset:61440
  v_mfma_f32_16x16x32_bf16 a[16:19], a[208:211], a[112:115], a[16:19]
  v_mfma_f32_16x16x32_bf16 a[48:51], a[208:211], a[116:119], a[48:51]
  buffer_load_dwordx4 a[184:187], v66, s[12:15], s82 offen offset:3072 sc1
  v_mfma_f32_16x16x32_bf16 a[20:23], a[212:215], a[112:115], a[20:23]
  v_mfma_f32_16x16x32_bf16 a[52:55], a[212:215], a[116:119], a[52:55]
  s_add_u32 m0, s80, 104448
  s_add_u32 s84, s81, 30720
  buffer_load_dwordx4 v164, s[16:19], s84 offen lds
  v_mfma_f32_16x16x32_bf16 a[24:27], a[216:219], a[112:115], a[24:27]
  v_mfma_f32_16x16x32_bf16 a[56:59], a[216:219], a[116:119], a[56:59]
  buffer_load_dwordx4 a[188:191], v66, s[4:7], s82 offen offset:3072 sc1
  s_add_u32 s82, s82, 4096
  v_mfma_f32_16x16x32_bf16 a[28:31], a[220:223], a[112:115], a[28:31]
  v_mfma_f32_16x16x32_bf16 a[60:63], a[220:223], a[116:119], a[60:63]
  s_add_u32 m0, s80, 105472
  s_add_u32 s84, s81, 35840
  buffer_load_dwordx4 v165, s[16:19], s84 offen lds
  s_add_u32 s81, s81, 163840
  s_cmp_eq_u32 s83, 5
  s_cbranch_scc0 concat_heads__mha_block_cached__mha_block_cached__near_ridge_kernel_f1_5
  s_cmp_eq_u32 s24, 0
  s_cbranch_scc0 concat_heads__mha_block_cached__mha_block_cached__near_ridge_kernel_wi6_x
  s_lshl_b32 s87, s66, 1
  s_add_u32 s87, s87, 1
  s_lshl_b32 s87, s87, 4
  v_mov_b32 v2, s87
  s_mov_b32 s86, 400000
concat_heads__mha_block_cached__mha_block_cached__near_ridge_kernel_wi6:
  buffer_load_dword v1, v2, s[76:79], 0 offen sc1
  s_waitcnt vmcnt(0)
  v_readfirstlane_b32 s87, v1
  s_nop 3
  s_cmp_ge_u32 s87, 32
  s_cbranch_scc1 concat_heads__mha_block_cached__mha_block_cached__near_ridge_kernel_wi6_x
  s_sleep 2
  s_sub_u32 s86, s86, 1
  s_cmp_lg_u32 s86, 0
  s_cbranch_scc1 concat_heads__mha_block_cached__mha_block_cached__near_ridge_kernel_wi6
concat_heads__mha_block_cached__mha_block_cached__near_ridge_kernel_wi6_x:
  s_barrier
  s_mov_b32 s14, 131072
  s_mov_b32 s6, 131072
concat_heads__mha_block_cached__mha_block_cached__near_ridge_kernel_f1_5:
  s_waitcnt vmcnt(16)
  s_barrier
  s_waitcnt lgkmcnt(0)
  v_mfma_f32_16x16x32_bf16 a[0:3], a[224:227], a[120:123], a[0:3]
  ds_read_b64_tr_b16 a[192:193], v156 offset:0
  ds_read_b64_tr_b16 a[194:195], v156 offset:4096
  v_mfma_f32_16x16x32_bf16 a[32:35], a[224:227], a[124:127], a[32:35]
  ds_read_b64_tr_b16 a[196:197], v157 offset:0
  ds_read_b64_tr_b16 a[198:199], v157 offset:4096
  v_mfma_f32_16x16x32_bf16 a[4:7], a[228:231], a[120:123], a[4:7]
  ds_read_b64_tr_b16 a[200:201], v158 offset:0
  ds_read_b64_tr_b16 a[202:203], v158 offset:4096
  v_mfma_f32_16x16x32_bf16 a[36:39], a[228:231], a[124:127], a[36:39]
  ds_read_b64_tr_b16 a[204:205], v159 offset:0
  ds_read_b64_tr_b16 a[206:207], v159 offset:4096
  v_mfma_f32_16x16x32_bf16 a[8:11], a[232:235], a[120:123], a[8:11]
  ds_read_b64_tr_b16 a[208:209], v160 offset:0
  ds_read_b64_tr_b16 a[210:211], v160 offset:4096
  v_mfma_f32_16x16x32_bf16 a[40:43], a[232:235], a[124:127], a[40:43]
  ds_read_b64_tr_b16 a[212:213], v161 offset:0
  ds_read_b64_tr_b16 a[214:215], v161 offset:4096
  v_mfma_f32_16x16x32_bf16 a[12:15], a[236:239], a[120:123], a[12:15]
  ds_read_b64_tr_b16 a[216:217], v162 offset:0
  ds_read_b64_tr_b16 a[218:219], v162 offset:4096
  v_mfma_f32_16x16x32_bf16 a[44:47], a[236:239], a[124:127], a[44:47]
  ds_read_b64_tr_b16 a[220:221], v163 offset:0
  ds_read_b64_tr_b16 a[222:223], v163 offset:4096
  v_mfma_f32_16x16x32_bf16 a[16:19], a[240:243], a[120:123], a[16:19]
  v_mfma_f32_16x16x32_bf16 a[48:51], a[240:243], a[124:127], a[48:51]
  buffer_load_dwordx4 a[64:67], v66, s[12:15], s82 offen offset:0 sc1
  v_mfma_f32_16x16x32_bf16 a[20:23], a[244:247], a[120:123], a[20:23]
  v_mfma_f32_16x16x32_bf16 a[52:55], a[244:247], a[124:127], a[52:55]
  s_add_u32 m0, s80, 0
  s_nop 0
  buffer_load_dwordx4 v164, s[16:19], s81 offen lds
  v_mfma_f32_16x16x32_bf16 a[24:27], a[248:251], a[120:123], a[24:27]
  v_mfma_f32_16x16x32_bf16 a[56:59], a[248:251], a[124:127], a[56:59]
  buffer_load_dwordx4 a[68:71], v66, s[4:7], s82 offen offset:0 sc1
  v_mfma_f32_16x16x32_bf16 a[28:31], a[252:255], a[120:123], a[28:31]
  v_mfma_f32_16x16x32_bf16 a[60:63], a[252:255], a[124:127], a[60:63]
  s_add_u32 m0, s80, 1024
  s_add_u32 s84, s81, 5120
  buffer_load_dwordx4 v165, s[16:19], s84 offen lds
  s_waitcnt lgkmcnt(0)
  v_mfma_f32_16x16x32_bf16 a[0:3], a[192:195], a[128:131], a[0:3]
  ds_read_b64_tr_b16 a[224:225], v156 offset:8192
  ds_read_b64_tr_b16 a[226:227], v156 offset:12288
  v_mfma_f32_16x16x32_bf16 a[32:35], a[192:195], a[132:135], a[32:35]
  ds_read_b64_tr_b16 a[228:229], v157 offset:8192
  ds_read_b64_tr_b16 a[230:231], v157 offset:12288
  v_mfma_f32_16x16x32_bf16 a[4:7], a[196:199], a[128:131], a[4:7]
  ds_read_b64_tr_b16 a[232:233], v158 offset:8192
  ds_read_b64_tr_b16 a[234:235], v158 offset:12288
  v_mfma_f32_16x16x32_bf16 a[36:39], a[196:199], a[132:135], a[36:39]
  ds_read_b64_tr_b16 a[236:237], v159 offset:8192
  ds_read_b64_tr_b16 a[238:239], v159 offset:12288
  v_mfma_f32_16x16x32_bf16 a[8:11], a[200:203], a[128:131], a[8:11]
  ds_read_b64_tr_b16 a[240:241], v160 offset:8192
  ds_read_b64_tr_b16 a[242:243], v160 offset:12288
  v_mfma_f32_16x16x32_bf16 a[40:43], a[200:203], a[132:135], a[40:43]
  ds_read_b64_tr_b16 a[244:245], v161 offset:8192
  ds_read_b64_tr_b16 a[246:247], v161 offset:12288
  v_mfma_f32_16x16x32_bf16 a[12:15], a[204:207], a[128:131], a[12:15]
  ds_read_b64_tr_b16 a[248:249], v162 offset:8192
  ds_read_b64_tr_b16 a[250:251], v162 offset:12288
  v_mfma_f32_16x16x32_bf16 a[44:47], a[204:207], a[132:135], a[44:47]
  ds_read_b64_tr_b16 a[252:253], v163 offset:8192
  ds_read_b64_tr_b16 a[254:255], v163 offset:12288
  v_mfma_f32_16x16x32_bf16 a[16:19], a[208:211], a[128:131], a[16:19]
  v_mfma_f32_16x16x32_bf16 a[48:51], a[208:211], a[132:135], a[48:51]
  buffer_load_dwordx4 a[72:75], v66, s[12:15], s82 offen offset:1024 sc1
  v_mfma_f32_16x16x32_bf16 a[20:23], a[212:215], a[128:131], a[20:23]
  v_mfma_f32_16x16x32_bf16 a[52:55], a[212:215], a[132:135], a[52:55]
  s_add_u32 m0, s80, 2048
  s_add_u32 s84, s81, 10240
  buffer_load_dwordx4 v164, s[16:19], s84 offen lds
  v_mfma_f32_16x16x32_bf16 a[24:27], a[216:219], a[128:131], a[24:27]
  v_mfma_f32_16x16x32_bf16 a[56:59], a[216:219], a[132:135], a[56:59]
  buffer_load_dwordx4 a[76:79], v66, s[4:7], s82 offen offset:1024 sc1
  v_mfma_f32_16x16x32_bf16 a[28:31], a[220:223], a[128:131], a[28:31]
  v_mfma_f32_16x16x32_bf16 a[60:63], a[220:223], a[132:135], a[60:63]
  s_add_u32 m0, s80, 3072
  s_add_u32 s84, s81, 15360
  buffer_load_dwordx4 v165, s[16:19], s84 offen lds
  s_waitcnt lgkmcnt(0)
  v_mfma_f32_16x16x32_bf16 a[0:3], a[224:227], a[136:139], a[0:3]
  ds_read_b64_tr_b16 a[192:193], v156 offset:16384
  ds_read_b64_tr_b16 a[194:195], v156 offset:20480
  v_mfma_f32_16x16x32_bf16 a[32:35], a[224:227], a[140:143], a[32:35]
  ds_read_b64_tr_b16 a[196:197], v157 offset:16384
  ds_read_b64_tr_b16 a[198:199], v157 offset:20480
  v_mfma_f32_16x16x32_bf16 a[4:7], a[228:231], a[136:139], a[4:7]
  ds_read_b64_tr_b16 a[200:201], v158 offset:16384
  ds_read_b64_tr_b16 a[202:203], v158 offset:20480
  v_mfma_f32_16x16x32_bf16 a[36:39], a[228:231], a[140:143], a[36:39]
  ds_read_b64_tr_b16 a[204:205], v159 offset:16384
  ds_read_b64_tr_b16 a[206:207], v159 offset:20480
  v_mfma_f32_16x16x32_bf16 a[8:11], a[232:235], a[136:139], a[8:11]
  ds_read_b64_tr_b16 a[208:209], v160 offset:16384
  ds_read_b64_tr_b16 a[210:211], v160 offset:20480
  v_mfma_f32_16x16x32_bf16 a[40:43], a[232:235], a[140:143], a[40:43]
  ds_read_b64_tr_b16 a[212:213], v161 offset:16384
  ds_read_b64_tr_b16 a[214:215], v161 offset:20480
  v_mfma_f32_16x16x32_bf16 a[12:15], a[236:239], a[136:139], a[12:15]
  ds_read_b64_tr_b16 a[216:217], v162 offset:16384
  ds_read_b64_tr_b16 a[218:219], v162 offset:20480
  v_mfma_f32_16x16x32_bf16 a[44:47], a[236:239], a[140:143], a[44:47]
  ds_read_b64_tr_b16 a[220:221], v163 offset:16384
  ds_read_b64_tr_b16 a[222:223], v163 offset:20480
  v_mfma_f32_16x16x32_bf16 a[16:19], a[240:243], a[136:139], a[16:19]
  v_mfma_f32_16x16x32_bf16 a[48:51], a[240:243], a[140:143], a[48:51]
  buffer_load_dwordx4 a[80:83], v66, s[12:15], s82 offen offset:2048 sc1
  v_mfma_f32_16x16x32_bf16 a[20:23], a[244:247], a[136:139], a[20:23]
  v_mfma_f32_16x16x32_bf16 a[52:55], a[244:247], a[140:143], a[52:55]
  s_add_u32 m0, s80, 4096
  s_add_u32 s84, s81, 20480
  buffer_load_dwordx4 v164, s[16:19], s84 offen lds
  v_mfma_f32_16x16x32_bf16 a[24:27], a[248:251], a[136:139], a[24:27]
  v_mfma_f32_16x16x32_bf16 a[56:59], a[248:251], a[140:143], a[56:59]
  buffer_load_dwordx4 a[84:87], v66, s[4:7], s82 offen offset:2048 sc1
  v_mfma_f32_16x16x32_bf16 a[28:31], a[252:255], a[136:139], a[28:31]
  v_mfma_f32_16x16x32_bf16 a[60:63], a[252:255], a[140:143], a[60:63]
  s_add_u32 m0, s80, 5120
  s_add_u32 s84, s81, 25600
  buffer_load_dwordx4 v165, s[16:19], s84 offen lds
  s_waitcnt lgkmcnt(0)
  v_mfma_f32_16x16x32_bf16 a[0:3], a[192:195], a[144:147], a[0:3]
  ds_read_b64_tr_b16 a[224:225], v156 offset:24576
  ds_read_b64_tr_b16 a[226:227], v156 offset:28672
  v_mfma_f32_16x16x32_bf16 a[32:35], a[192:195], a[148:151], a[32:35]
  ds_read_b64_tr_b16 a[228:229], v157 offset:24576
  ds_read_b64_tr_b16 a[230:231], v157 offset:28672
  v_mfma_f32_16x16x32_bf16 a[4:7], a[196:199], a[144:147], a[4:7]
  ds_read_b64_tr_b16 a[232:233], v158 offset:24576
  ds_read_b64_tr_b16 a[234:235], v158 offset:28672
  v_mfma_f32_16x16x32_bf16 a[36:39], a[196:199], a[148:151], a[36:39]
  ds_read_b64_tr_b16 a[236:237], v159 offset:24576
  ds_read_b64_tr_b16 a[238:239], v159 offset:28672
  v_mfma_f32_16x16x32_bf16 a[8:11], a[200:203], a[144:147], a[8:11]
  ds_read_b64_tr_b16 a[240:241], v160 offset:24576
  ds_read_b64_tr_b16 a[242:243], v160 offset:28672
  v_mfma_f32_16x16x32_bf16 a[40:43], a[200:203], a[148:151], a[40:43]
  ds_read_b64_tr_b16 a[244:245], v161 offset:24576
  ds_read_b64_tr_b16 a[246:247], v161 offset:28672
  v_mfma_f32_16x16x32_bf16 a[12:15], a[204:207], a[144:147], a[12:15]
  ds_read_b64_tr_b16 a[248:249], v162 offset:24576
  ds_read_b64_tr_b16 a[250:251], v162 offset:28672
  v_mfma_f32_16x16x32_bf16 a[44:47], a[204:207], a[148:151], a[44:47]
  ds_read_b64_tr_b16 a[252:253], v163 offset:24576
  ds_read_b64_tr_b16 a[254:255], v163 offset:28672
  v_mfma_f32_16x16x32_bf16 a[16:19], a[208:211], a[144:147], a[16:19]
  v_mfma_f32_16x16x32_bf16 a[48:51], a[208:211], a[148:151], a[48:51]
  buffer_load_dwordx4 a[88:91], v66, s[12:15], s82 offen offset:3072 sc1
  v_mfma_f32_16x16x32_bf16 a[20:23], a[212:215], a[144:147], a[20:23]
  v_mfma_f32_16x16x32_bf16 a[52:55], a[212:215], a[148:151], a[52:55]
  s_add_u32 m0, s80, 6144
  s_add_u32 s84, s81, 30720
  buffer_load_dwordx4 v164, s[16:19], s84 offen lds
  v_mfma_f32_16x16x32_bf16 a[24:27], a[216:219], a[144:147], a[24:27]
  v_mfma_f32_16x16x32_bf16 a[56:59], a[216:219], a[148:151], a[56:59]
  buffer_load_dwordx4 a[92:95], v66, s[4:7], s82 offen offset:3072 sc1
  s_add_u32 s82, s82, 4096
  v_mfma_f32_16x16x32_bf16 a[28:31], a[220:223], a[144:147], a[28:31]
  v_mfma_f32_16x16x32_bf16 a[60:63], a[220:223], a[148:151], a[60:63]
  s_add_u32 m0, s80, 7168
  s_add_u32 s84, s81, 35840
  buffer_load_dwordx4 v165, s[16:19], s84 offen lds
  s_add_u32 s81, s81, 163840
  s_waitcnt vmcnt(16)
  s_barrier
  s_waitcnt lgkmcnt(0)
  v_mfma_f32_16x16x32_bf16 a[0:3], a[224:227], a[152:155], a[0:3]
  ds_read_b64_tr_b16 a[192:193], v156 offset:32768
  ds_read_b64_tr_b16 a[194:195], v156 offset:36864
  v_mfma_f32_16x16x32_bf16 a[32:35], a[224:227], a[156:159], a[32:35]
  ds_read_b64_tr_b16 a[196:197], v157 offset:32768
  ds_read_b64_tr_b16 a[198:199], v157 offset:36864
  v_mfma_f32_16x16x32_bf16 a[4:7], a[228:231], a[152:155], a[4:7]
  ds_read_b64_tr_b16 a[200:201], v158 offset:32768
  ds_read_b64_tr_b16 a[202:203], v158 offset:36864
  v_mfma_f32_16x16x32_bf16 a[36:39], a[228:231], a[156:159], a[36:39]
  ds_read_b64_tr_b16 a[204:205], v159 offset:32768
  ds_read_b64_tr_b16 a[206:207], v159 offset:36864
  v_mfma_f32_16x16x32_bf16 a[8:11], a[232:235], a[152:155], a[8:11]
  ds_read_b64_tr_b16 a[208:209], v160 offset:32768
  ds_read_b64_tr_b16 a[210:211], v160 offset:36864
  v_mfma_f32_16x16x32_bf16 a[40:43], a[232:235], a[156:159], a[40:43]
  ds_read_b64_tr_b16 a[212:213], v161 offset:32768
  ds_read_b64_tr_b16 a[214:215], v161 offset:36864
  v_mfma_f32_16x16x32_bf16 a[12:15], a[236:239], a[152:155], a[12:15]
  ds_read_b64_tr_b16 a[216:217], v162 offset:32768
  ds_read_b64_tr_b16 a[218:219], v162 offset:36864
  v_mfma_f32_16x16x32_bf16 a[44:47], a[236:239], a[156:159], a[44:47]
  ds_read_b64_tr_b16 a[220:221], v163 offset:32768
  ds_read_b64_tr_b16 a[222:223], v163 offset:36864
  v_mfma_f32_16x16x32_bf16 a[16:19], a[240:243], a[152:155], a[16:19]
  v_mfma_f32_16x16x32_bf16 a[48:51], a[240:243], a[156:159], a[48:51]
  buffer_load_dwordx4 a[96:99], v66, s[12:15], s82 offen offset:0 sc1
  v_mfma_f32_16x16x32_bf16 a[20:23], a[244:247], a[152:155], a[20:23]
  v_mfma_f32_16x16x32_bf16 a[52:55], a[244:247], a[156:159], a[52:55]
  s_add_u32 m0, s80, 32768
  s_nop 0
  buffer_load_dwordx4 v164, s[16:19], s81 offen lds
  v_mfma_f32_16x16x32_bf16 a[24:27], a[248:251], a[152:155], a[24:27]
  v_mfma_f32_16x16x32_bf16 a[56:59], a[248:251], a[156:159], a[56:59]
  buffer_load_dwordx4 a[100:103], v66, s[4:7], s82 offen offset:0 sc1
  v_mfma_f32_16x16x32_bf16 a[28:31], a[252:255], a[152:155], a[28:31]
  v_mfma_f32_16x16x32_bf16 a[60:63], a[252:255], a[156:159], a[60:63]
  s_add_u32 m0, s80, 33792
  s_add_u32 s84, s81, 5120
  buffer_load_dwordx4 v165, s[16:19], s84 offen lds
  s_waitcnt lgkmcnt(0)
  v_mfma_f32_16x16x32_bf16 a[0:3], a[192:195], a[160:163], a[0:3]
  ds_read_b64_tr_b16 a[224:225], v156 offset:40960
  ds_read_b64_tr_b16 a[226:227], v156 offset:45056
  v_mfma_f32_16x16x32_bf16 a[32:35], a[192:195], a[164:167], a[32:35]
  ds_read_b64_tr_b16 a[228:229], v157 offset:40960
  ds_read_b64_tr_b16 a[230:231], v157 offset:45056
  v_mfma_f32_16x16x32_bf16 a[4:7], a[196:199], a[160:163], a[4:7]
  ds_read_b64_tr_b16 a[232:233], v158 offset:40960
  ds_read_b64_tr_b16 a[234:235], v158 offset:45056
  v_mfma_f32_16x16x32_bf16 a[36:39], a[196:199], a[164:167], a[36:39]
  ds_read_b64_tr_b16 a[236:237], v159 offset:40960
  ds_read_b64_tr_b16 a[238:239], v159 offset:45056
  v_mfma_f32_16x16x32_bf16 a[8:11], a[200:203], a[160:163], a[8:11]
  ds_read_b64_tr_b16 a[240:241], v160 offset:40960
  ds_read_b64_tr_b16 a[242:243], v160 offset:45056
  v_mfma_f32_16x16x32_bf16 a[40:43], a[200:203], a[164:167], a[40:43]
  ds_read_b64_tr_b16 a[244:245], v161 offset:40960
  ds_read_b64_tr_b16 a[246:247], v161 offset:45056
  v_mfma_f32_16x16x32_bf16 a[12:15], a[204:207], a[160:163], a[12:15]
  ds_read_b64_tr_b16 a[248:249], v162 offset:40960
  ds_read_b64_tr_b16 a[250:251], v162 offset:45056
  v_mfma_f32_16x16x32_bf16 a[44:47], a[204:207], a[164:167], a[44:47]
  ds_read_b64_tr_b16 a[252:253], v163 offset:40960
  ds_read_b64_tr_b16 a[254:255], v163 offset:45056
  v_mfma_f32_16x16x32_bf16 a[16:19], a[208:211], a[160:163], a[16:19]
  v_mfma_f32_16x16x32_bf16 a[48:51], a[208:211], a[164:167], a[48:51]
  buffer_load_dwordx4 a[104:107], v66, s[12:15], s82 offen offset:1024 sc1
  v_mfma_f32_16x16x32_bf16 a[20:23], a[212:215], a[160:163], a[20:23]
  v_mfma_f32_16x16x32_bf16 a[52:55], a[212:215], a[164:167], a[52:55]
  s_add_u32 m0, s80, 34816
  s_add_u32 s84, s81, 10240
  buffer_load_dwordx4 v164, s[16:19], s84 offen lds
  v_mfma_f32_16x16x32_bf16 a[24:27], a[216:219], a[160:163], a[24:27]
  v_mfma_f32_16x16x32_bf16 a[56:59], a[216:219], a[164:167], a[56:59]
  buffer_load_dwordx4 a[108:111], v66, s[4:7], s82 offen offset:1024 sc1
  v_mfma_f32_16x16x32_bf16 a[28:31], a[220:223], a[160:163], a[28:31]
  v_mfma_f32_16x16x32_bf16 a[60:63], a[220:223], a[164:167], a[60:63]
  s_add_u32 m0, s80, 35840
  s_add_u32 s84, s81, 15360
  buffer_load_dwordx4 v165, s[16:19], s84 offen lds
  s_waitcnt lgkmcnt(0)
  v_mfma_f32_16x16x32_bf16 a[0:3], a[224:227], a[168:171], a[0:3]
  ds_read_b64_tr_b16 a[192:193], v156 offset:49152
  ds_read_b64_tr_b16 a[194:195], v156 offset:53248
  v_mfma_f32_16x16x32_bf16 a[32:35], a[224:227], a[172:175], a[32:35]
  ds_read_b64_tr_b16 a[196:197], v157 offset:49152
  ds_read_b64_tr_b16 a[198:199], v157 offset:53248
  v_mfma_f32_16x16x32_bf16 a[4:7], a[228:231], a[168:171], a[4:7]
  ds_read_b64_tr_b16 a[200:201], v158 offset:49152
  ds_read_b64_tr_b16 a[202:203], v158 offset:53248
  v_mfma_f32_16x16x32_bf16 a[36:39], a[228:231], a[172:175], a[36:39]
  ds_read_b64_tr_b16 a[204:205], v159 offset:49152
  ds_read_b64_tr_b16 a[206:207], v159 offset:53248
  v_mfma_f32_16x16x32_bf16 a[8:11], a[232:235], a[168:171], a[8:11]
  ds_read_b64_tr_b16 a[208:209], v160 offset:49152
  ds_read_b64_tr_b16 a[210:211], v160 offset:53248
  v_mfma_f32_16x16x32_bf16 a[40:43], a[232:235], a[172:175], a[40:43]
  ds_read_b64_tr_b16 a[212:213], v161 offset:49152
  ds_read_b64_tr_b16 a[214:215], v161 offset:53248
  v_mfma_f32_16x16x32_bf16 a[12:15], a[236:239], a[168:171], a[12:15]
  ds_read_b64_tr_b16 a[216:217], v162 offset:49152
  ds_read_b64_tr_b16 a[218:219], v162 offset:53248
  v_mfma_f32_16x16x32_bf16 a[44:47], a[236:239], a[172:175], a[44:47]
  ds_read_b64_tr_b16 a[220:221], v163 offset:49152
  ds_read_b64_tr_b16 a[222:223], v163 offset:53248
  v_mfma_f32_16x16x32_bf16 a[16:19], a[240:243], a[168:171], a[16:19]
  v_mfma_f32_16x16x32_bf16 a[48:51], a[240:243], a[172:175], a[48:51]
  buffer_load_dwordx4 a[112:115], v66, s[12:15], s82 offen offset:2048 sc1
  v_mfma_f32_16x16x32_bf16 a[20:23], a[244:247], a[168:171], a[20:23]
  v_mfma_f32_16x16x32_bf16 a[52:55], a[244:247], a[172:175], a[52:55]
  s_add_u32 m0, s80, 36864
  s_add_u32 s84, s81, 20480
  buffer_load_dwordx4 v164, s[16:19], s84 offen lds
  v_mfma_f32_16x16x32_bf16 a[24:27], a[248:251], a[168:171], a[24:27]
  v_mfma_f32_16x16x32_bf16 a[56:59], a[248:251], a[172:175], a[56:59]
  buffer_load_dwordx4 a[116:119], v66, s[4:7], s82 offen offset:2048 sc1
  v_mfma_f32_16x16x32_bf16 a[28:31], a[252:255], a[168:171], a[28:31]
  v_mfma_f32_16x16x32_bf16 a[60:63], a[252:255], a[172:175], a[60:63]
  s_add_u32 m0, s80, 37888
  s_add_u32 s84, s81, 25600
  buffer_load_dwordx4 v165, s[16:19], s84 offen lds
  s_waitcnt lgkmcnt(0)
  v_mfma_f32_16x16x32_bf16 a[0:3], a[192:195], a[176:179], a[0:3]
  ds_read_b64_tr_b16 a[224:225], v156 offset:57344
  ds_read_b64_tr_b16 a[226:227], v156 offset:61440
  v_mfma_f32_16x16x32_bf16 a[32:35], a[192:195], a[180:183], a[32:35]
  ds_read_b64_tr_b16 a[228:229], v157 offset:57344
  ds_read_b64_tr_b16 a[230:231], v157 offset:61440
  v_mfma_f32_16x16x32_bf16 a[4:7], a[196:199], a[176:179], a[4:7]
  ds_read_b64_tr_b16 a[232:233], v158 offset:57344
  ds_read_b64_tr_b16 a[234:235], v158 offset:61440
  v_mfma_f32_16x16x32_bf16 a[36:39], a[196:199], a[180:183], a[36:39]
  ds_read_b64_tr_b16 a[236:237], v159 offset:57344
  ds_read_b64_tr_b16 a[238:239], v159 offset:61440
  v_mfma_f32_16x16x32_bf16 a[8:11], a[200:203], a[176:179], a[8:11]
  ds_read_b64_tr_b16 a[240:241], v160 offset:57344
  ds_read_b64_tr_b16 a[242:243], v160 offset:61440
  v_mfma_f32_16x16x32_bf16 a[40:43], a[200:203], a[180:183], a[40:43]
  ds_read_b64_tr_b16 a[244:245], v161 offset:57344
  ds_read_b64_tr_b16 a[246:247], v161 offset:61440
  v_mfma_f32_16x16x32_bf16 a[12:15], a[204:207], a[176:179], a[12:15]
  ds_read_b64_tr_b16 a[248:249], v162 offset:57344
  ds_read_b64_tr_b16 a[250:251], v162 offset:61440
  v_mfma_f32_16x16x32_bf16 a[44:47], a[204:207], a[180:183], a[44:47]
  ds_read_b64_tr_b16 a[252:253], v163 offset:57344
  ds_read_b64_tr_b16 a[254:255], v163 offset:61440
  v_mfma_f32_16x16x32_bf16 a[16:19], a[208:211], a[176:179], a[16:19]
  v_mfma_f32_16x16x32_bf16 a[48:51], a[208:211], a[180:183], a[48:51]
  buffer_load_dwordx4 a[120:123], v66, s[12:15], s82 offen offset:3072 sc1
  v_mfma_f32_16x16x32_bf16 a[20:23], a[212:215], a[176:179], a[20:23]
  v_mfma_f32_16x16x32_bf16 a[52:55], a[212:215], a[180:183], a[52:55]
  s_add_u32 m0, s80, 38912
  s_add_u32 s84, s81, 30720
  buffer_load_dwordx4 v164, s[16:19], s84 offen lds
  v_mfma_f32_16x16x32_bf16 a[24:27], a[216:219], a[176:179], a[24:27]
  v_mfma_f32_16x16x32_bf16 a[56:59], a[216:219], a[180:183], a[56:59]
  buffer_load_dwordx4 a[124:127], v66, s[4:7], s82 offen offset:3072 sc1
  s_add_u32 s82, s82, 4096
  v_mfma_f32_16x16x32_bf16 a[28:31], a[220:223], a[176:179], a[28:31]
  v_mfma_f32_16x16x32_bf16 a[60:63], a[220:223], a[180:183], a[60:63]
  s_add_u32 m0, s80, 39936
  s_add_u32 s84, s81, 35840
  buffer_load_dwordx4 v165, s[16:19], s84 offen lds
  s_add_u32 s81, s81, 163840
  s_sub_u32 s83, s83, 1
  s_cmp_lg_u32 s83, 0
  s_cbranch_scc1 concat_heads__mha_block_cached__mha_block_cached__near_ridge_kernel_t2loop
  s_waitcnt lgkmcnt(0)
  v_mfma_f32_16x16x32_bf16 a[0:3], a[224:227], a[184:187], a[0:3]
  v_mfma_f32_16x16x32_bf16 a[32:35], a[224:227], a[188:191], a[32:35]
  v_mfma_f32_16x16x32_bf16 a[4:7], a[228:231], a[184:187], a[4:7]
  v_mfma_f32_16x16x32_bf16 a[36:39], a[228:231], a[188:191], a[36:39]
  v_mfma_f32_16x16x32_bf16 a[8:11], a[232:235], a[184:187], a[8:11]
  v_mfma_f32_16x16x32_bf16 a[40:43], a[232:235], a[188:191], a[40:43]
  v_mfma_f32_16x16x32_bf16 a[12:15], a[236:239], a[184:187], a[12:15]
  v_mfma_f32_16x16x32_bf16 a[44:47], a[236:239], a[188:191], a[44:47]
  v_mfma_f32_16x16x32_bf16 a[16:19], a[240:243], a[184:187], a[16:19]
  v_mfma_f32_16x16x32_bf16 a[48:51], a[240:243], a[188:191], a[48:51]
  v_mfma_f32_16x16x32_bf16 a[20:23], a[244:247], a[184:187], a[20:23]
  v_mfma_f32_16x16x32_bf16 a[52:55], a[244:247], a[188:191], a[52:55]
  v_mfma_f32_16x16x32_bf16 a[24:27], a[248:251], a[184:187], a[24:27]
  v_mfma_f32_16x16x32_bf16 a[56:59], a[248:251], a[188:191], a[56:59]
  v_mfma_f32_16x16x32_bf16 a[28:31], a[252:255], a[184:187], a[28:31]
  v_mfma_f32_16x16x32_bf16 a[60:63], a[252:255], a[188:191], a[60:63]
  s_nop 15
  s_mov_b32 s44, s64
  s_and_b32 s45, s65, 0xffff
  s_mov_b32 s46, 6553600
  s_mov_b32 s47, 0x20000
  v_accvgpr_read_b32 v68, a0
  v_accvgpr_read_b32 v69, a1
  v_accvgpr_read_b32 v70, a2
  v_accvgpr_read_b32 v71, a3
  v_accvgpr_read_b32 v72, a4
  v_accvgpr_read_b32 v73, a5
  v_accvgpr_read_b32 v74, a6
  v_accvgpr_read_b32 v75, a7
  v_cvt_pk_bf16_f32 v84, v68, v69
  v_cvt_pk_bf16_f32 v85, v70, v71
  v_cvt_pk_bf16_f32 v86, v72, v73
  v_cvt_pk_bf16_f32 v87, v74, v75
  s_nop 1
  v_permlane16_swap_b32 v84, v86
  v_permlane16_swap_b32 v85, v87
  buffer_store_dwordx4 v[84:87], v166, s[44:47], s85 offen offset:0
  v_accvgpr_read_b32 v68, a8
  v_accvgpr_read_b32 v69, a9
  v_accvgpr_read_b32 v70, a10
  v_accvgpr_read_b32 v71, a11
  v_accvgpr_read_b32 v72, a12
  v_accvgpr_read_b32 v73, a13
  v_accvgpr_read_b32 v74, a14
  v_accvgpr_read_b32 v75, a15
  v_cvt_pk_bf16_f32 v88, v68, v69
  v_cvt_pk_bf16_f32 v89, v70, v71
  v_cvt_pk_bf16_f32 v90, v72, v73
  v_cvt_pk_bf16_f32 v91, v74, v75
  s_nop 1
  v_permlane16_swap_b32 v88, v90
  v_permlane16_swap_b32 v89, v91
  buffer_store_dwordx4 v[88:91], v166, s[44:47], s85 offen offset:64
  v_accvgpr_read_b32 v68, a16
  v_accvgpr_read_b32 v69, a17
  v_accvgpr_read_b32 v70, a18
  v_accvgpr_read_b32 v71, a19
  v_accvgpr_read_b32 v72, a20
  v_accvgpr_read_b32 v73, a21
  v_accvgpr_read_b32 v74, a22
  v_accvgpr_read_b32 v75, a23
  v_cvt_pk_bf16_f32 v84, v68, v69
  v_cvt_pk_bf16_f32 v85, v70, v71
  v_cvt_pk_bf16_f32 v86, v72, v73
  v_cvt_pk_bf16_f32 v87, v74, v75
  s_nop 1
  v_permlane16_swap_b32 v84, v86
  v_permlane16_swap_b32 v85, v87
  buffer_store_dwordx4 v[84:87], v166, s[44:47], s85 offen offset:128
  v_accvgpr_read_b32 v68, a24
  v_accvgpr_read_b32 v69, a25
  v_accvgpr_read_b32 v70, a26
  v_accvgpr_read_b32 v71, a27
  v_accvgpr_read_b32 v72, a28
  v_accvgpr_read_b32 v73, a29
  v_accvgpr_read_b32 v74, a30
  v_accvgpr_read_b32 v75, a31
  v_cvt_pk_bf16_f32 v88, v68, v69
  v_cvt_pk_bf16_f32 v89, v70, v71
  v_cvt_pk_bf16_f32 v90, v72, v73
  v_cvt_pk_bf16_f32 v91, v74, v75
  s_nop 1
  v_permlane16_swap_b32 v88, v90
  v_permlane16_swap_b32 v89, v91
  buffer_store_dwordx4 v[88:91], v166, s[44:47], s85 offen offset:192
  s_add_u32 s85, s85, 40960
  v_accvgpr_read_b32 v68, a32
  v_accvgpr_read_b32 v69, a33
  v_accvgpr_read_b32 v70, a34
  v_accvgpr_read_b32 v71, a35
  v_accvgpr_read_b32 v72, a36
  v_accvgpr_read_b32 v73, a37
  v_accvgpr_read_b32 v74, a38
  v_accvgpr_read_b32 v75, a39
  v_cvt_pk_bf16_f32 v84, v68, v69
  v_cvt_pk_bf16_f32 v85, v70, v71
  v_cvt_pk_bf16_f32 v86, v72, v73
  v_cvt_pk_bf16_f32 v87, v74, v75
  s_nop 1
  v_permlane16_swap_b32 v84, v86
  v_permlane16_swap_b32 v85, v87
  buffer_store_dwordx4 v[84:87], v166, s[44:47], s85 offen offset:0
  v_accvgpr_read_b32 v68, a40
  v_accvgpr_read_b32 v69, a41
  v_accvgpr_read_b32 v70, a42
  v_accvgpr_read_b32 v71, a43
  v_accvgpr_read_b32 v72, a44
  v_accvgpr_read_b32 v73, a45
  v_accvgpr_read_b32 v74, a46
  v_accvgpr_read_b32 v75, a47
  v_cvt_pk_bf16_f32 v88, v68, v69
  v_cvt_pk_bf16_f32 v89, v70, v71
  v_cvt_pk_bf16_f32 v90, v72, v73
  v_cvt_pk_bf16_f32 v91, v74, v75
  s_nop 1
  v_permlane16_swap_b32 v88, v90
  v_permlane16_swap_b32 v89, v91
  buffer_store_dwordx4 v[88:91], v166, s[44:47], s85 offen offset:64
  v_accvgpr_read_b32 v68, a48
  v_accvgpr_read_b32 v69, a49
  v_accvgpr_read_b32 v70, a50
  v_accvgpr_read_b32 v71, a51
  v_accvgpr_read_b32 v72, a52
  v_accvgpr_read_b32 v73, a53
  v_accvgpr_read_b32 v74, a54
  v_accvgpr_read_b32 v75, a55
  v_cvt_pk_bf16_f32 v84, v68, v69
  v_cvt_pk_bf16_f32 v85, v70, v71
  v_cvt_pk_bf16_f32 v86, v72, v73
  v_cvt_pk_bf16_f32 v87, v74, v75
  s_nop 1
  v_permlane16_swap_b32 v84, v86
  v_permlane16_swap_b32 v85, v87
  buffer_store_dwordx4 v[84:87], v166, s[44:47], s85 offen offset:128
  v_accvgpr_read_b32 v68, a56
  v_accvgpr_read_b32 v69, a57
  v_accvgpr_read_b32 v70, a58
  v_accvgpr_read_b32 v71, a59
  v_accvgpr_read_b32 v72, a60
  v_accvgpr_read_b32 v73, a61
  v_accvgpr_read_b32 v74, a62
  v_accvgpr_read_b32 v75, a63
  v_cvt_pk_bf16_f32 v88, v68, v69
  v_cvt_pk_bf16_f32 v89, v70, v71
  v_cvt_pk_bf16_f32 v90, v72, v73
  v_cvt_pk_bf16_f32 v91, v74, v75
  s_nop 1
  v_permlane16_swap_b32 v88, v90
  v_permlane16_swap_b32 v89, v91
  buffer_store_dwordx4 v[88:91], v166, s[44:47], s85 offen offset:192
concat_heads__mha_block_cached__mha_block_cached__near_ridge_kernel_exit:
  s_waitcnt vmcnt(0)
  s_endpgm
concat_heads__mha_block_cached__mha_block_cached__near_ridge_kernel_slow:
  s_waitcnt vmcnt(0) lgkmcnt(0)
  s_barrier
  s_mov_b32 s50, 1
  s_mov_b32 s29, s48
  s_mov_b32 s30, s49
  v_mov_b32 v8, 0xff800000
  v_mov_b32 v9, 0xff800000
  v_mov_b32 v10, 0xff800000
  v_mov_b32 v11, 0xff800000
  v_mov_b32 v12, 0xff800000
  s_mov_b32 s27, 0
  s_mov_b32 s31, 32
concat_heads__mha_block_cached__mha_block_cached__near_ridge_kernel_slow_loop:
  s_add_u32 m0, s25, 0
  s_nop 0
  buffer_load_dwordx4 v58, s[4:7], s27 offen nt lds
  buffer_load_dwordx4 v59, s[4:7], s27 offen offset:1024 nt lds
  buffer_load_dwordx4 v60, s[4:7], s27 offen offset:2048 nt lds
  buffer_load_dwordx4 v61, s[4:7], s27 offen offset:3072 nt lds
  s_add_u32 s27, s27, 8192
  s_waitcnt vmcnt(0)
  s_barrier
  ds_read_b128 a[160:163], v16 offset:0
  ds_read_b128 a[176:179], v20 offset:0
  ds_read_b128 a[164:167], v17 offset:0
  ds_read_b128 a[180:183], v21 offset:0
  ds_read_b128 a[168:171], v18 offset:0
  ds_read_b128 a[184:187], v22 offset:0
  ds_read_b128 a[172:175], v19 offset:0
  ds_read_b128 a[188:191], v23 offset:0
  s_waitcnt lgkmcnt(0)
  v_mfma_f32_16x16x32_bf16 v[148:151], a[160:163], v[68:71], 0
  v_mfma_f32_16x16x32_bf16 v[152:155], a[176:179], v[68:71], 0
  v_mfma_f32_16x16x32_bf16 v[148:151], a[164:167], v[72:75], v[148:151]
  v_mfma_f32_16x16x32_bf16 v[152:155], a[180:183], v[72:75], v[152:155]
  v_mfma_f32_16x16x32_bf16 v[148:151], a[168:171], v[76:79], v[148:151]
  v_mfma_f32_16x16x32_bf16 v[152:155], a[184:187], v[76:79], v[152:155]
  v_mfma_f32_16x16x32_bf16 v[148:151], a[172:175], v[80:83], v[148:151]
  v_mfma_f32_16x16x32_bf16 v[152:155], a[188:191], v[80:83], v[152:155]
  s_nop 15
  v_max3_f32 v8, v8, v148, v149
  v_max3_f32 v8, v8, v150, v151
  v_max3_f32 v8, v8, v152, v153
  v_max3_f32 v8, v8, v154, v155
  s_nop 7
  v_mfma_f32_16x16x32_bf16 v[148:151], a[160:163], v[84:87], 0
  v_mfma_f32_16x16x32_bf16 v[152:155], a[176:179], v[84:87], 0
  v_mfma_f32_16x16x32_bf16 v[148:151], a[164:167], v[88:91], v[148:151]
  v_mfma_f32_16x16x32_bf16 v[152:155], a[180:183], v[88:91], v[152:155]
  v_mfma_f32_16x16x32_bf16 v[148:151], a[168:171], v[92:95], v[148:151]
  v_mfma_f32_16x16x32_bf16 v[152:155], a[184:187], v[92:95], v[152:155]
  v_mfma_f32_16x16x32_bf16 v[148:151], a[172:175], v[96:99], v[148:151]
  v_mfma_f32_16x16x32_bf16 v[152:155], a[188:191], v[96:99], v[152:155]
  s_nop 15
  v_max3_f32 v9, v9, v148, v149
  v_max3_f32 v9, v9, v150, v151
  v_max3_f32 v9, v9, v152, v153
  v_max3_f32 v9, v9, v154, v155
  s_nop 7
  v_mfma_f32_16x16x32_bf16 v[148:151], a[160:163], v[100:103], 0
  v_mfma_f32_16x16x32_bf16 v[152:155], a[176:179], v[100:103], 0
  v_mfma_f32_16x16x32_bf16 v[148:151], a[164:167], v[104:107], v[148:151]
  v_mfma_f32_16x16x32_bf16 v[152:155], a[180:183], v[104:107], v[152:155]
  v_mfma_f32_16x16x32_bf16 v[148:151], a[168:171], v[108:111], v[148:151]
  v_mfma_f32_16x16x32_bf16 v[152:155], a[184:187], v[108:111], v[152:155]
  v_mfma_f32_16x16x32_bf16 v[148:151], a[172:175], v[112:115], v[148:151]
  v_mfma_f32_16x16x32_bf16 v[152:155], a[188:191], v[112:115], v[152:155]
  s_nop 15
  v_max3_f32 v10, v10, v148, v149
  v_max3_f32 v10, v10, v150, v151
  v_max3_f32 v10, v10, v152, v153
  v_max3_f32 v10, v10, v154, v155
  s_nop 7
  v_mfma_f32_16x16x32_bf16 v[148:151], a[160:163], v[116:119], 0
  v_mfma_f32_16x16x32_bf16 v[152:155], a[176:179], v[116:119], 0
  v_mfma_f32_16x16x32_bf16 v[148:151], a[164:167], v[120:123], v[148:151]
  v_mfma_f32_16x16x32_bf16 v[152:155], a[180:183], v[120:123], v[152:155]
  v_mfma_f32_16x16x32_bf16 v[148:151], a[168:171], v[124:127], v[148:151]
  v_mfma_f32_16x16x32_bf16 v[152:155], a[184:187], v[124:127], v[152:155]
  v_mfma_f32_16x16x32_bf16 v[148:151], a[172:175], v[128:131], v[148:151]
  v_mfma_f32_16x16x32_bf16 v[152:155], a[188:191], v[128:131], v[152:155]
  s_nop 15
  v_max3_f32 v11, v11, v148, v149
  v_max3_f32 v11, v11, v150, v151
  v_max3_f32 v11, v11, v152, v153
  v_max3_f32 v11, v11, v154, v155
  s_nop 7
  v_mfma_f32_16x16x32_bf16 v[148:151], a[160:163], v[132:135], 0
  v_mfma_f32_16x16x32_bf16 v[152:155], a[176:179], v[132:135], 0
  v_mfma_f32_16x16x32_bf16 v[148:151], a[164:167], v[136:139], v[148:151]
  v_mfma_f32_16x16x32_bf16 v[152:155], a[180:183], v[136:139], v[152:155]
  v_mfma_f32_16x16x32_bf16 v[148:151], a[168:171], v[140:143], v[148:151]
  v_mfma_f32_16x16x32_bf16 v[152:155], a[184:187], v[140:143], v[152:155]
  v_mfma_f32_16x16x32_bf16 v[148:151], a[172:175], v[144:147], v[148:151]
  v_mfma_f32_16x16x32_bf16 v[152:155], a[188:191], v[144:147], v[152:155]
  s_nop 15
  v_max3_f32 v12, v12, v148, v149
  v_max3_f32 v12, v12, v150, v151
  v_max3_f32 v12, v12, v152, v153
  v_max3_f32 v12, v12, v154, v155
  s_nop 7
  s_barrier
  s_sub_u32 s31, s31, 1
  s_cmp_lg_u32 s31, 0
  s_cbranch_scc1 concat_heads__mha_block_cached__mha_block_cached__near_ridge_kernel_slow_loop
  v_mov_b32 v1, v8
  s_nop 1
  v_permlane32_swap_b32 v1, v8
  s_nop 1
  v_max_f32 v8, v8, v1
  v_mov_b32 v1, v8
  s_nop 1
  v_permlane16_swap_b32 v1, v8
  s_nop 1
  v_max_f32 v8, v8, v1
  v_sub_f32 v172, 0, v8
  v_sub_f32 v173, 0, v8
  v_sub_f32 v174, 0, v8
  v_sub_f32 v175, 0, v8
  v_mov_b32 v8, 0
  v_mov_b32 v1, v9
  s_nop 1
  v_permlane32_swap_b32 v1, v9
  s_nop 1
  v_max_f32 v9, v9, v1
  v_mov_b32 v1, v9
  s_nop 1
  v_permlane16_swap_b32 v1, v9
  s_nop 1
  v_max_f32 v9, v9, v1
  v_sub_f32 v176, 0, v9
  v_sub_f32 v177, 0, v9
  v_sub_f32 v178, 0, v9
  v_sub_f32 v179, 0, v9
  v_mov_b32 v9, 0
  v_mov_b32 v1, v10
  s_nop 1
  v_permlane32_swap_b32 v1, v10
  s_nop 1
  v_max_f32 v10, v10, v1
  v_mov_b32 v1, v10
  s_nop 1
  v_permlane16_swap_b32 v1, v10
  s_nop 1
  v_max_f32 v10, v10, v1
  v_sub_f32 v180, 0, v10
  v_sub_f32 v181, 0, v10
  v_sub_f32 v182, 0, v10
  v_sub_f32 v183, 0, v10
  v_mov_b32 v10, 0
  v_mov_b32 v1, v11
  s_nop 1
  v_permlane32_swap_b32 v1, v11
  s_nop 1
  v_max_f32 v11, v11, v1
  v_mov_b32 v1, v11
  s_nop 1
  v_permlane16_swap_b32 v1, v11
  s_nop 1
  v_max_f32 v11, v11, v1
  v_sub_f32 v184, 0, v11
  v_sub_f32 v185, 0, v11
  v_sub_f32 v186, 0, v11
  v_sub_f32 v187, 0, v11
  v_mov_b32 v11, 0
  v_mov_b32 v1, v12
  s_nop 1
  v_permlane32_swap_b32 v1, v12
  s_nop 1
  v_max_f32 v12, v12, v1
  v_mov_b32 v1, v12
  s_nop 1
  v_permlane16_swap_b32 v1, v12
  s_nop 1
  v_max_f32 v12, v12, v1
  v_sub_f32 v188, 0, v12
  v_sub_f32 v189, 0, v12
  v_sub_f32 v190, 0, v12
  v_sub_f32 v191, 0, v12
  v_mov_b32 v12, 0
  s_mov_b32 s27, 0
  s_mov_b32 s28, 0
  s_add_u32 m0, s25, 0
  s_nop 0
  buffer_load_dwordx4 v58, s[4:7], s27 offen nt lds
  buffer_load_dwordx4 v59, s[4:7], s27 offen offset:1024 nt lds
  buffer_load_dwordx4 v60, s[4:7], s27 offen offset:2048 nt lds
  buffer_load_dwordx4 v61, s[4:7], s27 offen offset:3072 nt lds
  s_add_u32 s27, s27, 8192
  s_add_u32 m0, s25, 16384
  s_nop 0
  buffer_load_dwordx4 v62, s[8:11], s28 offen nt lds
  buffer_load_dwordx4 v63, s[8:11], s28 offen offset:1024 nt lds
  buffer_load_dwordx4 v62, s[8:11], s28 offen offset:2048 nt lds
  buffer_load_dwordx4 v63, s[8:11], s28 offen offset:3072 nt lds
  s_add_u32 s28, s28, 8192
  s_add_u32 m0, s25, 32768
  s_nop 0
  buffer_load_dwordx4 v58, s[4:7], s27 offen nt lds
  buffer_load_dwordx4 v59, s[4:7], s27 offen offset:1024 nt lds
  buffer_load_dwordx4 v60, s[4:7], s27 offen offset:2048 nt lds
  buffer_load_dwordx4 v61, s[4:7], s27 offen offset:3072 nt lds
  s_add_u32 s27, s27, 8192
  s_add_u32 m0, s25, 49152
  s_nop 0
  buffer_load_dwordx4 v62, s[8:11], s28 offen nt lds
  buffer_load_dwordx4 v63, s[8:11], s28 offen offset:1024 nt lds
  buffer_load_dwordx4 v62, s[8:11], s28 offen offset:2048 nt lds
  buffer_load_dwordx4 v63, s[8:11], s28 offen offset:3072 nt lds
  s_add_u32 s28, s28, 8192
  s_branch concat_heads__mha_block_cached__mha_block_cached__near_ridge_kernel_att
.section .rodata,"a"
.p2align 6
.amdhsa_kernel concat_heads__mha_block_cached__mha_block_cached__near_ridge_kernel
  .amdhsa_next_free_vgpr 512
  .amdhsa_next_free_sgpr 102
  .amdhsa_accum_offset 256
  .amdhsa_group_segment_fixed_size 0
  .amdhsa_kernarg_size 104
  .amdhsa_user_sgpr_count 2
  .amdhsa_user_sgpr_kernarg_segment_ptr 1
  .amdhsa_system_sgpr_workgroup_id_x 1
.end_amdhsa_kernel
```
